```python
import torch

def _softmax(x, axis=-1):
    return torch.softmax(x, dim=axis)
def _gelu(x):
    return torch.nn.functional.gelu(x, approximate="tanh")
def _silu(x):
    return torch.nn.functional.silu(x)
def _sigmoid(x):
    return torch.sigmoid(x)
def _layernorm(x, axis=-1, eps=1e-5):
    m = x.mean(dim=axis, keepdim=True)
    v = x.var(dim=axis, keepdim=True, unbiased=False)
    return (x - m) / torch.sqrt(v + eps)
def _scatter_add(tgt, idx, src, axis=0):
    return tgt.clone().index_add_(axis, idx, src)
def _segment_sum(src, seg, n):
    out = torch.zeros((n,) + src.shape[1:], dtype=src.dtype)
    return out.index_add_(0, seg, src)
def _pad(x, pw):
    flat = tuple(v for pair in reversed(pw) for v in pair)
    return torch.nn.functional.pad(x, flat)

kernel_name = 'gated_mix__ssm_conv_s5__linear_attn_block__prompt'

def setup_inputs():

    _w = (lambda a: (lambda t: t.to(torch.bfloat16) if t.is_floating_point() else t)(torch.as_tensor(a)))
    def _A_setup():
        B, S, D = 1, 2048, 1024
        P = D
        Lambda_re = -0.5 * (lambda _x: torch.exp(torch.as_tensor(_x)))((lambda *s: torch.randn(*s, dtype=torch.bfloat16) * 0.4)(P))
        Lambda_im = (lambda *s: torch.randn(*s, dtype=torch.bfloat16) * 0.8)(P) * 1.0
        B_re = (lambda *s: torch.randn(*s, dtype=torch.bfloat16) * 0.4)(P, D) * (D ** -0.5)
        B_im = (lambda *s: torch.randn(*s, dtype=torch.bfloat16) * 0.4)(P, D) * (D ** -0.5)
        C_re = (lambda *s: torch.randn(*s, dtype=torch.bfloat16) * 0.4)(D, P) * (P ** -0.5)
        C_im = (lambda *s: torch.randn(*s, dtype=torch.bfloat16) * 0.4)(D, P) * (P ** -0.5)
        log_dt = (lambda *s: torch.randn(*s, dtype=torch.bfloat16) * 0.4)(P) * 0.3 - 2.0
        Dskip = (lambda *s: torch.randn(*s, dtype=torch.bfloat16) * 0.05)(D)
        return {
            "x": _w((lambda *s: torch.randn(*s, dtype=torch.bfloat16) * 0.05)(B, S, D)),
            "Lambda_re": _w(Lambda_re),
            "Lambda_im": _w(Lambda_im),
            "B_re": _w(B_re),
            "B_im": _w(B_im),
            "C_re": _w(C_re),
            "C_im": _w(C_im),
            "log_dt": _w(log_dt),
            "Dskip": _w(Dskip),
        }
    _A_in = _A_setup()

    def _B_setup():
        B, S, D = 1, 2048, 1024
        return {
            "x": _w((lambda *s: torch.randn(*s, dtype=torch.bfloat16) * 0.05)(B, S, D)),
            "wqkv": _w((lambda *s: torch.randn(*s, dtype=torch.bfloat16) * 0.8)(D, 3 * D)),
            "wo": _w((lambda *s: torch.randn(*s, dtype=torch.bfloat16) * 0.05)(D, D)),
        }
    _B_in = _B_setup()

    return {
        "A_x": _A_in["x"],
        "A_Lambda_re": _A_in["Lambda_re"],
        "A_Lambda_im": _A_in["Lambda_im"],
        "A_B_re": _A_in["B_re"],
        "A_B_im": _A_in["B_im"],
        "A_C_re": _A_in["C_re"],
        "A_C_im": _A_in["C_im"],
        "A_log_dt": _A_in["log_dt"],
        "A_Dskip": _A_in["Dskip"],
        "B_x": _B_in["x"],
        "B_wqkv": _B_in["wqkv"],
        "B_wo": _B_in["wo"],
        "gate_w": _w((lambda *s: torch.randn(*s, dtype=torch.bfloat16) * 0.05)(1024) * 16.0),
    }

def reference(A_x, A_Lambda_re, A_Lambda_im, A_B_re, A_B_im, A_C_re, A_C_im, A_log_dt, A_Dskip, B_x, B_wqkv, B_wo, gate_w):
    def _A_ref(x, Lambda_re, Lambda_im, B_re, B_im, C_re, C_im, log_dt, Dskip):
        Bsz, L, H = x.shape
        Lam = Lambda_re + 1j * Lambda_im
        Bmat = B_re + 1j * B_im
        Cmat = C_re + 1j * C_im
        dt = torch.exp(log_dt)
        Lam_bar = torch.exp(dt * Lam)
        B_bar = ((Lam_bar - 1.0) / Lam)[:, None] * Bmat
        Bu = torch.einsum("bld,pd->blp", x + 0j, B_bar)
        h = torch.zeros_like(Bu[:, 0, :])
        hs = []
        for t in range(L):
            h = Lam_bar[None, :] * h + Bu[:, t, :]
            hs.append(h)
        hseq = torch.stack(hs, 1)
        y = 2.0 * torch.einsum("blp,dp->bld", hseq, Cmat).real + x * Dskip[None, None, :]
        return y

    def _B_ref(x, wqkv, wo):
        B, S, D = x.shape
        H = 32; Dh = D // H
        qkv = (lambda x, *d: x.permute(*d))((x @ wqkv).reshape(B, S, 3, H, Dh), 2, 0, 3, 1, 4)
        q, k, v = qkv[0], qkv[1], qkv[2]
        phi = lambda t: torch.where(t > 0, t + 1, torch.exp(t)) + 1e-6
        pq, pk = phi(q), phi(k)
        kv = torch.einsum("bhsd,bhse->bhde", pk, v)
        z = torch.einsum("bhsd->bhd", pk)
        num = torch.einsum("bhqd,bhde->bhqe", pq, kv)
        den = torch.einsum("bhqd,bhd->bhq", pq, z)[..., None] + 1e-6
        o = num / den
        return (lambda x, *d: x.permute(*d))(o, 0, 2, 1, 3).reshape(B, S, D) @ wo

    x = A_x
    g = _sigmoid((x * gate_w).sum(-1, keepdims=True))
    a = _A_ref(x, A_Lambda_re, A_Lambda_im, A_B_re, A_B_im, A_C_re, A_C_im, A_log_dt, A_Dskip)
    b = _B_ref(x, B_wqkv, B_wo)
    return g * a + (1 - g) * b
```

```asm
; @launch grid=(256,1,1) block=(256,1,1) lds=163840
.amdgcn_target "amdgcn-amd-amdhsa--gfx950"
.text
.globl gated_mix__ssm_conv_s5__linear_attn_block__prompt_kernel
.p2align 8
.type gated_mix__ssm_conv_s5__linear_attn_block__prompt_kernel,@function
gated_mix__ssm_conv_s5__linear_attn_block__prompt_kernel:
    s_cmp_ge_u32 s2, 256
    s_cbranch_scc1 Lend
    s_load_dwordx2 s[8:9], s[0:1], 0
    s_load_dwordx4 s[68:71], s[0:1], 24
    s_load_dwordx2 s[72:73], s[0:1], 80
    s_load_dwordx4 s[76:79], s[0:1], 112
    s_load_dwordx2 s[88:89], s[0:1], 96
    s_load_dwordx2 s[92:93], s[0:1], 8
    s_load_dwordx2 s[94:95], s[0:1], 16
    s_load_dwordx2 s[96:97], s[0:1], 56
    s_load_dwordx4 s[44:47], s[0:1], 40
    s_load_dwordx2 s[74:75], s[0:1], 88
    s_load_dwordx2 s[82:83], s[0:1], 104
    s_and_b32 s30, s2, 7
    s_lshr_b32 s31, s2, 3
    s_and_b32 s32, s30, 1
    s_lshl_b32 s32, s32, 2
    s_and_b32 s33, s31, 3
    s_add_u32 s32, s32, s33
    s_lshr_b32 s33, s30, 1
    s_lshl_b32 s33, s33, 2
    s_bfe_u32 s34, s31, 0x20002
    s_add_u32 s33, s33, s34
    v_lshrrev_b32 v1, 6, v0
    v_and_b32 v0, 63, v0
    v_readfirstlane_b32 s35, v1
    s_mov_b32 s10, 4194304
    s_mov_b32 s11, 0x20000
    s_mov_b32 s66, 24117248
    s_mov_b32 s67, 0x20000
    s_lshr_b32 s50, s35, 1
    s_and_b32 s51, s35, 1
    s_getpc_b64 s[84:85]
Lpc:
    s_and_b32 s85, s85, 0xffff
    s_mov_b32 s100, s84
    s_mov_b32 s101, s85
    s_mov_b32 s86, Lcode_end-Lpc
    s_mov_b32 s87, 0x20000
    s_lshl_b32 s36, s31, 2
    s_add_u32 s36, s36, s35
    s_lshl_b32 s36, s36, 13
    v_lshlrev_b32 v2, 7, v0
    s_cmp_lt_u32 s36, s86
    s_cbranch_scc0 Lnopfc
    buffer_load_dword v21, v2, s[84:87], s36 offen
Lnopfc:
    s_cmp_ge_u32 s31, 16
    s_cbranch_scc1 L_B
    v_lshrrev_b32 v4, 5, v0
    v_lshlrev_b32 v4, 5, v4
    v_bfe_u32 v5, v0, 3, 2
    v_add_u32 v4, v4, v5
    v_lshlrev_b32 v4, 11, v4
    v_and_b32 v5, 7, v0
    v_lshrrev_b32 v12, 4, v0
    v_xor_b32 v5, v5, v12
    v_lshlrev_b32 v5, 4, v5
    v_add_u32 v2, v4, v5
    v_xor_b32 v3, 64, v2
    s_lshl_b32 s36, s32, 8
    s_lshl_b32 s37, s50, 7
    s_add_u32 s36, s36, s37
    s_lshl_b32 s37, s51, 4
    s_add_u32 s36, s36, s37
    s_lshl_b32 s36, s36, 11
    s_add_u32 s16, s36, 0
    s_add_u32 s17, s36, 130048
    s_add_u32 s18, s36, 6144
    s_add_u32 s19, s36, 136192
    s_add_u32 s20, s36, 16384
    s_add_u32 s21, s36, 146432
    s_add_u32 s22, s36, 22528
    s_add_u32 s23, s36, 152576
    v_lshrrev_b32 v4, 3, v0
    v_lshlrev_b32 v4, 11, v4
    v_and_b32 v5, 7, v0
    v_xor_b32 v5, v5, v12
    v_lshlrev_b32 v5, 4, v5
    v_add_u32 v4, v4, v5
    v_xor_b32 v5, 64, v4
    s_lshl_b32 s36, s33, 6
    s_lshl_b32 s37, s51, 5
    s_add_u32 s36, s36, s37
    s_lshl_b32 s36, s36, 11
    s_add_u32 s24, s36, 0
    s_add_u32 s25, s36, 15360
    s_add_u32 s26, s36, 30720
    s_add_u32 s27, s36, 46080
    s_lshl_b32 s48, s35, 13
    s_lshl_b32 s49, s35, 12
    s_add_u32 s49, s49, 98304
    s_waitcnt lgkmcnt(0)
    s_and_b32 s9, s9, 0xffff
    s_mov_b32 s60, s68
    s_mov_b32 s61, s69
    s_mov_b32 s62, s70
    s_mov_b32 s63, s71
    s_mov_b32 s64, s78
    s_and_b32 s65, s79, 0xffff
    s_mov_b32 s36, 12779520
    s_load_dword s91, s[78:79], s36
    s_cmp_lt_u32 s35, 2
    s_cselect_b32 s12, s68, s70
    s_cselect_b32 s13, s69, s71
    s_and_b32 s13, s13, 0xffff
    s_mov_b32 s14, 2097152
    s_mov_b32 s15, 0x20000
    s_mov_b32 s80, s8
    s_mov_b32 s81, s9
    s_and_b32 s76, s33, 1
    s_mul_i32 s76, s76, 1
    s_mov_b32 s99, s76
    s_lshl_b32 s76, s76, 7
    s_add_u32 s8, s80, s76
    s_addc_u32 s9, s81, 0
    s_mov_b32 s68, s12
    s_mov_b32 s69, s13
    s_mov_b32 s77, s76
    s_add_u32 s12, s68, s77
    s_addc_u32 s13, s69, 0
    s_lshr_b32 s36, s2, 3
    s_lshl_b32 s36, s36, 3
    s_and_b32 s37, s2, 7
    s_add_u32 s36, s36, s37
    s_lshl_b32 s34, s36, 2
    s_add_u32 s34, s34, s35
    v_lshlrev_b32 v17, 7, v0
    s_add_u32 m0, s49, 0
    s_nop 0
    buffer_load_dwordx4 v4, s[12:15], s24 offen offset:0 lds
    buffer_load_dwordx4 v5, s[12:15], s25 offen offset:1024 lds
    buffer_load_dwordx4 v4, s[12:15], s26 offen offset:2048 lds
    buffer_load_dwordx4 v5, s[12:15], s27 offen offset:3072 lds
    s_add_u32 m0, s48, 0
    s_nop 0
    buffer_load_dwordx4 v2, s[8:11], s16 offen offset:0 lds
    buffer_load_dwordx4 v3, s[8:11], s17 offen offset:1024 lds
    buffer_load_dwordx4 v2, s[8:11], s18 offen offset:2048 lds
    buffer_load_dwordx4 v3, s[8:11], s19 offen offset:3072 lds
    s_add_u32 m0, s48, 4096
    s_nop 0
    buffer_load_dwordx4 v2, s[8:11], s20 offen offset:0 lds
    buffer_load_dwordx4 v3, s[8:11], s21 offen offset:1024 lds
    buffer_load_dwordx4 v2, s[8:11], s22 offen offset:2048 lds
    buffer_load_dwordx4 v3, s[8:11], s23 offen offset:3072 lds
    s_mov_b32 s84, s88
    s_and_b32 s85, s89, 0xffff
    s_mov_b32 s86, 2048
    s_mov_b32 s87, 0x20000
    v_lshlrev_b32 v6, 5, v0
    s_lshl_b32 s36, s32, 8
    s_lshl_b32 s37, s33, 4
    s_add_u32 s36, s36, s37
    s_lshl_b32 s37, s35, 2
    s_add_u32 s36, s36, s37
    s_mov_b32 s90, s36
    s_lshl_b32 s36, s36, 11
    s_mov_b32 s40, s80
    s_mov_b32 s41, s81
    s_mov_b32 s42, 4194304
    s_mov_b32 s43, 0x20000
    buffer_load_dwordx4 v[40:43], v6, s[40:43], s36 offen
    buffer_load_dwordx4 v[44:47], v6, s[40:43], s36 offen offset:16
    s_add_u32 s36, s36, 2048
    buffer_load_dwordx4 v[48:51], v6, s[40:43], s36 offen
    buffer_load_dwordx4 v[52:55], v6, s[40:43], s36 offen offset:16
    s_add_u32 s36, s36, 2048
    buffer_load_dwordx4 v[56:59], v6, s[40:43], s36 offen
    buffer_load_dwordx4 v[60:63], v6, s[40:43], s36 offen offset:16
    s_add_u32 s36, s36, 2048
    buffer_load_dwordx4 v[64:67], v6, s[40:43], s36 offen
    buffer_load_dwordx4 v[68:71], v6, s[40:43], s36 offen offset:16
    buffer_load_dwordx4 v[72:75], v6, s[84:87], 0 offen
    buffer_load_dwordx4 v[76:79], v6, s[84:87], 0 offen offset:16
    v_and_b32 v7, 15, v0
    s_lshl_b32 s36, s33, 6
    s_lshl_b32 s37, s51, 5
    s_add_u32 s36, s36, s37
    v_add_u32 v7, s36, v7
    v_lshlrev_b32 v7, 1, v7
    s_mov_b32 s84, s92
    s_and_b32 s85, s93, 0xffff
    buffer_load_ushort v80, v7, s[84:87], 0 offen
    buffer_load_ushort v81, v7, s[84:87], 0 offen offset:32
    s_mov_b32 s84, s94
    s_and_b32 s85, s95, 0xffff
    buffer_load_ushort v82, v7, s[84:87], 0 offen
    buffer_load_ushort v83, v7, s[84:87], 0 offen offset:32
    s_mov_b32 s84, s96
    s_and_b32 s85, s97, 0xffff
    buffer_load_ushort v84, v7, s[84:87], 0 offen
    buffer_load_ushort v85, v7, s[84:87], 0 offen offset:32
    s_add_u32 s77, s77, 128
    s_and_b32 s77, s77, 2047
    s_add_u32 s12, s68, s77
    s_addc_u32 s13, s69, 0
    s_add_u32 s76, s76, 128
    s_and_b32 s76, s76, 2047
    s_add_u32 s8, s80, s76
    s_addc_u32 s9, s81, 0
    s_add_u32 m0, s49, 16384
    s_nop 0
    buffer_load_dwordx4 v4, s[12:15], s24 offen offset:0 lds
    buffer_load_dwordx4 v5, s[12:15], s25 offen offset:1024 lds
    buffer_load_dwordx4 v4, s[12:15], s26 offen offset:2048 lds
    buffer_load_dwordx4 v5, s[12:15], s27 offen offset:3072 lds
    s_add_u32 m0, s48, 32768
    s_nop 0
    buffer_load_dwordx4 v2, s[8:11], s16 offen offset:0 lds
    buffer_load_dwordx4 v3, s[8:11], s17 offen offset:1024 lds
    buffer_load_dwordx4 v2, s[8:11], s18 offen offset:2048 lds
    buffer_load_dwordx4 v3, s[8:11], s19 offen offset:3072 lds
    s_add_u32 m0, s48, 36864
    s_nop 0
    buffer_load_dwordx4 v2, s[8:11], s20 offen offset:0 lds
    buffer_load_dwordx4 v3, s[8:11], s21 offen offset:1024 lds
    buffer_load_dwordx4 v2, s[8:11], s22 offen offset:2048 lds
    buffer_load_dwordx4 v3, s[8:11], s23 offen offset:3072 lds
    s_add_u32 s77, s77, 128
    s_and_b32 s77, s77, 2047
    s_add_u32 s12, s68, s77
    s_addc_u32 s13, s69, 0
    s_add_u32 s76, s76, 128
    s_and_b32 s76, s76, 2047
    s_add_u32 s8, s80, s76
    s_addc_u32 s9, s81, 0
    s_add_u32 m0, s49, 32768
    s_nop 0
    buffer_load_dwordx4 v4, s[12:15], s24 offen offset:0 lds
    buffer_load_dwordx4 v5, s[12:15], s25 offen offset:1024 lds
    buffer_load_dwordx4 v4, s[12:15], s26 offen offset:2048 lds
    buffer_load_dwordx4 v5, s[12:15], s27 offen offset:3072 lds
    s_add_u32 m0, s48, 65536
    s_nop 0
    buffer_load_dwordx4 v2, s[8:11], s16 offen offset:0 lds
    buffer_load_dwordx4 v3, s[8:11], s17 offen offset:1024 lds
    buffer_load_dwordx4 v2, s[8:11], s18 offen offset:2048 lds
    buffer_load_dwordx4 v3, s[8:11], s19 offen offset:3072 lds
    s_add_u32 m0, s48, 69632
    s_nop 0
    buffer_load_dwordx4 v2, s[8:11], s20 offen offset:0 lds
    buffer_load_dwordx4 v3, s[8:11], s21 offen offset:1024 lds
    buffer_load_dwordx4 v2, s[8:11], s22 offen offset:2048 lds
    buffer_load_dwordx4 v3, s[8:11], s23 offen offset:3072 lds
    s_add_u32 s77, s77, 128
    s_and_b32 s77, s77, 2047
    s_add_u32 s12, s68, s77
    s_addc_u32 s13, s69, 0
    s_add_u32 s76, s76, 128
    s_and_b32 s76, s76, 2047
    s_add_u32 s8, s80, s76
    s_addc_u32 s9, s81, 0
    s_lshl_b32 s38, s2, 2
    s_add_u32 s38, s38, s35
    s_lshl_b32 s38, s38, 13
    s_mov_b32 s40, s72
    s_and_b32 s41, s73, 0xffff
    s_mov_b32 s42, 6291456
    s_mov_b32 s43, 0x20000
    v_lshlrev_b32 v17, 7, v0
    buffer_load_dword v18, v17, s[40:43], s38 offen
    v_and_b32 v14, 15, v0
    v_lshlrev_b32 v14, 7, v14
    v_lshrrev_b32 v15, 4, v0
    v_bfe_u32 v16, v0, 1, 3
    v_xor_b32 v15, v15, v16
    v_lshlrev_b32 v15, 4, v15
    v_add_u32 v14, v14, v15
    s_lshl_b32 s52, s50, 14
    v_add_u32 v8, s52, v14
    v_xor_b32 v9, 64, v8
    v_add_u32 v10, 0x10000, v8
    v_add_u32 v11, 0x10000, v9
    s_lshl_b32 s53, s51, 12
    s_add_u32 s53, s53, 98304
    v_add_u32 v12, s53, v14
    v_xor_b32 v13, 64, v12
    s_mov_b32 s54, 0x3fb8aa3b
    s_and_b32 s75, s75, 0xffff
    s_waitcnt vmcnt(41)
    s_barrier
    ds_read_b128 a[0:3], v8 offset:0
    ds_read_b128 a[32:35], v12 offset:0
    ds_read_b128 a[36:39], v12 offset:2048
    ds_read_b128 a[40:43], v12 offset:8192
    ds_read_b128 a[44:47], v12 offset:10240
    ds_read_b128 a[4:7], v8 offset:2048
    ds_read_b128 a[8:11], v8 offset:4096
    ds_read_b128 a[12:15], v8 offset:6144
    ds_read_b128 a[16:19], v8 offset:8192
    ds_read_b128 a[20:23], v8 offset:10240
    ds_read_b128 a[24:27], v8 offset:12288
    ds_read_b128 a[28:31], v8 offset:14336
    s_waitcnt lgkmcnt(0)
    v_mfma_f32_16x16x32_bf16 v[128:131], a[0:3], a[32:35], 0
    ds_read_b128 a[48:51], v9 offset:0
    v_mfma_f32_16x16x32_bf16 v[132:135], a[0:3], a[36:39], 0
    ds_read_b128 a[80:83], v13 offset:0
    v_mfma_f32_16x16x32_bf16 v[136:139], a[0:3], a[40:43], 0
    v_mfma_f32_16x16x32_bf16 v[140:143], a[0:3], a[44:47], 0
    ds_read_b128 a[84:87], v13 offset:2048
    v_mfma_f32_16x16x32_bf16 v[144:147], a[4:7], a[32:35], 0
    ds_read_b128 a[88:91], v13 offset:8192
    v_mfma_f32_16x16x32_bf16 v[148:151], a[4:7], a[36:39], 0
    v_mfma_f32_16x16x32_bf16 v[152:155], a[4:7], a[40:43], 0
    ds_read_b128 a[92:95], v13 offset:10240
    v_mfma_f32_16x16x32_bf16 v[156:159], a[4:7], a[44:47], 0
    ds_read_b128 a[52:55], v9 offset:2048
    v_mfma_f32_16x16x32_bf16 v[160:163], a[8:11], a[32:35], 0
    v_mfma_f32_16x16x32_bf16 v[164:167], a[8:11], a[36:39], 0
    ds_read_b128 a[56:59], v9 offset:4096
    v_mfma_f32_16x16x32_bf16 v[168:171], a[8:11], a[40:43], 0
    v_mfma_f32_16x16x32_bf16 v[172:175], a[8:11], a[44:47], 0
    ds_read_b128 a[60:63], v9 offset:6144
    v_mfma_f32_16x16x32_bf16 v[176:179], a[12:15], a[32:35], 0
    ds_read_b128 a[64:67], v9 offset:8192
    v_mfma_f32_16x16x32_bf16 v[180:183], a[12:15], a[36:39], 0
    v_mfma_f32_16x16x32_bf16 v[184:187], a[12:15], a[40:43], 0
    ds_read_b128 a[68:71], v9 offset:10240
    v_mfma_f32_16x16x32_bf16 v[188:191], a[12:15], a[44:47], 0
    ds_read_b128 a[72:75], v9 offset:12288
    v_mfma_f32_16x16x32_bf16 v[192:195], a[16:19], a[32:35], 0
    v_mfma_f32_16x16x32_bf16 v[196:199], a[16:19], a[36:39], 0
    ds_read_b128 a[76:79], v9 offset:14336
    v_mfma_f32_16x16x32_bf16 v[200:203], a[16:19], a[40:43], 0
    v_mfma_f32_16x16x32_bf16 v[204:207], a[16:19], a[44:47], 0
    v_mfma_f32_16x16x32_bf16 v[208:211], a[20:23], a[32:35], 0
    v_mfma_f32_16x16x32_bf16 v[212:215], a[20:23], a[36:39], 0
    v_mfma_f32_16x16x32_bf16 v[216:219], a[20:23], a[40:43], 0
    v_mfma_f32_16x16x32_bf16 v[220:223], a[20:23], a[44:47], 0
    v_mfma_f32_16x16x32_bf16 v[224:227], a[24:27], a[32:35], 0
    v_mfma_f32_16x16x32_bf16 v[228:231], a[24:27], a[36:39], 0
    v_mfma_f32_16x16x32_bf16 v[232:235], a[24:27], a[40:43], 0
    v_mfma_f32_16x16x32_bf16 v[236:239], a[24:27], a[44:47], 0
    v_mfma_f32_16x16x32_bf16 v[240:243], a[28:31], a[32:35], 0
    v_mfma_f32_16x16x32_bf16 v[244:247], a[28:31], a[36:39], 0
    v_mfma_f32_16x16x32_bf16 v[248:251], a[28:31], a[40:43], 0
    v_mfma_f32_16x16x32_bf16 v[252:255], a[28:31], a[44:47], 0
    s_waitcnt lgkmcnt(10)
    v_mfma_f32_16x16x32_bf16 v[128:131], a[48:51], a[80:83], v[128:131]
    s_waitcnt lgkmcnt(9)
    v_mfma_f32_16x16x32_bf16 v[132:135], a[48:51], a[84:87], v[132:135]
    s_waitcnt lgkmcnt(8)
    v_mfma_f32_16x16x32_bf16 v[136:139], a[48:51], a[88:91], v[136:139]
    s_waitcnt lgkmcnt(7)
    v_mfma_f32_16x16x32_bf16 v[140:143], a[48:51], a[92:95], v[140:143]
    s_waitcnt lgkmcnt(6)
    v_mfma_f32_16x16x32_bf16 v[144:147], a[52:55], a[80:83], v[144:147]
    v_mfma_f32_16x16x32_bf16 v[148:151], a[52:55], a[84:87], v[148:151]
    s_waitcnt lgkmcnt(0)
    s_waitcnt vmcnt(13)
    s_barrier
    v_mfma_f32_16x16x32_bf16 v[152:155], a[52:55], a[88:91], v[152:155]
    ds_read_b128 a[0:3], v8 offset:32768
    v_mfma_f32_16x16x32_bf16 v[156:159], a[52:55], a[92:95], v[156:159]
    ds_read_b128 a[32:35], v12 offset:16384
    s_add_u32 m0, s49, 0
    v_mfma_f32_16x16x32_bf16 v[160:163], a[56:59], a[80:83], v[160:163]
    ds_read_b128 a[36:39], v12 offset:18432
    buffer_load_dwordx4 v4, s[12:15], s24 offen offset:0 lds
    v_mfma_f32_16x16x32_bf16 v[164:167], a[56:59], a[84:87], v[164:167]
    ds_read_b128 a[40:43], v12 offset:24576
    v_mfma_f32_16x16x32_bf16 v[168:171], a[56:59], a[88:91], v[168:171]
    buffer_load_dwordx4 v5, s[12:15], s25 offen offset:1024 lds
    v_mfma_f32_16x16x32_bf16 v[172:175], a[56:59], a[92:95], v[172:175]
    ds_read_b128 a[44:47], v12 offset:26624
    v_mfma_f32_16x16x32_bf16 v[176:179], a[60:63], a[80:83], v[176:179]
    ds_read_b128 a[4:7], v8 offset:34816
    buffer_load_dwordx4 v4, s[12:15], s26 offen offset:2048 lds
    v_mfma_f32_16x16x32_bf16 v[180:183], a[60:63], a[84:87], v[180:183]
    ds_read_b128 a[8:11], v8 offset:36864
    buffer_load_dwordx4 v5, s[12:15], s27 offen offset:3072 lds
    v_mfma_f32_16x16x32_bf16 v[184:187], a[60:63], a[88:91], v[184:187]
    ds_read_b128 a[12:15], v8 offset:38912
    v_mfma_f32_16x16x32_bf16 v[188:191], a[60:63], a[92:95], v[188:191]
    s_add_u32 s77, s77, 128
    v_mfma_f32_16x16x32_bf16 v[192:195], a[64:67], a[80:83], v[192:195]
    ds_read_b128 a[16:19], v8 offset:40960
    v_mfma_f32_16x16x32_bf16 v[196:199], a[64:67], a[84:87], v[196:199]
    ds_read_b128 a[20:23], v8 offset:43008
    s_and_b32 s77, s77, 2047
    v_mfma_f32_16x16x32_bf16 v[200:203], a[64:67], a[88:91], v[200:203]
    ds_read_b128 a[24:27], v8 offset:45056
    v_mfma_f32_16x16x32_bf16 v[204:207], a[64:67], a[92:95], v[204:207]
    ds_read_b128 a[28:31], v8 offset:47104
    s_add_u32 s12, s68, s77
    v_mfma_f32_16x16x32_bf16 v[208:211], a[68:71], a[80:83], v[208:211]
    s_addc_u32 s13, s69, 0
    v_mfma_f32_16x16x32_bf16 v[212:215], a[68:71], a[84:87], v[212:215]
    v_mfma_f32_16x16x32_bf16 v[216:219], a[68:71], a[88:91], v[216:219]
    s_add_u32 m0, s48, 0
    v_mfma_f32_16x16x32_bf16 v[220:223], a[68:71], a[92:95], v[220:223]
    v_mfma_f32_16x16x32_bf16 v[224:227], a[72:75], a[80:83], v[224:227]
    buffer_load_dwordx4 v2, s[8:11], s16 offen offset:0 lds
    v_mfma_f32_16x16x32_bf16 v[228:231], a[72:75], a[84:87], v[228:231]
    buffer_load_dwordx4 v3, s[8:11], s17 offen offset:1024 lds
    v_mfma_f32_16x16x32_bf16 v[232:235], a[72:75], a[88:91], v[232:235]
    v_mfma_f32_16x16x32_bf16 v[236:239], a[72:75], a[92:95], v[236:239]
    buffer_load_dwordx4 v2, s[8:11], s18 offen offset:2048 lds
    v_mfma_f32_16x16x32_bf16 v[240:243], a[76:79], a[80:83], v[240:243]
    v_mfma_f32_16x16x32_bf16 v[244:247], a[76:79], a[84:87], v[244:247]
    buffer_load_dwordx4 v3, s[8:11], s19 offen offset:3072 lds
    v_mfma_f32_16x16x32_bf16 v[248:251], a[76:79], a[88:91], v[248:251]
    v_mfma_f32_16x16x32_bf16 v[252:255], a[76:79], a[92:95], v[252:255]
    s_waitcnt lgkmcnt(10)
    v_mfma_f32_16x16x32_bf16 v[128:131], a[0:3], a[32:35], v[128:131]
    ds_read_b128 a[48:51], v9 offset:32768
    s_waitcnt lgkmcnt(10)
    v_mfma_f32_16x16x32_bf16 v[132:135], a[0:3], a[36:39], v[132:135]
    ds_read_b128 a[80:83], v13 offset:16384
    s_add_u32 m0, s48, 4096
    v_lshlrev_b32 v88, 16, v72
    s_waitcnt lgkmcnt(10)
    v_mfma_f32_16x16x32_bf16 v[136:139], a[0:3], a[40:43], v[136:139]
    v_and_b32 v89, 0xffff0000, v72
    s_waitcnt lgkmcnt(9)
    v_mfma_f32_16x16x32_bf16 v[140:143], a[0:3], a[44:47], v[140:143]
    ds_read_b128 a[84:87], v13 offset:18432
    s_waitcnt lgkmcnt(9)
    v_mfma_f32_16x16x32_bf16 v[144:147], a[4:7], a[32:35], v[144:147]
    ds_read_b128 a[88:91], v13 offset:24576
    buffer_load_dwordx4 v2, s[8:11], s20 offen offset:0 lds
    v_lshlrev_b32 v90, 16, v73
    v_mfma_f32_16x16x32_bf16 v[148:151], a[4:7], a[36:39], v[148:151]
    v_and_b32 v91, 0xffff0000, v73
    v_mfma_f32_16x16x32_bf16 v[152:155], a[4:7], a[40:43], v[152:155]
    ds_read_b128 a[92:95], v13 offset:26624
    v_mfma_f32_16x16x32_bf16 v[156:159], a[4:7], a[44:47], v[156:159]
    ds_read_b128 a[52:55], v9 offset:34816
    buffer_load_dwordx4 v3, s[8:11], s21 offen offset:1024 lds
    v_lshlrev_b32 v92, 16, v74
    s_waitcnt lgkmcnt(11)
    v_mfma_f32_16x16x32_bf16 v[160:163], a[8:11], a[32:35], v[160:163]
    v_and_b32 v93, 0xffff0000, v74
    v_mfma_f32_16x16x32_bf16 v[164:167], a[8:11], a[36:39], v[164:167]
    ds_read_b128 a[56:59], v9 offset:36864
    v_mfma_f32_16x16x32_bf16 v[168:171], a[8:11], a[40:43], v[168:171]
    v_lshlrev_b32 v94, 16, v75
    v_mfma_f32_16x16x32_bf16 v[172:175], a[8:11], a[44:47], v[172:175]
    ds_read_b128 a[60:63], v9 offset:38912
    buffer_load_dwordx4 v2, s[8:11], s22 offen offset:2048 lds
    s_waitcnt lgkmcnt(12)
    v_mfma_f32_16x16x32_bf16 v[176:179], a[12:15], a[32:35], v[176:179]
    ds_read_b128 a[64:67], v9 offset:40960
    v_and_b32 v95, 0xffff0000, v75
    v_mfma_f32_16x16x32_bf16 v[180:183], a[12:15], a[36:39], v[180:183]
    v_lshlrev_b32 v96, 16, v76
    v_mfma_f32_16x16x32_bf16 v[184:187], a[12:15], a[40:43], v[184:187]
    ds_read_b128 a[68:71], v9 offset:43008
    buffer_load_dwordx4 v3, s[8:11], s23 offen offset:3072 lds
    v_mfma_f32_16x16x32_bf16 v[188:191], a[12:15], a[44:47], v[188:191]
    ds_read_b128 a[72:75], v9 offset:45056
    v_and_b32 v97, 0xffff0000, v76
    s_waitcnt lgkmcnt(14)
    v_mfma_f32_16x16x32_bf16 v[192:195], a[16:19], a[32:35], v[192:195]
    v_lshlrev_b32 v98, 16, v77
    v_mfma_f32_16x16x32_bf16 v[196:199], a[16:19], a[36:39], v[196:199]
    ds_read_b128 a[76:79], v9 offset:47104
    s_add_u32 s76, s76, 128
    v_mfma_f32_16x16x32_bf16 v[200:203], a[16:19], a[40:43], v[200:203]
    v_and_b32 v99, 0xffff0000, v77
    v_mfma_f32_16x16x32_bf16 v[204:207], a[16:19], a[44:47], v[204:207]
    v_lshlrev_b32 v100, 16, v78
    s_waitcnt lgkmcnt(14)
    v_mfma_f32_16x16x32_bf16 v[208:211], a[20:23], a[32:35], v[208:211]
    v_mfma_f32_16x16x32_bf16 v[212:215], a[20:23], a[36:39], v[212:215]
    s_and_b32 s76, s76, 2047
    v_and_b32 v101, 0xffff0000, v78
    v_mfma_f32_16x16x32_bf16 v[216:219], a[20:23], a[40:43], v[216:219]
    v_mfma_f32_16x16x32_bf16 v[220:223], a[20:23], a[44:47], v[220:223]
    v_lshlrev_b32 v102, 16, v79
    s_waitcnt lgkmcnt(13)
    v_mfma_f32_16x16x32_bf16 v[224:227], a[24:27], a[32:35], v[224:227]
    s_add_u32 s8, s80, s76
    v_and_b32 v103, 0xffff0000, v79
    v_mfma_f32_16x16x32_bf16 v[228:231], a[24:27], a[36:39], v[228:231]
    v_mfma_f32_16x16x32_bf16 v[232:235], a[24:27], a[40:43], v[232:235]
    v_lshlrev_b32 v108, 16, v40
    v_mfma_f32_16x16x32_bf16 v[236:239], a[24:27], a[44:47], v[236:239]
    s_addc_u32 s9, s81, 0
    v_and_b32 v109, 0xffff0000, v40
    s_waitcnt lgkmcnt(12)
    v_mfma_f32_16x16x32_bf16 v[240:243], a[28:31], a[32:35], v[240:243]
    v_mfma_f32_16x16x32_bf16 v[244:247], a[28:31], a[36:39], v[244:247]
    v_lshlrev_b32 v111, 16, v48
    v_mfma_f32_16x16x32_bf16 v[248:251], a[28:31], a[40:43], v[248:251]
    v_mfma_f32_16x16x32_bf16 v[252:255], a[28:31], a[44:47], v[252:255]
    s_waitcnt lgkmcnt(10)
    v_mfma_f32_16x16x32_bf16 v[128:131], a[48:51], a[80:83], v[128:131]
    v_and_b32 v112, 0xffff0000, v48
    s_waitcnt lgkmcnt(9)
    v_mfma_f32_16x16x32_bf16 v[132:135], a[48:51], a[84:87], v[132:135]
    s_waitcnt lgkmcnt(8)
    v_mfma_f32_16x16x32_bf16 v[136:139], a[48:51], a[88:91], v[136:139]
    v_lshlrev_b32 v114, 16, v56
    s_waitcnt lgkmcnt(7)
    v_mfma_f32_16x16x32_bf16 v[140:143], a[48:51], a[92:95], v[140:143]
    s_waitcnt lgkmcnt(6)
    v_mfma_f32_16x16x32_bf16 v[144:147], a[52:55], a[80:83], v[144:147]
    v_and_b32 v115, 0xffff0000, v56
    v_mfma_f32_16x16x32_bf16 v[148:151], a[52:55], a[84:87], v[148:151]
    s_waitcnt lgkmcnt(0)
    s_waitcnt vmcnt(13)
    s_barrier
    v_mfma_f32_16x16x32_bf16 v[152:155], a[52:55], a[88:91], v[152:155]
    ds_read_b128 a[0:3], v10 offset:0
    v_mfma_f32_16x16x32_bf16 v[156:159], a[52:55], a[92:95], v[156:159]
    ds_read_b128 a[32:35], v12 offset:32768
    s_add_u32 m0, s49, 16384
    v_lshlrev_b32 v117, 16, v64
    v_mfma_f32_16x16x32_bf16 v[160:163], a[56:59], a[80:83], v[160:163]
    ds_read_b128 a[36:39], v12 offset:34816
    buffer_load_dwordx4 v4, s[12:15], s24 offen offset:0 lds
    v_and_b32 v118, 0xffff0000, v64
    v_mfma_f32_16x16x32_bf16 v[164:167], a[56:59], a[84:87], v[164:167]
    ds_read_b128 a[40:43], v12 offset:40960
    v_mfma_f32_16x16x32_bf16 v[168:171], a[56:59], a[88:91], v[168:171]
    buffer_load_dwordx4 v5, s[12:15], s25 offen offset:1024 lds
    v_mul_f32 v108, v108, v88
    v_mfma_f32_16x16x32_bf16 v[172:175], a[56:59], a[92:95], v[172:175]
    ds_read_b128 a[44:47], v12 offset:43008
    v_mul_f32 v109, v109, v89
    v_mfma_f32_16x16x32_bf16 v[176:179], a[60:63], a[80:83], v[176:179]
    ds_read_b128 a[4:7], v10 offset:2048
    buffer_load_dwordx4 v4, s[12:15], s26 offen offset:2048 lds
    v_mfma_f32_16x16x32_bf16 v[180:183], a[60:63], a[84:87], v[180:183]
    ds_read_b128 a[8:11], v10 offset:4096
    buffer_load_dwordx4 v5, s[12:15], s27 offen offset:3072 lds
    v_mul_f32 v111, v111, v88
    v_mfma_f32_16x16x32_bf16 v[184:187], a[60:63], a[88:91], v[184:187]
    ds_read_b128 a[12:15], v10 offset:6144
    v_mul_f32 v112, v112, v89
    v_mfma_f32_16x16x32_bf16 v[188:191], a[60:63], a[92:95], v[188:191]
    s_add_u32 s77, s77, 128
    v_mfma_f32_16x16x32_bf16 v[192:195], a[64:67], a[80:83], v[192:195]
    ds_read_b128 a[16:19], v10 offset:8192
    v_mul_f32 v114, v114, v88
    v_mfma_f32_16x16x32_bf16 v[196:199], a[64:67], a[84:87], v[196:199]
    ds_read_b128 a[20:23], v10 offset:10240
    s_and_b32 s77, s77, 2047
    v_mul_f32 v115, v115, v89
    v_mfma_f32_16x16x32_bf16 v[200:203], a[64:67], a[88:91], v[200:203]
    ds_read_b128 a[24:27], v10 offset:12288
    v_mfma_f32_16x16x32_bf16 v[204:207], a[64:67], a[92:95], v[204:207]
    ds_read_b128 a[28:31], v10 offset:14336
    s_add_u32 s12, s68, s77
    v_mul_f32 v117, v117, v88
    v_mfma_f32_16x16x32_bf16 v[208:211], a[68:71], a[80:83], v[208:211]
    s_addc_u32 s13, s69, 0
    v_mul_f32 v118, v118, v89
    v_mfma_f32_16x16x32_bf16 v[212:215], a[68:71], a[84:87], v[212:215]
    v_mfma_f32_16x16x32_bf16 v[216:219], a[68:71], a[88:91], v[216:219]
    s_add_u32 m0, s48, 32768
    v_cvt_pk_bf16_f32 v110, v108, v109
    v_mfma_f32_16x16x32_bf16 v[220:223], a[68:71], a[92:95], v[220:223]
    v_cvt_pk_bf16_f32 v113, v111, v112
    v_mfma_f32_16x16x32_bf16 v[224:227], a[72:75], a[80:83], v[224:227]
    buffer_load_dwordx4 v2, s[8:11], s16 offen offset:0 lds
    v_mfma_f32_16x16x32_bf16 v[228:231], a[72:75], a[84:87], v[228:231]
    buffer_load_dwordx4 v3, s[8:11], s17 offen offset:1024 lds
    v_cvt_pk_bf16_f32 v116, v114, v115
    v_mfma_f32_16x16x32_bf16 v[232:235], a[72:75], a[88:91], v[232:235]
    v_cvt_pk_bf16_f32 v119, v117, v118
    v_mfma_f32_16x16x32_bf16 v[236:239], a[72:75], a[92:95], v[236:239]
    buffer_load_dwordx4 v2, s[8:11], s18 offen offset:2048 lds
    v_mfma_f32_16x16x32_bf16 v[240:243], a[76:79], a[80:83], v[240:243]
    v_lshlrev_b32 v108, 16, v110
    v_mfma_f32_16x16x32_bf16 v[244:247], a[76:79], a[84:87], v[244:247]
    buffer_load_dwordx4 v3, s[8:11], s19 offen offset:3072 lds
    v_and_b32 v109, 0xffff0000, v110
    v_mfma_f32_16x16x32_bf16 v[248:251], a[76:79], a[88:91], v[248:251]
    v_mfma_f32_16x16x32_bf16 v[252:255], a[76:79], a[92:95], v[252:255]
    s_waitcnt lgkmcnt(10)
    v_mfma_f32_16x16x32_bf16 v[128:131], a[0:3], a[32:35], v[128:131]
    ds_read_b128 a[48:51], v11 offset:0
    s_waitcnt lgkmcnt(10)
    v_mfma_f32_16x16x32_bf16 v[132:135], a[0:3], a[36:39], v[132:135]
    ds_read_b128 a[80:83], v13 offset:32768
    s_add_u32 m0, s48, 36864
    v_lshlrev_b32 v111, 16, v113
    s_waitcnt lgkmcnt(10)
    v_mfma_f32_16x16x32_bf16 v[136:139], a[0:3], a[40:43], v[136:139]
    v_and_b32 v112, 0xffff0000, v113
    s_waitcnt lgkmcnt(9)
    v_mfma_f32_16x16x32_bf16 v[140:143], a[0:3], a[44:47], v[140:143]
    ds_read_b128 a[84:87], v13 offset:34816
    s_waitcnt lgkmcnt(9)
    v_mfma_f32_16x16x32_bf16 v[144:147], a[4:7], a[32:35], v[144:147]
    ds_read_b128 a[88:91], v13 offset:40960
    buffer_load_dwordx4 v2, s[8:11], s20 offen offset:0 lds
    v_lshlrev_b32 v114, 16, v116
    v_mfma_f32_16x16x32_bf16 v[148:151], a[4:7], a[36:39], v[148:151]
    v_and_b32 v115, 0xffff0000, v116
    v_mfma_f32_16x16x32_bf16 v[152:155], a[4:7], a[40:43], v[152:155]
    ds_read_b128 a[92:95], v13 offset:43008
    v_mfma_f32_16x16x32_bf16 v[156:159], a[4:7], a[44:47], v[156:159]
    ds_read_b128 a[52:55], v11 offset:2048
    buffer_load_dwordx4 v3, s[8:11], s21 offen offset:1024 lds
    v_lshlrev_b32 v117, 16, v119
    s_waitcnt lgkmcnt(11)
    v_mfma_f32_16x16x32_bf16 v[160:163], a[8:11], a[32:35], v[160:163]
    v_and_b32 v118, 0xffff0000, v119
    v_mfma_f32_16x16x32_bf16 v[164:167], a[8:11], a[36:39], v[164:167]
    ds_read_b128 a[56:59], v11 offset:4096
    v_mfma_f32_16x16x32_bf16 v[168:171], a[8:11], a[40:43], v[168:171]
    v_add_f32 v104, v108, v109
    v_mfma_f32_16x16x32_bf16 v[172:175], a[8:11], a[44:47], v[172:175]
    ds_read_b128 a[60:63], v11 offset:6144
    buffer_load_dwordx4 v2, s[8:11], s22 offen offset:2048 lds
    s_waitcnt lgkmcnt(12)
    v_mfma_f32_16x16x32_bf16 v[176:179], a[12:15], a[32:35], v[176:179]
    ds_read_b128 a[64:67], v11 offset:8192
    v_add_f32 v105, v111, v112
    v_mfma_f32_16x16x32_bf16 v[180:183], a[12:15], a[36:39], v[180:183]
    v_add_f32 v106, v114, v115
    v_mfma_f32_16x16x32_bf16 v[184:187], a[12:15], a[40:43], v[184:187]
    ds_read_b128 a[68:71], v11 offset:10240
    buffer_load_dwordx4 v3, s[8:11], s23 offen offset:3072 lds
    v_mfma_f32_16x16x32_bf16 v[188:191], a[12:15], a[44:47], v[188:191]
    ds_read_b128 a[72:75], v11 offset:12288
    v_add_f32 v107, v117, v118
    s_waitcnt lgkmcnt(14)
    v_mfma_f32_16x16x32_bf16 v[192:195], a[16:19], a[32:35], v[192:195]
    v_lshlrev_b32 v108, 16, v41
    v_mfma_f32_16x16x32_bf16 v[196:199], a[16:19], a[36:39], v[196:199]
    ds_read_b128 a[76:79], v11 offset:14336
    s_add_u32 s76, s76, 128
    v_mfma_f32_16x16x32_bf16 v[200:203], a[16:19], a[40:43], v[200:203]
    v_and_b32 v109, 0xffff0000, v41
    v_mfma_f32_16x16x32_bf16 v[204:207], a[16:19], a[44:47], v[204:207]
    v_lshlrev_b32 v111, 16, v49
    s_waitcnt lgkmcnt(14)
    v_mfma_f32_16x16x32_bf16 v[208:211], a[20:23], a[32:35], v[208:211]
    v_mfma_f32_16x16x32_bf16 v[212:215], a[20:23], a[36:39], v[212:215]
    s_and_b32 s76, s76, 2047
    v_and_b32 v112, 0xffff0000, v49
    v_mfma_f32_16x16x32_bf16 v[216:219], a[20:23], a[40:43], v[216:219]
    v_mfma_f32_16x16x32_bf16 v[220:223], a[20:23], a[44:47], v[220:223]
    v_lshlrev_b32 v114, 16, v57
    s_waitcnt lgkmcnt(13)
    v_mfma_f32_16x16x32_bf16 v[224:227], a[24:27], a[32:35], v[224:227]
    s_add_u32 s8, s80, s76
    v_and_b32 v115, 0xffff0000, v57
    v_mfma_f32_16x16x32_bf16 v[228:231], a[24:27], a[36:39], v[228:231]
    v_mfma_f32_16x16x32_bf16 v[232:235], a[24:27], a[40:43], v[232:235]
    v_lshlrev_b32 v117, 16, v65
    v_mfma_f32_16x16x32_bf16 v[236:239], a[24:27], a[44:47], v[236:239]
    s_addc_u32 s9, s81, 0
    v_and_b32 v118, 0xffff0000, v65
    s_waitcnt lgkmcnt(12)
    v_mfma_f32_16x16x32_bf16 v[240:243], a[28:31], a[32:35], v[240:243]
    v_mfma_f32_16x16x32_bf16 v[244:247], a[28:31], a[36:39], v[244:247]
    v_mul_f32 v108, v108, v90
    v_mfma_f32_16x16x32_bf16 v[248:251], a[28:31], a[40:43], v[248:251]
    v_mfma_f32_16x16x32_bf16 v[252:255], a[28:31], a[44:47], v[252:255]
    s_waitcnt lgkmcnt(10)
    v_mfma_f32_16x16x32_bf16 v[128:131], a[48:51], a[80:83], v[128:131]
    v_mul_f32 v109, v109, v91
    s_waitcnt lgkmcnt(9)
    v_mfma_f32_16x16x32_bf16 v[132:135], a[48:51], a[84:87], v[132:135]
    s_waitcnt lgkmcnt(8)
    v_mfma_f32_16x16x32_bf16 v[136:139], a[48:51], a[88:91], v[136:139]
    v_mul_f32 v111, v111, v90
    s_waitcnt lgkmcnt(7)
    v_mfma_f32_16x16x32_bf16 v[140:143], a[48:51], a[92:95], v[140:143]
    s_waitcnt lgkmcnt(6)
    v_mfma_f32_16x16x32_bf16 v[144:147], a[52:55], a[80:83], v[144:147]
    v_mul_f32 v112, v112, v91
    v_mfma_f32_16x16x32_bf16 v[148:151], a[52:55], a[84:87], v[148:151]
    s_waitcnt lgkmcnt(0)
    s_waitcnt vmcnt(12)
    s_barrier
    v_mfma_f32_16x16x32_bf16 v[152:155], a[52:55], a[88:91], v[152:155]
    ds_read_b128 a[0:3], v8 offset:0
    v_mfma_f32_16x16x32_bf16 v[156:159], a[52:55], a[92:95], v[156:159]
    ds_read_b128 a[32:35], v12 offset:0
    s_add_u32 m0, s49, 32768
    v_mul_f32 v114, v114, v90
    v_mfma_f32_16x16x32_bf16 v[160:163], a[56:59], a[80:83], v[160:163]
    ds_read_b128 a[36:39], v12 offset:2048
    buffer_load_dwordx4 v4, s[12:15], s24 offen offset:0 lds
    v_mul_f32 v115, v115, v91
    v_mfma_f32_16x16x32_bf16 v[164:167], a[56:59], a[84:87], v[164:167]
    ds_read_b128 a[40:43], v12 offset:8192
    v_mfma_f32_16x16x32_bf16 v[168:171], a[56:59], a[88:91], v[168:171]
    buffer_load_dwordx4 v5, s[12:15], s25 offen offset:1024 lds
    v_mul_f32 v117, v117, v90
    v_mfma_f32_16x16x32_bf16 v[172:175], a[56:59], a[92:95], v[172:175]
    ds_read_b128 a[44:47], v12 offset:10240
    v_mul_f32 v118, v118, v91
    v_mfma_f32_16x16x32_bf16 v[176:179], a[60:63], a[80:83], v[176:179]
    ds_read_b128 a[4:7], v8 offset:2048
    buffer_load_dwordx4 v4, s[12:15], s26 offen offset:2048 lds
    v_mfma_f32_16x16x32_bf16 v[180:183], a[60:63], a[84:87], v[180:183]
    ds_read_b128 a[8:11], v8 offset:4096
    buffer_load_dwordx4 v5, s[12:15], s27 offen offset:3072 lds
    v_cvt_pk_bf16_f32 v110, v108, v109
    v_mfma_f32_16x16x32_bf16 v[184:187], a[60:63], a[88:91], v[184:187]
    ds_read_b128 a[12:15], v8 offset:6144
    v_cvt_pk_bf16_f32 v113, v111, v112
    v_mfma_f32_16x16x32_bf16 v[188:191], a[60:63], a[92:95], v[188:191]
    s_add_u32 s77, s77, 128
    v_mfma_f32_16x16x32_bf16 v[192:195], a[64:67], a[80:83], v[192:195]
    ds_read_b128 a[16:19], v8 offset:8192
    v_cvt_pk_bf16_f32 v116, v114, v115
    v_mfma_f32_16x16x32_bf16 v[196:199], a[64:67], a[84:87], v[196:199]
    ds_read_b128 a[20:23], v8 offset:10240
    s_and_b32 s77, s77, 2047
    v_cvt_pk_bf16_f32 v119, v117, v118
    v_mfma_f32_16x16x32_bf16 v[200:203], a[64:67], a[88:91], v[200:203]
    ds_read_b128 a[24:27], v8 offset:12288
    v_mfma_f32_16x16x32_bf16 v[204:207], a[64:67], a[92:95], v[204:207]
    ds_read_b128 a[28:31], v8 offset:14336
    s_add_u32 s12, s68, s77
    v_lshlrev_b32 v108, 16, v110
    v_mfma_f32_16x16x32_bf16 v[208:211], a[68:71], a[80:83], v[208:211]
    s_addc_u32 s13, s69, 0
    v_and_b32 v109, 0xffff0000, v110
    v_mfma_f32_16x16x32_bf16 v[212:215], a[68:71], a[84:87], v[212:215]
    v_mfma_f32_16x16x32_bf16 v[216:219], a[68:71], a[88:91], v[216:219]
    s_add_u32 m0, s48, 65536
    v_lshlrev_b32 v111, 16, v113
    v_mfma_f32_16x16x32_bf16 v[220:223], a[68:71], a[92:95], v[220:223]
    v_and_b32 v112, 0xffff0000, v113
    v_mfma_f32_16x16x32_bf16 v[224:227], a[72:75], a[80:83], v[224:227]
    buffer_load_dwordx4 v2, s[8:11], s16 offen offset:0 lds
    v_mfma_f32_16x16x32_bf16 v[228:231], a[72:75], a[84:87], v[228:231]
    buffer_load_dwordx4 v3, s[8:11], s17 offen offset:1024 lds
    v_lshlrev_b32 v114, 16, v116
    v_mfma_f32_16x16x32_bf16 v[232:235], a[72:75], a[88:91], v[232:235]
    v_and_b32 v115, 0xffff0000, v116
    v_mfma_f32_16x16x32_bf16 v[236:239], a[72:75], a[92:95], v[236:239]
    buffer_load_dwordx4 v2, s[8:11], s18 offen offset:2048 lds
    v_mfma_f32_16x16x32_bf16 v[240:243], a[76:79], a[80:83], v[240:243]
    v_lshlrev_b32 v117, 16, v119
    v_mfma_f32_16x16x32_bf16 v[244:247], a[76:79], a[84:87], v[244:247]
    buffer_load_dwordx4 v3, s[8:11], s19 offen offset:3072 lds
    v_and_b32 v118, 0xffff0000, v119
    v_mfma_f32_16x16x32_bf16 v[248:251], a[76:79], a[88:91], v[248:251]
    v_mfma_f32_16x16x32_bf16 v[252:255], a[76:79], a[92:95], v[252:255]
    s_waitcnt lgkmcnt(10)
    v_mfma_f32_16x16x32_bf16 v[128:131], a[0:3], a[32:35], v[128:131]
    ds_read_b128 a[48:51], v9 offset:0
    s_waitcnt lgkmcnt(10)
    v_mfma_f32_16x16x32_bf16 v[132:135], a[0:3], a[36:39], v[132:135]
    ds_read_b128 a[80:83], v13 offset:0
    s_add_u32 m0, s48, 69632
    v_add_f32 v104, v104, v108
    s_waitcnt lgkmcnt(10)
    v_mfma_f32_16x16x32_bf16 v[136:139], a[0:3], a[40:43], v[136:139]
    v_add_f32 v105, v105, v111
    s_waitcnt lgkmcnt(9)
    v_mfma_f32_16x16x32_bf16 v[140:143], a[0:3], a[44:47], v[140:143]
    ds_read_b128 a[84:87], v13 offset:2048
    s_waitcnt lgkmcnt(9)
    v_mfma_f32_16x16x32_bf16 v[144:147], a[4:7], a[32:35], v[144:147]
    ds_read_b128 a[88:91], v13 offset:8192
    buffer_load_dwordx4 v2, s[8:11], s20 offen offset:0 lds
    v_add_f32 v106, v106, v114
    v_mfma_f32_16x16x32_bf16 v[148:151], a[4:7], a[36:39], v[148:151]
    v_add_f32 v107, v107, v117
    v_mfma_f32_16x16x32_bf16 v[152:155], a[4:7], a[40:43], v[152:155]
    ds_read_b128 a[92:95], v13 offset:10240
    v_mfma_f32_16x16x32_bf16 v[156:159], a[4:7], a[44:47], v[156:159]
    ds_read_b128 a[52:55], v9 offset:2048
    buffer_load_dwordx4 v3, s[8:11], s21 offen offset:1024 lds
    v_add_f32 v104, v104, v109
    s_waitcnt lgkmcnt(11)
    v_mfma_f32_16x16x32_bf16 v[160:163], a[8:11], a[32:35], v[160:163]
    v_add_f32 v105, v105, v112
    v_mfma_f32_16x16x32_bf16 v[164:167], a[8:11], a[36:39], v[164:167]
    ds_read_b128 a[56:59], v9 offset:4096
    v_mfma_f32_16x16x32_bf16 v[168:171], a[8:11], a[40:43], v[168:171]
    v_add_f32 v106, v106, v115
    v_mfma_f32_16x16x32_bf16 v[172:175], a[8:11], a[44:47], v[172:175]
    ds_read_b128 a[60:63], v9 offset:6144
    buffer_load_dwordx4 v2, s[8:11], s22 offen offset:2048 lds
    s_waitcnt lgkmcnt(12)
    v_mfma_f32_16x16x32_bf16 v[176:179], a[12:15], a[32:35], v[176:179]
    ds_read_b128 a[64:67], v9 offset:8192
    v_add_f32 v107, v107, v118
    v_mfma_f32_16x16x32_bf16 v[180:183], a[12:15], a[36:39], v[180:183]
    v_lshlrev_b32 v108, 16, v42
    v_mfma_f32_16x16x32_bf16 v[184:187], a[12:15], a[40:43], v[184:187]
    ds_read_b128 a[68:71], v9 offset:10240
    buffer_load_dwordx4 v3, s[8:11], s23 offen offset:3072 lds
    v_mfma_f32_16x16x32_bf16 v[188:191], a[12:15], a[44:47], v[188:191]
    ds_read_b128 a[72:75], v9 offset:12288
    v_and_b32 v109, 0xffff0000, v42
    s_waitcnt lgkmcnt(14)
    v_mfma_f32_16x16x32_bf16 v[192:195], a[16:19], a[32:35], v[192:195]
    v_lshlrev_b32 v111, 16, v50
    v_mfma_f32_16x16x32_bf16 v[196:199], a[16:19], a[36:39], v[196:199]
    ds_read_b128 a[76:79], v9 offset:14336
    s_add_u32 s76, s76, 128
    v_mfma_f32_16x16x32_bf16 v[200:203], a[16:19], a[40:43], v[200:203]
    v_and_b32 v112, 0xffff0000, v50
    v_mfma_f32_16x16x32_bf16 v[204:207], a[16:19], a[44:47], v[204:207]
    v_lshlrev_b32 v114, 16, v58
    s_waitcnt lgkmcnt(14)
    v_mfma_f32_16x16x32_bf16 v[208:211], a[20:23], a[32:35], v[208:211]
    v_mfma_f32_16x16x32_bf16 v[212:215], a[20:23], a[36:39], v[212:215]
    s_and_b32 s76, s76, 2047
    v_and_b32 v115, 0xffff0000, v58
    v_mfma_f32_16x16x32_bf16 v[216:219], a[20:23], a[40:43], v[216:219]
    v_mfma_f32_16x16x32_bf16 v[220:223], a[20:23], a[44:47], v[220:223]
    v_lshlrev_b32 v117, 16, v66
    s_waitcnt lgkmcnt(13)
    v_mfma_f32_16x16x32_bf16 v[224:227], a[24:27], a[32:35], v[224:227]
    s_add_u32 s8, s80, s76
    v_and_b32 v118, 0xffff0000, v66
    v_mfma_f32_16x16x32_bf16 v[228:231], a[24:27], a[36:39], v[228:231]
    v_mfma_f32_16x16x32_bf16 v[232:235], a[24:27], a[40:43], v[232:235]
    v_mul_f32 v108, v108, v92
    v_mfma_f32_16x16x32_bf16 v[236:239], a[24:27], a[44:47], v[236:239]
    s_addc_u32 s9, s81, 0
    v_mul_f32 v109, v109, v93
    s_waitcnt lgkmcnt(12)
    v_mfma_f32_16x16x32_bf16 v[240:243], a[28:31], a[32:35], v[240:243]
    v_mfma_f32_16x16x32_bf16 v[244:247], a[28:31], a[36:39], v[244:247]
    v_mul_f32 v111, v111, v92
    v_mfma_f32_16x16x32_bf16 v[248:251], a[28:31], a[40:43], v[248:251]
    v_mfma_f32_16x16x32_bf16 v[252:255], a[28:31], a[44:47], v[252:255]
    s_waitcnt lgkmcnt(10)
    v_mfma_f32_16x16x32_bf16 v[128:131], a[48:51], a[80:83], v[128:131]
    v_mul_f32 v112, v112, v93
    s_waitcnt lgkmcnt(9)
    v_mfma_f32_16x16x32_bf16 v[132:135], a[48:51], a[84:87], v[132:135]
    s_waitcnt lgkmcnt(8)
    v_mfma_f32_16x16x32_bf16 v[136:139], a[48:51], a[88:91], v[136:139]
    v_mul_f32 v114, v114, v92
    s_waitcnt lgkmcnt(7)
    v_mfma_f32_16x16x32_bf16 v[140:143], a[48:51], a[92:95], v[140:143]
    s_waitcnt lgkmcnt(6)
    v_mfma_f32_16x16x32_bf16 v[144:147], a[52:55], a[80:83], v[144:147]
    v_mul_f32 v115, v115, v93
    v_mfma_f32_16x16x32_bf16 v[148:151], a[52:55], a[84:87], v[148:151]
    s_waitcnt lgkmcnt(0)
    s_waitcnt vmcnt(12)
    s_barrier
    v_mfma_f32_16x16x32_bf16 v[152:155], a[52:55], a[88:91], v[152:155]
    ds_read_b128 a[0:3], v8 offset:32768
    v_mfma_f32_16x16x32_bf16 v[156:159], a[52:55], a[92:95], v[156:159]
    ds_read_b128 a[32:35], v12 offset:16384
    s_add_u32 m0, s49, 0
    v_mul_f32 v117, v117, v92
    v_mfma_f32_16x16x32_bf16 v[160:163], a[56:59], a[80:83], v[160:163]
    ds_read_b128 a[36:39], v12 offset:18432
    buffer_load_dwordx4 v4, s[12:15], s24 offen offset:0 lds
    v_mul_f32 v118, v118, v93
    v_mfma_f32_16x16x32_bf16 v[164:167], a[56:59], a[84:87], v[164:167]
    ds_read_b128 a[40:43], v12 offset:24576
    v_mfma_f32_16x16x32_bf16 v[168:171], a[56:59], a[88:91], v[168:171]
    buffer_load_dwordx4 v5, s[12:15], s25 offen offset:1024 lds
    v_cvt_pk_bf16_f32 v110, v108, v109
    v_mfma_f32_16x16x32_bf16 v[172:175], a[56:59], a[92:95], v[172:175]
    ds_read_b128 a[44:47], v12 offset:26624
    v_cvt_pk_bf16_f32 v113, v111, v112
    v_mfma_f32_16x16x32_bf16 v[176:179], a[60:63], a[80:83], v[176:179]
    ds_read_b128 a[4:7], v8 offset:34816
    buffer_load_dwordx4 v4, s[12:15], s26 offen offset:2048 lds
    v_mfma_f32_16x16x32_bf16 v[180:183], a[60:63], a[84:87], v[180:183]
    ds_read_b128 a[8:11], v8 offset:36864
    buffer_load_dwordx4 v5, s[12:15], s27 offen offset:3072 lds
    v_cvt_pk_bf16_f32 v116, v114, v115
    v_mfma_f32_16x16x32_bf16 v[184:187], a[60:63], a[88:91], v[184:187]
    ds_read_b128 a[12:15], v8 offset:38912
    v_cvt_pk_bf16_f32 v119, v117, v118
    v_mfma_f32_16x16x32_bf16 v[188:191], a[60:63], a[92:95], v[188:191]
    s_add_u32 s77, s77, 128
    v_mfma_f32_16x16x32_bf16 v[192:195], a[64:67], a[80:83], v[192:195]
    ds_read_b128 a[16:19], v8 offset:40960
    v_lshlrev_b32 v108, 16, v110
    v_mfma_f32_16x16x32_bf16 v[196:199], a[64:67], a[84:87], v[196:199]
    ds_read_b128 a[20:23], v8 offset:43008
    s_and_b32 s77, s77, 2047
    v_and_b32 v109, 0xffff0000, v110
    v_mfma_f32_16x16x32_bf16 v[200:203], a[64:67], a[88:91], v[200:203]
    ds_read_b128 a[24:27], v8 offset:45056
    v_mfma_f32_16x16x32_bf16 v[204:207], a[64:67], a[92:95], v[204:207]
    ds_read_b128 a[28:31], v8 offset:47104
    s_add_u32 s12, s68, s77
    v_lshlrev_b32 v111, 16, v113
    v_mfma_f32_16x16x32_bf16 v[208:211], a[68:71], a[80:83], v[208:211]
    s_addc_u32 s13, s69, 0
    v_and_b32 v112, 0xffff0000, v113
    v_mfma_f32_16x16x32_bf16 v[212:215], a[68:71], a[84:87], v[212:215]
    v_mfma_f32_16x16x32_bf16 v[216:219], a[68:71], a[88:91], v[216:219]
    s_add_u32 m0, s48, 0
    v_lshlrev_b32 v114, 16, v116
    v_mfma_f32_16x16x32_bf16 v[220:223], a[68:71], a[92:95], v[220:223]
    v_and_b32 v115, 0xffff0000, v116
    v_mfma_f32_16x16x32_bf16 v[224:227], a[72:75], a[80:83], v[224:227]
    buffer_load_dwordx4 v2, s[8:11], s16 offen offset:0 lds
    v_mfma_f32_16x16x32_bf16 v[228:231], a[72:75], a[84:87], v[228:231]
    buffer_load_dwordx4 v3, s[8:11], s17 offen offset:1024 lds
    v_lshlrev_b32 v117, 16, v119
    v_mfma_f32_16x16x32_bf16 v[232:235], a[72:75], a[88:91], v[232:235]
    v_and_b32 v118, 0xffff0000, v119
    v_mfma_f32_16x16x32_bf16 v[236:239], a[72:75], a[92:95], v[236:239]
    buffer_load_dwordx4 v2, s[8:11], s18 offen offset:2048 lds
    v_mfma_f32_16x16x32_bf16 v[240:243], a[76:79], a[80:83], v[240:243]
    v_add_f32 v104, v104, v108
    v_mfma_f32_16x16x32_bf16 v[244:247], a[76:79], a[84:87], v[244:247]
    buffer_load_dwordx4 v3, s[8:11], s19 offen offset:3072 lds
    v_add_f32 v105, v105, v111
    v_mfma_f32_16x16x32_bf16 v[248:251], a[76:79], a[88:91], v[248:251]
    v_mfma_f32_16x16x32_bf16 v[252:255], a[76:79], a[92:95], v[252:255]
    s_waitcnt lgkmcnt(10)
    v_mfma_f32_16x16x32_bf16 v[128:131], a[0:3], a[32:35], v[128:131]
    ds_read_b128 a[48:51], v9 offset:32768
    s_waitcnt lgkmcnt(10)
    v_mfma_f32_16x16x32_bf16 v[132:135], a[0:3], a[36:39], v[132:135]
    ds_read_b128 a[80:83], v13 offset:16384
    s_add_u32 m0, s48, 4096
    v_add_f32 v106, v106, v114
    s_waitcnt lgkmcnt(10)
    v_mfma_f32_16x16x32_bf16 v[136:139], a[0:3], a[40:43], v[136:139]
    v_add_f32 v107, v107, v117
    s_waitcnt lgkmcnt(9)
    v_mfma_f32_16x16x32_bf16 v[140:143], a[0:3], a[44:47], v[140:143]
    ds_read_b128 a[84:87], v13 offset:18432
    s_waitcnt lgkmcnt(9)
    v_mfma_f32_16x16x32_bf16 v[144:147], a[4:7], a[32:35], v[144:147]
    ds_read_b128 a[88:91], v13 offset:24576
    buffer_load_dwordx4 v2, s[8:11], s20 offen offset:0 lds
    v_add_f32 v104, v104, v109
    v_mfma_f32_16x16x32_bf16 v[148:151], a[4:7], a[36:39], v[148:151]
    v_add_f32 v105, v105, v112
    v_mfma_f32_16x16x32_bf16 v[152:155], a[4:7], a[40:43], v[152:155]
    ds_read_b128 a[92:95], v13 offset:26624
    v_mfma_f32_16x16x32_bf16 v[156:159], a[4:7], a[44:47], v[156:159]
    ds_read_b128 a[52:55], v9 offset:34816
    buffer_load_dwordx4 v3, s[8:11], s21 offen offset:1024 lds
    v_add_f32 v106, v106, v115
    s_waitcnt lgkmcnt(11)
    v_mfma_f32_16x16x32_bf16 v[160:163], a[8:11], a[32:35], v[160:163]
    v_add_f32 v107, v107, v118
    v_mfma_f32_16x16x32_bf16 v[164:167], a[8:11], a[36:39], v[164:167]
    ds_read_b128 a[56:59], v9 offset:36864
    v_mfma_f32_16x16x32_bf16 v[168:171], a[8:11], a[40:43], v[168:171]
    v_lshlrev_b32 v108, 16, v43
    v_mfma_f32_16x16x32_bf16 v[172:175], a[8:11], a[44:47], v[172:175]
    ds_read_b128 a[60:63], v9 offset:38912
    buffer_load_dwordx4 v2, s[8:11], s22 offen offset:2048 lds
    s_waitcnt lgkmcnt(12)
    v_mfma_f32_16x16x32_bf16 v[176:179], a[12:15], a[32:35], v[176:179]
    ds_read_b128 a[64:67], v9 offset:40960
    v_and_b32 v109, 0xffff0000, v43
    v_mfma_f32_16x16x32_bf16 v[180:183], a[12:15], a[36:39], v[180:183]
    v_lshlrev_b32 v111, 16, v51
    v_mfma_f32_16x16x32_bf16 v[184:187], a[12:15], a[40:43], v[184:187]
    ds_read_b128 a[68:71], v9 offset:43008
    buffer_load_dwordx4 v3, s[8:11], s23 offen offset:3072 lds
    v_mfma_f32_16x16x32_bf16 v[188:191], a[12:15], a[44:47], v[188:191]
    ds_read_b128 a[72:75], v9 offset:45056
    v_and_b32 v112, 0xffff0000, v51
    s_waitcnt lgkmcnt(14)
    v_mfma_f32_16x16x32_bf16 v[192:195], a[16:19], a[32:35], v[192:195]
    v_lshlrev_b32 v114, 16, v59
    v_mfma_f32_16x16x32_bf16 v[196:199], a[16:19], a[36:39], v[196:199]
    ds_read_b128 a[76:79], v9 offset:47104
    s_add_u32 s76, s76, 128
    v_mfma_f32_16x16x32_bf16 v[200:203], a[16:19], a[40:43], v[200:203]
    v_and_b32 v115, 0xffff0000, v59
    v_mfma_f32_16x16x32_bf16 v[204:207], a[16:19], a[44:47], v[204:207]
    v_lshlrev_b32 v117, 16, v67
    s_waitcnt lgkmcnt(14)
    v_mfma_f32_16x16x32_bf16 v[208:211], a[20:23], a[32:35], v[208:211]
    v_mfma_f32_16x16x32_bf16 v[212:215], a[20:23], a[36:39], v[212:215]
    s_and_b32 s76, s76, 2047
    v_and_b32 v118, 0xffff0000, v67
    v_mfma_f32_16x16x32_bf16 v[216:219], a[20:23], a[40:43], v[216:219]
    v_mfma_f32_16x16x32_bf16 v[220:223], a[20:23], a[44:47], v[220:223]
    v_mul_f32 v108, v108, v94
    s_waitcnt lgkmcnt(13)
    v_mfma_f32_16x16x32_bf16 v[224:227], a[24:27], a[32:35], v[224:227]
    s_add_u32 s8, s80, s76
    v_mul_f32 v109, v109, v95
    v_mfma_f32_16x16x32_bf16 v[228:231], a[24:27], a[36:39], v[228:231]
    v_mfma_f32_16x16x32_bf16 v[232:235], a[24:27], a[40:43], v[232:235]
    v_mul_f32 v111, v111, v94
    v_mfma_f32_16x16x32_bf16 v[236:239], a[24:27], a[44:47], v[236:239]
    s_addc_u32 s9, s81, 0
    v_mul_f32 v112, v112, v95
    s_waitcnt lgkmcnt(12)
    v_mfma_f32_16x16x32_bf16 v[240:243], a[28:31], a[32:35], v[240:243]
    v_mfma_f32_16x16x32_bf16 v[244:247], a[28:31], a[36:39], v[244:247]
    v_mul_f32 v114, v114, v94
    v_mfma_f32_16x16x32_bf16 v[248:251], a[28:31], a[40:43], v[248:251]
    v_mfma_f32_16x16x32_bf16 v[252:255], a[28:31], a[44:47], v[252:255]
    s_waitcnt lgkmcnt(10)
    v_mfma_f32_16x16x32_bf16 v[128:131], a[48:51], a[80:83], v[128:131]
    v_mul_f32 v115, v115, v95
    s_waitcnt lgkmcnt(9)
    v_mfma_f32_16x16x32_bf16 v[132:135], a[48:51], a[84:87], v[132:135]
    s_waitcnt lgkmcnt(8)
    v_mfma_f32_16x16x32_bf16 v[136:139], a[48:51], a[88:91], v[136:139]
    v_mul_f32 v117, v117, v94
    s_waitcnt lgkmcnt(7)
    v_mfma_f32_16x16x32_bf16 v[140:143], a[48:51], a[92:95], v[140:143]
    s_waitcnt lgkmcnt(6)
    v_mfma_f32_16x16x32_bf16 v[144:147], a[52:55], a[80:83], v[144:147]
    v_mul_f32 v118, v118, v95
    v_mfma_f32_16x16x32_bf16 v[148:151], a[52:55], a[84:87], v[148:151]
    s_waitcnt lgkmcnt(0)
    s_waitcnt vmcnt(12)
    s_barrier
    v_mfma_f32_16x16x32_bf16 v[152:155], a[52:55], a[88:91], v[152:155]
    ds_read_b128 a[0:3], v10 offset:0
    v_mfma_f32_16x16x32_bf16 v[156:159], a[52:55], a[92:95], v[156:159]
    ds_read_b128 a[32:35], v12 offset:32768
    s_add_u32 m0, s49, 16384
    v_cvt_pk_bf16_f32 v110, v108, v109
    v_mfma_f32_16x16x32_bf16 v[160:163], a[56:59], a[80:83], v[160:163]
    ds_read_b128 a[36:39], v12 offset:34816
    buffer_load_dwordx4 v4, s[12:15], s24 offen offset:0 lds
    v_cvt_pk_bf16_f32 v113, v111, v112
    v_mfma_f32_16x16x32_bf16 v[164:167], a[56:59], a[84:87], v[164:167]
    ds_read_b128 a[40:43], v12 offset:40960
    v_mfma_f32_16x16x32_bf16 v[168:171], a[56:59], a[88:91], v[168:171]
    buffer_load_dwordx4 v5, s[12:15], s25 offen offset:1024 lds
    v_cvt_pk_bf16_f32 v116, v114, v115
    v_mfma_f32_16x16x32_bf16 v[172:175], a[56:59], a[92:95], v[172:175]
    ds_read_b128 a[44:47], v12 offset:43008
    v_cvt_pk_bf16_f32 v119, v117, v118
    v_mfma_f32_16x16x32_bf16 v[176:179], a[60:63], a[80:83], v[176:179]
    ds_read_b128 a[4:7], v10 offset:2048
    buffer_load_dwordx4 v4, s[12:15], s26 offen offset:2048 lds
    v_mfma_f32_16x16x32_bf16 v[180:183], a[60:63], a[84:87], v[180:183]
    ds_read_b128 a[8:11], v10 offset:4096
    buffer_load_dwordx4 v5, s[12:15], s27 offen offset:3072 lds
    v_lshlrev_b32 v108, 16, v110
    v_mfma_f32_16x16x32_bf16 v[184:187], a[60:63], a[88:91], v[184:187]
    ds_read_b128 a[12:15], v10 offset:6144
    v_and_b32 v109, 0xffff0000, v110
    v_mfma_f32_16x16x32_bf16 v[188:191], a[60:63], a[92:95], v[188:191]
    s_add_u32 s77, s77, 128
    v_mfma_f32_16x16x32_bf16 v[192:195], a[64:67], a[80:83], v[192:195]
    ds_read_b128 a[16:19], v10 offset:8192
    v_lshlrev_b32 v111, 16, v113
    v_mfma_f32_16x16x32_bf16 v[196:199], a[64:67], a[84:87], v[196:199]
    ds_read_b128 a[20:23], v10 offset:10240
    s_and_b32 s77, s77, 2047
    v_and_b32 v112, 0xffff0000, v113
    v_mfma_f32_16x16x32_bf16 v[200:203], a[64:67], a[88:91], v[200:203]
    ds_read_b128 a[24:27], v10 offset:12288
    v_mfma_f32_16x16x32_bf16 v[204:207], a[64:67], a[92:95], v[204:207]
    ds_read_b128 a[28:31], v10 offset:14336
    s_add_u32 s12, s68, s77
    v_lshlrev_b32 v114, 16, v116
    v_mfma_f32_16x16x32_bf16 v[208:211], a[68:71], a[80:83], v[208:211]
    s_addc_u32 s13, s69, 0
    v_and_b32 v115, 0xffff0000, v116
    v_mfma_f32_16x16x32_bf16 v[212:215], a[68:71], a[84:87], v[212:215]
    v_mfma_f32_16x16x32_bf16 v[216:219], a[68:71], a[88:91], v[216:219]
    s_add_u32 m0, s48, 32768
    v_lshlrev_b32 v117, 16, v119
    v_mfma_f32_16x16x32_bf16 v[220:223], a[68:71], a[92:95], v[220:223]
    v_and_b32 v118, 0xffff0000, v119
    v_mfma_f32_16x16x32_bf16 v[224:227], a[72:75], a[80:83], v[224:227]
    buffer_load_dwordx4 v2, s[8:11], s16 offen offset:0 lds
    v_mfma_f32_16x16x32_bf16 v[228:231], a[72:75], a[84:87], v[228:231]
    buffer_load_dwordx4 v3, s[8:11], s17 offen offset:1024 lds
    v_add_f32 v104, v104, v108
    v_mfma_f32_16x16x32_bf16 v[232:235], a[72:75], a[88:91], v[232:235]
    v_add_f32 v105, v105, v111
    v_mfma_f32_16x16x32_bf16 v[236:239], a[72:75], a[92:95], v[236:239]
    buffer_load_dwordx4 v2, s[8:11], s18 offen offset:2048 lds
    v_mfma_f32_16x16x32_bf16 v[240:243], a[76:79], a[80:83], v[240:243]
    v_add_f32 v106, v106, v114
    v_mfma_f32_16x16x32_bf16 v[244:247], a[76:79], a[84:87], v[244:247]
    buffer_load_dwordx4 v3, s[8:11], s19 offen offset:3072 lds
    v_add_f32 v107, v107, v117
    v_mfma_f32_16x16x32_bf16 v[248:251], a[76:79], a[88:91], v[248:251]
    v_mfma_f32_16x16x32_bf16 v[252:255], a[76:79], a[92:95], v[252:255]
    s_waitcnt lgkmcnt(10)
    v_mfma_f32_16x16x32_bf16 v[128:131], a[0:3], a[32:35], v[128:131]
    ds_read_b128 a[48:51], v11 offset:0
    s_waitcnt lgkmcnt(10)
    v_mfma_f32_16x16x32_bf16 v[132:135], a[0:3], a[36:39], v[132:135]
    ds_read_b128 a[80:83], v13 offset:32768
    s_add_u32 m0, s48, 36864
    v_add_f32 v104, v104, v109
    s_waitcnt lgkmcnt(10)
    v_mfma_f32_16x16x32_bf16 v[136:139], a[0:3], a[40:43], v[136:139]
    v_add_f32 v105, v105, v112
    s_waitcnt lgkmcnt(9)
    v_mfma_f32_16x16x32_bf16 v[140:143], a[0:3], a[44:47], v[140:143]
    ds_read_b128 a[84:87], v13 offset:34816
    s_waitcnt lgkmcnt(9)
    v_mfma_f32_16x16x32_bf16 v[144:147], a[4:7], a[32:35], v[144:147]
    ds_read_b128 a[88:91], v13 offset:40960
    buffer_load_dwordx4 v2, s[8:11], s20 offen offset:0 lds
    v_add_f32 v106, v106, v115
    v_mfma_f32_16x16x32_bf16 v[148:151], a[4:7], a[36:39], v[148:151]
    v_add_f32 v107, v107, v118
    v_mfma_f32_16x16x32_bf16 v[152:155], a[4:7], a[40:43], v[152:155]
    ds_read_b128 a[92:95], v13 offset:43008
    v_mfma_f32_16x16x32_bf16 v[156:159], a[4:7], a[44:47], v[156:159]
    ds_read_b128 a[52:55], v11 offset:2048
    buffer_load_dwordx4 v3, s[8:11], s21 offen offset:1024 lds
    v_lshlrev_b32 v108, 16, v44
    s_waitcnt lgkmcnt(11)
    v_mfma_f32_16x16x32_bf16 v[160:163], a[8:11], a[32:35], v[160:163]
    v_and_b32 v109, 0xffff0000, v44
    v_mfma_f32_16x16x32_bf16 v[164:167], a[8:11], a[36:39], v[164:167]
    ds_read_b128 a[56:59], v11 offset:4096
    v_mfma_f32_16x16x32_bf16 v[168:171], a[8:11], a[40:43], v[168:171]
    v_lshlrev_b32 v111, 16, v52
    v_mfma_f32_16x16x32_bf16 v[172:175], a[8:11], a[44:47], v[172:175]
    ds_read_b128 a[60:63], v11 offset:6144
    buffer_load_dwordx4 v2, s[8:11], s22 offen offset:2048 lds
    s_waitcnt lgkmcnt(12)
    v_mfma_f32_16x16x32_bf16 v[176:179], a[12:15], a[32:35], v[176:179]
    ds_read_b128 a[64:67], v11 offset:8192
    v_and_b32 v112, 0xffff0000, v52
    v_mfma_f32_16x16x32_bf16 v[180:183], a[12:15], a[36:39], v[180:183]
    v_lshlrev_b32 v114, 16, v60
    v_mfma_f32_16x16x32_bf16 v[184:187], a[12:15], a[40:43], v[184:187]
    ds_read_b128 a[68:71], v11 offset:10240
    buffer_load_dwordx4 v3, s[8:11], s23 offen offset:3072 lds
    v_mfma_f32_16x16x32_bf16 v[188:191], a[12:15], a[44:47], v[188:191]
    ds_read_b128 a[72:75], v11 offset:12288
    v_and_b32 v115, 0xffff0000, v60
    s_waitcnt lgkmcnt(14)
    v_mfma_f32_16x16x32_bf16 v[192:195], a[16:19], a[32:35], v[192:195]
    v_lshlrev_b32 v117, 16, v68
    v_mfma_f32_16x16x32_bf16 v[196:199], a[16:19], a[36:39], v[196:199]
    ds_read_b128 a[76:79], v11 offset:14336
    s_add_u32 s76, s76, 128
    v_mfma_f32_16x16x32_bf16 v[200:203], a[16:19], a[40:43], v[200:203]
    v_and_b32 v118, 0xffff0000, v68
    v_mfma_f32_16x16x32_bf16 v[204:207], a[16:19], a[44:47], v[204:207]
    v_mul_f32 v108, v108, v96
    s_waitcnt lgkmcnt(14)
    v_mfma_f32_16x16x32_bf16 v[208:211], a[20:23], a[32:35], v[208:211]
    v_mfma_f32_16x16x32_bf16 v[212:215], a[20:23], a[36:39], v[212:215]
    s_and_b32 s76, s76, 2047
    v_mul_f32 v109, v109, v97
    v_mfma_f32_16x16x32_bf16 v[216:219], a[20:23], a[40:43], v[216:219]
    v_mfma_f32_16x16x32_bf16 v[220:223], a[20:23], a[44:47], v[220:223]
    v_mul_f32 v111, v111, v96
    s_waitcnt lgkmcnt(13)
    v_mfma_f32_16x16x32_bf16 v[224:227], a[24:27], a[32:35], v[224:227]
    s_add_u32 s8, s80, s76
    v_mul_f32 v112, v112, v97
    v_mfma_f32_16x16x32_bf16 v[228:231], a[24:27], a[36:39], v[228:231]
    v_mfma_f32_16x16x32_bf16 v[232:235], a[24:27], a[40:43], v[232:235]
    v_mul_f32 v114, v114, v96
    v_mfma_f32_16x16x32_bf16 v[236:239], a[24:27], a[44:47], v[236:239]
    s_addc_u32 s9, s81, 0
    v_mul_f32 v115, v115, v97
    s_waitcnt lgkmcnt(12)
    v_mfma_f32_16x16x32_bf16 v[240:243], a[28:31], a[32:35], v[240:243]
    v_mfma_f32_16x16x32_bf16 v[244:247], a[28:31], a[36:39], v[244:247]
    v_mul_f32 v117, v117, v96
    v_mfma_f32_16x16x32_bf16 v[248:251], a[28:31], a[40:43], v[248:251]
    v_mfma_f32_16x16x32_bf16 v[252:255], a[28:31], a[44:47], v[252:255]
    s_waitcnt lgkmcnt(10)
    v_mfma_f32_16x16x32_bf16 v[128:131], a[48:51], a[80:83], v[128:131]
    v_mul_f32 v118, v118, v97
    s_waitcnt lgkmcnt(9)
    v_mfma_f32_16x16x32_bf16 v[132:135], a[48:51], a[84:87], v[132:135]
    s_waitcnt lgkmcnt(8)
    v_mfma_f32_16x16x32_bf16 v[136:139], a[48:51], a[88:91], v[136:139]
    v_cvt_pk_bf16_f32 v110, v108, v109
    s_waitcnt lgkmcnt(7)
    v_mfma_f32_16x16x32_bf16 v[140:143], a[48:51], a[92:95], v[140:143]
    s_waitcnt lgkmcnt(6)
    v_mfma_f32_16x16x32_bf16 v[144:147], a[52:55], a[80:83], v[144:147]
    v_cvt_pk_bf16_f32 v113, v111, v112
    v_mfma_f32_16x16x32_bf16 v[148:151], a[52:55], a[84:87], v[148:151]
    s_waitcnt lgkmcnt(0)
    s_waitcnt vmcnt(12)
    s_barrier
    v_mfma_f32_16x16x32_bf16 v[152:155], a[52:55], a[88:91], v[152:155]
    ds_read_b128 a[0:3], v8 offset:0
    v_mfma_f32_16x16x32_bf16 v[156:159], a[52:55], a[92:95], v[156:159]
    ds_read_b128 a[32:35], v12 offset:0
    s_add_u32 m0, s49, 32768
    v_cvt_pk_bf16_f32 v116, v114, v115
    v_mfma_f32_16x16x32_bf16 v[160:163], a[56:59], a[80:83], v[160:163]
    ds_read_b128 a[36:39], v12 offset:2048
    buffer_load_dwordx4 v4, s[12:15], s24 offen offset:0 lds
    v_cvt_pk_bf16_f32 v119, v117, v118
    v_mfma_f32_16x16x32_bf16 v[164:167], a[56:59], a[84:87], v[164:167]
    ds_read_b128 a[40:43], v12 offset:8192
    v_mfma_f32_16x16x32_bf16 v[168:171], a[56:59], a[88:91], v[168:171]
    buffer_load_dwordx4 v5, s[12:15], s25 offen offset:1024 lds
    v_lshlrev_b32 v108, 16, v110
    v_mfma_f32_16x16x32_bf16 v[172:175], a[56:59], a[92:95], v[172:175]
    ds_read_b128 a[44:47], v12 offset:10240
    v_and_b32 v109, 0xffff0000, v110
    v_mfma_f32_16x16x32_bf16 v[176:179], a[60:63], a[80:83], v[176:179]
    ds_read_b128 a[4:7], v8 offset:2048
    buffer_load_dwordx4 v4, s[12:15], s26 offen offset:2048 lds
    v_mfma_f32_16x16x32_bf16 v[180:183], a[60:63], a[84:87], v[180:183]
    ds_read_b128 a[8:11], v8 offset:4096
    buffer_load_dwordx4 v5, s[12:15], s27 offen offset:3072 lds
    v_lshlrev_b32 v111, 16, v113
    v_mfma_f32_16x16x32_bf16 v[184:187], a[60:63], a[88:91], v[184:187]
    ds_read_b128 a[12:15], v8 offset:6144
    v_and_b32 v112, 0xffff0000, v113
    v_mfma_f32_16x16x32_bf16 v[188:191], a[60:63], a[92:95], v[188:191]
    s_add_u32 s77, s77, 128
    v_mfma_f32_16x16x32_bf16 v[192:195], a[64:67], a[80:83], v[192:195]
    ds_read_b128 a[16:19], v8 offset:8192
    v_lshlrev_b32 v114, 16, v116
    v_mfma_f32_16x16x32_bf16 v[196:199], a[64:67], a[84:87], v[196:199]
    ds_read_b128 a[20:23], v8 offset:10240
    s_and_b32 s77, s77, 2047
    v_and_b32 v115, 0xffff0000, v116
    v_mfma_f32_16x16x32_bf16 v[200:203], a[64:67], a[88:91], v[200:203]
    ds_read_b128 a[24:27], v8 offset:12288
    v_mfma_f32_16x16x32_bf16 v[204:207], a[64:67], a[92:95], v[204:207]
    ds_read_b128 a[28:31], v8 offset:14336
    s_add_u32 s12, s68, s77
    v_lshlrev_b32 v117, 16, v119
    v_mfma_f32_16x16x32_bf16 v[208:211], a[68:71], a[80:83], v[208:211]
    s_addc_u32 s13, s69, 0
    v_and_b32 v118, 0xffff0000, v119
    v_mfma_f32_16x16x32_bf16 v[212:215], a[68:71], a[84:87], v[212:215]
    v_mfma_f32_16x16x32_bf16 v[216:219], a[68:71], a[88:91], v[216:219]
    s_add_u32 m0, s48, 65536
    v_add_f32 v104, v104, v108
    v_mfma_f32_16x16x32_bf16 v[220:223], a[68:71], a[92:95], v[220:223]
    v_add_f32 v105, v105, v111
    v_mfma_f32_16x16x32_bf16 v[224:227], a[72:75], a[80:83], v[224:227]
    buffer_load_dwordx4 v2, s[8:11], s16 offen offset:0 lds
    v_mfma_f32_16x16x32_bf16 v[228:231], a[72:75], a[84:87], v[228:231]
    buffer_load_dwordx4 v3, s[8:11], s17 offen offset:1024 lds
    v_add_f32 v106, v106, v114
    v_mfma_f32_16x16x32_bf16 v[232:235], a[72:75], a[88:91], v[232:235]
    v_add_f32 v107, v107, v117
    v_mfma_f32_16x16x32_bf16 v[236:239], a[72:75], a[92:95], v[236:239]
    buffer_load_dwordx4 v2, s[8:11], s18 offen offset:2048 lds
    v_mfma_f32_16x16x32_bf16 v[240:243], a[76:79], a[80:83], v[240:243]
    v_add_f32 v104, v104, v109
    v_mfma_f32_16x16x32_bf16 v[244:247], a[76:79], a[84:87], v[244:247]
    buffer_load_dwordx4 v3, s[8:11], s19 offen offset:3072 lds
    v_add_f32 v105, v105, v112
    v_mfma_f32_16x16x32_bf16 v[248:251], a[76:79], a[88:91], v[248:251]
    v_mfma_f32_16x16x32_bf16 v[252:255], a[76:79], a[92:95], v[252:255]
    s_waitcnt lgkmcnt(10)
    v_mfma_f32_16x16x32_bf16 v[128:131], a[0:3], a[32:35], v[128:131]
    ds_read_b128 a[48:51], v9 offset:0
    s_waitcnt lgkmcnt(10)
    v_mfma_f32_16x16x32_bf16 v[132:135], a[0:3], a[36:39], v[132:135]
    ds_read_b128 a[80:83], v13 offset:0
    s_add_u32 m0, s48, 69632
    v_add_f32 v106, v106, v115
    s_waitcnt lgkmcnt(10)
    v_mfma_f32_16x16x32_bf16 v[136:139], a[0:3], a[40:43], v[136:139]
    v_add_f32 v107, v107, v118
    s_waitcnt lgkmcnt(9)
    v_mfma_f32_16x16x32_bf16 v[140:143], a[0:3], a[44:47], v[140:143]
    ds_read_b128 a[84:87], v13 offset:2048
    s_waitcnt lgkmcnt(9)
    v_mfma_f32_16x16x32_bf16 v[144:147], a[4:7], a[32:35], v[144:147]
    ds_read_b128 a[88:91], v13 offset:8192
    buffer_load_dwordx4 v2, s[8:11], s20 offen offset:0 lds
    v_lshlrev_b32 v108, 16, v45
    v_mfma_f32_16x16x32_bf16 v[148:151], a[4:7], a[36:39], v[148:151]
    v_and_b32 v109, 0xffff0000, v45
    v_mfma_f32_16x16x32_bf16 v[152:155], a[4:7], a[40:43], v[152:155]
    ds_read_b128 a[92:95], v13 offset:10240
    v_mfma_f32_16x16x32_bf16 v[156:159], a[4:7], a[44:47], v[156:159]
    ds_read_b128 a[52:55], v9 offset:2048
    buffer_load_dwordx4 v3, s[8:11], s21 offen offset:1024 lds
    v_lshlrev_b32 v111, 16, v53
    s_waitcnt lgkmcnt(11)
    v_mfma_f32_16x16x32_bf16 v[160:163], a[8:11], a[32:35], v[160:163]
    v_and_b32 v112, 0xffff0000, v53
    v_mfma_f32_16x16x32_bf16 v[164:167], a[8:11], a[36:39], v[164:167]
    ds_read_b128 a[56:59], v9 offset:4096
    v_mfma_f32_16x16x32_bf16 v[168:171], a[8:11], a[40:43], v[168:171]
    v_lshlrev_b32 v114, 16, v61
    v_mfma_f32_16x16x32_bf16 v[172:175], a[8:11], a[44:47], v[172:175]
    ds_read_b128 a[60:63], v9 offset:6144
    buffer_load_dwordx4 v2, s[8:11], s22 offen offset:2048 lds
    s_waitcnt lgkmcnt(12)
    v_mfma_f32_16x16x32_bf16 v[176:179], a[12:15], a[32:35], v[176:179]
    ds_read_b128 a[64:67], v9 offset:8192
    v_and_b32 v115, 0xffff0000, v61
    v_mfma_f32_16x16x32_bf16 v[180:183], a[12:15], a[36:39], v[180:183]
    v_lshlrev_b32 v117, 16, v69
    v_mfma_f32_16x16x32_bf16 v[184:187], a[12:15], a[40:43], v[184:187]
    ds_read_b128 a[68:71], v9 offset:10240
    buffer_load_dwordx4 v3, s[8:11], s23 offen offset:3072 lds
    v_mfma_f32_16x16x32_bf16 v[188:191], a[12:15], a[44:47], v[188:191]
    ds_read_b128 a[72:75], v9 offset:12288
    v_and_b32 v118, 0xffff0000, v69
    s_waitcnt lgkmcnt(14)
    v_mfma_f32_16x16x32_bf16 v[192:195], a[16:19], a[32:35], v[192:195]
    v_mul_f32 v108, v108, v98
    v_mfma_f32_16x16x32_bf16 v[196:199], a[16:19], a[36:39], v[196:199]
    ds_read_b128 a[76:79], v9 offset:14336
    s_add_u32 s76, s76, 128
    v_mfma_f32_16x16x32_bf16 v[200:203], a[16:19], a[40:43], v[200:203]
    v_mul_f32 v109, v109, v99
    v_mfma_f32_16x16x32_bf16 v[204:207], a[16:19], a[44:47], v[204:207]
    v_mul_f32 v111, v111, v98
    s_waitcnt lgkmcnt(14)
    v_mfma_f32_16x16x32_bf16 v[208:211], a[20:23], a[32:35], v[208:211]
    v_mfma_f32_16x16x32_bf16 v[212:215], a[20:23], a[36:39], v[212:215]
    s_and_b32 s76, s76, 2047
    v_mul_f32 v112, v112, v99
    v_mfma_f32_16x16x32_bf16 v[216:219], a[20:23], a[40:43], v[216:219]
    v_mfma_f32_16x16x32_bf16 v[220:223], a[20:23], a[44:47], v[220:223]
    v_mul_f32 v114, v114, v98
    s_waitcnt lgkmcnt(13)
    v_mfma_f32_16x16x32_bf16 v[224:227], a[24:27], a[32:35], v[224:227]
    s_add_u32 s8, s80, s76
    v_mul_f32 v115, v115, v99
    v_mfma_f32_16x16x32_bf16 v[228:231], a[24:27], a[36:39], v[228:231]
    v_mfma_f32_16x16x32_bf16 v[232:235], a[24:27], a[40:43], v[232:235]
    v_mul_f32 v117, v117, v98
    v_mfma_f32_16x16x32_bf16 v[236:239], a[24:27], a[44:47], v[236:239]
    s_addc_u32 s9, s81, 0
    v_mul_f32 v118, v118, v99
    s_waitcnt lgkmcnt(12)
    v_mfma_f32_16x16x32_bf16 v[240:243], a[28:31], a[32:35], v[240:243]
    v_mfma_f32_16x16x32_bf16 v[244:247], a[28:31], a[36:39], v[244:247]
    v_cvt_pk_bf16_f32 v110, v108, v109
    v_mfma_f32_16x16x32_bf16 v[248:251], a[28:31], a[40:43], v[248:251]
    v_mfma_f32_16x16x32_bf16 v[252:255], a[28:31], a[44:47], v[252:255]
    s_waitcnt lgkmcnt(10)
    v_mfma_f32_16x16x32_bf16 v[128:131], a[48:51], a[80:83], v[128:131]
    v_cvt_pk_bf16_f32 v113, v111, v112
    s_waitcnt lgkmcnt(9)
    v_mfma_f32_16x16x32_bf16 v[132:135], a[48:51], a[84:87], v[132:135]
    s_waitcnt lgkmcnt(8)
    v_mfma_f32_16x16x32_bf16 v[136:139], a[48:51], a[88:91], v[136:139]
    v_cvt_pk_bf16_f32 v116, v114, v115
    s_waitcnt lgkmcnt(7)
    v_mfma_f32_16x16x32_bf16 v[140:143], a[48:51], a[92:95], v[140:143]
    s_waitcnt lgkmcnt(6)
    v_mfma_f32_16x16x32_bf16 v[144:147], a[52:55], a[80:83], v[144:147]
    v_cvt_pk_bf16_f32 v119, v117, v118
    v_mfma_f32_16x16x32_bf16 v[148:151], a[52:55], a[84:87], v[148:151]
    s_waitcnt lgkmcnt(0)
    s_waitcnt vmcnt(12)
    s_barrier
    v_mfma_f32_16x16x32_bf16 v[152:155], a[52:55], a[88:91], v[152:155]
    ds_read_b128 a[0:3], v8 offset:32768
    v_mfma_f32_16x16x32_bf16 v[156:159], a[52:55], a[92:95], v[156:159]
    ds_read_b128 a[32:35], v12 offset:16384
    s_add_u32 m0, s49, 0
    v_lshlrev_b32 v108, 16, v110
    v_mfma_f32_16x16x32_bf16 v[160:163], a[56:59], a[80:83], v[160:163]
    ds_read_b128 a[36:39], v12 offset:18432
    buffer_load_dwordx4 v4, s[12:15], s24 offen offset:0 lds
    v_and_b32 v109, 0xffff0000, v110
    v_mfma_f32_16x16x32_bf16 v[164:167], a[56:59], a[84:87], v[164:167]
    ds_read_b128 a[40:43], v12 offset:24576
    v_mfma_f32_16x16x32_bf16 v[168:171], a[56:59], a[88:91], v[168:171]
    buffer_load_dwordx4 v5, s[12:15], s25 offen offset:1024 lds
    v_lshlrev_b32 v111, 16, v113
    v_mfma_f32_16x16x32_bf16 v[172:175], a[56:59], a[92:95], v[172:175]
    ds_read_b128 a[44:47], v12 offset:26624
    v_and_b32 v112, 0xffff0000, v113
    v_mfma_f32_16x16x32_bf16 v[176:179], a[60:63], a[80:83], v[176:179]
    ds_read_b128 a[4:7], v8 offset:34816
    buffer_load_dwordx4 v4, s[12:15], s26 offen offset:2048 lds
    v_mfma_f32_16x16x32_bf16 v[180:183], a[60:63], a[84:87], v[180:183]
    ds_read_b128 a[8:11], v8 offset:36864
    buffer_load_dwordx4 v5, s[12:15], s27 offen offset:3072 lds
    v_lshlrev_b32 v114, 16, v116
    v_mfma_f32_16x16x32_bf16 v[184:187], a[60:63], a[88:91], v[184:187]
    ds_read_b128 a[12:15], v8 offset:38912
    v_and_b32 v115, 0xffff0000, v116
    v_mfma_f32_16x16x32_bf16 v[188:191], a[60:63], a[92:95], v[188:191]
    s_add_u32 s77, s77, 128
    v_mfma_f32_16x16x32_bf16 v[192:195], a[64:67], a[80:83], v[192:195]
    ds_read_b128 a[16:19], v8 offset:40960
    v_lshlrev_b32 v117, 16, v119
    v_mfma_f32_16x16x32_bf16 v[196:199], a[64:67], a[84:87], v[196:199]
    ds_read_b128 a[20:23], v8 offset:43008
    s_and_b32 s77, s77, 2047
    v_and_b32 v118, 0xffff0000, v119
    v_mfma_f32_16x16x32_bf16 v[200:203], a[64:67], a[88:91], v[200:203]
    ds_read_b128 a[24:27], v8 offset:45056
    v_mfma_f32_16x16x32_bf16 v[204:207], a[64:67], a[92:95], v[204:207]
    ds_read_b128 a[28:31], v8 offset:47104
    s_add_u32 s12, s68, s77
    v_add_f32 v104, v104, v108
    v_mfma_f32_16x16x32_bf16 v[208:211], a[68:71], a[80:83], v[208:211]
    s_addc_u32 s13, s69, 0
    v_add_f32 v105, v105, v111
    v_mfma_f32_16x16x32_bf16 v[212:215], a[68:71], a[84:87], v[212:215]
    v_mfma_f32_16x16x32_bf16 v[216:219], a[68:71], a[88:91], v[216:219]
    s_add_u32 m0, s48, 0
    v_add_f32 v106, v106, v114
    v_mfma_f32_16x16x32_bf16 v[220:223], a[68:71], a[92:95], v[220:223]
    v_add_f32 v107, v107, v117
    v_mfma_f32_16x16x32_bf16 v[224:227], a[72:75], a[80:83], v[224:227]
    buffer_load_dwordx4 v2, s[8:11], s16 offen offset:0 lds
    v_mfma_f32_16x16x32_bf16 v[228:231], a[72:75], a[84:87], v[228:231]
    buffer_load_dwordx4 v3, s[8:11], s17 offen offset:1024 lds
    v_add_f32 v104, v104, v109
    v_mfma_f32_16x16x32_bf16 v[232:235], a[72:75], a[88:91], v[232:235]
    v_add_f32 v105, v105, v112
    v_mfma_f32_16x16x32_bf16 v[236:239], a[72:75], a[92:95], v[236:239]
    buffer_load_dwordx4 v2, s[8:11], s18 offen offset:2048 lds
    v_mfma_f32_16x16x32_bf16 v[240:243], a[76:79], a[80:83], v[240:243]
    v_add_f32 v106, v106, v115
    v_mfma_f32_16x16x32_bf16 v[244:247], a[76:79], a[84:87], v[244:247]
    buffer_load_dwordx4 v3, s[8:11], s19 offen offset:3072 lds
    v_add_f32 v107, v107, v118
    v_mfma_f32_16x16x32_bf16 v[248:251], a[76:79], a[88:91], v[248:251]
    v_mfma_f32_16x16x32_bf16 v[252:255], a[76:79], a[92:95], v[252:255]
    s_waitcnt lgkmcnt(10)
    v_mfma_f32_16x16x32_bf16 v[128:131], a[0:3], a[32:35], v[128:131]
    ds_read_b128 a[48:51], v9 offset:32768
    s_waitcnt lgkmcnt(10)
    v_mfma_f32_16x16x32_bf16 v[132:135], a[0:3], a[36:39], v[132:135]
    ds_read_b128 a[80:83], v13 offset:16384
    s_add_u32 m0, s48, 4096
    v_lshlrev_b32 v108, 16, v46
    s_waitcnt lgkmcnt(10)
    v_mfma_f32_16x16x32_bf16 v[136:139], a[0:3], a[40:43], v[136:139]
    v_and_b32 v109, 0xffff0000, v46
    s_waitcnt lgkmcnt(9)
    v_mfma_f32_16x16x32_bf16 v[140:143], a[0:3], a[44:47], v[140:143]
    ds_read_b128 a[84:87], v13 offset:18432
    s_waitcnt lgkmcnt(9)
    v_mfma_f32_16x16x32_bf16 v[144:147], a[4:7], a[32:35], v[144:147]
    ds_read_b128 a[88:91], v13 offset:24576
    buffer_load_dwordx4 v2, s[8:11], s20 offen offset:0 lds
    v_lshlrev_b32 v111, 16, v54
    v_mfma_f32_16x16x32_bf16 v[148:151], a[4:7], a[36:39], v[148:151]
    v_and_b32 v112, 0xffff0000, v54
    v_mfma_f32_16x16x32_bf16 v[152:155], a[4:7], a[40:43], v[152:155]
    ds_read_b128 a[92:95], v13 offset:26624
    v_mfma_f32_16x16x32_bf16 v[156:159], a[4:7], a[44:47], v[156:159]
    ds_read_b128 a[52:55], v9 offset:34816
    buffer_load_dwordx4 v3, s[8:11], s21 offen offset:1024 lds
    v_lshlrev_b32 v114, 16, v62
    s_waitcnt lgkmcnt(11)
    v_mfma_f32_16x16x32_bf16 v[160:163], a[8:11], a[32:35], v[160:163]
    v_and_b32 v115, 0xffff0000, v62
    v_mfma_f32_16x16x32_bf16 v[164:167], a[8:11], a[36:39], v[164:167]
    ds_read_b128 a[56:59], v9 offset:36864
    v_mfma_f32_16x16x32_bf16 v[168:171], a[8:11], a[40:43], v[168:171]
    v_lshlrev_b32 v117, 16, v70
    v_mfma_f32_16x16x32_bf16 v[172:175], a[8:11], a[44:47], v[172:175]
    ds_read_b128 a[60:63], v9 offset:38912
    buffer_load_dwordx4 v2, s[8:11], s22 offen offset:2048 lds
    s_waitcnt lgkmcnt(12)
    v_mfma_f32_16x16x32_bf16 v[176:179], a[12:15], a[32:35], v[176:179]
    ds_read_b128 a[64:67], v9 offset:40960
    v_and_b32 v118, 0xffff0000, v70
    v_mfma_f32_16x16x32_bf16 v[180:183], a[12:15], a[36:39], v[180:183]
    v_mul_f32 v108, v108, v100
    v_mfma_f32_16x16x32_bf16 v[184:187], a[12:15], a[40:43], v[184:187]
    ds_read_b128 a[68:71], v9 offset:43008
    buffer_load_dwordx4 v3, s[8:11], s23 offen offset:3072 lds
    v_mfma_f32_16x16x32_bf16 v[188:191], a[12:15], a[44:47], v[188:191]
    ds_read_b128 a[72:75], v9 offset:45056
    v_mul_f32 v109, v109, v101
    s_waitcnt lgkmcnt(14)
    v_mfma_f32_16x16x32_bf16 v[192:195], a[16:19], a[32:35], v[192:195]
    v_mul_f32 v111, v111, v100
    v_mfma_f32_16x16x32_bf16 v[196:199], a[16:19], a[36:39], v[196:199]
    ds_read_b128 a[76:79], v9 offset:47104
    s_add_u32 s76, s76, 128
    v_mfma_f32_16x16x32_bf16 v[200:203], a[16:19], a[40:43], v[200:203]
    v_mul_f32 v112, v112, v101
    v_mfma_f32_16x16x32_bf16 v[204:207], a[16:19], a[44:47], v[204:207]
    v_mul_f32 v114, v114, v100
    s_waitcnt lgkmcnt(14)
    v_mfma_f32_16x16x32_bf16 v[208:211], a[20:23], a[32:35], v[208:211]
    v_mfma_f32_16x16x32_bf16 v[212:215], a[20:23], a[36:39], v[212:215]
    s_and_b32 s76, s76, 2047
    v_mul_f32 v115, v115, v101
    v_mfma_f32_16x16x32_bf16 v[216:219], a[20:23], a[40:43], v[216:219]
    v_mfma_f32_16x16x32_bf16 v[220:223], a[20:23], a[44:47], v[220:223]
    v_mul_f32 v117, v117, v100
    s_waitcnt lgkmcnt(13)
    v_mfma_f32_16x16x32_bf16 v[224:227], a[24:27], a[32:35], v[224:227]
    s_add_u32 s8, s80, s76
    v_mul_f32 v118, v118, v101
    v_mfma_f32_16x16x32_bf16 v[228:231], a[24:27], a[36:39], v[228:231]
    v_mfma_f32_16x16x32_bf16 v[232:235], a[24:27], a[40:43], v[232:235]
    v_cvt_pk_bf16_f32 v110, v108, v109
    v_mfma_f32_16x16x32_bf16 v[236:239], a[24:27], a[44:47], v[236:239]
    s_addc_u32 s9, s81, 0
    v_cvt_pk_bf16_f32 v113, v111, v112
    s_waitcnt lgkmcnt(12)
    v_mfma_f32_16x16x32_bf16 v[240:243], a[28:31], a[32:35], v[240:243]
    v_mfma_f32_16x16x32_bf16 v[244:247], a[28:31], a[36:39], v[244:247]
    v_cvt_pk_bf16_f32 v116, v114, v115
    v_mfma_f32_16x16x32_bf16 v[248:251], a[28:31], a[40:43], v[248:251]
    v_mfma_f32_16x16x32_bf16 v[252:255], a[28:31], a[44:47], v[252:255]
    s_waitcnt lgkmcnt(10)
    v_mfma_f32_16x16x32_bf16 v[128:131], a[48:51], a[80:83], v[128:131]
    v_cvt_pk_bf16_f32 v119, v117, v118
    s_waitcnt lgkmcnt(9)
    v_mfma_f32_16x16x32_bf16 v[132:135], a[48:51], a[84:87], v[132:135]
    s_waitcnt lgkmcnt(8)
    v_mfma_f32_16x16x32_bf16 v[136:139], a[48:51], a[88:91], v[136:139]
    v_lshlrev_b32 v108, 16, v110
    s_waitcnt lgkmcnt(7)
    v_mfma_f32_16x16x32_bf16 v[140:143], a[48:51], a[92:95], v[140:143]
    s_waitcnt lgkmcnt(6)
    v_mfma_f32_16x16x32_bf16 v[144:147], a[52:55], a[80:83], v[144:147]
    v_and_b32 v109, 0xffff0000, v110
    v_mfma_f32_16x16x32_bf16 v[148:151], a[52:55], a[84:87], v[148:151]
    s_waitcnt lgkmcnt(0)
    s_waitcnt vmcnt(12)
    s_barrier
    v_mfma_f32_16x16x32_bf16 v[152:155], a[52:55], a[88:91], v[152:155]
    ds_read_b128 a[0:3], v10 offset:0
    v_mfma_f32_16x16x32_bf16 v[156:159], a[52:55], a[92:95], v[156:159]
    ds_read_b128 a[32:35], v12 offset:32768
    s_add_u32 m0, s49, 16384
    v_lshlrev_b32 v111, 16, v113
    v_mfma_f32_16x16x32_bf16 v[160:163], a[56:59], a[80:83], v[160:163]
    ds_read_b128 a[36:39], v12 offset:34816
    buffer_load_dwordx4 v4, s[12:15], s24 offen offset:0 lds
    v_and_b32 v112, 0xffff0000, v113
    v_mfma_f32_16x16x32_bf16 v[164:167], a[56:59], a[84:87], v[164:167]
    ds_read_b128 a[40:43], v12 offset:40960
    v_mfma_f32_16x16x32_bf16 v[168:171], a[56:59], a[88:91], v[168:171]
    buffer_load_dwordx4 v5, s[12:15], s25 offen offset:1024 lds
    v_lshlrev_b32 v114, 16, v116
    v_mfma_f32_16x16x32_bf16 v[172:175], a[56:59], a[92:95], v[172:175]
    ds_read_b128 a[44:47], v12 offset:43008
    v_and_b32 v115, 0xffff0000, v116
    v_mfma_f32_16x16x32_bf16 v[176:179], a[60:63], a[80:83], v[176:179]
    ds_read_b128 a[4:7], v10 offset:2048
    buffer_load_dwordx4 v4, s[12:15], s26 offen offset:2048 lds
    v_mfma_f32_16x16x32_bf16 v[180:183], a[60:63], a[84:87], v[180:183]
    ds_read_b128 a[8:11], v10 offset:4096
    buffer_load_dwordx4 v5, s[12:15], s27 offen offset:3072 lds
    v_lshlrev_b32 v117, 16, v119
    v_mfma_f32_16x16x32_bf16 v[184:187], a[60:63], a[88:91], v[184:187]
    ds_read_b128 a[12:15], v10 offset:6144
    v_and_b32 v118, 0xffff0000, v119
    v_mfma_f32_16x16x32_bf16 v[188:191], a[60:63], a[92:95], v[188:191]
    s_add_u32 s77, s77, 128
    v_mfma_f32_16x16x32_bf16 v[192:195], a[64:67], a[80:83], v[192:195]
    ds_read_b128 a[16:19], v10 offset:8192
    v_add_f32 v104, v104, v108
    v_mfma_f32_16x16x32_bf16 v[196:199], a[64:67], a[84:87], v[196:199]
    ds_read_b128 a[20:23], v10 offset:10240
    s_and_b32 s77, s77, 2047
    v_add_f32 v105, v105, v111
    v_mfma_f32_16x16x32_bf16 v[200:203], a[64:67], a[88:91], v[200:203]
    ds_read_b128 a[24:27], v10 offset:12288
    v_mfma_f32_16x16x32_bf16 v[204:207], a[64:67], a[92:95], v[204:207]
    ds_read_b128 a[28:31], v10 offset:14336
    s_add_u32 s12, s68, s77
    v_add_f32 v106, v106, v114
    v_mfma_f32_16x16x32_bf16 v[208:211], a[68:71], a[80:83], v[208:211]
    s_addc_u32 s13, s69, 0
    v_add_f32 v107, v107, v117
    v_mfma_f32_16x16x32_bf16 v[212:215], a[68:71], a[84:87], v[212:215]
    v_mfma_f32_16x16x32_bf16 v[216:219], a[68:71], a[88:91], v[216:219]
    s_add_u32 m0, s48, 32768
    v_add_f32 v104, v104, v109
    v_mfma_f32_16x16x32_bf16 v[220:223], a[68:71], a[92:95], v[220:223]
    v_add_f32 v105, v105, v112
    v_mfma_f32_16x16x32_bf16 v[224:227], a[72:75], a[80:83], v[224:227]
    buffer_load_dwordx4 v2, s[8:11], s16 offen offset:0 lds
    v_mfma_f32_16x16x32_bf16 v[228:231], a[72:75], a[84:87], v[228:231]
    buffer_load_dwordx4 v3, s[8:11], s17 offen offset:1024 lds
    v_add_f32 v106, v106, v115
    v_mfma_f32_16x16x32_bf16 v[232:235], a[72:75], a[88:91], v[232:235]
    v_add_f32 v107, v107, v118
    v_mfma_f32_16x16x32_bf16 v[236:239], a[72:75], a[92:95], v[236:239]
    buffer_load_dwordx4 v2, s[8:11], s18 offen offset:2048 lds
    v_mfma_f32_16x16x32_bf16 v[240:243], a[76:79], a[80:83], v[240:243]
    v_lshlrev_b32 v108, 16, v47
    v_mfma_f32_16x16x32_bf16 v[244:247], a[76:79], a[84:87], v[244:247]
    buffer_load_dwordx4 v3, s[8:11], s19 offen offset:3072 lds
    v_and_b32 v109, 0xffff0000, v47
    v_mfma_f32_16x16x32_bf16 v[248:251], a[76:79], a[88:91], v[248:251]
    v_mfma_f32_16x16x32_bf16 v[252:255], a[76:79], a[92:95], v[252:255]
    s_waitcnt lgkmcnt(10)
    v_mfma_f32_16x16x32_bf16 v[128:131], a[0:3], a[32:35], v[128:131]
    ds_read_b128 a[48:51], v11 offset:0
    s_waitcnt lgkmcnt(10)
    v_mfma_f32_16x16x32_bf16 v[132:135], a[0:3], a[36:39], v[132:135]
    ds_read_b128 a[80:83], v13 offset:32768
    s_add_u32 m0, s48, 36864
    v_lshlrev_b32 v111, 16, v55
    s_waitcnt lgkmcnt(10)
    v_mfma_f32_16x16x32_bf16 v[136:139], a[0:3], a[40:43], v[136:139]
    v_and_b32 v112, 0xffff0000, v55
    s_waitcnt lgkmcnt(9)
    v_mfma_f32_16x16x32_bf16 v[140:143], a[0:3], a[44:47], v[140:143]
    ds_read_b128 a[84:87], v13 offset:34816
    s_waitcnt lgkmcnt(9)
    v_mfma_f32_16x16x32_bf16 v[144:147], a[4:7], a[32:35], v[144:147]
    ds_read_b128 a[88:91], v13 offset:40960
    buffer_load_dwordx4 v2, s[8:11], s20 offen offset:0 lds
    v_lshlrev_b32 v114, 16, v63
    v_mfma_f32_16x16x32_bf16 v[148:151], a[4:7], a[36:39], v[148:151]
    v_and_b32 v115, 0xffff0000, v63
    v_mfma_f32_16x16x32_bf16 v[152:155], a[4:7], a[40:43], v[152:155]
    ds_read_b128 a[92:95], v13 offset:43008
    v_mfma_f32_16x16x32_bf16 v[156:159], a[4:7], a[44:47], v[156:159]
    ds_read_b128 a[52:55], v11 offset:2048
    buffer_load_dwordx4 v3, s[8:11], s21 offen offset:1024 lds
    v_lshlrev_b32 v117, 16, v71
    s_waitcnt lgkmcnt(11)
    v_mfma_f32_16x16x32_bf16 v[160:163], a[8:11], a[32:35], v[160:163]
    v_and_b32 v118, 0xffff0000, v71
    v_mfma_f32_16x16x32_bf16 v[164:167], a[8:11], a[36:39], v[164:167]
    ds_read_b128 a[56:59], v11 offset:4096
    v_mfma_f32_16x16x32_bf16 v[168:171], a[8:11], a[40:43], v[168:171]
    v_mul_f32 v108, v108, v102
    v_mfma_f32_16x16x32_bf16 v[172:175], a[8:11], a[44:47], v[172:175]
    ds_read_b128 a[60:63], v11 offset:6144
    buffer_load_dwordx4 v2, s[8:11], s22 offen offset:2048 lds
    s_waitcnt lgkmcnt(12)
    v_mfma_f32_16x16x32_bf16 v[176:179], a[12:15], a[32:35], v[176:179]
    ds_read_b128 a[64:67], v11 offset:8192
    v_mul_f32 v109, v109, v103
    v_mfma_f32_16x16x32_bf16 v[180:183], a[12:15], a[36:39], v[180:183]
    v_mul_f32 v111, v111, v102
    v_mfma_f32_16x16x32_bf16 v[184:187], a[12:15], a[40:43], v[184:187]
    ds_read_b128 a[68:71], v11 offset:10240
    buffer_load_dwordx4 v3, s[8:11], s23 offen offset:3072 lds
    v_mfma_f32_16x16x32_bf16 v[188:191], a[12:15], a[44:47], v[188:191]
    ds_read_b128 a[72:75], v11 offset:12288
    v_mul_f32 v112, v112, v103
    s_waitcnt lgkmcnt(14)
    v_mfma_f32_16x16x32_bf16 v[192:195], a[16:19], a[32:35], v[192:195]
    v_mul_f32 v114, v114, v102
    v_mfma_f32_16x16x32_bf16 v[196:199], a[16:19], a[36:39], v[196:199]
    ds_read_b128 a[76:79], v11 offset:14336
    s_add_u32 s76, s76, 128
    v_mfma_f32_16x16x32_bf16 v[200:203], a[16:19], a[40:43], v[200:203]
    v_mul_f32 v115, v115, v103
    v_mfma_f32_16x16x32_bf16 v[204:207], a[16:19], a[44:47], v[204:207]
    v_mul_f32 v117, v117, v102
    s_waitcnt lgkmcnt(14)
    v_mfma_f32_16x16x32_bf16 v[208:211], a[20:23], a[32:35], v[208:211]
    v_mfma_f32_16x16x32_bf16 v[212:215], a[20:23], a[36:39], v[212:215]
    s_and_b32 s76, s76, 2047
    v_mul_f32 v118, v118, v103
    v_mfma_f32_16x16x32_bf16 v[216:219], a[20:23], a[40:43], v[216:219]
    v_mfma_f32_16x16x32_bf16 v[220:223], a[20:23], a[44:47], v[220:223]
    v_cvt_pk_bf16_f32 v110, v108, v109
    s_waitcnt lgkmcnt(13)
    v_mfma_f32_16x16x32_bf16 v[224:227], a[24:27], a[32:35], v[224:227]
    s_add_u32 s8, s80, s76
    v_cvt_pk_bf16_f32 v113, v111, v112
    v_mfma_f32_16x16x32_bf16 v[228:231], a[24:27], a[36:39], v[228:231]
    v_mfma_f32_16x16x32_bf16 v[232:235], a[24:27], a[40:43], v[232:235]
    v_cvt_pk_bf16_f32 v116, v114, v115
    v_mfma_f32_16x16x32_bf16 v[236:239], a[24:27], a[44:47], v[236:239]
    s_addc_u32 s9, s81, 0
    v_cvt_pk_bf16_f32 v119, v117, v118
    s_waitcnt lgkmcnt(12)
    v_mfma_f32_16x16x32_bf16 v[240:243], a[28:31], a[32:35], v[240:243]
    v_mfma_f32_16x16x32_bf16 v[244:247], a[28:31], a[36:39], v[244:247]
    v_lshlrev_b32 v108, 16, v110
    v_mfma_f32_16x16x32_bf16 v[248:251], a[28:31], a[40:43], v[248:251]
    v_mfma_f32_16x16x32_bf16 v[252:255], a[28:31], a[44:47], v[252:255]
    s_waitcnt lgkmcnt(10)
    v_mfma_f32_16x16x32_bf16 v[128:131], a[48:51], a[80:83], v[128:131]
    v_and_b32 v109, 0xffff0000, v110
    s_waitcnt lgkmcnt(9)
    v_mfma_f32_16x16x32_bf16 v[132:135], a[48:51], a[84:87], v[132:135]
    s_waitcnt lgkmcnt(8)
    v_mfma_f32_16x16x32_bf16 v[136:139], a[48:51], a[88:91], v[136:139]
    v_lshlrev_b32 v111, 16, v113
    s_waitcnt lgkmcnt(7)
    v_mfma_f32_16x16x32_bf16 v[140:143], a[48:51], a[92:95], v[140:143]
    s_waitcnt lgkmcnt(6)
    v_mfma_f32_16x16x32_bf16 v[144:147], a[52:55], a[80:83], v[144:147]
    v_and_b32 v112, 0xffff0000, v113
    v_mfma_f32_16x16x32_bf16 v[148:151], a[52:55], a[84:87], v[148:151]
    s_waitcnt lgkmcnt(0)
    s_waitcnt vmcnt(12)
    s_barrier
    v_mfma_f32_16x16x32_bf16 v[152:155], a[52:55], a[88:91], v[152:155]
    ds_read_b128 a[0:3], v8 offset:0
    v_mfma_f32_16x16x32_bf16 v[156:159], a[52:55], a[92:95], v[156:159]
    ds_read_b128 a[32:35], v12 offset:0
    s_add_u32 m0, s49, 32768
    v_lshlrev_b32 v114, 16, v116
    v_mfma_f32_16x16x32_bf16 v[160:163], a[56:59], a[80:83], v[160:163]
    ds_read_b128 a[36:39], v12 offset:2048
    buffer_load_dwordx4 v4, s[12:15], s24 offen offset:0 lds
    v_and_b32 v115, 0xffff0000, v116
    v_mfma_f32_16x16x32_bf16 v[164:167], a[56:59], a[84:87], v[164:167]
    ds_read_b128 a[40:43], v12 offset:8192
    v_mfma_f32_16x16x32_bf16 v[168:171], a[56:59], a[88:91], v[168:171]
    buffer_load_dwordx4 v5, s[12:15], s25 offen offset:1024 lds
    v_lshlrev_b32 v117, 16, v119
    v_mfma_f32_16x16x32_bf16 v[172:175], a[56:59], a[92:95], v[172:175]
    ds_read_b128 a[44:47], v12 offset:10240
    v_and_b32 v118, 0xffff0000, v119
    v_mfma_f32_16x16x32_bf16 v[176:179], a[60:63], a[80:83], v[176:179]
    ds_read_b128 a[4:7], v8 offset:2048
    buffer_load_dwordx4 v4, s[12:15], s26 offen offset:2048 lds
    v_mfma_f32_16x16x32_bf16 v[180:183], a[60:63], a[84:87], v[180:183]
    ds_read_b128 a[8:11], v8 offset:4096
    buffer_load_dwordx4 v5, s[12:15], s27 offen offset:3072 lds
    v_add_f32 v104, v104, v108
    v_mfma_f32_16x16x32_bf16 v[184:187], a[60:63], a[88:91], v[184:187]
    ds_read_b128 a[12:15], v8 offset:6144
    v_add_f32 v105, v105, v111
    v_mfma_f32_16x16x32_bf16 v[188:191], a[60:63], a[92:95], v[188:191]
    s_add_u32 s77, s77, 128
    v_mfma_f32_16x16x32_bf16 v[192:195], a[64:67], a[80:83], v[192:195]
    ds_read_b128 a[16:19], v8 offset:8192
    v_add_f32 v106, v106, v114
    v_mfma_f32_16x16x32_bf16 v[196:199], a[64:67], a[84:87], v[196:199]
    ds_read_b128 a[20:23], v8 offset:10240
    s_and_b32 s77, s77, 2047
    v_add_f32 v107, v107, v117
    v_mfma_f32_16x16x32_bf16 v[200:203], a[64:67], a[88:91], v[200:203]
    ds_read_b128 a[24:27], v8 offset:12288
    v_mfma_f32_16x16x32_bf16 v[204:207], a[64:67], a[92:95], v[204:207]
    ds_read_b128 a[28:31], v8 offset:14336
    s_add_u32 s12, s68, s77
    v_add_f32 v104, v104, v109
    v_mfma_f32_16x16x32_bf16 v[208:211], a[68:71], a[80:83], v[208:211]
    s_addc_u32 s13, s69, 0
    v_add_f32 v105, v105, v112
    v_mfma_f32_16x16x32_bf16 v[212:215], a[68:71], a[84:87], v[212:215]
    v_mfma_f32_16x16x32_bf16 v[216:219], a[68:71], a[88:91], v[216:219]
    s_add_u32 m0, s48, 65536
    v_add_f32 v106, v106, v115
    v_mfma_f32_16x16x32_bf16 v[220:223], a[68:71], a[92:95], v[220:223]
    v_add_f32 v107, v107, v118
    v_mfma_f32_16x16x32_bf16 v[224:227], a[72:75], a[80:83], v[224:227]
    buffer_load_dwordx4 v2, s[8:11], s16 offen offset:0 lds
    v_mfma_f32_16x16x32_bf16 v[228:231], a[72:75], a[84:87], v[228:231]
    buffer_load_dwordx4 v3, s[8:11], s17 offen offset:1024 lds
    v_add_f32_dpp v104, v104, v104 row_shr:1 row_mask:0xf bank_mask:0xf bound_ctrl:0
    v_mfma_f32_16x16x32_bf16 v[232:235], a[72:75], a[88:91], v[232:235]
    v_add_f32_dpp v105, v105, v105 row_shr:1 row_mask:0xf bank_mask:0xf bound_ctrl:0
    v_mfma_f32_16x16x32_bf16 v[236:239], a[72:75], a[92:95], v[236:239]
    buffer_load_dwordx4 v2, s[8:11], s18 offen offset:2048 lds
    v_mfma_f32_16x16x32_bf16 v[240:243], a[76:79], a[80:83], v[240:243]
    v_add_f32_dpp v106, v106, v106 row_shr:1 row_mask:0xf bank_mask:0xf bound_ctrl:0
    v_mfma_f32_16x16x32_bf16 v[244:247], a[76:79], a[84:87], v[244:247]
    buffer_load_dwordx4 v3, s[8:11], s19 offen offset:3072 lds
    v_add_f32_dpp v107, v107, v107 row_shr:1 row_mask:0xf bank_mask:0xf bound_ctrl:0
    v_mfma_f32_16x16x32_bf16 v[248:251], a[76:79], a[88:91], v[248:251]
    v_mfma_f32_16x16x32_bf16 v[252:255], a[76:79], a[92:95], v[252:255]
    s_waitcnt lgkmcnt(10)
    v_mfma_f32_16x16x32_bf16 v[128:131], a[0:3], a[32:35], v[128:131]
    ds_read_b128 a[48:51], v9 offset:0
    s_waitcnt lgkmcnt(10)
    v_mfma_f32_16x16x32_bf16 v[132:135], a[0:3], a[36:39], v[132:135]
    ds_read_b128 a[80:83], v13 offset:0
    s_add_u32 m0, s48, 69632
    v_add_f32_dpp v104, v104, v104 row_shr:2 row_mask:0xf bank_mask:0xf bound_ctrl:0
    s_waitcnt lgkmcnt(10)
    v_mfma_f32_16x16x32_bf16 v[136:139], a[0:3], a[40:43], v[136:139]
    v_add_f32_dpp v105, v105, v105 row_shr:2 row_mask:0xf bank_mask:0xf bound_ctrl:0
    s_waitcnt lgkmcnt(9)
    v_mfma_f32_16x16x32_bf16 v[140:143], a[0:3], a[44:47], v[140:143]
    ds_read_b128 a[84:87], v13 offset:2048
    s_waitcnt lgkmcnt(9)
    v_mfma_f32_16x16x32_bf16 v[144:147], a[4:7], a[32:35], v[144:147]
    ds_read_b128 a[88:91], v13 offset:8192
    buffer_load_dwordx4 v2, s[8:11], s20 offen offset:0 lds
    v_add_f32_dpp v106, v106, v106 row_shr:2 row_mask:0xf bank_mask:0xf bound_ctrl:0
    v_mfma_f32_16x16x32_bf16 v[148:151], a[4:7], a[36:39], v[148:151]
    v_add_f32_dpp v107, v107, v107 row_shr:2 row_mask:0xf bank_mask:0xf bound_ctrl:0
    v_mfma_f32_16x16x32_bf16 v[152:155], a[4:7], a[40:43], v[152:155]
    ds_read_b128 a[92:95], v13 offset:10240
    v_mfma_f32_16x16x32_bf16 v[156:159], a[4:7], a[44:47], v[156:159]
    ds_read_b128 a[52:55], v9 offset:2048
    buffer_load_dwordx4 v3, s[8:11], s21 offen offset:1024 lds
    v_add_f32_dpp v104, v104, v104 row_shr:4 row_mask:0xf bank_mask:0xf bound_ctrl:0
    s_waitcnt lgkmcnt(11)
    v_mfma_f32_16x16x32_bf16 v[160:163], a[8:11], a[32:35], v[160:163]
    v_add_f32_dpp v105, v105, v105 row_shr:4 row_mask:0xf bank_mask:0xf bound_ctrl:0
    v_mfma_f32_16x16x32_bf16 v[164:167], a[8:11], a[36:39], v[164:167]
    ds_read_b128 a[56:59], v9 offset:4096
    v_mfma_f32_16x16x32_bf16 v[168:171], a[8:11], a[40:43], v[168:171]
    v_add_f32_dpp v106, v106, v106 row_shr:4 row_mask:0xf bank_mask:0xf bound_ctrl:0
    v_mfma_f32_16x16x32_bf16 v[172:175], a[8:11], a[44:47], v[172:175]
    ds_read_b128 a[60:63], v9 offset:6144
    buffer_load_dwordx4 v2, s[8:11], s22 offen offset:2048 lds
    s_waitcnt lgkmcnt(12)
    v_mfma_f32_16x16x32_bf16 v[176:179], a[12:15], a[32:35], v[176:179]
    ds_read_b128 a[64:67], v9 offset:8192
    v_add_f32_dpp v107, v107, v107 row_shr:4 row_mask:0xf bank_mask:0xf bound_ctrl:0
    v_mfma_f32_16x16x32_bf16 v[180:183], a[12:15], a[36:39], v[180:183]
    v_add_f32_dpp v104, v104, v104 row_shr:8 row_mask:0xf bank_mask:0xf bound_ctrl:0
    v_mfma_f32_16x16x32_bf16 v[184:187], a[12:15], a[40:43], v[184:187]
    ds_read_b128 a[68:71], v9 offset:10240
    buffer_load_dwordx4 v3, s[8:11], s23 offen offset:3072 lds
    v_mfma_f32_16x16x32_bf16 v[188:191], a[12:15], a[44:47], v[188:191]
    ds_read_b128 a[72:75], v9 offset:12288
    v_add_f32_dpp v105, v105, v105 row_shr:8 row_mask:0xf bank_mask:0xf bound_ctrl:0
    s_waitcnt lgkmcnt(14)
    v_mfma_f32_16x16x32_bf16 v[192:195], a[16:19], a[32:35], v[192:195]
    v_add_f32_dpp v106, v106, v106 row_shr:8 row_mask:0xf bank_mask:0xf bound_ctrl:0
    v_mfma_f32_16x16x32_bf16 v[196:199], a[16:19], a[36:39], v[196:199]
    ds_read_b128 a[76:79], v9 offset:14336
    s_add_u32 s76, s76, 128
    v_mfma_f32_16x16x32_bf16 v[200:203], a[16:19], a[40:43], v[200:203]
    v_add_f32_dpp v107, v107, v107 row_shr:8 row_mask:0xf bank_mask:0xf bound_ctrl:0
    v_mfma_f32_16x16x32_bf16 v[204:207], a[16:19], a[44:47], v[204:207]
    v_add_f32_dpp v104, v104, v104 row_bcast:15 row_mask:0xa bank_mask:0xf
    s_waitcnt lgkmcnt(14)
    v_mfma_f32_16x16x32_bf16 v[208:211], a[20:23], a[32:35], v[208:211]
    v_mfma_f32_16x16x32_bf16 v[212:215], a[20:23], a[36:39], v[212:215]
    s_and_b32 s76, s76, 2047
    v_add_f32_dpp v105, v105, v105 row_bcast:15 row_mask:0xa bank_mask:0xf
    v_mfma_f32_16x16x32_bf16 v[216:219], a[20:23], a[40:43], v[216:219]
    v_mfma_f32_16x16x32_bf16 v[220:223], a[20:23], a[44:47], v[220:223]
    v_add_f32_dpp v106, v106, v106 row_bcast:15 row_mask:0xa bank_mask:0xf
    s_waitcnt lgkmcnt(13)
    v_mfma_f32_16x16x32_bf16 v[224:227], a[24:27], a[32:35], v[224:227]
    s_add_u32 s8, s80, s76
    v_add_f32_dpp v107, v107, v107 row_bcast:15 row_mask:0xa bank_mask:0xf
    v_mfma_f32_16x16x32_bf16 v[228:231], a[24:27], a[36:39], v[228:231]
    v_mfma_f32_16x16x32_bf16 v[232:235], a[24:27], a[40:43], v[232:235]
    v_add_f32_dpp v104, v104, v104 row_bcast:31 row_mask:0xc bank_mask:0xf
    v_mfma_f32_16x16x32_bf16 v[236:239], a[24:27], a[44:47], v[236:239]
    s_addc_u32 s9, s81, 0
    v_add_f32_dpp v105, v105, v105 row_bcast:31 row_mask:0xc bank_mask:0xf
    s_waitcnt lgkmcnt(12)
    v_mfma_f32_16x16x32_bf16 v[240:243], a[28:31], a[32:35], v[240:243]
    v_mfma_f32_16x16x32_bf16 v[244:247], a[28:31], a[36:39], v[244:247]
    v_add_f32_dpp v106, v106, v106 row_bcast:31 row_mask:0xc bank_mask:0xf
    v_mfma_f32_16x16x32_bf16 v[248:251], a[28:31], a[40:43], v[248:251]
    v_mfma_f32_16x16x32_bf16 v[252:255], a[28:31], a[44:47], v[252:255]
    s_waitcnt lgkmcnt(10)
    v_mfma_f32_16x16x32_bf16 v[128:131], a[48:51], a[80:83], v[128:131]
    v_add_f32_dpp v107, v107, v107 row_bcast:31 row_mask:0xc bank_mask:0xf
    s_waitcnt lgkmcnt(9)
    v_mfma_f32_16x16x32_bf16 v[132:135], a[48:51], a[84:87], v[132:135]
    s_waitcnt lgkmcnt(8)
    v_mfma_f32_16x16x32_bf16 v[136:139], a[48:51], a[88:91], v[136:139]
    v_cvt_pk_bf16_f32 v108, v104, v105
    s_waitcnt lgkmcnt(7)
    v_mfma_f32_16x16x32_bf16 v[140:143], a[48:51], a[92:95], v[140:143]
    s_waitcnt lgkmcnt(6)
    v_mfma_f32_16x16x32_bf16 v[144:147], a[52:55], a[80:83], v[144:147]
    v_cvt_pk_bf16_f32 v109, v106, v107
    v_mfma_f32_16x16x32_bf16 v[148:151], a[52:55], a[84:87], v[148:151]
    s_waitcnt lgkmcnt(0)
    s_waitcnt vmcnt(12)
    s_barrier
    v_mfma_f32_16x16x32_bf16 v[152:155], a[52:55], a[88:91], v[152:155]
    ds_read_b128 a[0:3], v8 offset:32768
    v_mfma_f32_16x16x32_bf16 v[156:159], a[52:55], a[92:95], v[156:159]
    ds_read_b128 a[32:35], v12 offset:16384
    s_add_u32 m0, s49, 0
    v_lshlrev_b32 v104, 16, v108
    v_mfma_f32_16x16x32_bf16 v[160:163], a[56:59], a[80:83], v[160:163]
    ds_read_b128 a[36:39], v12 offset:18432
    buffer_load_dwordx4 v4, s[12:15], s24 offen offset:0 lds
    v_and_b32 v105, 0xffff0000, v108
    v_mfma_f32_16x16x32_bf16 v[164:167], a[56:59], a[84:87], v[164:167]
    ds_read_b128 a[40:43], v12 offset:24576
    v_mfma_f32_16x16x32_bf16 v[168:171], a[56:59], a[88:91], v[168:171]
    buffer_load_dwordx4 v5, s[12:15], s25 offen offset:1024 lds
    v_lshlrev_b32 v106, 16, v109
    v_mfma_f32_16x16x32_bf16 v[172:175], a[56:59], a[92:95], v[172:175]
    ds_read_b128 a[44:47], v12 offset:26624
    v_and_b32 v107, 0xffff0000, v109
    v_mfma_f32_16x16x32_bf16 v[176:179], a[60:63], a[80:83], v[176:179]
    ds_read_b128 a[4:7], v8 offset:34816
    buffer_load_dwordx4 v4, s[12:15], s26 offen offset:2048 lds
    v_mfma_f32_16x16x32_bf16 v[180:183], a[60:63], a[84:87], v[180:183]
    ds_read_b128 a[8:11], v8 offset:36864
    buffer_load_dwordx4 v5, s[12:15], s27 offen offset:3072 lds
    v_mul_f32_e64 v104, -v104, s54
    v_mfma_f32_16x16x32_bf16 v[184:187], a[60:63], a[88:91], v[184:187]
    ds_read_b128 a[12:15], v8 offset:38912
    v_mul_f32_e64 v105, -v105, s54
    v_mfma_f32_16x16x32_bf16 v[188:191], a[60:63], a[92:95], v[188:191]
    s_add_u32 s77, s77, 128
    v_mfma_f32_16x16x32_bf16 v[192:195], a[64:67], a[80:83], v[192:195]
    ds_read_b128 a[16:19], v8 offset:40960
    v_mul_f32_e64 v106, -v106, s54
    v_mfma_f32_16x16x32_bf16 v[196:199], a[64:67], a[84:87], v[196:199]
    ds_read_b128 a[20:23], v8 offset:43008
    s_and_b32 s77, s77, 2047
    v_mul_f32_e64 v107, -v107, s54
    v_mfma_f32_16x16x32_bf16 v[200:203], a[64:67], a[88:91], v[200:203]
    ds_read_b128 a[24:27], v8 offset:45056
    v_mfma_f32_16x16x32_bf16 v[204:207], a[64:67], a[92:95], v[204:207]
    ds_read_b128 a[28:31], v8 offset:47104
    s_add_u32 s12, s68, s77
    v_exp_f32 v104, v104
    v_mfma_f32_16x16x32_bf16 v[208:211], a[68:71], a[80:83], v[208:211]
    s_addc_u32 s13, s69, 0
    v_exp_f32 v105, v105
    v_mfma_f32_16x16x32_bf16 v[212:215], a[68:71], a[84:87], v[212:215]
    v_mfma_f32_16x16x32_bf16 v[216:219], a[68:71], a[88:91], v[216:219]
    s_add_u32 m0, s48, 0
    v_exp_f32 v106, v106
    v_mfma_f32_16x16x32_bf16 v[220:223], a[68:71], a[92:95], v[220:223]
    v_exp_f32 v107, v107
    v_mfma_f32_16x16x32_bf16 v[224:227], a[72:75], a[80:83], v[224:227]
    buffer_load_dwordx4 v2, s[8:11], s16 offen offset:0 lds
    v_mfma_f32_16x16x32_bf16 v[228:231], a[72:75], a[84:87], v[228:231]
    buffer_load_dwordx4 v3, s[8:11], s17 offen offset:1024 lds
    s_nop 0
    v_mfma_f32_16x16x32_bf16 v[232:235], a[72:75], a[88:91], v[232:235]
    v_add_f32 v104, 1.0, v104
    v_mfma_f32_16x16x32_bf16 v[236:239], a[72:75], a[92:95], v[236:239]
    buffer_load_dwordx4 v2, s[8:11], s18 offen offset:2048 lds
    v_mfma_f32_16x16x32_bf16 v[240:243], a[76:79], a[80:83], v[240:243]
    v_add_f32 v105, 1.0, v105
    v_mfma_f32_16x16x32_bf16 v[244:247], a[76:79], a[84:87], v[244:247]
    buffer_load_dwordx4 v3, s[8:11], s19 offen offset:3072 lds
    v_add_f32 v106, 1.0, v106
    v_mfma_f32_16x16x32_bf16 v[248:251], a[76:79], a[88:91], v[248:251]
    v_mfma_f32_16x16x32_bf16 v[252:255], a[76:79], a[92:95], v[252:255]
    s_waitcnt lgkmcnt(10)
    v_mfma_f32_16x16x32_bf16 v[128:131], a[0:3], a[32:35], v[128:131]
    ds_read_b128 a[48:51], v9 offset:32768
    s_waitcnt lgkmcnt(10)
    v_mfma_f32_16x16x32_bf16 v[132:135], a[0:3], a[36:39], v[132:135]
    ds_read_b128 a[80:83], v13 offset:16384
    s_add_u32 m0, s48, 4096
    v_add_f32 v107, 1.0, v107
    s_waitcnt lgkmcnt(10)
    v_mfma_f32_16x16x32_bf16 v[136:139], a[0:3], a[40:43], v[136:139]
    v_rcp_f32 v104, v104
    s_waitcnt lgkmcnt(9)
    v_mfma_f32_16x16x32_bf16 v[140:143], a[0:3], a[44:47], v[140:143]
    ds_read_b128 a[84:87], v13 offset:18432
    s_waitcnt lgkmcnt(9)
    v_mfma_f32_16x16x32_bf16 v[144:147], a[4:7], a[32:35], v[144:147]
    ds_read_b128 a[88:91], v13 offset:24576
    buffer_load_dwordx4 v2, s[8:11], s20 offen offset:0 lds
    v_rcp_f32 v105, v105
    v_mfma_f32_16x16x32_bf16 v[148:151], a[4:7], a[36:39], v[148:151]
    v_rcp_f32 v106, v106
    v_mfma_f32_16x16x32_bf16 v[152:155], a[4:7], a[40:43], v[152:155]
    ds_read_b128 a[92:95], v13 offset:26624
    v_mfma_f32_16x16x32_bf16 v[156:159], a[4:7], a[44:47], v[156:159]
    ds_read_b128 a[52:55], v9 offset:34816
    buffer_load_dwordx4 v3, s[8:11], s21 offen offset:1024 lds
    v_rcp_f32 v107, v107
    s_waitcnt lgkmcnt(11)
    v_mfma_f32_16x16x32_bf16 v[160:163], a[8:11], a[32:35], v[160:163]
    s_nop 0
    v_mfma_f32_16x16x32_bf16 v[164:167], a[8:11], a[36:39], v[164:167]
    ds_read_b128 a[56:59], v9 offset:36864
    v_mfma_f32_16x16x32_bf16 v[168:171], a[8:11], a[40:43], v[168:171]
    v_cvt_pk_bf16_f32 v108, v104, v105
    v_mfma_f32_16x16x32_bf16 v[172:175], a[8:11], a[44:47], v[172:175]
    ds_read_b128 a[60:63], v9 offset:38912
    buffer_load_dwordx4 v2, s[8:11], s22 offen offset:2048 lds
    s_waitcnt lgkmcnt(12)
    v_mfma_f32_16x16x32_bf16 v[176:179], a[12:15], a[32:35], v[176:179]
    ds_read_b128 a[64:67], v9 offset:40960
    v_cvt_pk_bf16_f32 v109, v106, v107
    v_mfma_f32_16x16x32_bf16 v[180:183], a[12:15], a[36:39], v[180:183]
    v_lshlrev_b32 v104, 16, v108
    v_mfma_f32_16x16x32_bf16 v[184:187], a[12:15], a[40:43], v[184:187]
    ds_read_b128 a[68:71], v9 offset:43008
    buffer_load_dwordx4 v3, s[8:11], s23 offen offset:3072 lds
    v_mfma_f32_16x16x32_bf16 v[188:191], a[12:15], a[44:47], v[188:191]
    ds_read_b128 a[72:75], v9 offset:45056
    v_and_b32 v105, 0xffff0000, v108
    s_waitcnt lgkmcnt(14)
    v_mfma_f32_16x16x32_bf16 v[192:195], a[16:19], a[32:35], v[192:195]
    v_lshlrev_b32 v106, 16, v109
    v_mfma_f32_16x16x32_bf16 v[196:199], a[16:19], a[36:39], v[196:199]
    ds_read_b128 a[76:79], v9 offset:47104
    s_add_u32 s76, s76, 128
    v_mfma_f32_16x16x32_bf16 v[200:203], a[16:19], a[40:43], v[200:203]
    v_and_b32 v107, 0xffff0000, v109
    v_mfma_f32_16x16x32_bf16 v[204:207], a[16:19], a[44:47], v[204:207]
    v_lshlrev_b32 v80, 16, v80
    s_waitcnt lgkmcnt(14)
    v_mfma_f32_16x16x32_bf16 v[208:211], a[20:23], a[32:35], v[208:211]
    v_mfma_f32_16x16x32_bf16 v[212:215], a[20:23], a[36:39], v[212:215]
    s_and_b32 s76, s76, 2047
    v_lshlrev_b32 v82, 16, v82
    v_mfma_f32_16x16x32_bf16 v[216:219], a[20:23], a[40:43], v[216:219]
    v_mfma_f32_16x16x32_bf16 v[220:223], a[20:23], a[44:47], v[220:223]
    v_lshlrev_b32 v84, 16, v84
    s_waitcnt lgkmcnt(13)
    v_mfma_f32_16x16x32_bf16 v[224:227], a[24:27], a[32:35], v[224:227]
    s_add_u32 s8, s80, s76
    v_mul_f32 v84, s54, v84
    v_mfma_f32_16x16x32_bf16 v[228:231], a[24:27], a[36:39], v[228:231]
    v_mfma_f32_16x16x32_bf16 v[232:235], a[24:27], a[40:43], v[232:235]
    v_exp_f32 v84, v84
    v_mfma_f32_16x16x32_bf16 v[236:239], a[24:27], a[44:47], v[236:239]
    s_addc_u32 s9, s81, 0
    s_nop 0
    s_waitcnt lgkmcnt(12)
    v_mfma_f32_16x16x32_bf16 v[240:243], a[28:31], a[32:35], v[240:243]
    v_mfma_f32_16x16x32_bf16 v[244:247], a[28:31], a[36:39], v[244:247]
    v_cvt_pk_bf16_f32 v84, v84, v84
    v_mfma_f32_16x16x32_bf16 v[248:251], a[28:31], a[40:43], v[248:251]
    v_mfma_f32_16x16x32_bf16 v[252:255], a[28:31], a[44:47], v[252:255]
    s_waitcnt lgkmcnt(10)
    v_mfma_f32_16x16x32_bf16 v[128:131], a[48:51], a[80:83], v[128:131]
    v_lshlrev_b32 v84, 16, v84
    s_waitcnt lgkmcnt(9)
    v_mfma_f32_16x16x32_bf16 v[132:135], a[48:51], a[84:87], v[132:135]
    s_waitcnt lgkmcnt(8)
    v_mfma_f32_16x16x32_bf16 v[136:139], a[48:51], a[88:91], v[136:139]
    v_mul_f32 v40, v84, v80
    s_waitcnt lgkmcnt(7)
    v_mfma_f32_16x16x32_bf16 v[140:143], a[48:51], a[92:95], v[140:143]
    s_waitcnt lgkmcnt(6)
    v_mfma_f32_16x16x32_bf16 v[144:147], a[52:55], a[80:83], v[144:147]
    v_mul_f32 v41, v84, v82
    v_mfma_f32_16x16x32_bf16 v[148:151], a[52:55], a[84:87], v[148:151]
    s_waitcnt lgkmcnt(0)
    s_waitcnt vmcnt(12)
    s_barrier
    v_mfma_f32_16x16x32_bf16 v[152:155], a[52:55], a[88:91], v[152:155]
    ds_read_b128 a[0:3], v10 offset:0
    v_mfma_f32_16x16x32_bf16 v[156:159], a[52:55], a[92:95], v[156:159]
    ds_read_b128 a[32:35], v12 offset:32768
    s_add_u32 m0, s49, 16384
    v_mul_f32 v40, s54, v40
    v_mfma_f32_16x16x32_bf16 v[160:163], a[56:59], a[80:83], v[160:163]
    ds_read_b128 a[36:39], v12 offset:34816
    buffer_load_dwordx4 v4, s[12:15], s24 offen offset:0 lds
    v_exp_f32 v40, v40
    v_mfma_f32_16x16x32_bf16 v[164:167], a[56:59], a[84:87], v[164:167]
    ds_read_b128 a[40:43], v12 offset:40960
    v_mfma_f32_16x16x32_bf16 v[168:171], a[56:59], a[88:91], v[168:171]
    buffer_load_dwordx4 v5, s[12:15], s25 offen offset:1024 lds
    v_mul_f32 v41, 0.15915494, v41
    v_mfma_f32_16x16x32_bf16 v[172:175], a[56:59], a[92:95], v[172:175]
    ds_read_b128 a[44:47], v12 offset:43008
    v_rndne_f32 v42, v41
    v_mfma_f32_16x16x32_bf16 v[176:179], a[60:63], a[80:83], v[176:179]
    ds_read_b128 a[4:7], v10 offset:2048
    buffer_load_dwordx4 v4, s[12:15], s26 offen offset:2048 lds
    v_mfma_f32_16x16x32_bf16 v[180:183], a[60:63], a[84:87], v[180:183]
    ds_read_b128 a[8:11], v10 offset:4096
    buffer_load_dwordx4 v5, s[12:15], s27 offen offset:3072 lds
    v_sub_f32 v41, v41, v42
    v_mfma_f32_16x16x32_bf16 v[184:187], a[60:63], a[88:91], v[184:187]
    ds_read_b128 a[12:15], v10 offset:6144
    v_cos_f32 v42, v41
    v_mfma_f32_16x16x32_bf16 v[188:191], a[60:63], a[92:95], v[188:191]
    s_add_u32 s77, s77, 128
    v_mfma_f32_16x16x32_bf16 v[192:195], a[64:67], a[80:83], v[192:195]
    ds_read_b128 a[16:19], v10 offset:8192
    v_sin_f32 v43, v41
    v_mfma_f32_16x16x32_bf16 v[196:199], a[64:67], a[84:87], v[196:199]
    ds_read_b128 a[20:23], v10 offset:10240
    s_and_b32 s77, s77, 2047
    s_nop 0
    v_mfma_f32_16x16x32_bf16 v[200:203], a[64:67], a[88:91], v[200:203]
    ds_read_b128 a[24:27], v10 offset:12288
    v_mfma_f32_16x16x32_bf16 v[204:207], a[64:67], a[92:95], v[204:207]
    ds_read_b128 a[28:31], v10 offset:14336
    s_add_u32 s12, s68, s77
    v_mul_f32 v20, v40, v42
    v_mfma_f32_16x16x32_bf16 v[208:211], a[68:71], a[80:83], v[208:211]
    s_addc_u32 s13, s69, 0
    v_mul_f32 v21, v40, v43
    v_mfma_f32_16x16x32_bf16 v[212:215], a[68:71], a[84:87], v[212:215]
    v_mfma_f32_16x16x32_bf16 v[216:219], a[68:71], a[88:91], v[216:219]
    s_add_u32 m0, s48, 32768
    v_add_f32 v40, -1.0, v20
    v_mfma_f32_16x16x32_bf16 v[220:223], a[68:71], a[92:95], v[220:223]
    v_mul_f32 v42, v80, v80
    v_mfma_f32_16x16x32_bf16 v[224:227], a[72:75], a[80:83], v[224:227]
    buffer_load_dwordx4 v2, s[8:11], s16 offen offset:0 lds
    v_mfma_f32_16x16x32_bf16 v[228:231], a[72:75], a[84:87], v[228:231]
    buffer_load_dwordx4 v3, s[8:11], s17 offen offset:1024 lds
    v_fma_f32 v42, v82, v82, v42
    v_mfma_f32_16x16x32_bf16 v[232:235], a[72:75], a[88:91], v[232:235]
    v_rcp_f32 v42, v42
    v_mfma_f32_16x16x32_bf16 v[236:239], a[72:75], a[92:95], v[236:239]
    buffer_load_dwordx4 v2, s[8:11], s18 offen offset:2048 lds
    v_mfma_f32_16x16x32_bf16 v[240:243], a[76:79], a[80:83], v[240:243]
    v_mul_f32 v43, v40, v80
    v_mfma_f32_16x16x32_bf16 v[244:247], a[76:79], a[84:87], v[244:247]
    buffer_load_dwordx4 v3, s[8:11], s19 offen offset:3072 lds
    v_fma_f32 v43, v21, v82, v43
    v_mfma_f32_16x16x32_bf16 v[248:251], a[76:79], a[88:91], v[248:251]
    v_mfma_f32_16x16x32_bf16 v[252:255], a[76:79], a[92:95], v[252:255]
    s_waitcnt lgkmcnt(10)
    v_mfma_f32_16x16x32_bf16 v[128:131], a[0:3], a[32:35], v[128:131]
    ds_read_b128 a[48:51], v11 offset:0
    s_waitcnt lgkmcnt(10)
    v_mfma_f32_16x16x32_bf16 v[132:135], a[0:3], a[36:39], v[132:135]
    ds_read_b128 a[80:83], v13 offset:32768
    s_add_u32 m0, s48, 36864
    v_mul_f32 v44, v40, v82
    s_waitcnt lgkmcnt(10)
    v_mfma_f32_16x16x32_bf16 v[136:139], a[0:3], a[40:43], v[136:139]
    v_fma_f32 v44, v21, v80, -v44
    s_waitcnt lgkmcnt(9)
    v_mfma_f32_16x16x32_bf16 v[140:143], a[0:3], a[44:47], v[140:143]
    ds_read_b128 a[84:87], v13 offset:34816
    s_waitcnt lgkmcnt(9)
    v_mfma_f32_16x16x32_bf16 v[144:147], a[4:7], a[32:35], v[144:147]
    ds_read_b128 a[88:91], v13 offset:40960
    buffer_load_dwordx4 v2, s[8:11], s20 offen offset:0 lds
    v_mul_f32 v28, v43, v42
    v_mfma_f32_16x16x32_bf16 v[148:151], a[4:7], a[36:39], v[148:151]
    v_mul_f32 v29, v44, v42
    v_mfma_f32_16x16x32_bf16 v[152:155], a[4:7], a[40:43], v[152:155]
    ds_read_b128 a[92:95], v13 offset:43008
    v_mfma_f32_16x16x32_bf16 v[156:159], a[4:7], a[44:47], v[156:159]
    ds_read_b128 a[52:55], v11 offset:2048
    buffer_load_dwordx4 v3, s[8:11], s21 offen offset:1024 lds
    v_mul_f32 v40, v21, v21
    s_waitcnt lgkmcnt(11)
    v_mfma_f32_16x16x32_bf16 v[160:163], a[8:11], a[32:35], v[160:163]
    v_mul_f32 v41, v21, v20
    v_mfma_f32_16x16x32_bf16 v[164:167], a[8:11], a[36:39], v[164:167]
    ds_read_b128 a[56:59], v11 offset:4096
    v_mfma_f32_16x16x32_bf16 v[168:171], a[8:11], a[40:43], v[168:171]
    v_fma_f32 v22, v20, v20, -v40
    v_mfma_f32_16x16x32_bf16 v[172:175], a[8:11], a[44:47], v[172:175]
    ds_read_b128 a[60:63], v11 offset:6144
    buffer_load_dwordx4 v2, s[8:11], s22 offen offset:2048 lds
    s_waitcnt lgkmcnt(12)
    v_mfma_f32_16x16x32_bf16 v[176:179], a[12:15], a[32:35], v[176:179]
    ds_read_b128 a[64:67], v11 offset:8192
    v_fma_f32 v23, v20, v21, v41
    v_mfma_f32_16x16x32_bf16 v[180:183], a[12:15], a[36:39], v[180:183]
    v_mul_f32 v40, v23, v23
    v_mfma_f32_16x16x32_bf16 v[184:187], a[12:15], a[40:43], v[184:187]
    ds_read_b128 a[68:71], v11 offset:10240
    buffer_load_dwordx4 v3, s[8:11], s23 offen offset:3072 lds
    v_mfma_f32_16x16x32_bf16 v[188:191], a[12:15], a[44:47], v[188:191]
    ds_read_b128 a[72:75], v11 offset:12288
    v_mul_f32 v41, v23, v22
    s_waitcnt lgkmcnt(14)
    v_mfma_f32_16x16x32_bf16 v[192:195], a[16:19], a[32:35], v[192:195]
    v_fma_f32 v42, v22, v22, -v40
    v_mfma_f32_16x16x32_bf16 v[196:199], a[16:19], a[36:39], v[196:199]
    ds_read_b128 a[76:79], v11 offset:14336
    s_add_u32 s76, s76, 128
    v_mfma_f32_16x16x32_bf16 v[200:203], a[16:19], a[40:43], v[200:203]
    v_fma_f32 v43, v22, v23, v41
    v_mfma_f32_16x16x32_bf16 v[204:207], a[16:19], a[44:47], v[204:207]
    v_mul_f32 v40, v43, v43
    s_waitcnt lgkmcnt(14)
    v_mfma_f32_16x16x32_bf16 v[208:211], a[20:23], a[32:35], v[208:211]
    v_mfma_f32_16x16x32_bf16 v[212:215], a[20:23], a[36:39], v[212:215]
    s_and_b32 s76, s76, 2047
    v_mul_f32 v41, v43, v42
    v_mfma_f32_16x16x32_bf16 v[216:219], a[20:23], a[40:43], v[216:219]
    v_mfma_f32_16x16x32_bf16 v[220:223], a[20:23], a[44:47], v[220:223]
    v_fma_f32 v44, v42, v42, -v40
    s_waitcnt lgkmcnt(13)
    v_mfma_f32_16x16x32_bf16 v[224:227], a[24:27], a[32:35], v[224:227]
    s_add_u32 s8, s80, s76
    v_fma_f32 v45, v42, v43, v41
    v_mfma_f32_16x16x32_bf16 v[228:231], a[24:27], a[36:39], v[228:231]
    v_mfma_f32_16x16x32_bf16 v[232:235], a[24:27], a[40:43], v[232:235]
    v_mul_f32 v40, v45, v45
    v_mfma_f32_16x16x32_bf16 v[236:239], a[24:27], a[44:47], v[236:239]
    s_addc_u32 s9, s81, 0
    v_mul_f32 v41, v45, v44
    s_waitcnt lgkmcnt(12)
    v_mfma_f32_16x16x32_bf16 v[240:243], a[28:31], a[32:35], v[240:243]
    v_mfma_f32_16x16x32_bf16 v[244:247], a[28:31], a[36:39], v[244:247]
    v_fma_f32 v42, v44, v44, -v40
    v_mfma_f32_16x16x32_bf16 v[248:251], a[28:31], a[40:43], v[248:251]
    v_mfma_f32_16x16x32_bf16 v[252:255], a[28:31], a[44:47], v[252:255]
    s_waitcnt lgkmcnt(10)
    v_mfma_f32_16x16x32_bf16 v[128:131], a[48:51], a[80:83], v[128:131]
    v_fma_f32 v43, v44, v45, v41
    s_waitcnt lgkmcnt(9)
    v_mfma_f32_16x16x32_bf16 v[132:135], a[48:51], a[84:87], v[132:135]
    s_waitcnt lgkmcnt(8)
    v_mfma_f32_16x16x32_bf16 v[136:139], a[48:51], a[88:91], v[136:139]
    v_mul_f32 v40, v43, v43
    s_waitcnt lgkmcnt(7)
    v_mfma_f32_16x16x32_bf16 v[140:143], a[48:51], a[92:95], v[140:143]
    s_waitcnt lgkmcnt(6)
    v_mfma_f32_16x16x32_bf16 v[144:147], a[52:55], a[80:83], v[144:147]
    v_mul_f32 v41, v43, v42
    v_mfma_f32_16x16x32_bf16 v[148:151], a[52:55], a[84:87], v[148:151]
    s_waitcnt lgkmcnt(0)
    s_waitcnt vmcnt(12)
    s_barrier
    v_mfma_f32_16x16x32_bf16 v[152:155], a[52:55], a[88:91], v[152:155]
    ds_read_b128 a[0:3], v8 offset:0
    v_mfma_f32_16x16x32_bf16 v[156:159], a[52:55], a[92:95], v[156:159]
    ds_read_b128 a[32:35], v12 offset:0
    s_add_u32 m0, s49, 32768
    v_fma_f32 v24, v42, v42, -v40
    v_mfma_f32_16x16x32_bf16 v[160:163], a[56:59], a[80:83], v[160:163]
    ds_read_b128 a[36:39], v12 offset:2048
    buffer_load_dwordx4 v4, s[12:15], s24 offen offset:0 lds
    v_fma_f32 v25, v42, v43, v41
    v_mfma_f32_16x16x32_bf16 v[164:167], a[56:59], a[84:87], v[164:167]
    ds_read_b128 a[40:43], v12 offset:8192
    v_mfma_f32_16x16x32_bf16 v[168:171], a[56:59], a[88:91], v[168:171]
    buffer_load_dwordx4 v5, s[12:15], s25 offen offset:1024 lds
    v_mul_f32 v40, v25, v25
    v_mfma_f32_16x16x32_bf16 v[172:175], a[56:59], a[92:95], v[172:175]
    ds_read_b128 a[44:47], v12 offset:10240
    v_mul_f32 v41, v25, v24
    v_mfma_f32_16x16x32_bf16 v[176:179], a[60:63], a[80:83], v[176:179]
    ds_read_b128 a[4:7], v8 offset:2048
    buffer_load_dwordx4 v4, s[12:15], s26 offen offset:2048 lds
    v_mfma_f32_16x16x32_bf16 v[180:183], a[60:63], a[84:87], v[180:183]
    ds_read_b128 a[8:11], v8 offset:4096
    buffer_load_dwordx4 v5, s[12:15], s27 offen offset:3072 lds
    v_fma_f32 v42, v24, v24, -v40
    v_mfma_f32_16x16x32_bf16 v[184:187], a[60:63], a[88:91], v[184:187]
    ds_read_b128 a[12:15], v8 offset:6144
    v_fma_f32 v43, v24, v25, v41
    v_mfma_f32_16x16x32_bf16 v[188:191], a[60:63], a[92:95], v[188:191]
    s_add_u32 s77, s77, 128
    v_mfma_f32_16x16x32_bf16 v[192:195], a[64:67], a[80:83], v[192:195]
    ds_read_b128 a[16:19], v8 offset:8192
    v_mul_f32 v40, v43, v43
    v_mfma_f32_16x16x32_bf16 v[196:199], a[64:67], a[84:87], v[196:199]
    ds_read_b128 a[20:23], v8 offset:10240
    s_and_b32 s77, s77, 2047
    v_mul_f32 v41, v43, v42
    v_mfma_f32_16x16x32_bf16 v[200:203], a[64:67], a[88:91], v[200:203]
    ds_read_b128 a[24:27], v8 offset:12288
    v_mfma_f32_16x16x32_bf16 v[204:207], a[64:67], a[92:95], v[204:207]
    ds_read_b128 a[28:31], v8 offset:14336
    s_add_u32 s12, s68, s77
    v_fma_f32 v44, v42, v42, -v40
    v_mfma_f32_16x16x32_bf16 v[208:211], a[68:71], a[80:83], v[208:211]
    s_addc_u32 s13, s69, 0
    v_fma_f32 v45, v42, v43, v41
    v_mfma_f32_16x16x32_bf16 v[212:215], a[68:71], a[84:87], v[212:215]
    v_mfma_f32_16x16x32_bf16 v[216:219], a[68:71], a[88:91], v[216:219]
    s_add_u32 m0, s48, 65536
    v_mul_f32 v40, v45, v45
    v_mfma_f32_16x16x32_bf16 v[220:223], a[68:71], a[92:95], v[220:223]
    v_mul_f32 v41, v45, v44
    v_mfma_f32_16x16x32_bf16 v[224:227], a[72:75], a[80:83], v[224:227]
    buffer_load_dwordx4 v2, s[8:11], s16 offen offset:0 lds
    v_mfma_f32_16x16x32_bf16 v[228:231], a[72:75], a[84:87], v[228:231]
    buffer_load_dwordx4 v3, s[8:11], s17 offen offset:1024 lds
    v_fma_f32 v26, v44, v44, -v40
    v_mfma_f32_16x16x32_bf16 v[232:235], a[72:75], a[88:91], v[232:235]
    v_fma_f32 v27, v44, v45, v41
    v_mfma_f32_16x16x32_bf16 v[236:239], a[72:75], a[92:95], v[236:239]
    buffer_load_dwordx4 v2, s[8:11], s18 offen offset:2048 lds
    v_mfma_f32_16x16x32_bf16 v[240:243], a[76:79], a[80:83], v[240:243]
    v_lshlrev_b32 v81, 16, v81
    v_mfma_f32_16x16x32_bf16 v[244:247], a[76:79], a[84:87], v[244:247]
    buffer_load_dwordx4 v3, s[8:11], s19 offen offset:3072 lds
    v_lshlrev_b32 v83, 16, v83
    v_mfma_f32_16x16x32_bf16 v[248:251], a[76:79], a[88:91], v[248:251]
    v_mfma_f32_16x16x32_bf16 v[252:255], a[76:79], a[92:95], v[252:255]
    s_waitcnt lgkmcnt(10)
    v_mfma_f32_16x16x32_bf16 v[128:131], a[0:3], a[32:35], v[128:131]
    ds_read_b128 a[48:51], v9 offset:0
    s_waitcnt lgkmcnt(10)
    v_mfma_f32_16x16x32_bf16 v[132:135], a[0:3], a[36:39], v[132:135]
    ds_read_b128 a[80:83], v13 offset:0
    s_add_u32 m0, s48, 69632
    v_lshlrev_b32 v85, 16, v85
    s_waitcnt lgkmcnt(10)
    v_mfma_f32_16x16x32_bf16 v[136:139], a[0:3], a[40:43], v[136:139]
    v_mul_f32 v85, s54, v85
    s_waitcnt lgkmcnt(9)
    v_mfma_f32_16x16x32_bf16 v[140:143], a[0:3], a[44:47], v[140:143]
    ds_read_b128 a[84:87], v13 offset:2048
    s_waitcnt lgkmcnt(9)
    v_mfma_f32_16x16x32_bf16 v[144:147], a[4:7], a[32:35], v[144:147]
    ds_read_b128 a[88:91], v13 offset:8192
    buffer_load_dwordx4 v2, s[8:11], s20 offen offset:0 lds
    v_exp_f32 v85, v85
    v_mfma_f32_16x16x32_bf16 v[148:151], a[4:7], a[36:39], v[148:151]
    s_nop 0
    v_mfma_f32_16x16x32_bf16 v[152:155], a[4:7], a[40:43], v[152:155]
    ds_read_b128 a[92:95], v13 offset:10240
    v_mfma_f32_16x16x32_bf16 v[156:159], a[4:7], a[44:47], v[156:159]
    ds_read_b128 a[52:55], v9 offset:2048
    buffer_load_dwordx4 v3, s[8:11], s21 offen offset:1024 lds
    v_cvt_pk_bf16_f32 v85, v85, v85
    s_waitcnt lgkmcnt(11)
    v_mfma_f32_16x16x32_bf16 v[160:163], a[8:11], a[32:35], v[160:163]
    v_lshlrev_b32 v85, 16, v85
    v_mfma_f32_16x16x32_bf16 v[164:167], a[8:11], a[36:39], v[164:167]
    ds_read_b128 a[56:59], v9 offset:4096
    v_mfma_f32_16x16x32_bf16 v[168:171], a[8:11], a[40:43], v[168:171]
    v_mul_f32 v48, v85, v81
    v_mfma_f32_16x16x32_bf16 v[172:175], a[8:11], a[44:47], v[172:175]
    ds_read_b128 a[60:63], v9 offset:6144
    buffer_load_dwordx4 v2, s[8:11], s22 offen offset:2048 lds
    s_waitcnt lgkmcnt(12)
    v_mfma_f32_16x16x32_bf16 v[176:179], a[12:15], a[32:35], v[176:179]
    ds_read_b128 a[64:67], v9 offset:8192
    v_mul_f32 v49, v85, v83
    v_mfma_f32_16x16x32_bf16 v[180:183], a[12:15], a[36:39], v[180:183]
    v_mul_f32 v48, s54, v48
    v_mfma_f32_16x16x32_bf16 v[184:187], a[12:15], a[40:43], v[184:187]
    ds_read_b128 a[68:71], v9 offset:10240
    buffer_load_dwordx4 v3, s[8:11], s23 offen offset:3072 lds
    v_mfma_f32_16x16x32_bf16 v[188:191], a[12:15], a[44:47], v[188:191]
    ds_read_b128 a[72:75], v9 offset:12288
    v_exp_f32 v48, v48
    s_waitcnt lgkmcnt(14)
    v_mfma_f32_16x16x32_bf16 v[192:195], a[16:19], a[32:35], v[192:195]
    v_mul_f32 v49, 0.15915494, v49
    v_mfma_f32_16x16x32_bf16 v[196:199], a[16:19], a[36:39], v[196:199]
    ds_read_b128 a[76:79], v9 offset:14336
    s_add_u32 s76, s76, 128
    v_mfma_f32_16x16x32_bf16 v[200:203], a[16:19], a[40:43], v[200:203]
    v_rndne_f32 v50, v49
    v_mfma_f32_16x16x32_bf16 v[204:207], a[16:19], a[44:47], v[204:207]
    v_sub_f32 v49, v49, v50
    s_waitcnt lgkmcnt(14)
    v_mfma_f32_16x16x32_bf16 v[208:211], a[20:23], a[32:35], v[208:211]
    v_mfma_f32_16x16x32_bf16 v[212:215], a[20:23], a[36:39], v[212:215]
    s_and_b32 s76, s76, 2047
    v_cos_f32 v50, v49
    v_mfma_f32_16x16x32_bf16 v[216:219], a[20:23], a[40:43], v[216:219]
    v_mfma_f32_16x16x32_bf16 v[220:223], a[20:23], a[44:47], v[220:223]
    v_sin_f32 v51, v49
    s_waitcnt lgkmcnt(13)
    v_mfma_f32_16x16x32_bf16 v[224:227], a[24:27], a[32:35], v[224:227]
    s_add_u32 s8, s80, s76
    s_nop 0
    v_mfma_f32_16x16x32_bf16 v[228:231], a[24:27], a[36:39], v[228:231]
    v_mfma_f32_16x16x32_bf16 v[232:235], a[24:27], a[40:43], v[232:235]
    v_mul_f32 v30, v48, v50
    v_mfma_f32_16x16x32_bf16 v[236:239], a[24:27], a[44:47], v[236:239]
    s_addc_u32 s9, s81, 0
    v_mul_f32 v31, v48, v51
    s_waitcnt lgkmcnt(12)
    v_mfma_f32_16x16x32_bf16 v[240:243], a[28:31], a[32:35], v[240:243]
    v_mfma_f32_16x16x32_bf16 v[244:247], a[28:31], a[36:39], v[244:247]
    v_add_f32 v48, -1.0, v30
    v_mfma_f32_16x16x32_bf16 v[248:251], a[28:31], a[40:43], v[248:251]
    v_mfma_f32_16x16x32_bf16 v[252:255], a[28:31], a[44:47], v[252:255]
    s_waitcnt lgkmcnt(10)
    v_mfma_f32_16x16x32_bf16 v[128:131], a[48:51], a[80:83], v[128:131]
    v_mul_f32 v50, v81, v81
    s_waitcnt lgkmcnt(9)
    v_mfma_f32_16x16x32_bf16 v[132:135], a[48:51], a[84:87], v[132:135]
    s_waitcnt lgkmcnt(8)
    v_mfma_f32_16x16x32_bf16 v[136:139], a[48:51], a[88:91], v[136:139]
    v_fma_f32 v50, v83, v83, v50
    s_waitcnt lgkmcnt(7)
    v_mfma_f32_16x16x32_bf16 v[140:143], a[48:51], a[92:95], v[140:143]
    s_waitcnt lgkmcnt(6)
    v_mfma_f32_16x16x32_bf16 v[144:147], a[52:55], a[80:83], v[144:147]
    v_rcp_f32 v50, v50
    v_mfma_f32_16x16x32_bf16 v[148:151], a[52:55], a[84:87], v[148:151]
    s_waitcnt lgkmcnt(0)
    s_waitcnt vmcnt(12)
    s_barrier
    v_mfma_f32_16x16x32_bf16 v[152:155], a[52:55], a[88:91], v[152:155]
    ds_read_b128 a[0:3], v8 offset:32768
    v_mfma_f32_16x16x32_bf16 v[156:159], a[52:55], a[92:95], v[156:159]
    ds_read_b128 a[32:35], v12 offset:16384
    s_add_u32 m0, s49, 0
    v_mul_f32 v51, v48, v81
    v_mfma_f32_16x16x32_bf16 v[160:163], a[56:59], a[80:83], v[160:163]
    ds_read_b128 a[36:39], v12 offset:18432
    buffer_load_dwordx4 v4, s[12:15], s24 offen offset:0 lds
    v_fma_f32 v51, v31, v83, v51
    v_mfma_f32_16x16x32_bf16 v[164:167], a[56:59], a[84:87], v[164:167]
    ds_read_b128 a[40:43], v12 offset:24576
    v_mfma_f32_16x16x32_bf16 v[168:171], a[56:59], a[88:91], v[168:171]
    buffer_load_dwordx4 v5, s[12:15], s25 offen offset:1024 lds
    v_mul_f32 v52, v48, v83
    v_mfma_f32_16x16x32_bf16 v[172:175], a[56:59], a[92:95], v[172:175]
    ds_read_b128 a[44:47], v12 offset:26624
    v_fma_f32 v52, v31, v81, -v52
    v_mfma_f32_16x16x32_bf16 v[176:179], a[60:63], a[80:83], v[176:179]
    ds_read_b128 a[4:7], v8 offset:34816
    buffer_load_dwordx4 v4, s[12:15], s26 offen offset:2048 lds
    v_mfma_f32_16x16x32_bf16 v[180:183], a[60:63], a[84:87], v[180:183]
    ds_read_b128 a[8:11], v8 offset:36864
    buffer_load_dwordx4 v5, s[12:15], s27 offen offset:3072 lds
    v_mul_f32 v38, v51, v50
    v_mfma_f32_16x16x32_bf16 v[184:187], a[60:63], a[88:91], v[184:187]
    ds_read_b128 a[12:15], v8 offset:38912
    v_mul_f32 v39, v52, v50
    v_mfma_f32_16x16x32_bf16 v[188:191], a[60:63], a[92:95], v[188:191]
    s_add_u32 s77, s77, 128
    v_mfma_f32_16x16x32_bf16 v[192:195], a[64:67], a[80:83], v[192:195]
    ds_read_b128 a[16:19], v8 offset:40960
    v_mul_f32 v48, v31, v31
    v_mfma_f32_16x16x32_bf16 v[196:199], a[64:67], a[84:87], v[196:199]
    ds_read_b128 a[20:23], v8 offset:43008
    s_and_b32 s77, s77, 2047
    v_mul_f32 v49, v31, v30
    v_mfma_f32_16x16x32_bf16 v[200:203], a[64:67], a[88:91], v[200:203]
    ds_read_b128 a[24:27], v8 offset:45056
    v_mfma_f32_16x16x32_bf16 v[204:207], a[64:67], a[92:95], v[204:207]
    ds_read_b128 a[28:31], v8 offset:47104
    s_add_u32 s12, s68, s77
    v_fma_f32 v32, v30, v30, -v48
    v_mfma_f32_16x16x32_bf16 v[208:211], a[68:71], a[80:83], v[208:211]
    s_addc_u32 s13, s69, 0
    v_fma_f32 v33, v30, v31, v49
    v_mfma_f32_16x16x32_bf16 v[212:215], a[68:71], a[84:87], v[212:215]
    v_mfma_f32_16x16x32_bf16 v[216:219], a[68:71], a[88:91], v[216:219]
    s_add_u32 m0, s48, 0
    v_mul_f32 v48, v33, v33
    v_mfma_f32_16x16x32_bf16 v[220:223], a[68:71], a[92:95], v[220:223]
    v_mul_f32 v49, v33, v32
    v_mfma_f32_16x16x32_bf16 v[224:227], a[72:75], a[80:83], v[224:227]
    buffer_load_dwordx4 v2, s[8:11], s16 offen offset:0 lds
    v_mfma_f32_16x16x32_bf16 v[228:231], a[72:75], a[84:87], v[228:231]
    buffer_load_dwordx4 v3, s[8:11], s17 offen offset:1024 lds
    v_fma_f32 v50, v32, v32, -v48
    v_mfma_f32_16x16x32_bf16 v[232:235], a[72:75], a[88:91], v[232:235]
    v_fma_f32 v51, v32, v33, v49
    v_mfma_f32_16x16x32_bf16 v[236:239], a[72:75], a[92:95], v[236:239]
    buffer_load_dwordx4 v2, s[8:11], s18 offen offset:2048 lds
    v_mfma_f32_16x16x32_bf16 v[240:243], a[76:79], a[80:83], v[240:243]
    v_mul_f32 v48, v51, v51
    v_mfma_f32_16x16x32_bf16 v[244:247], a[76:79], a[84:87], v[244:247]
    buffer_load_dwordx4 v3, s[8:11], s19 offen offset:3072 lds
    v_mul_f32 v49, v51, v50
    v_mfma_f32_16x16x32_bf16 v[248:251], a[76:79], a[88:91], v[248:251]
    v_mfma_f32_16x16x32_bf16 v[252:255], a[76:79], a[92:95], v[252:255]
    s_waitcnt lgkmcnt(10)
    v_mfma_f32_16x16x32_bf16 v[128:131], a[0:3], a[32:35], v[128:131]
    ds_read_b128 a[48:51], v9 offset:32768
    s_waitcnt lgkmcnt(10)
    v_mfma_f32_16x16x32_bf16 v[132:135], a[0:3], a[36:39], v[132:135]
    ds_read_b128 a[80:83], v13 offset:16384
    s_add_u32 m0, s48, 4096
    v_fma_f32 v52, v50, v50, -v48
    s_waitcnt lgkmcnt(10)
    v_mfma_f32_16x16x32_bf16 v[136:139], a[0:3], a[40:43], v[136:139]
    v_fma_f32 v53, v50, v51, v49
    s_waitcnt lgkmcnt(9)
    v_mfma_f32_16x16x32_bf16 v[140:143], a[0:3], a[44:47], v[140:143]
    ds_read_b128 a[84:87], v13 offset:18432
    s_waitcnt lgkmcnt(9)
    v_mfma_f32_16x16x32_bf16 v[144:147], a[4:7], a[32:35], v[144:147]
    ds_read_b128 a[88:91], v13 offset:24576
    buffer_load_dwordx4 v2, s[8:11], s20 offen offset:0 lds
    v_mul_f32 v48, v53, v53
    v_mfma_f32_16x16x32_bf16 v[148:151], a[4:7], a[36:39], v[148:151]
    v_mul_f32 v49, v53, v52
    v_mfma_f32_16x16x32_bf16 v[152:155], a[4:7], a[40:43], v[152:155]
    ds_read_b128 a[92:95], v13 offset:26624
    v_mfma_f32_16x16x32_bf16 v[156:159], a[4:7], a[44:47], v[156:159]
    ds_read_b128 a[52:55], v9 offset:34816
    buffer_load_dwordx4 v3, s[8:11], s21 offen offset:1024 lds
    v_fma_f32 v50, v52, v52, -v48
    s_waitcnt lgkmcnt(11)
    v_mfma_f32_16x16x32_bf16 v[160:163], a[8:11], a[32:35], v[160:163]
    v_fma_f32 v51, v52, v53, v49
    v_mfma_f32_16x16x32_bf16 v[164:167], a[8:11], a[36:39], v[164:167]
    ds_read_b128 a[56:59], v9 offset:36864
    v_mfma_f32_16x16x32_bf16 v[168:171], a[8:11], a[40:43], v[168:171]
    v_mul_f32 v48, v51, v51
    v_mfma_f32_16x16x32_bf16 v[172:175], a[8:11], a[44:47], v[172:175]
    ds_read_b128 a[60:63], v9 offset:38912
    buffer_load_dwordx4 v2, s[8:11], s22 offen offset:2048 lds
    s_waitcnt lgkmcnt(12)
    v_mfma_f32_16x16x32_bf16 v[176:179], a[12:15], a[32:35], v[176:179]
    ds_read_b128 a[64:67], v9 offset:40960
    v_mul_f32 v49, v51, v50
    v_mfma_f32_16x16x32_bf16 v[180:183], a[12:15], a[36:39], v[180:183]
    v_fma_f32 v34, v50, v50, -v48
    v_mfma_f32_16x16x32_bf16 v[184:187], a[12:15], a[40:43], v[184:187]
    ds_read_b128 a[68:71], v9 offset:43008
    buffer_load_dwordx4 v3, s[8:11], s23 offen offset:3072 lds
    v_mfma_f32_16x16x32_bf16 v[188:191], a[12:15], a[44:47], v[188:191]
    ds_read_b128 a[72:75], v9 offset:45056
    v_fma_f32 v35, v50, v51, v49
    s_waitcnt lgkmcnt(14)
    v_mfma_f32_16x16x32_bf16 v[192:195], a[16:19], a[32:35], v[192:195]
    v_mul_f32 v48, v35, v35
    v_mfma_f32_16x16x32_bf16 v[196:199], a[16:19], a[36:39], v[196:199]
    ds_read_b128 a[76:79], v9 offset:47104
    s_add_u32 s76, s76, 128
    v_mfma_f32_16x16x32_bf16 v[200:203], a[16:19], a[40:43], v[200:203]
    v_mul_f32 v49, v35, v34
    v_mfma_f32_16x16x32_bf16 v[204:207], a[16:19], a[44:47], v[204:207]
    v_fma_f32 v50, v34, v34, -v48
    s_waitcnt lgkmcnt(14)
    v_mfma_f32_16x16x32_bf16 v[208:211], a[20:23], a[32:35], v[208:211]
    v_mfma_f32_16x16x32_bf16 v[212:215], a[20:23], a[36:39], v[212:215]
    s_and_b32 s76, s76, 2047
    v_fma_f32 v51, v34, v35, v49
    v_mfma_f32_16x16x32_bf16 v[216:219], a[20:23], a[40:43], v[216:219]
    v_mfma_f32_16x16x32_bf16 v[220:223], a[20:23], a[44:47], v[220:223]
    v_mul_f32 v48, v51, v51
    s_waitcnt lgkmcnt(13)
    v_mfma_f32_16x16x32_bf16 v[224:227], a[24:27], a[32:35], v[224:227]
    s_add_u32 s8, s80, s76
    v_mul_f32 v49, v51, v50
    v_mfma_f32_16x16x32_bf16 v[228:231], a[24:27], a[36:39], v[228:231]
    v_mfma_f32_16x16x32_bf16 v[232:235], a[24:27], a[40:43], v[232:235]
    v_fma_f32 v52, v50, v50, -v48
    v_mfma_f32_16x16x32_bf16 v[236:239], a[24:27], a[44:47], v[236:239]
    s_addc_u32 s9, s81, 0
    v_fma_f32 v53, v50, v51, v49
    s_waitcnt lgkmcnt(12)
    v_mfma_f32_16x16x32_bf16 v[240:243], a[28:31], a[32:35], v[240:243]
    v_mfma_f32_16x16x32_bf16 v[244:247], a[28:31], a[36:39], v[244:247]
    v_mul_f32 v48, v53, v53
    v_mfma_f32_16x16x32_bf16 v[248:251], a[28:31], a[40:43], v[248:251]
    v_mfma_f32_16x16x32_bf16 v[252:255], a[28:31], a[44:47], v[252:255]
    s_waitcnt lgkmcnt(10)
    v_mfma_f32_16x16x32_bf16 v[128:131], a[48:51], a[80:83], v[128:131]
    s_waitcnt lgkmcnt(9)
    v_mfma_f32_16x16x32_bf16 v[132:135], a[48:51], a[84:87], v[132:135]
    s_waitcnt lgkmcnt(8)
    v_mfma_f32_16x16x32_bf16 v[136:139], a[48:51], a[88:91], v[136:139]
    s_waitcnt lgkmcnt(7)
    v_mfma_f32_16x16x32_bf16 v[140:143], a[48:51], a[92:95], v[140:143]
    s_waitcnt lgkmcnt(6)
    v_mfma_f32_16x16x32_bf16 v[144:147], a[52:55], a[80:83], v[144:147]
    v_mfma_f32_16x16x32_bf16 v[148:151], a[52:55], a[84:87], v[148:151]
    s_waitcnt lgkmcnt(0)
    s_waitcnt vmcnt(12)
    s_barrier
    v_mfma_f32_16x16x32_bf16 v[152:155], a[52:55], a[88:91], v[152:155]
    ds_read_b128 a[0:3], v10 offset:0
    v_mfma_f32_16x16x32_bf16 v[156:159], a[52:55], a[92:95], v[156:159]
    ds_read_b128 a[32:35], v12 offset:32768
    v_mul_f32 v49, v53, v52
    v_mfma_f32_16x16x32_bf16 v[160:163], a[56:59], a[80:83], v[160:163]
    ds_read_b128 a[36:39], v12 offset:34816
    v_mfma_f32_16x16x32_bf16 v[164:167], a[56:59], a[84:87], v[164:167]
    ds_read_b128 a[40:43], v12 offset:40960
    v_mfma_f32_16x16x32_bf16 v[168:171], a[56:59], a[88:91], v[168:171]
    v_mfma_f32_16x16x32_bf16 v[172:175], a[56:59], a[92:95], v[172:175]
    ds_read_b128 a[44:47], v12 offset:43008
    v_mfma_f32_16x16x32_bf16 v[176:179], a[60:63], a[80:83], v[176:179]
    ds_read_b128 a[4:7], v10 offset:2048
    v_mfma_f32_16x16x32_bf16 v[180:183], a[60:63], a[84:87], v[180:183]
    ds_read_b128 a[8:11], v10 offset:4096
    v_mfma_f32_16x16x32_bf16 v[184:187], a[60:63], a[88:91], v[184:187]
    ds_read_b128 a[12:15], v10 offset:6144
    v_mfma_f32_16x16x32_bf16 v[188:191], a[60:63], a[92:95], v[188:191]
    v_fma_f32 v36, v52, v52, -v48
    v_mfma_f32_16x16x32_bf16 v[192:195], a[64:67], a[80:83], v[192:195]
    ds_read_b128 a[16:19], v10 offset:8192
    v_mfma_f32_16x16x32_bf16 v[196:199], a[64:67], a[84:87], v[196:199]
    ds_read_b128 a[20:23], v10 offset:10240
    v_mfma_f32_16x16x32_bf16 v[200:203], a[64:67], a[88:91], v[200:203]
    ds_read_b128 a[24:27], v10 offset:12288
    v_mfma_f32_16x16x32_bf16 v[204:207], a[64:67], a[92:95], v[204:207]
    ds_read_b128 a[28:31], v10 offset:14336
    v_mfma_f32_16x16x32_bf16 v[208:211], a[68:71], a[80:83], v[208:211]
    v_mfma_f32_16x16x32_bf16 v[212:215], a[68:71], a[84:87], v[212:215]
    v_mfma_f32_16x16x32_bf16 v[216:219], a[68:71], a[88:91], v[216:219]
    v_mfma_f32_16x16x32_bf16 v[220:223], a[68:71], a[92:95], v[220:223]
    v_fma_f32 v37, v52, v53, v49
    v_mfma_f32_16x16x32_bf16 v[224:227], a[72:75], a[80:83], v[224:227]
    v_mfma_f32_16x16x32_bf16 v[228:231], a[72:75], a[84:87], v[228:231]
    v_mfma_f32_16x16x32_bf16 v[232:235], a[72:75], a[88:91], v[232:235]
    v_mfma_f32_16x16x32_bf16 v[236:239], a[72:75], a[92:95], v[236:239]
    v_mfma_f32_16x16x32_bf16 v[240:243], a[76:79], a[80:83], v[240:243]
    v_mfma_f32_16x16x32_bf16 v[244:247], a[76:79], a[84:87], v[244:247]
    v_mfma_f32_16x16x32_bf16 v[248:251], a[76:79], a[88:91], v[248:251]
    v_mfma_f32_16x16x32_bf16 v[252:255], a[76:79], a[92:95], v[252:255]
    s_waitcnt lgkmcnt(10)
    v_mfma_f32_16x16x32_bf16 v[128:131], a[0:3], a[32:35], v[128:131]
    ds_read_b128 a[48:51], v11 offset:0
    s_waitcnt lgkmcnt(10)
    v_mfma_f32_16x16x32_bf16 v[132:135], a[0:3], a[36:39], v[132:135]
    ds_read_b128 a[80:83], v13 offset:32768
    s_waitcnt lgkmcnt(10)
    v_mfma_f32_16x16x32_bf16 v[136:139], a[0:3], a[40:43], v[136:139]
    s_waitcnt lgkmcnt(9)
    v_mfma_f32_16x16x32_bf16 v[140:143], a[0:3], a[44:47], v[140:143]
    ds_read_b128 a[84:87], v13 offset:34816
    s_waitcnt lgkmcnt(9)
    v_mfma_f32_16x16x32_bf16 v[144:147], a[4:7], a[32:35], v[144:147]
    ds_read_b128 a[88:91], v13 offset:40960
    v_mfma_f32_16x16x32_bf16 v[148:151], a[4:7], a[36:39], v[148:151]
    v_mfma_f32_16x16x32_bf16 v[152:155], a[4:7], a[40:43], v[152:155]
    ds_read_b128 a[92:95], v13 offset:43008
    v_mfma_f32_16x16x32_bf16 v[156:159], a[4:7], a[44:47], v[156:159]
    ds_read_b128 a[52:55], v11 offset:2048
    s_waitcnt lgkmcnt(11)
    v_mfma_f32_16x16x32_bf16 v[160:163], a[8:11], a[32:35], v[160:163]
    v_mfma_f32_16x16x32_bf16 v[164:167], a[8:11], a[36:39], v[164:167]
    ds_read_b128 a[56:59], v11 offset:4096
    v_mfma_f32_16x16x32_bf16 v[168:171], a[8:11], a[40:43], v[168:171]
    v_mfma_f32_16x16x32_bf16 v[172:175], a[8:11], a[44:47], v[172:175]
    ds_read_b128 a[60:63], v11 offset:6144
    s_waitcnt lgkmcnt(12)
    v_mfma_f32_16x16x32_bf16 v[176:179], a[12:15], a[32:35], v[176:179]
    ds_read_b128 a[64:67], v11 offset:8192
    v_mfma_f32_16x16x32_bf16 v[180:183], a[12:15], a[36:39], v[180:183]
    v_mfma_f32_16x16x32_bf16 v[184:187], a[12:15], a[40:43], v[184:187]
    ds_read_b128 a[68:71], v11 offset:10240
    v_mfma_f32_16x16x32_bf16 v[188:191], a[12:15], a[44:47], v[188:191]
    ds_read_b128 a[72:75], v11 offset:12288
    s_waitcnt lgkmcnt(14)
    v_mfma_f32_16x16x32_bf16 v[192:195], a[16:19], a[32:35], v[192:195]
    v_mfma_f32_16x16x32_bf16 v[196:199], a[16:19], a[36:39], v[196:199]
    ds_read_b128 a[76:79], v11 offset:14336
    v_mfma_f32_16x16x32_bf16 v[200:203], a[16:19], a[40:43], v[200:203]
    v_mfma_f32_16x16x32_bf16 v[204:207], a[16:19], a[44:47], v[204:207]
    s_waitcnt lgkmcnt(14)
    v_mfma_f32_16x16x32_bf16 v[208:211], a[20:23], a[32:35], v[208:211]
    v_mfma_f32_16x16x32_bf16 v[212:215], a[20:23], a[36:39], v[212:215]
    v_mfma_f32_16x16x32_bf16 v[216:219], a[20:23], a[40:43], v[216:219]
    v_mfma_f32_16x16x32_bf16 v[220:223], a[20:23], a[44:47], v[220:223]
    s_waitcnt lgkmcnt(13)
    v_mfma_f32_16x16x32_bf16 v[224:227], a[24:27], a[32:35], v[224:227]
    v_mfma_f32_16x16x32_bf16 v[228:231], a[24:27], a[36:39], v[228:231]
    v_mfma_f32_16x16x32_bf16 v[232:235], a[24:27], a[40:43], v[232:235]
    v_mfma_f32_16x16x32_bf16 v[236:239], a[24:27], a[44:47], v[236:239]
    s_waitcnt lgkmcnt(12)
    v_mfma_f32_16x16x32_bf16 v[240:243], a[28:31], a[32:35], v[240:243]
    v_mfma_f32_16x16x32_bf16 v[244:247], a[28:31], a[36:39], v[244:247]
    v_mfma_f32_16x16x32_bf16 v[248:251], a[28:31], a[40:43], v[248:251]
    v_mfma_f32_16x16x32_bf16 v[252:255], a[28:31], a[44:47], v[252:255]
    s_waitcnt lgkmcnt(10)
    v_mfma_f32_16x16x32_bf16 v[128:131], a[48:51], a[80:83], v[128:131]
    s_waitcnt lgkmcnt(9)
    v_mfma_f32_16x16x32_bf16 v[132:135], a[48:51], a[84:87], v[132:135]
    s_waitcnt lgkmcnt(8)
    v_mfma_f32_16x16x32_bf16 v[136:139], a[48:51], a[88:91], v[136:139]
    s_waitcnt lgkmcnt(7)
    v_mfma_f32_16x16x32_bf16 v[140:143], a[48:51], a[92:95], v[140:143]
    s_waitcnt lgkmcnt(6)
    v_mfma_f32_16x16x32_bf16 v[144:147], a[52:55], a[80:83], v[144:147]
    v_mfma_f32_16x16x32_bf16 v[148:151], a[52:55], a[84:87], v[148:151]
    s_waitcnt lgkmcnt(0)
    s_waitcnt vmcnt(0)
    s_barrier
    v_mfma_f32_16x16x32_bf16 v[152:155], a[52:55], a[88:91], v[152:155]
    ds_read_b128 a[0:3], v8 offset:0
    v_mfma_f32_16x16x32_bf16 v[156:159], a[52:55], a[92:95], v[156:159]
    ds_read_b128 a[32:35], v12 offset:0
    v_mfma_f32_16x16x32_bf16 v[160:163], a[56:59], a[80:83], v[160:163]
    ds_read_b128 a[36:39], v12 offset:2048
    v_mfma_f32_16x16x32_bf16 v[164:167], a[56:59], a[84:87], v[164:167]
    ds_read_b128 a[40:43], v12 offset:8192
    v_mfma_f32_16x16x32_bf16 v[168:171], a[56:59], a[88:91], v[168:171]
    v_mfma_f32_16x16x32_bf16 v[172:175], a[56:59], a[92:95], v[172:175]
    ds_read_b128 a[44:47], v12 offset:10240
    v_mfma_f32_16x16x32_bf16 v[176:179], a[60:63], a[80:83], v[176:179]
    ds_read_b128 a[4:7], v8 offset:2048
    v_mfma_f32_16x16x32_bf16 v[180:183], a[60:63], a[84:87], v[180:183]
    ds_read_b128 a[8:11], v8 offset:4096
    v_mfma_f32_16x16x32_bf16 v[184:187], a[60:63], a[88:91], v[184:187]
    ds_read_b128 a[12:15], v8 offset:6144
    v_mfma_f32_16x16x32_bf16 v[188:191], a[60:63], a[92:95], v[188:191]
    v_mfma_f32_16x16x32_bf16 v[192:195], a[64:67], a[80:83], v[192:195]
    ds_read_b128 a[16:19], v8 offset:8192
    v_mfma_f32_16x16x32_bf16 v[196:199], a[64:67], a[84:87], v[196:199]
    ds_read_b128 a[20:23], v8 offset:10240
    v_mfma_f32_16x16x32_bf16 v[200:203], a[64:67], a[88:91], v[200:203]
    ds_read_b128 a[24:27], v8 offset:12288
    v_mfma_f32_16x16x32_bf16 v[204:207], a[64:67], a[92:95], v[204:207]
    ds_read_b128 a[28:31], v8 offset:14336
    v_mfma_f32_16x16x32_bf16 v[208:211], a[68:71], a[80:83], v[208:211]
    v_mfma_f32_16x16x32_bf16 v[212:215], a[68:71], a[84:87], v[212:215]
    v_mfma_f32_16x16x32_bf16 v[216:219], a[68:71], a[88:91], v[216:219]
    v_mfma_f32_16x16x32_bf16 v[220:223], a[68:71], a[92:95], v[220:223]
    v_mfma_f32_16x16x32_bf16 v[224:227], a[72:75], a[80:83], v[224:227]
    v_mfma_f32_16x16x32_bf16 v[228:231], a[72:75], a[84:87], v[228:231]
    v_mfma_f32_16x16x32_bf16 v[232:235], a[72:75], a[88:91], v[232:235]
    v_mfma_f32_16x16x32_bf16 v[236:239], a[72:75], a[92:95], v[236:239]
    v_mfma_f32_16x16x32_bf16 v[240:243], a[76:79], a[80:83], v[240:243]
    v_mfma_f32_16x16x32_bf16 v[244:247], a[76:79], a[84:87], v[244:247]
    v_mfma_f32_16x16x32_bf16 v[248:251], a[76:79], a[88:91], v[248:251]
    v_mfma_f32_16x16x32_bf16 v[252:255], a[76:79], a[92:95], v[252:255]
    s_waitcnt lgkmcnt(10)
    v_mfma_f32_16x16x32_bf16 v[128:131], a[0:3], a[32:35], v[128:131]
    ds_read_b128 a[48:51], v9 offset:0
    s_waitcnt lgkmcnt(10)
    v_mfma_f32_16x16x32_bf16 v[132:135], a[0:3], a[36:39], v[132:135]
    ds_read_b128 a[80:83], v13 offset:0
    s_waitcnt lgkmcnt(10)
    v_mfma_f32_16x16x32_bf16 v[136:139], a[0:3], a[40:43], v[136:139]
    s_waitcnt lgkmcnt(9)
    v_mfma_f32_16x16x32_bf16 v[140:143], a[0:3], a[44:47], v[140:143]
    ds_read_b128 a[84:87], v13 offset:2048
    s_waitcnt lgkmcnt(9)
    v_mfma_f32_16x16x32_bf16 v[144:147], a[4:7], a[32:35], v[144:147]
    ds_read_b128 a[88:91], v13 offset:8192
    v_mfma_f32_16x16x32_bf16 v[148:151], a[4:7], a[36:39], v[148:151]
    v_mfma_f32_16x16x32_bf16 v[152:155], a[4:7], a[40:43], v[152:155]
    ds_read_b128 a[92:95], v13 offset:10240
    v_mfma_f32_16x16x32_bf16 v[156:159], a[4:7], a[44:47], v[156:159]
    ds_read_b128 a[52:55], v9 offset:2048
    s_waitcnt lgkmcnt(11)
    v_mfma_f32_16x16x32_bf16 v[160:163], a[8:11], a[32:35], v[160:163]
    v_mfma_f32_16x16x32_bf16 v[164:167], a[8:11], a[36:39], v[164:167]
    ds_read_b128 a[56:59], v9 offset:4096
    v_mfma_f32_16x16x32_bf16 v[168:171], a[8:11], a[40:43], v[168:171]
    v_mfma_f32_16x16x32_bf16 v[172:175], a[8:11], a[44:47], v[172:175]
    ds_read_b128 a[60:63], v9 offset:6144
    s_waitcnt lgkmcnt(12)
    v_mfma_f32_16x16x32_bf16 v[176:179], a[12:15], a[32:35], v[176:179]
    ds_read_b128 a[64:67], v9 offset:8192
    v_mfma_f32_16x16x32_bf16 v[180:183], a[12:15], a[36:39], v[180:183]
    v_mfma_f32_16x16x32_bf16 v[184:187], a[12:15], a[40:43], v[184:187]
    ds_read_b128 a[68:71], v9 offset:10240
    v_mfma_f32_16x16x32_bf16 v[188:191], a[12:15], a[44:47], v[188:191]
    ds_read_b128 a[72:75], v9 offset:12288
    s_waitcnt lgkmcnt(14)
    v_mfma_f32_16x16x32_bf16 v[192:195], a[16:19], a[32:35], v[192:195]
    v_mfma_f32_16x16x32_bf16 v[196:199], a[16:19], a[36:39], v[196:199]
    ds_read_b128 a[76:79], v9 offset:14336
    v_mfma_f32_16x16x32_bf16 v[200:203], a[16:19], a[40:43], v[200:203]
    v_mfma_f32_16x16x32_bf16 v[204:207], a[16:19], a[44:47], v[204:207]
    s_waitcnt lgkmcnt(14)
    v_mfma_f32_16x16x32_bf16 v[208:211], a[20:23], a[32:35], v[208:211]
    v_mfma_f32_16x16x32_bf16 v[212:215], a[20:23], a[36:39], v[212:215]
    v_mfma_f32_16x16x32_bf16 v[216:219], a[20:23], a[40:43], v[216:219]
    v_mfma_f32_16x16x32_bf16 v[220:223], a[20:23], a[44:47], v[220:223]
    s_waitcnt lgkmcnt(13)
    v_mfma_f32_16x16x32_bf16 v[224:227], a[24:27], a[32:35], v[224:227]
    v_mfma_f32_16x16x32_bf16 v[228:231], a[24:27], a[36:39], v[228:231]
    v_mfma_f32_16x16x32_bf16 v[232:235], a[24:27], a[40:43], v[232:235]
    v_mfma_f32_16x16x32_bf16 v[236:239], a[24:27], a[44:47], v[236:239]
    s_waitcnt lgkmcnt(12)
    v_mfma_f32_16x16x32_bf16 v[240:243], a[28:31], a[32:35], v[240:243]
    v_mfma_f32_16x16x32_bf16 v[244:247], a[28:31], a[36:39], v[244:247]
    v_mfma_f32_16x16x32_bf16 v[248:251], a[28:31], a[40:43], v[248:251]
    v_mfma_f32_16x16x32_bf16 v[252:255], a[28:31], a[44:47], v[252:255]
    s_waitcnt lgkmcnt(10)
    v_mfma_f32_16x16x32_bf16 v[128:131], a[48:51], a[80:83], v[128:131]
    s_waitcnt lgkmcnt(9)
    v_mfma_f32_16x16x32_bf16 v[132:135], a[48:51], a[84:87], v[132:135]
    s_waitcnt lgkmcnt(8)
    v_mfma_f32_16x16x32_bf16 v[136:139], a[48:51], a[88:91], v[136:139]
    s_waitcnt lgkmcnt(7)
    v_mfma_f32_16x16x32_bf16 v[140:143], a[48:51], a[92:95], v[140:143]
    s_waitcnt lgkmcnt(6)
    v_mfma_f32_16x16x32_bf16 v[144:147], a[52:55], a[80:83], v[144:147]
    v_mfma_f32_16x16x32_bf16 v[148:151], a[52:55], a[84:87], v[148:151]
    v_mfma_f32_16x16x32_bf16 v[152:155], a[52:55], a[88:91], v[152:155]
    v_mfma_f32_16x16x32_bf16 v[156:159], a[52:55], a[92:95], v[156:159]
    s_waitcnt lgkmcnt(5)
    v_mfma_f32_16x16x32_bf16 v[160:163], a[56:59], a[80:83], v[160:163]
    v_mfma_f32_16x16x32_bf16 v[164:167], a[56:59], a[84:87], v[164:167]
    v_mfma_f32_16x16x32_bf16 v[168:171], a[56:59], a[88:91], v[168:171]
    v_mfma_f32_16x16x32_bf16 v[172:175], a[56:59], a[92:95], v[172:175]
    s_waitcnt lgkmcnt(4)
    v_mfma_f32_16x16x32_bf16 v[176:179], a[60:63], a[80:83], v[176:179]
    v_mfma_f32_16x16x32_bf16 v[180:183], a[60:63], a[84:87], v[180:183]
    v_mfma_f32_16x16x32_bf16 v[184:187], a[60:63], a[88:91], v[184:187]
    v_mfma_f32_16x16x32_bf16 v[188:191], a[60:63], a[92:95], v[188:191]
    s_waitcnt lgkmcnt(3)
    v_mfma_f32_16x16x32_bf16 v[192:195], a[64:67], a[80:83], v[192:195]
    v_mfma_f32_16x16x32_bf16 v[196:199], a[64:67], a[84:87], v[196:199]
    v_mfma_f32_16x16x32_bf16 v[200:203], a[64:67], a[88:91], v[200:203]
    v_mfma_f32_16x16x32_bf16 v[204:207], a[64:67], a[92:95], v[204:207]
    s_waitcnt lgkmcnt(2)
    v_mfma_f32_16x16x32_bf16 v[208:211], a[68:71], a[80:83], v[208:211]
    v_mfma_f32_16x16x32_bf16 v[212:215], a[68:71], a[84:87], v[212:215]
    v_mfma_f32_16x16x32_bf16 v[216:219], a[68:71], a[88:91], v[216:219]
    v_mfma_f32_16x16x32_bf16 v[220:223], a[68:71], a[92:95], v[220:223]
    s_waitcnt lgkmcnt(1)
    v_mfma_f32_16x16x32_bf16 v[224:227], a[72:75], a[80:83], v[224:227]
    v_mfma_f32_16x16x32_bf16 v[228:231], a[72:75], a[84:87], v[228:231]
    v_mfma_f32_16x16x32_bf16 v[232:235], a[72:75], a[88:91], v[232:235]
    v_mfma_f32_16x16x32_bf16 v[236:239], a[72:75], a[92:95], v[236:239]
    s_waitcnt lgkmcnt(0)
    v_mfma_f32_16x16x32_bf16 v[240:243], a[76:79], a[80:83], v[240:243]
    v_mfma_f32_16x16x32_bf16 v[244:247], a[76:79], a[84:87], v[244:247]
    v_mfma_f32_16x16x32_bf16 v[248:251], a[76:79], a[88:91], v[248:251]
    v_mfma_f32_16x16x32_bf16 v[252:255], a[76:79], a[92:95], v[252:255]
LepiA:
    s_load_dwordx4 s[68:71], s[0:1], 40
    s_load_dwordx2 s[72:73], s[0:1], 88
    s_load_dwordx2 s[74:75], s[0:1], 104
    s_load_dwordx2 s[80:81], s[0:1], 0
    s_load_dwordx2 s[82:83], s[0:1], 64
    s_add_u32 s91, s91, 1
    s_lshl_b32 s58, s90, 2
    s_add_u32 s58, s58, 12582912
    v_mov_b32 v6, 0
    v_cmp_eq_u32 vcc, 63, v0
    s_and_saveexec_b64 s[60:61], vcc
    buffer_store_dwordx4 v[104:107], v6, s[64:67], s58 offen sc1
    s_mov_b64 exec, s[60:61]
    s_nop 4
    v_mov_b32 v40, v128
    v_mov_b32 v48, v132
    v_mov_b32 v41, v129
    v_mov_b32 v49, v133
    v_mov_b32 v42, v136
    v_mov_b32 v50, v140
    v_mov_b32 v43, v137
    v_mov_b32 v51, v141
    v_pk_fma_f32 v[44:45], v[42:43], v[22:23], v[130:131] op_sel:[0,1,0] op_sel_hi:[1,1,1] neg_lo:[0,1,0] neg_hi:[0,1,0]
    v_pk_fma_f32 v[52:53], v[50:51], v[32:33], v[134:135] op_sel:[0,1,0] op_sel_hi:[1,1,1] neg_lo:[0,1,0] neg_hi:[0,1,0]
    v_pk_fma_f32 v[46:47], v[40:41], v[22:23], v[138:139] op_sel:[0,1,0] op_sel_hi:[1,1,1]
    v_pk_fma_f32 v[54:55], v[48:49], v[32:33], v[142:143] op_sel:[0,1,0] op_sel_hi:[1,1,1]
    v_pk_fma_f32 v[40:41], v[40:41], v[22:23], v[44:45] op_sel:[0,0,0] op_sel_hi:[1,0,1]
    v_pk_fma_f32 v[48:49], v[48:49], v[32:33], v[52:53] op_sel:[0,0,0] op_sel_hi:[1,0,1]
    v_pk_fma_f32 v[42:43], v[42:43], v[22:23], v[46:47] op_sel:[0,0,0] op_sel_hi:[1,0,1]
    v_pk_fma_f32 v[50:51], v[50:51], v[32:33], v[54:55] op_sel:[0,0,0] op_sel_hi:[1,0,1]
    v_pk_fma_f32 v[44:45], v[42:43], v[22:23], v[144:145] op_sel:[0,1,0] op_sel_hi:[1,1,1] neg_lo:[0,1,0] neg_hi:[0,1,0]
    v_pk_fma_f32 v[52:53], v[50:51], v[32:33], v[148:149] op_sel:[0,1,0] op_sel_hi:[1,1,1] neg_lo:[0,1,0] neg_hi:[0,1,0]
    v_pk_fma_f32 v[46:47], v[40:41], v[22:23], v[152:153] op_sel:[0,1,0] op_sel_hi:[1,1,1]
    v_pk_fma_f32 v[54:55], v[48:49], v[32:33], v[156:157] op_sel:[0,1,0] op_sel_hi:[1,1,1]
    v_pk_fma_f32 v[40:41], v[40:41], v[22:23], v[44:45] op_sel:[0,0,0] op_sel_hi:[1,0,1]
    v_pk_fma_f32 v[48:49], v[48:49], v[32:33], v[52:53] op_sel:[0,0,0] op_sel_hi:[1,0,1]
    v_pk_fma_f32 v[42:43], v[42:43], v[22:23], v[46:47] op_sel:[0,0,0] op_sel_hi:[1,0,1]
    v_pk_fma_f32 v[50:51], v[50:51], v[32:33], v[54:55] op_sel:[0,0,0] op_sel_hi:[1,0,1]
    v_pk_fma_f32 v[44:45], v[42:43], v[22:23], v[146:147] op_sel:[0,1,0] op_sel_hi:[1,1,1] neg_lo:[0,1,0] neg_hi:[0,1,0]
    v_pk_fma_f32 v[52:53], v[50:51], v[32:33], v[150:151] op_sel:[0,1,0] op_sel_hi:[1,1,1] neg_lo:[0,1,0] neg_hi:[0,1,0]
    v_pk_fma_f32 v[46:47], v[40:41], v[22:23], v[154:155] op_sel:[0,1,0] op_sel_hi:[1,1,1]
    v_pk_fma_f32 v[54:55], v[48:49], v[32:33], v[158:159] op_sel:[0,1,0] op_sel_hi:[1,1,1]
    v_pk_fma_f32 v[40:41], v[40:41], v[22:23], v[44:45] op_sel:[0,0,0] op_sel_hi:[1,0,1]
    v_pk_fma_f32 v[48:49], v[48:49], v[32:33], v[52:53] op_sel:[0,0,0] op_sel_hi:[1,0,1]
    v_pk_fma_f32 v[42:43], v[42:43], v[22:23], v[46:47] op_sel:[0,0,0] op_sel_hi:[1,0,1]
    v_pk_fma_f32 v[50:51], v[50:51], v[32:33], v[54:55] op_sel:[0,0,0] op_sel_hi:[1,0,1]
    v_pk_fma_f32 v[44:45], v[42:43], v[22:23], v[160:161] op_sel:[0,1,0] op_sel_hi:[1,1,1] neg_lo:[0,1,0] neg_hi:[0,1,0]
    v_pk_fma_f32 v[52:53], v[50:51], v[32:33], v[164:165] op_sel:[0,1,0] op_sel_hi:[1,1,1] neg_lo:[0,1,0] neg_hi:[0,1,0]
    v_pk_fma_f32 v[46:47], v[40:41], v[22:23], v[168:169] op_sel:[0,1,0] op_sel_hi:[1,1,1]
    v_pk_fma_f32 v[54:55], v[48:49], v[32:33], v[172:173] op_sel:[0,1,0] op_sel_hi:[1,1,1]
    v_pk_fma_f32 v[40:41], v[40:41], v[22:23], v[44:45] op_sel:[0,0,0] op_sel_hi:[1,0,1]
    v_pk_fma_f32 v[48:49], v[48:49], v[32:33], v[52:53] op_sel:[0,0,0] op_sel_hi:[1,0,1]
    v_pk_fma_f32 v[42:43], v[42:43], v[22:23], v[46:47] op_sel:[0,0,0] op_sel_hi:[1,0,1]
    v_pk_fma_f32 v[50:51], v[50:51], v[32:33], v[54:55] op_sel:[0,0,0] op_sel_hi:[1,0,1]
    v_pk_fma_f32 v[44:45], v[42:43], v[22:23], v[162:163] op_sel:[0,1,0] op_sel_hi:[1,1,1] neg_lo:[0,1,0] neg_hi:[0,1,0]
    v_pk_fma_f32 v[52:53], v[50:51], v[32:33], v[166:167] op_sel:[0,1,0] op_sel_hi:[1,1,1] neg_lo:[0,1,0] neg_hi:[0,1,0]
    v_pk_fma_f32 v[46:47], v[40:41], v[22:23], v[170:171] op_sel:[0,1,0] op_sel_hi:[1,1,1]
    v_pk_fma_f32 v[54:55], v[48:49], v[32:33], v[174:175] op_sel:[0,1,0] op_sel_hi:[1,1,1]
    v_pk_fma_f32 v[40:41], v[40:41], v[22:23], v[44:45] op_sel:[0,0,0] op_sel_hi:[1,0,1]
    v_pk_fma_f32 v[48:49], v[48:49], v[32:33], v[52:53] op_sel:[0,0,0] op_sel_hi:[1,0,1]
    v_pk_fma_f32 v[42:43], v[42:43], v[22:23], v[46:47] op_sel:[0,0,0] op_sel_hi:[1,0,1]
    v_pk_fma_f32 v[50:51], v[50:51], v[32:33], v[54:55] op_sel:[0,0,0] op_sel_hi:[1,0,1]
    v_pk_fma_f32 v[44:45], v[42:43], v[22:23], v[176:177] op_sel:[0,1,0] op_sel_hi:[1,1,1] neg_lo:[0,1,0] neg_hi:[0,1,0]
    v_pk_fma_f32 v[52:53], v[50:51], v[32:33], v[180:181] op_sel:[0,1,0] op_sel_hi:[1,1,1] neg_lo:[0,1,0] neg_hi:[0,1,0]
    v_pk_fma_f32 v[46:47], v[40:41], v[22:23], v[184:185] op_sel:[0,1,0] op_sel_hi:[1,1,1]
    v_pk_fma_f32 v[54:55], v[48:49], v[32:33], v[188:189] op_sel:[0,1,0] op_sel_hi:[1,1,1]
    v_pk_fma_f32 v[40:41], v[40:41], v[22:23], v[44:45] op_sel:[0,0,0] op_sel_hi:[1,0,1]
    v_pk_fma_f32 v[48:49], v[48:49], v[32:33], v[52:53] op_sel:[0,0,0] op_sel_hi:[1,0,1]
    v_pk_fma_f32 v[42:43], v[42:43], v[22:23], v[46:47] op_sel:[0,0,0] op_sel_hi:[1,0,1]
    v_pk_fma_f32 v[50:51], v[50:51], v[32:33], v[54:55] op_sel:[0,0,0] op_sel_hi:[1,0,1]
    v_pk_fma_f32 v[44:45], v[42:43], v[22:23], v[178:179] op_sel:[0,1,0] op_sel_hi:[1,1,1] neg_lo:[0,1,0] neg_hi:[0,1,0]
    v_pk_fma_f32 v[52:53], v[50:51], v[32:33], v[182:183] op_sel:[0,1,0] op_sel_hi:[1,1,1] neg_lo:[0,1,0] neg_hi:[0,1,0]
    v_pk_fma_f32 v[46:47], v[40:41], v[22:23], v[186:187] op_sel:[0,1,0] op_sel_hi:[1,1,1]
    v_pk_fma_f32 v[54:55], v[48:49], v[32:33], v[190:191] op_sel:[0,1,0] op_sel_hi:[1,1,1]
    v_pk_fma_f32 v[40:41], v[40:41], v[22:23], v[44:45] op_sel:[0,0,0] op_sel_hi:[1,0,1]
    v_pk_fma_f32 v[48:49], v[48:49], v[32:33], v[52:53] op_sel:[0,0,0] op_sel_hi:[1,0,1]
    v_pk_fma_f32 v[42:43], v[42:43], v[22:23], v[46:47] op_sel:[0,0,0] op_sel_hi:[1,0,1]
    v_pk_fma_f32 v[50:51], v[50:51], v[32:33], v[54:55] op_sel:[0,0,0] op_sel_hi:[1,0,1]
    v_pk_fma_f32 v[44:45], v[42:43], v[22:23], v[192:193] op_sel:[0,1,0] op_sel_hi:[1,1,1] neg_lo:[0,1,0] neg_hi:[0,1,0]
    v_pk_fma_f32 v[52:53], v[50:51], v[32:33], v[196:197] op_sel:[0,1,0] op_sel_hi:[1,1,1] neg_lo:[0,1,0] neg_hi:[0,1,0]
    v_pk_fma_f32 v[46:47], v[40:41], v[22:23], v[200:201] op_sel:[0,1,0] op_sel_hi:[1,1,1]
    v_pk_fma_f32 v[54:55], v[48:49], v[32:33], v[204:205] op_sel:[0,1,0] op_sel_hi:[1,1,1]
    v_pk_fma_f32 v[40:41], v[40:41], v[22:23], v[44:45] op_sel:[0,0,0] op_sel_hi:[1,0,1]
    v_pk_fma_f32 v[48:49], v[48:49], v[32:33], v[52:53] op_sel:[0,0,0] op_sel_hi:[1,0,1]
    v_pk_fma_f32 v[42:43], v[42:43], v[22:23], v[46:47] op_sel:[0,0,0] op_sel_hi:[1,0,1]
    v_pk_fma_f32 v[50:51], v[50:51], v[32:33], v[54:55] op_sel:[0,0,0] op_sel_hi:[1,0,1]
    v_pk_fma_f32 v[44:45], v[42:43], v[22:23], v[194:195] op_sel:[0,1,0] op_sel_hi:[1,1,1] neg_lo:[0,1,0] neg_hi:[0,1,0]
    v_pk_fma_f32 v[52:53], v[50:51], v[32:33], v[198:199] op_sel:[0,1,0] op_sel_hi:[1,1,1] neg_lo:[0,1,0] neg_hi:[0,1,0]
    v_pk_fma_f32 v[46:47], v[40:41], v[22:23], v[202:203] op_sel:[0,1,0] op_sel_hi:[1,1,1]
    v_pk_fma_f32 v[54:55], v[48:49], v[32:33], v[206:207] op_sel:[0,1,0] op_sel_hi:[1,1,1]
    v_pk_fma_f32 v[40:41], v[40:41], v[22:23], v[44:45] op_sel:[0,0,0] op_sel_hi:[1,0,1]
    v_pk_fma_f32 v[48:49], v[48:49], v[32:33], v[52:53] op_sel:[0,0,0] op_sel_hi:[1,0,1]
    v_pk_fma_f32 v[42:43], v[42:43], v[22:23], v[46:47] op_sel:[0,0,0] op_sel_hi:[1,0,1]
    v_pk_fma_f32 v[50:51], v[50:51], v[32:33], v[54:55] op_sel:[0,0,0] op_sel_hi:[1,0,1]
    v_pk_fma_f32 v[44:45], v[42:43], v[22:23], v[208:209] op_sel:[0,1,0] op_sel_hi:[1,1,1] neg_lo:[0,1,0] neg_hi:[0,1,0]
    v_pk_fma_f32 v[52:53], v[50:51], v[32:33], v[212:213] op_sel:[0,1,0] op_sel_hi:[1,1,1] neg_lo:[0,1,0] neg_hi:[0,1,0]
    v_pk_fma_f32 v[46:47], v[40:41], v[22:23], v[216:217] op_sel:[0,1,0] op_sel_hi:[1,1,1]
    v_pk_fma_f32 v[54:55], v[48:49], v[32:33], v[220:221] op_sel:[0,1,0] op_sel_hi:[1,1,1]
    v_pk_fma_f32 v[40:41], v[40:41], v[22:23], v[44:45] op_sel:[0,0,0] op_sel_hi:[1,0,1]
    v_pk_fma_f32 v[48:49], v[48:49], v[32:33], v[52:53] op_sel:[0,0,0] op_sel_hi:[1,0,1]
    v_pk_fma_f32 v[42:43], v[42:43], v[22:23], v[46:47] op_sel:[0,0,0] op_sel_hi:[1,0,1]
    v_pk_fma_f32 v[50:51], v[50:51], v[32:33], v[54:55] op_sel:[0,0,0] op_sel_hi:[1,0,1]
    v_pk_fma_f32 v[44:45], v[42:43], v[22:23], v[210:211] op_sel:[0,1,0] op_sel_hi:[1,1,1] neg_lo:[0,1,0] neg_hi:[0,1,0]
    v_pk_fma_f32 v[52:53], v[50:51], v[32:33], v[214:215] op_sel:[0,1,0] op_sel_hi:[1,1,1] neg_lo:[0,1,0] neg_hi:[0,1,0]
    v_pk_fma_f32 v[46:47], v[40:41], v[22:23], v[218:219] op_sel:[0,1,0] op_sel_hi:[1,1,1]
    v_pk_fma_f32 v[54:55], v[48:49], v[32:33], v[222:223] op_sel:[0,1,0] op_sel_hi:[1,1,1]
    v_pk_fma_f32 v[40:41], v[40:41], v[22:23], v[44:45] op_sel:[0,0,0] op_sel_hi:[1,0,1]
    v_pk_fma_f32 v[48:49], v[48:49], v[32:33], v[52:53] op_sel:[0,0,0] op_sel_hi:[1,0,1]
    v_pk_fma_f32 v[42:43], v[42:43], v[22:23], v[46:47] op_sel:[0,0,0] op_sel_hi:[1,0,1]
    v_pk_fma_f32 v[50:51], v[50:51], v[32:33], v[54:55] op_sel:[0,0,0] op_sel_hi:[1,0,1]
    v_pk_fma_f32 v[44:45], v[42:43], v[22:23], v[224:225] op_sel:[0,1,0] op_sel_hi:[1,1,1] neg_lo:[0,1,0] neg_hi:[0,1,0]
    v_pk_fma_f32 v[52:53], v[50:51], v[32:33], v[228:229] op_sel:[0,1,0] op_sel_hi:[1,1,1] neg_lo:[0,1,0] neg_hi:[0,1,0]
    v_pk_fma_f32 v[46:47], v[40:41], v[22:23], v[232:233] op_sel:[0,1,0] op_sel_hi:[1,1,1]
    v_pk_fma_f32 v[54:55], v[48:49], v[32:33], v[236:237] op_sel:[0,1,0] op_sel_hi:[1,1,1]
    v_pk_fma_f32 v[40:41], v[40:41], v[22:23], v[44:45] op_sel:[0,0,0] op_sel_hi:[1,0,1]
    v_pk_fma_f32 v[48:49], v[48:49], v[32:33], v[52:53] op_sel:[0,0,0] op_sel_hi:[1,0,1]
    v_pk_fma_f32 v[42:43], v[42:43], v[22:23], v[46:47] op_sel:[0,0,0] op_sel_hi:[1,0,1]
    v_pk_fma_f32 v[50:51], v[50:51], v[32:33], v[54:55] op_sel:[0,0,0] op_sel_hi:[1,0,1]
    v_pk_fma_f32 v[44:45], v[42:43], v[22:23], v[226:227] op_sel:[0,1,0] op_sel_hi:[1,1,1] neg_lo:[0,1,0] neg_hi:[0,1,0]
    v_pk_fma_f32 v[52:53], v[50:51], v[32:33], v[230:231] op_sel:[0,1,0] op_sel_hi:[1,1,1] neg_lo:[0,1,0] neg_hi:[0,1,0]
    v_pk_fma_f32 v[46:47], v[40:41], v[22:23], v[234:235] op_sel:[0,1,0] op_sel_hi:[1,1,1]
    v_pk_fma_f32 v[54:55], v[48:49], v[32:33], v[238:239] op_sel:[0,1,0] op_sel_hi:[1,1,1]
    v_pk_fma_f32 v[40:41], v[40:41], v[22:23], v[44:45] op_sel:[0,0,0] op_sel_hi:[1,0,1]
    v_pk_fma_f32 v[48:49], v[48:49], v[32:33], v[52:53] op_sel:[0,0,0] op_sel_hi:[1,0,1]
    v_pk_fma_f32 v[42:43], v[42:43], v[22:23], v[46:47] op_sel:[0,0,0] op_sel_hi:[1,0,1]
    v_pk_fma_f32 v[50:51], v[50:51], v[32:33], v[54:55] op_sel:[0,0,0] op_sel_hi:[1,0,1]
    v_pk_fma_f32 v[44:45], v[42:43], v[22:23], v[240:241] op_sel:[0,1,0] op_sel_hi:[1,1,1] neg_lo:[0,1,0] neg_hi:[0,1,0]
    v_pk_fma_f32 v[52:53], v[50:51], v[32:33], v[244:245] op_sel:[0,1,0] op_sel_hi:[1,1,1] neg_lo:[0,1,0] neg_hi:[0,1,0]
    v_pk_fma_f32 v[46:47], v[40:41], v[22:23], v[248:249] op_sel:[0,1,0] op_sel_hi:[1,1,1]
    v_pk_fma_f32 v[54:55], v[48:49], v[32:33], v[252:253] op_sel:[0,1,0] op_sel_hi:[1,1,1]
    v_pk_fma_f32 v[40:41], v[40:41], v[22:23], v[44:45] op_sel:[0,0,0] op_sel_hi:[1,0,1]
    v_pk_fma_f32 v[48:49], v[48:49], v[32:33], v[52:53] op_sel:[0,0,0] op_sel_hi:[1,0,1]
    v_pk_fma_f32 v[42:43], v[42:43], v[22:23], v[46:47] op_sel:[0,0,0] op_sel_hi:[1,0,1]
    v_pk_fma_f32 v[50:51], v[50:51], v[32:33], v[54:55] op_sel:[0,0,0] op_sel_hi:[1,0,1]
    v_pk_fma_f32 v[44:45], v[42:43], v[22:23], v[242:243] op_sel:[0,1,0] op_sel_hi:[1,1,1] neg_lo:[0,1,0] neg_hi:[0,1,0]
    v_pk_fma_f32 v[52:53], v[50:51], v[32:33], v[246:247] op_sel:[0,1,0] op_sel_hi:[1,1,1] neg_lo:[0,1,0] neg_hi:[0,1,0]
    v_pk_fma_f32 v[46:47], v[40:41], v[22:23], v[250:251] op_sel:[0,1,0] op_sel_hi:[1,1,1]
    v_pk_fma_f32 v[54:55], v[48:49], v[32:33], v[254:255] op_sel:[0,1,0] op_sel_hi:[1,1,1]
    v_pk_fma_f32 v[40:41], v[40:41], v[22:23], v[44:45] op_sel:[0,0,0] op_sel_hi:[1,0,1]
    v_pk_fma_f32 v[48:49], v[48:49], v[32:33], v[52:53] op_sel:[0,0,0] op_sel_hi:[1,0,1]
    v_pk_fma_f32 v[42:43], v[42:43], v[22:23], v[46:47] op_sel:[0,0,0] op_sel_hi:[1,0,1]
    v_pk_fma_f32 v[50:51], v[50:51], v[32:33], v[54:55] op_sel:[0,0,0] op_sel_hi:[1,0,1]
    v_fma_f32 v56, v20, v40, v41
    v_fma_f32 v57, v20, v42, v43
    v_fma_f32 v56, -v21, v42, v56
    v_fma_f32 v57, v21, v40, v57
    v_fma_f32 v58, v30, v48, v49
    v_fma_f32 v59, v30, v50, v51
    v_fma_f32 v58, -v31, v50, v58
    v_fma_f32 v59, v31, v48, v59
    v_lshrrev_b32 v60, 4, v0
    s_lshl_b32 s58, s50, 2
    v_add_u32 v61, s58, v60
    v_lshlrev_b32 v62, 9, v61
    v_and_b32 v63, 15, v0
    s_lshl_b32 s58, s51, 5
    v_add_u32 v63, s58, v63
    v_lshlrev_b32 v63, 3, v63
    v_add_u32 v63, 32768, v63
    v_add_u32 v62, v62, v63
    ds_write_b64 v62, v[56:57]
    ds_write_b64 v62, v[58:59] offset:128
    s_waitcnt lgkmcnt(0)
    s_barrier
    ds_read_b64 v[64:65], v63 offset:0
    ds_read_b64 v[66:67], v63 offset:512
    ds_read_b64 v[68:69], v63 offset:1024
    ds_read_b64 v[70:71], v63 offset:1536
    ds_read_b64 v[72:73], v63 offset:2048
    ds_read_b64 v[74:75], v63 offset:2560
    ds_read_b64 v[76:77], v63 offset:3072
    ds_read_b64 v[78:79], v63 offset:3584
    ds_read_b64 v[80:81], v63 offset:128
    ds_read_b64 v[82:83], v63 offset:640
    ds_read_b64 v[84:85], v63 offset:1152
    ds_read_b64 v[86:87], v63 offset:1664
    ds_read_b64 v[88:89], v63 offset:2176
    ds_read_b64 v[90:91], v63 offset:2688
    ds_read_b64 v[92:93], v63 offset:3200
    ds_read_b64 v[94:95], v63 offset:3712
    s_waitcnt lgkmcnt(0)
    v_fma_f32 v96, -v25, v65, v66
    v_fma_f32 v97, v25, v64, v67
    v_fma_f32 v56, v24, v64, v96
    v_fma_f32 v57, v24, v65, v97
    v_fma_f32 v98, -v35, v81, v82
    v_fma_f32 v99, v35, v80, v83
    v_fma_f32 v58, v34, v80, v98
    v_fma_f32 v59, v34, v81, v99
    v_fma_f32 v96, -v25, v57, v68
    v_fma_f32 v97, v25, v56, v69
    v_fma_f32 v56, v24, v56, v96
    v_fma_f32 v57, v24, v57, v97
    v_fma_f32 v98, -v35, v59, v84
    v_fma_f32 v99, v35, v58, v85
    v_fma_f32 v58, v34, v58, v98
    v_fma_f32 v59, v34, v59, v99
    v_fma_f32 v96, -v25, v57, v70
    v_fma_f32 v97, v25, v56, v71
    v_fma_f32 v56, v24, v56, v96
    v_fma_f32 v57, v24, v57, v97
    v_fma_f32 v98, -v35, v59, v86
    v_fma_f32 v99, v35, v58, v87
    v_fma_f32 v58, v34, v58, v98
    v_fma_f32 v59, v34, v59, v99
    v_fma_f32 v96, -v25, v57, v72
    v_fma_f32 v97, v25, v56, v73
    v_fma_f32 v56, v24, v56, v96
    v_fma_f32 v57, v24, v57, v97
    v_fma_f32 v98, -v35, v59, v88
    v_fma_f32 v99, v35, v58, v89
    v_fma_f32 v58, v34, v58, v98
    v_fma_f32 v59, v34, v59, v99
    v_fma_f32 v96, -v25, v57, v74
    v_fma_f32 v97, v25, v56, v75
    v_fma_f32 v56, v24, v56, v96
    v_fma_f32 v57, v24, v57, v97
    v_fma_f32 v98, -v35, v59, v90
    v_fma_f32 v99, v35, v58, v91
    v_fma_f32 v58, v34, v58, v98
    v_fma_f32 v59, v34, v59, v99
    v_fma_f32 v96, -v25, v57, v76
    v_fma_f32 v97, v25, v56, v77
    v_fma_f32 v56, v24, v56, v96
    v_fma_f32 v57, v24, v57, v97
    v_fma_f32 v98, -v35, v59, v92
    v_fma_f32 v99, v35, v58, v93
    v_fma_f32 v58, v34, v58, v98
    v_fma_f32 v59, v34, v59, v99
    v_fma_f32 v96, -v25, v57, v78
    v_fma_f32 v97, v25, v56, v79
    v_fma_f32 v56, v24, v56, v96
    v_fma_f32 v57, v24, v57, v97
    v_fma_f32 v98, -v35, v59, v94
    v_fma_f32 v99, v35, v58, v95
    v_fma_f32 v58, v34, v58, v98
    v_fma_f32 v59, v34, v59, v99
    v_subrev_u32 v62, 32768, v63
    v_lshlrev_b32 v62, 1, v62
    s_cmp_lg_u32 s50, 0
    s_cbranch_scc1 La_nopub_1
    s_lshl_b32 s58, s33, 3
    s_add_u32 s58, s58, s32
    s_lshl_b32 s58, s58, 10
    s_add_u32 s58, s58, 12648448
    v_mov_b32 v40, v56
    v_mov_b32 v41, v57
    v_mov_b32 v42, s91
    v_mov_b32 v43, s91
    v_mov_b32 v44, v58
    v_mov_b32 v45, v59
    v_mov_b32 v46, s91
    v_mov_b32 v47, s91
    v_cmp_gt_u32 vcc, 16, v0
    s_and_saveexec_b64 s[60:61], vcc
    buffer_store_dwordx4 v[40:43], v62, s[64:67], s58 offen sc1
    buffer_store_dwordx4 v[44:47], v62, s[64:67], s58 offen offset:256 sc1
    s_mov_b64 exec, s[60:61]
La_nopub_1:
    v_mov_b32 v56, 0
    v_mov_b32 v57, 0
    v_mov_b32 v58, 0
    v_mov_b32 v59, 0
    s_cmp_eq_u32 s32, 0
    s_cbranch_scc1 La_nocarry_2
    s_lshl_b32 s58, s33, 13
    s_add_u32 s58, s58, 12648448
    s_mov_b32 s63, 0
La_poll_3:
    s_mov_b32 s59, s58
    buffer_load_dwordx4 v[2:5], v62, s[64:67], s59 offen sc1
    buffer_load_dwordx4 v[6:9], v62, s[64:67], s59 offen offset:256 sc1
    s_add_u32 s59, s59, 1024
    s_cmp_gt_u32 s32, 1
    s_cbranch_scc0 La_chk_5
    buffer_load_dwordx4 v[10:13], v62, s[64:67], s59 offen sc1
    buffer_load_dwordx4 v[14:17], v62, s[64:67], s59 offen offset:256 sc1
    s_add_u32 s59, s59, 1024
    s_cmp_gt_u32 s32, 2
    s_cbranch_scc0 La_chk_5
    buffer_load_dwordx4 v[40:43], v62, s[64:67], s59 offen sc1
    buffer_load_dwordx4 v[44:47], v62, s[64:67], s59 offen offset:256 sc1
    s_add_u32 s59, s59, 1024
    s_cmp_gt_u32 s32, 3
    s_cbranch_scc0 La_chk_5
    buffer_load_dwordx4 v[48:51], v62, s[64:67], s59 offen sc1
    buffer_load_dwordx4 v[52:55], v62, s[64:67], s59 offen offset:256 sc1
    s_add_u32 s59, s59, 1024
    s_cmp_gt_u32 s32, 4
    s_cbranch_scc0 La_chk_5
    buffer_load_dwordx4 v[100:103], v62, s[64:67], s59 offen sc1
    buffer_load_dwordx4 v[104:107], v62, s[64:67], s59 offen offset:256 sc1
    s_add_u32 s59, s59, 1024
    s_cmp_gt_u32 s32, 5
    s_cbranch_scc0 La_chk_5
    buffer_load_dwordx4 v[108:111], v62, s[64:67], s59 offen sc1
    buffer_load_dwordx4 v[112:115], v62, s[64:67], s59 offen offset:256 sc1
    s_add_u32 s59, s59, 1024
    s_cmp_gt_u32 s32, 6
    s_cbranch_scc0 La_chk_5
    buffer_load_dwordx4 v[116:119], v62, s[64:67], s59 offen sc1
    buffer_load_dwordx4 v[120:123], v62, s[64:67], s59 offen offset:256 sc1
La_chk_5:
    s_waitcnt vmcnt(0)
    v_mov_b32 v96, 0
    v_xor_b32 v97, s91, v4
    v_xor_b32 v98, s91, v8
    v_or3_b32 v96, v96, v97, v98
    s_cmp_gt_u32 s32, 1
    s_cbranch_scc0 La_chk2_6
    v_xor_b32 v97, s91, v12
    v_xor_b32 v98, s91, v16
    v_or3_b32 v96, v96, v97, v98
    s_cmp_gt_u32 s32, 2
    s_cbranch_scc0 La_chk2_6
    v_xor_b32 v97, s91, v42
    v_xor_b32 v98, s91, v46
    v_or3_b32 v96, v96, v97, v98
    s_cmp_gt_u32 s32, 3
    s_cbranch_scc0 La_chk2_6
    v_xor_b32 v97, s91, v50
    v_xor_b32 v98, s91, v54
    v_or3_b32 v96, v96, v97, v98
    s_cmp_gt_u32 s32, 4
    s_cbranch_scc0 La_chk2_6
    v_xor_b32 v97, s91, v102
    v_xor_b32 v98, s91, v106
    v_or3_b32 v96, v96, v97, v98
    s_cmp_gt_u32 s32, 5
    s_cbranch_scc0 La_chk2_6
    v_xor_b32 v97, s91, v110
    v_xor_b32 v98, s91, v114
    v_or3_b32 v96, v96, v97, v98
    s_cmp_gt_u32 s32, 6
    s_cbranch_scc0 La_chk2_6
    v_xor_b32 v97, s91, v118
    v_xor_b32 v98, s91, v122
    v_or3_b32 v96, v96, v97, v98
La_chk2_6:
    v_cmp_ne_u32 vcc, 0, v96
    s_add_u32 s63, s63, 1
    s_cbranch_vccz La_polldone_4
    s_sleep 2
    s_cmp_lt_u32 s63, 0x100000
    s_cbranch_scc1 La_poll_3
La_polldone_4:
    v_fma_f32 v96, -v27, v57, v2
    v_fma_f32 v97, v27, v56, v3
    v_fma_f32 v56, v26, v56, v96
    v_fma_f32 v57, v26, v57, v97
    v_fma_f32 v98, -v37, v59, v6
    v_fma_f32 v99, v37, v58, v7
    v_fma_f32 v58, v36, v58, v98
    v_fma_f32 v59, v36, v59, v99
    s_cmp_gt_u32 s32, 1
    s_cbranch_scc0 La_nocarry_2
    v_fma_f32 v96, -v27, v57, v10
    v_fma_f32 v97, v27, v56, v11
    v_fma_f32 v56, v26, v56, v96
    v_fma_f32 v57, v26, v57, v97
    v_fma_f32 v98, -v37, v59, v14
    v_fma_f32 v99, v37, v58, v15
    v_fma_f32 v58, v36, v58, v98
    v_fma_f32 v59, v36, v59, v99
    s_cmp_gt_u32 s32, 2
    s_cbranch_scc0 La_nocarry_2
    v_fma_f32 v96, -v27, v57, v40
    v_fma_f32 v97, v27, v56, v41
    v_fma_f32 v56, v26, v56, v96
    v_fma_f32 v57, v26, v57, v97
    v_fma_f32 v98, -v37, v59, v44
    v_fma_f32 v99, v37, v58, v45
    v_fma_f32 v58, v36, v58, v98
    v_fma_f32 v59, v36, v59, v99
    s_cmp_gt_u32 s32, 3
    s_cbranch_scc0 La_nocarry_2
    v_fma_f32 v96, -v27, v57, v48
    v_fma_f32 v97, v27, v56, v49
    v_fma_f32 v56, v26, v56, v96
    v_fma_f32 v57, v26, v57, v97
    v_fma_f32 v98, -v37, v59, v52
    v_fma_f32 v99, v37, v58, v53
    v_fma_f32 v58, v36, v58, v98
    v_fma_f32 v59, v36, v59, v99
    s_cmp_gt_u32 s32, 4
    s_cbranch_scc0 La_nocarry_2
    v_fma_f32 v96, -v27, v57, v100
    v_fma_f32 v97, v27, v56, v101
    v_fma_f32 v56, v26, v56, v96
    v_fma_f32 v57, v26, v57, v97
    v_fma_f32 v98, -v37, v59, v104
    v_fma_f32 v99, v37, v58, v105
    v_fma_f32 v58, v36, v58, v98
    v_fma_f32 v59, v36, v59, v99
    s_cmp_gt_u32 s32, 5
    s_cbranch_scc0 La_nocarry_2
    v_fma_f32 v96, -v27, v57, v108
    v_fma_f32 v97, v27, v56, v109
    v_fma_f32 v56, v26, v56, v96
    v_fma_f32 v57, v26, v57, v97
    v_fma_f32 v98, -v37, v59, v112
    v_fma_f32 v99, v37, v58, v113
    v_fma_f32 v58, v36, v58, v98
    v_fma_f32 v59, v36, v59, v99
    s_cmp_gt_u32 s32, 6
    s_cbranch_scc0 La_nocarry_2
    v_fma_f32 v96, -v27, v57, v116
    v_fma_f32 v97, v27, v56, v117
    v_fma_f32 v56, v26, v56, v96
    v_fma_f32 v57, v26, v57, v97
    v_fma_f32 v98, -v37, v59, v120
    v_fma_f32 v99, v37, v58, v121
    v_fma_f32 v58, v36, v58, v98
    v_fma_f32 v59, v36, v59, v99
La_nocarry_2:
    v_mov_b32 v40, v56
    v_mov_b32 v41, v57
    v_mov_b32 v48, v58
    v_mov_b32 v49, v59
    v_fma_f32 v96, -v25, v57, v64
    v_fma_f32 v97, v25, v56, v65
    v_fma_f32 v56, v24, v56, v96
    v_fma_f32 v57, v24, v57, v97
    v_fma_f32 v98, -v35, v59, v80
    v_fma_f32 v99, v35, v58, v81
    v_fma_f32 v58, v34, v58, v98
    v_fma_f32 v59, v34, v59, v99
    v_cmp_lt_u32 vcc, 0, v61
    s_nop 1
    v_cndmask_b32 v40, v40, v56, vcc
    v_cndmask_b32 v41, v41, v57, vcc
    v_cndmask_b32 v48, v48, v58, vcc
    v_cndmask_b32 v49, v49, v59, vcc
    v_fma_f32 v96, -v25, v57, v66
    v_fma_f32 v97, v25, v56, v67
    v_fma_f32 v56, v24, v56, v96
    v_fma_f32 v57, v24, v57, v97
    v_fma_f32 v98, -v35, v59, v82
    v_fma_f32 v99, v35, v58, v83
    v_fma_f32 v58, v34, v58, v98
    v_fma_f32 v59, v34, v59, v99
    v_cmp_lt_u32 vcc, 1, v61
    s_nop 1
    v_cndmask_b32 v40, v40, v56, vcc
    v_cndmask_b32 v41, v41, v57, vcc
    v_cndmask_b32 v48, v48, v58, vcc
    v_cndmask_b32 v49, v49, v59, vcc
    v_fma_f32 v96, -v25, v57, v68
    v_fma_f32 v97, v25, v56, v69
    v_fma_f32 v56, v24, v56, v96
    v_fma_f32 v57, v24, v57, v97
    v_fma_f32 v98, -v35, v59, v84
    v_fma_f32 v99, v35, v58, v85
    v_fma_f32 v58, v34, v58, v98
    v_fma_f32 v59, v34, v59, v99
    v_cmp_lt_u32 vcc, 2, v61
    s_nop 1
    v_cndmask_b32 v40, v40, v56, vcc
    v_cndmask_b32 v41, v41, v57, vcc
    v_cndmask_b32 v48, v48, v58, vcc
    v_cndmask_b32 v49, v49, v59, vcc
    v_fma_f32 v96, -v25, v57, v70
    v_fma_f32 v97, v25, v56, v71
    v_fma_f32 v56, v24, v56, v96
    v_fma_f32 v57, v24, v57, v97
    v_fma_f32 v98, -v35, v59, v86
    v_fma_f32 v99, v35, v58, v87
    v_fma_f32 v58, v34, v58, v98
    v_fma_f32 v59, v34, v59, v99
    v_cmp_lt_u32 vcc, 3, v61
    s_nop 1
    v_cndmask_b32 v40, v40, v56, vcc
    v_cndmask_b32 v41, v41, v57, vcc
    v_cndmask_b32 v48, v48, v58, vcc
    v_cndmask_b32 v49, v49, v59, vcc
    v_fma_f32 v96, -v25, v57, v72
    v_fma_f32 v97, v25, v56, v73
    v_fma_f32 v56, v24, v56, v96
    v_fma_f32 v57, v24, v57, v97
    v_fma_f32 v98, -v35, v59, v88
    v_fma_f32 v99, v35, v58, v89
    v_fma_f32 v58, v34, v58, v98
    v_fma_f32 v59, v34, v59, v99
    v_cmp_lt_u32 vcc, 4, v61
    s_nop 1
    v_cndmask_b32 v40, v40, v56, vcc
    v_cndmask_b32 v41, v41, v57, vcc
    v_cndmask_b32 v48, v48, v58, vcc
    v_cndmask_b32 v49, v49, v59, vcc
    v_fma_f32 v96, -v25, v57, v74
    v_fma_f32 v97, v25, v56, v75
    v_fma_f32 v56, v24, v56, v96
    v_fma_f32 v57, v24, v57, v97
    v_fma_f32 v98, -v35, v59, v90
    v_fma_f32 v99, v35, v58, v91
    v_fma_f32 v58, v34, v58, v98
    v_fma_f32 v59, v34, v59, v99
    v_cmp_lt_u32 vcc, 5, v61
    s_nop 1
    v_cndmask_b32 v40, v40, v56, vcc
    v_cndmask_b32 v41, v41, v57, vcc
    v_cndmask_b32 v48, v48, v58, vcc
    v_cndmask_b32 v49, v49, v59, vcc
    v_fma_f32 v96, -v25, v57, v76
    v_fma_f32 v97, v25, v56, v77
    v_fma_f32 v56, v24, v56, v96
    v_fma_f32 v57, v24, v57, v97
    v_fma_f32 v98, -v35, v59, v92
    v_fma_f32 v99, v35, v58, v93
    v_fma_f32 v58, v34, v58, v98
    v_fma_f32 v59, v34, v59, v99
    v_cmp_lt_u32 vcc, 6, v61
    s_nop 1
    v_cndmask_b32 v40, v40, v56, vcc
    v_cndmask_b32 v41, v41, v57, vcc
    v_cndmask_b32 v48, v48, v58, vcc
    v_cndmask_b32 v49, v49, v59, vcc
    v_fmac_f32 v128, v20, v40
    v_fmac_f32 v132, v30, v48
    v_fmac_f32 v136, v20, v41
    v_fmac_f32 v140, v30, v49
    v_fma_f32 v128, -v21, v41, v128
    v_fma_f32 v132, -v31, v49, v132
    v_fmac_f32 v136, v21, v40
    v_fmac_f32 v140, v31, v48
    v_fmac_f32 v129, v20, v128
    v_fmac_f32 v133, v30, v132
    v_fmac_f32 v137, v20, v136
    v_fmac_f32 v141, v30, v140
    v_fma_f32 v129, -v21, v136, v129
    v_fma_f32 v133, -v31, v140, v133
    v_fmac_f32 v137, v21, v128
    v_fmac_f32 v141, v31, v132
    v_fmac_f32 v130, v20, v129
    v_fmac_f32 v134, v30, v133
    v_fmac_f32 v138, v20, v137
    v_fmac_f32 v142, v30, v141
    v_fma_f32 v130, -v21, v137, v130
    v_fma_f32 v134, -v31, v141, v134
    v_fmac_f32 v138, v21, v129
    v_fmac_f32 v142, v31, v133
    v_fmac_f32 v131, v20, v130
    v_fmac_f32 v135, v30, v134
    v_fmac_f32 v139, v20, v138
    v_fmac_f32 v143, v30, v142
    v_fma_f32 v131, -v21, v138, v131
    v_fma_f32 v135, -v31, v142, v135
    v_fmac_f32 v139, v21, v130
    v_fmac_f32 v143, v31, v134
    v_fmac_f32 v144, v20, v131
    v_fmac_f32 v148, v30, v135
    v_fmac_f32 v152, v20, v139
    v_fmac_f32 v156, v30, v143
    v_fma_f32 v144, -v21, v139, v144
    v_fma_f32 v148, -v31, v143, v148
    v_fmac_f32 v152, v21, v131
    v_fmac_f32 v156, v31, v135
    v_fmac_f32 v145, v20, v144
    v_fmac_f32 v149, v30, v148
    v_fmac_f32 v153, v20, v152
    v_fmac_f32 v157, v30, v156
    v_fma_f32 v145, -v21, v152, v145
    v_fma_f32 v149, -v31, v156, v149
    v_fmac_f32 v153, v21, v144
    v_fmac_f32 v157, v31, v148
    v_fmac_f32 v146, v20, v145
    v_fmac_f32 v150, v30, v149
    v_fmac_f32 v154, v20, v153
    v_fmac_f32 v158, v30, v157
    v_fma_f32 v146, -v21, v153, v146
    v_fma_f32 v150, -v31, v157, v150
    v_fmac_f32 v154, v21, v145
    v_fmac_f32 v158, v31, v149
    v_fmac_f32 v147, v20, v146
    v_fmac_f32 v151, v30, v150
    v_fmac_f32 v155, v20, v154
    v_fmac_f32 v159, v30, v158
    v_fma_f32 v147, -v21, v154, v147
    v_fma_f32 v151, -v31, v158, v151
    v_fmac_f32 v155, v21, v146
    v_fmac_f32 v159, v31, v150
    v_fmac_f32 v160, v20, v147
    v_fmac_f32 v164, v30, v151
    v_fmac_f32 v168, v20, v155
    v_fmac_f32 v172, v30, v159
    v_fma_f32 v160, -v21, v155, v160
    v_fma_f32 v164, -v31, v159, v164
    v_fmac_f32 v168, v21, v147
    v_fmac_f32 v172, v31, v151
    v_fmac_f32 v161, v20, v160
    v_fmac_f32 v165, v30, v164
    v_fmac_f32 v169, v20, v168
    v_fmac_f32 v173, v30, v172
    v_fma_f32 v161, -v21, v168, v161
    v_fma_f32 v165, -v31, v172, v165
    v_fmac_f32 v169, v21, v160
    v_fmac_f32 v173, v31, v164
    v_fmac_f32 v162, v20, v161
    v_fmac_f32 v166, v30, v165
    v_fmac_f32 v170, v20, v169
    v_fmac_f32 v174, v30, v173
    v_fma_f32 v162, -v21, v169, v162
    v_fma_f32 v166, -v31, v173, v166
    v_fmac_f32 v170, v21, v161
    v_fmac_f32 v174, v31, v165
    v_fmac_f32 v163, v20, v162
    v_fmac_f32 v167, v30, v166
    v_fmac_f32 v171, v20, v170
    v_fmac_f32 v175, v30, v174
    v_fma_f32 v163, -v21, v170, v163
    v_fma_f32 v167, -v31, v174, v167
    v_fmac_f32 v171, v21, v162
    v_fmac_f32 v175, v31, v166
    v_fmac_f32 v176, v20, v163
    v_fmac_f32 v180, v30, v167
    v_fmac_f32 v184, v20, v171
    v_fmac_f32 v188, v30, v175
    v_fma_f32 v176, -v21, v171, v176
    v_fma_f32 v180, -v31, v175, v180
    v_fmac_f32 v184, v21, v163
    v_fmac_f32 v188, v31, v167
    v_fmac_f32 v177, v20, v176
    v_fmac_f32 v181, v30, v180
    v_fmac_f32 v185, v20, v184
    v_fmac_f32 v189, v30, v188
    v_fma_f32 v177, -v21, v184, v177
    v_fma_f32 v181, -v31, v188, v181
    v_fmac_f32 v185, v21, v176
    v_fmac_f32 v189, v31, v180
    v_fmac_f32 v178, v20, v177
    v_fmac_f32 v182, v30, v181
    v_fmac_f32 v186, v20, v185
    v_fmac_f32 v190, v30, v189
    v_fma_f32 v178, -v21, v185, v178
    v_fma_f32 v182, -v31, v189, v182
    v_fmac_f32 v186, v21, v177
    v_fmac_f32 v190, v31, v181
    v_fmac_f32 v179, v20, v178
    v_fmac_f32 v183, v30, v182
    v_fmac_f32 v187, v20, v186
    v_fmac_f32 v191, v30, v190
    v_fma_f32 v179, -v21, v186, v179
    v_fma_f32 v183, -v31, v190, v183
    v_fmac_f32 v187, v21, v178
    v_fmac_f32 v191, v31, v182
    v_fmac_f32 v192, v20, v179
    v_fmac_f32 v196, v30, v183
    v_fmac_f32 v200, v20, v187
    v_fmac_f32 v204, v30, v191
    v_fma_f32 v192, -v21, v187, v192
    v_fma_f32 v196, -v31, v191, v196
    v_fmac_f32 v200, v21, v179
    v_fmac_f32 v204, v31, v183
    v_fmac_f32 v193, v20, v192
    v_fmac_f32 v197, v30, v196
    v_fmac_f32 v201, v20, v200
    v_fmac_f32 v205, v30, v204
    v_fma_f32 v193, -v21, v200, v193
    v_fma_f32 v197, -v31, v204, v197
    v_fmac_f32 v201, v21, v192
    v_fmac_f32 v205, v31, v196
    v_fmac_f32 v194, v20, v193
    v_fmac_f32 v198, v30, v197
    v_fmac_f32 v202, v20, v201
    v_fmac_f32 v206, v30, v205
    v_fma_f32 v194, -v21, v201, v194
    v_fma_f32 v198, -v31, v205, v198
    v_fmac_f32 v202, v21, v193
    v_fmac_f32 v206, v31, v197
    v_fmac_f32 v195, v20, v194
    v_fmac_f32 v199, v30, v198
    v_fmac_f32 v203, v20, v202
    v_fmac_f32 v207, v30, v206
    v_fma_f32 v195, -v21, v202, v195
    v_fma_f32 v199, -v31, v206, v199
    v_fmac_f32 v203, v21, v194
    v_fmac_f32 v207, v31, v198
    v_fmac_f32 v208, v20, v195
    v_fmac_f32 v212, v30, v199
    v_fmac_f32 v216, v20, v203
    v_fmac_f32 v220, v30, v207
    v_fma_f32 v208, -v21, v203, v208
    v_fma_f32 v212, -v31, v207, v212
    v_fmac_f32 v216, v21, v195
    v_fmac_f32 v220, v31, v199
    v_fmac_f32 v209, v20, v208
    v_fmac_f32 v213, v30, v212
    v_fmac_f32 v217, v20, v216
    v_fmac_f32 v221, v30, v220
    v_fma_f32 v209, -v21, v216, v209
    v_fma_f32 v213, -v31, v220, v213
    v_fmac_f32 v217, v21, v208
    v_fmac_f32 v221, v31, v212
    v_fmac_f32 v210, v20, v209
    v_fmac_f32 v214, v30, v213
    v_fmac_f32 v218, v20, v217
    v_fmac_f32 v222, v30, v221
    v_fma_f32 v210, -v21, v217, v210
    v_fma_f32 v214, -v31, v221, v214
    v_fmac_f32 v218, v21, v209
    v_fmac_f32 v222, v31, v213
    v_fmac_f32 v211, v20, v210
    v_fmac_f32 v215, v30, v214
    v_fmac_f32 v219, v20, v218
    v_fmac_f32 v223, v30, v222
    v_fma_f32 v211, -v21, v218, v211
    v_fma_f32 v215, -v31, v222, v215
    v_fmac_f32 v219, v21, v210
    v_fmac_f32 v223, v31, v214
    v_fmac_f32 v224, v20, v211
    v_fmac_f32 v228, v30, v215
    v_fmac_f32 v232, v20, v219
    v_fmac_f32 v236, v30, v223
    v_fma_f32 v224, -v21, v219, v224
    v_fma_f32 v228, -v31, v223, v228
    v_fmac_f32 v232, v21, v211
    v_fmac_f32 v236, v31, v215
    v_fmac_f32 v225, v20, v224
    v_fmac_f32 v229, v30, v228
    v_fmac_f32 v233, v20, v232
    v_fmac_f32 v237, v30, v236
    v_fma_f32 v225, -v21, v232, v225
    v_fma_f32 v229, -v31, v236, v229
    v_fmac_f32 v233, v21, v224
    v_fmac_f32 v237, v31, v228
    v_fmac_f32 v226, v20, v225
    v_fmac_f32 v230, v30, v229
    v_fmac_f32 v234, v20, v233
    v_fmac_f32 v238, v30, v237
    v_fma_f32 v226, -v21, v233, v226
    v_fma_f32 v230, -v31, v237, v230
    v_fmac_f32 v234, v21, v225
    v_fmac_f32 v238, v31, v229
    v_fmac_f32 v227, v20, v226
    v_fmac_f32 v231, v30, v230
    v_fmac_f32 v235, v20, v234
    v_fmac_f32 v239, v30, v238
    v_fma_f32 v227, -v21, v234, v227
    v_fma_f32 v231, -v31, v238, v231
    v_fmac_f32 v235, v21, v226
    v_fmac_f32 v239, v31, v230
    v_fmac_f32 v240, v20, v227
    v_fmac_f32 v244, v30, v231
    v_fmac_f32 v248, v20, v235
    v_fmac_f32 v252, v30, v239
    v_fma_f32 v240, -v21, v235, v240
    v_fma_f32 v244, -v31, v239, v244
    v_fmac_f32 v248, v21, v227
    v_fmac_f32 v252, v31, v231
    v_fmac_f32 v241, v20, v240
    v_fmac_f32 v245, v30, v244
    v_fmac_f32 v249, v20, v248
    v_fmac_f32 v253, v30, v252
    v_fma_f32 v241, -v21, v248, v241
    v_fma_f32 v245, -v31, v252, v245
    v_fmac_f32 v249, v21, v240
    v_fmac_f32 v253, v31, v244
    v_fmac_f32 v242, v20, v241
    v_fmac_f32 v246, v30, v245
    v_fmac_f32 v250, v20, v249
    v_fmac_f32 v254, v30, v253
    v_fma_f32 v242, -v21, v249, v242
    v_fma_f32 v246, -v31, v253, v246
    v_fmac_f32 v250, v21, v241
    v_fmac_f32 v254, v31, v245
    v_fmac_f32 v243, v20, v242
    v_fmac_f32 v247, v30, v246
    v_fmac_f32 v251, v20, v250
    v_fmac_f32 v255, v30, v254
    v_fma_f32 v243, -v21, v250, v243
    v_fma_f32 v247, -v31, v254, v247
    v_fmac_f32 v251, v21, v242
    v_fmac_f32 v255, v31, v246
    s_lshl_b32 s58, s32, 1
    s_add_u32 s58, s58, s50
    s_lshl_b32 s58, s58, 7
    s_lshl_b32 s59, s33, 2
    s_add_u32 s58, s58, s59
    s_lshl_b32 s59, s51, 1
    s_add_u32 s58, s58, s59
    s_lshl_b32 s58, s58, 12
    s_add_u32 s58, s58, 0
    v_lshlrev_b32 v62, 4, v0
    v_xor_b32 v63, 64, v62
    v_pk_mul_f32 v[96:97], v[136:137], v[28:29] op_sel:[0,1] op_sel_hi:[1,1]
    v_pk_mul_f32 v[98:99], v[128:129], v[28:29] op_sel:[0,1] op_sel_hi:[1,1]
    v_pk_fma_f32 v[96:97], v[128:129], v[28:29], v[96:97] op_sel:[0,0,0] op_sel_hi:[1,0,1] neg_lo:[0,0,1] neg_hi:[0,0,1]
    v_pk_fma_f32 v[98:99], v[136:137], v[28:29], v[98:99] op_sel:[0,0,0] op_sel_hi:[1,0,1] neg_lo:[1,0,1] neg_hi:[1,0,1]
    v_cvt_pk_bf16_f32 v64, v96, v97
    v_cvt_pk_bf16_f32 v68, v98, v99
    v_pk_mul_f32 v[96:97], v[138:139], v[28:29] op_sel:[0,1] op_sel_hi:[1,1]
    v_pk_mul_f32 v[98:99], v[130:131], v[28:29] op_sel:[0,1] op_sel_hi:[1,1]
    v_pk_fma_f32 v[96:97], v[130:131], v[28:29], v[96:97] op_sel:[0,0,0] op_sel_hi:[1,0,1] neg_lo:[0,0,1] neg_hi:[0,0,1]
    v_pk_fma_f32 v[98:99], v[138:139], v[28:29], v[98:99] op_sel:[0,0,0] op_sel_hi:[1,0,1] neg_lo:[1,0,1] neg_hi:[1,0,1]
    v_cvt_pk_bf16_f32 v65, v96, v97
    v_cvt_pk_bf16_f32 v69, v98, v99
    v_pk_mul_f32 v[96:97], v[152:153], v[28:29] op_sel:[0,1] op_sel_hi:[1,1]
    v_pk_mul_f32 v[98:99], v[144:145], v[28:29] op_sel:[0,1] op_sel_hi:[1,1]
    v_pk_fma_f32 v[96:97], v[144:145], v[28:29], v[96:97] op_sel:[0,0,0] op_sel_hi:[1,0,1] neg_lo:[0,0,1] neg_hi:[0,0,1]
    v_pk_fma_f32 v[98:99], v[152:153], v[28:29], v[98:99] op_sel:[0,0,0] op_sel_hi:[1,0,1] neg_lo:[1,0,1] neg_hi:[1,0,1]
    v_cvt_pk_bf16_f32 v66, v96, v97
    v_cvt_pk_bf16_f32 v70, v98, v99
    v_pk_mul_f32 v[96:97], v[154:155], v[28:29] op_sel:[0,1] op_sel_hi:[1,1]
    v_pk_mul_f32 v[98:99], v[146:147], v[28:29] op_sel:[0,1] op_sel_hi:[1,1]
    v_pk_fma_f32 v[96:97], v[146:147], v[28:29], v[96:97] op_sel:[0,0,0] op_sel_hi:[1,0,1] neg_lo:[0,0,1] neg_hi:[0,0,1]
    v_pk_fma_f32 v[98:99], v[154:155], v[28:29], v[98:99] op_sel:[0,0,0] op_sel_hi:[1,0,1] neg_lo:[1,0,1] neg_hi:[1,0,1]
    v_cvt_pk_bf16_f32 v67, v96, v97
    v_cvt_pk_bf16_f32 v71, v98, v99
    s_add_u32 s59, s58, 0
    buffer_store_dwordx4 v[64:67], v62, s[64:67], s59 offen sc1
    s_add_u32 s59, s59, 262144
    buffer_store_dwordx4 v[68:71], v62, s[64:67], s59 offen sc1
    v_pk_mul_f32 v[96:97], v[168:169], v[28:29] op_sel:[0,1] op_sel_hi:[1,1]
    v_pk_mul_f32 v[98:99], v[160:161], v[28:29] op_sel:[0,1] op_sel_hi:[1,1]
    v_pk_fma_f32 v[96:97], v[160:161], v[28:29], v[96:97] op_sel:[0,0,0] op_sel_hi:[1,0,1] neg_lo:[0,0,1] neg_hi:[0,0,1]
    v_pk_fma_f32 v[98:99], v[168:169], v[28:29], v[98:99] op_sel:[0,0,0] op_sel_hi:[1,0,1] neg_lo:[1,0,1] neg_hi:[1,0,1]
    v_cvt_pk_bf16_f32 v72, v96, v97
    v_cvt_pk_bf16_f32 v76, v98, v99
    v_pk_mul_f32 v[96:97], v[170:171], v[28:29] op_sel:[0,1] op_sel_hi:[1,1]
    v_pk_mul_f32 v[98:99], v[162:163], v[28:29] op_sel:[0,1] op_sel_hi:[1,1]
    v_pk_fma_f32 v[96:97], v[162:163], v[28:29], v[96:97] op_sel:[0,0,0] op_sel_hi:[1,0,1] neg_lo:[0,0,1] neg_hi:[0,0,1]
    v_pk_fma_f32 v[98:99], v[170:171], v[28:29], v[98:99] op_sel:[0,0,0] op_sel_hi:[1,0,1] neg_lo:[1,0,1] neg_hi:[1,0,1]
    v_cvt_pk_bf16_f32 v73, v96, v97
    v_cvt_pk_bf16_f32 v77, v98, v99
    v_pk_mul_f32 v[96:97], v[184:185], v[28:29] op_sel:[0,1] op_sel_hi:[1,1]
    v_pk_mul_f32 v[98:99], v[176:177], v[28:29] op_sel:[0,1] op_sel_hi:[1,1]
    v_pk_fma_f32 v[96:97], v[176:177], v[28:29], v[96:97] op_sel:[0,0,0] op_sel_hi:[1,0,1] neg_lo:[0,0,1] neg_hi:[0,0,1]
    v_pk_fma_f32 v[98:99], v[184:185], v[28:29], v[98:99] op_sel:[0,0,0] op_sel_hi:[1,0,1] neg_lo:[1,0,1] neg_hi:[1,0,1]
    v_cvt_pk_bf16_f32 v74, v96, v97
    v_cvt_pk_bf16_f32 v78, v98, v99
    v_pk_mul_f32 v[96:97], v[186:187], v[28:29] op_sel:[0,1] op_sel_hi:[1,1]
    v_pk_mul_f32 v[98:99], v[178:179], v[28:29] op_sel:[0,1] op_sel_hi:[1,1]
    v_pk_fma_f32 v[96:97], v[178:179], v[28:29], v[96:97] op_sel:[0,0,0] op_sel_hi:[1,0,1] neg_lo:[0,0,1] neg_hi:[0,0,1]
    v_pk_fma_f32 v[98:99], v[186:187], v[28:29], v[98:99] op_sel:[0,0,0] op_sel_hi:[1,0,1] neg_lo:[1,0,1] neg_hi:[1,0,1]
    v_cvt_pk_bf16_f32 v75, v96, v97
    v_cvt_pk_bf16_f32 v79, v98, v99
    s_add_u32 s59, s58, 1024
    buffer_store_dwordx4 v[72:75], v63, s[64:67], s59 offen sc1
    s_add_u32 s59, s59, 262144
    buffer_store_dwordx4 v[76:79], v63, s[64:67], s59 offen sc1
    v_pk_mul_f32 v[96:97], v[200:201], v[28:29] op_sel:[0,1] op_sel_hi:[1,1]
    v_pk_mul_f32 v[98:99], v[192:193], v[28:29] op_sel:[0,1] op_sel_hi:[1,1]
    v_pk_fma_f32 v[96:97], v[192:193], v[28:29], v[96:97] op_sel:[0,0,0] op_sel_hi:[1,0,1] neg_lo:[0,0,1] neg_hi:[0,0,1]
    v_pk_fma_f32 v[98:99], v[200:201], v[28:29], v[98:99] op_sel:[0,0,0] op_sel_hi:[1,0,1] neg_lo:[1,0,1] neg_hi:[1,0,1]
    v_cvt_pk_bf16_f32 v64, v96, v97
    v_cvt_pk_bf16_f32 v68, v98, v99
    v_pk_mul_f32 v[96:97], v[202:203], v[28:29] op_sel:[0,1] op_sel_hi:[1,1]
    v_pk_mul_f32 v[98:99], v[194:195], v[28:29] op_sel:[0,1] op_sel_hi:[1,1]
    v_pk_fma_f32 v[96:97], v[194:195], v[28:29], v[96:97] op_sel:[0,0,0] op_sel_hi:[1,0,1] neg_lo:[0,0,1] neg_hi:[0,0,1]
    v_pk_fma_f32 v[98:99], v[202:203], v[28:29], v[98:99] op_sel:[0,0,0] op_sel_hi:[1,0,1] neg_lo:[1,0,1] neg_hi:[1,0,1]
    v_cvt_pk_bf16_f32 v65, v96, v97
    v_cvt_pk_bf16_f32 v69, v98, v99
    v_pk_mul_f32 v[96:97], v[216:217], v[28:29] op_sel:[0,1] op_sel_hi:[1,1]
    v_pk_mul_f32 v[98:99], v[208:209], v[28:29] op_sel:[0,1] op_sel_hi:[1,1]
    v_pk_fma_f32 v[96:97], v[208:209], v[28:29], v[96:97] op_sel:[0,0,0] op_sel_hi:[1,0,1] neg_lo:[0,0,1] neg_hi:[0,0,1]
    v_pk_fma_f32 v[98:99], v[216:217], v[28:29], v[98:99] op_sel:[0,0,0] op_sel_hi:[1,0,1] neg_lo:[1,0,1] neg_hi:[1,0,1]
    v_cvt_pk_bf16_f32 v66, v96, v97
    v_cvt_pk_bf16_f32 v70, v98, v99
    v_pk_mul_f32 v[96:97], v[218:219], v[28:29] op_sel:[0,1] op_sel_hi:[1,1]
    v_pk_mul_f32 v[98:99], v[210:211], v[28:29] op_sel:[0,1] op_sel_hi:[1,1]
    v_pk_fma_f32 v[96:97], v[210:211], v[28:29], v[96:97] op_sel:[0,0,0] op_sel_hi:[1,0,1] neg_lo:[0,0,1] neg_hi:[0,0,1]
    v_pk_fma_f32 v[98:99], v[218:219], v[28:29], v[98:99] op_sel:[0,0,0] op_sel_hi:[1,0,1] neg_lo:[1,0,1] neg_hi:[1,0,1]
    v_cvt_pk_bf16_f32 v67, v96, v97
    v_cvt_pk_bf16_f32 v71, v98, v99
    s_add_u32 s59, s58, 2048
    buffer_store_dwordx4 v[64:67], v62, s[64:67], s59 offen sc1
    s_add_u32 s59, s59, 262144
    buffer_store_dwordx4 v[68:71], v62, s[64:67], s59 offen sc1
    v_pk_mul_f32 v[96:97], v[232:233], v[28:29] op_sel:[0,1] op_sel_hi:[1,1]
    v_pk_mul_f32 v[98:99], v[224:225], v[28:29] op_sel:[0,1] op_sel_hi:[1,1]
    v_pk_fma_f32 v[96:97], v[224:225], v[28:29], v[96:97] op_sel:[0,0,0] op_sel_hi:[1,0,1] neg_lo:[0,0,1] neg_hi:[0,0,1]
    v_pk_fma_f32 v[98:99], v[232:233], v[28:29], v[98:99] op_sel:[0,0,0] op_sel_hi:[1,0,1] neg_lo:[1,0,1] neg_hi:[1,0,1]
    v_cvt_pk_bf16_f32 v72, v96, v97
    v_cvt_pk_bf16_f32 v76, v98, v99
    v_pk_mul_f32 v[96:97], v[234:235], v[28:29] op_sel:[0,1] op_sel_hi:[1,1]
    v_pk_mul_f32 v[98:99], v[226:227], v[28:29] op_sel:[0,1] op_sel_hi:[1,1]
    v_pk_fma_f32 v[96:97], v[226:227], v[28:29], v[96:97] op_sel:[0,0,0] op_sel_hi:[1,0,1] neg_lo:[0,0,1] neg_hi:[0,0,1]
    v_pk_fma_f32 v[98:99], v[234:235], v[28:29], v[98:99] op_sel:[0,0,0] op_sel_hi:[1,0,1] neg_lo:[1,0,1] neg_hi:[1,0,1]
    v_cvt_pk_bf16_f32 v73, v96, v97
    v_cvt_pk_bf16_f32 v77, v98, v99
    v_pk_mul_f32 v[96:97], v[248:249], v[28:29] op_sel:[0,1] op_sel_hi:[1,1]
    v_pk_mul_f32 v[98:99], v[240:241], v[28:29] op_sel:[0,1] op_sel_hi:[1,1]
    v_pk_fma_f32 v[96:97], v[240:241], v[28:29], v[96:97] op_sel:[0,0,0] op_sel_hi:[1,0,1] neg_lo:[0,0,1] neg_hi:[0,0,1]
    v_pk_fma_f32 v[98:99], v[248:249], v[28:29], v[98:99] op_sel:[0,0,0] op_sel_hi:[1,0,1] neg_lo:[1,0,1] neg_hi:[1,0,1]
    v_cvt_pk_bf16_f32 v74, v96, v97
    v_cvt_pk_bf16_f32 v78, v98, v99
    v_pk_mul_f32 v[96:97], v[250:251], v[28:29] op_sel:[0,1] op_sel_hi:[1,1]
    v_pk_mul_f32 v[98:99], v[242:243], v[28:29] op_sel:[0,1] op_sel_hi:[1,1]
    v_pk_fma_f32 v[96:97], v[242:243], v[28:29], v[96:97] op_sel:[0,0,0] op_sel_hi:[1,0,1] neg_lo:[0,0,1] neg_hi:[0,0,1]
    v_pk_fma_f32 v[98:99], v[250:251], v[28:29], v[98:99] op_sel:[0,0,0] op_sel_hi:[1,0,1] neg_lo:[1,0,1] neg_hi:[1,0,1]
    v_cvt_pk_bf16_f32 v75, v96, v97
    v_cvt_pk_bf16_f32 v79, v98, v99
    s_add_u32 s59, s58, 3072
    buffer_store_dwordx4 v[72:75], v63, s[64:67], s59 offen sc1
    s_add_u32 s59, s59, 262144
    buffer_store_dwordx4 v[76:79], v63, s[64:67], s59 offen sc1
    v_pk_mul_f32 v[96:97], v[140:141], v[38:39] op_sel:[0,1] op_sel_hi:[1,1]
    v_pk_mul_f32 v[98:99], v[132:133], v[38:39] op_sel:[0,1] op_sel_hi:[1,1]
    v_pk_fma_f32 v[96:97], v[132:133], v[38:39], v[96:97] op_sel:[0,0,0] op_sel_hi:[1,0,1] neg_lo:[0,0,1] neg_hi:[0,0,1]
    v_pk_fma_f32 v[98:99], v[140:141], v[38:39], v[98:99] op_sel:[0,0,0] op_sel_hi:[1,0,1] neg_lo:[1,0,1] neg_hi:[1,0,1]
    v_cvt_pk_bf16_f32 v64, v96, v97
    v_cvt_pk_bf16_f32 v68, v98, v99
    v_pk_mul_f32 v[96:97], v[142:143], v[38:39] op_sel:[0,1] op_sel_hi:[1,1]
    v_pk_mul_f32 v[98:99], v[134:135], v[38:39] op_sel:[0,1] op_sel_hi:[1,1]
    v_pk_fma_f32 v[96:97], v[134:135], v[38:39], v[96:97] op_sel:[0,0,0] op_sel_hi:[1,0,1] neg_lo:[0,0,1] neg_hi:[0,0,1]
    v_pk_fma_f32 v[98:99], v[142:143], v[38:39], v[98:99] op_sel:[0,0,0] op_sel_hi:[1,0,1] neg_lo:[1,0,1] neg_hi:[1,0,1]
    v_cvt_pk_bf16_f32 v65, v96, v97
    v_cvt_pk_bf16_f32 v69, v98, v99
    v_pk_mul_f32 v[96:97], v[156:157], v[38:39] op_sel:[0,1] op_sel_hi:[1,1]
    v_pk_mul_f32 v[98:99], v[148:149], v[38:39] op_sel:[0,1] op_sel_hi:[1,1]
    v_pk_fma_f32 v[96:97], v[148:149], v[38:39], v[96:97] op_sel:[0,0,0] op_sel_hi:[1,0,1] neg_lo:[0,0,1] neg_hi:[0,0,1]
    v_pk_fma_f32 v[98:99], v[156:157], v[38:39], v[98:99] op_sel:[0,0,0] op_sel_hi:[1,0,1] neg_lo:[1,0,1] neg_hi:[1,0,1]
    v_cvt_pk_bf16_f32 v66, v96, v97
    v_cvt_pk_bf16_f32 v70, v98, v99
    v_pk_mul_f32 v[96:97], v[158:159], v[38:39] op_sel:[0,1] op_sel_hi:[1,1]
    v_pk_mul_f32 v[98:99], v[150:151], v[38:39] op_sel:[0,1] op_sel_hi:[1,1]
    v_pk_fma_f32 v[96:97], v[150:151], v[38:39], v[96:97] op_sel:[0,0,0] op_sel_hi:[1,0,1] neg_lo:[0,0,1] neg_hi:[0,0,1]
    v_pk_fma_f32 v[98:99], v[158:159], v[38:39], v[98:99] op_sel:[0,0,0] op_sel_hi:[1,0,1] neg_lo:[1,0,1] neg_hi:[1,0,1]
    v_cvt_pk_bf16_f32 v67, v96, v97
    v_cvt_pk_bf16_f32 v71, v98, v99
    s_add_u32 s59, s58, 4096
    buffer_store_dwordx4 v[64:67], v62, s[64:67], s59 offen sc1
    s_add_u32 s59, s59, 262144
    buffer_store_dwordx4 v[68:71], v62, s[64:67], s59 offen sc1
    v_pk_mul_f32 v[96:97], v[172:173], v[38:39] op_sel:[0,1] op_sel_hi:[1,1]
    v_pk_mul_f32 v[98:99], v[164:165], v[38:39] op_sel:[0,1] op_sel_hi:[1,1]
    v_pk_fma_f32 v[96:97], v[164:165], v[38:39], v[96:97] op_sel:[0,0,0] op_sel_hi:[1,0,1] neg_lo:[0,0,1] neg_hi:[0,0,1]
    v_pk_fma_f32 v[98:99], v[172:173], v[38:39], v[98:99] op_sel:[0,0,0] op_sel_hi:[1,0,1] neg_lo:[1,0,1] neg_hi:[1,0,1]
    v_cvt_pk_bf16_f32 v72, v96, v97
    v_cvt_pk_bf16_f32 v76, v98, v99
    v_pk_mul_f32 v[96:97], v[174:175], v[38:39] op_sel:[0,1] op_sel_hi:[1,1]
    v_pk_mul_f32 v[98:99], v[166:167], v[38:39] op_sel:[0,1] op_sel_hi:[1,1]
    v_pk_fma_f32 v[96:97], v[166:167], v[38:39], v[96:97] op_sel:[0,0,0] op_sel_hi:[1,0,1] neg_lo:[0,0,1] neg_hi:[0,0,1]
    v_pk_fma_f32 v[98:99], v[174:175], v[38:39], v[98:99] op_sel:[0,0,0] op_sel_hi:[1,0,1] neg_lo:[1,0,1] neg_hi:[1,0,1]
    v_cvt_pk_bf16_f32 v73, v96, v97
    v_cvt_pk_bf16_f32 v77, v98, v99
    v_pk_mul_f32 v[96:97], v[188:189], v[38:39] op_sel:[0,1] op_sel_hi:[1,1]
    v_pk_mul_f32 v[98:99], v[180:181], v[38:39] op_sel:[0,1] op_sel_hi:[1,1]
    v_pk_fma_f32 v[96:97], v[180:181], v[38:39], v[96:97] op_sel:[0,0,0] op_sel_hi:[1,0,1] neg_lo:[0,0,1] neg_hi:[0,0,1]
    v_pk_fma_f32 v[98:99], v[188:189], v[38:39], v[98:99] op_sel:[0,0,0] op_sel_hi:[1,0,1] neg_lo:[1,0,1] neg_hi:[1,0,1]
    v_cvt_pk_bf16_f32 v74, v96, v97
    v_cvt_pk_bf16_f32 v78, v98, v99
    v_pk_mul_f32 v[96:97], v[190:191], v[38:39] op_sel:[0,1] op_sel_hi:[1,1]
    v_pk_mul_f32 v[98:99], v[182:183], v[38:39] op_sel:[0,1] op_sel_hi:[1,1]
    v_pk_fma_f32 v[96:97], v[182:183], v[38:39], v[96:97] op_sel:[0,0,0] op_sel_hi:[1,0,1] neg_lo:[0,0,1] neg_hi:[0,0,1]
    v_pk_fma_f32 v[98:99], v[190:191], v[38:39], v[98:99] op_sel:[0,0,0] op_sel_hi:[1,0,1] neg_lo:[1,0,1] neg_hi:[1,0,1]
    v_cvt_pk_bf16_f32 v75, v96, v97
    v_cvt_pk_bf16_f32 v79, v98, v99
    s_add_u32 s59, s58, 5120
    buffer_store_dwordx4 v[72:75], v63, s[64:67], s59 offen sc1
    s_add_u32 s59, s59, 262144
    buffer_store_dwordx4 v[76:79], v63, s[64:67], s59 offen sc1
    v_pk_mul_f32 v[96:97], v[204:205], v[38:39] op_sel:[0,1] op_sel_hi:[1,1]
    v_pk_mul_f32 v[98:99], v[196:197], v[38:39] op_sel:[0,1] op_sel_hi:[1,1]
    v_pk_fma_f32 v[96:97], v[196:197], v[38:39], v[96:97] op_sel:[0,0,0] op_sel_hi:[1,0,1] neg_lo:[0,0,1] neg_hi:[0,0,1]
    v_pk_fma_f32 v[98:99], v[204:205], v[38:39], v[98:99] op_sel:[0,0,0] op_sel_hi:[1,0,1] neg_lo:[1,0,1] neg_hi:[1,0,1]
    v_cvt_pk_bf16_f32 v64, v96, v97
    v_cvt_pk_bf16_f32 v68, v98, v99
    v_pk_mul_f32 v[96:97], v[206:207], v[38:39] op_sel:[0,1] op_sel_hi:[1,1]
    v_pk_mul_f32 v[98:99], v[198:199], v[38:39] op_sel:[0,1] op_sel_hi:[1,1]
    v_pk_fma_f32 v[96:97], v[198:199], v[38:39], v[96:97] op_sel:[0,0,0] op_sel_hi:[1,0,1] neg_lo:[0,0,1] neg_hi:[0,0,1]
    v_pk_fma_f32 v[98:99], v[206:207], v[38:39], v[98:99] op_sel:[0,0,0] op_sel_hi:[1,0,1] neg_lo:[1,0,1] neg_hi:[1,0,1]
    v_cvt_pk_bf16_f32 v65, v96, v97
    v_cvt_pk_bf16_f32 v69, v98, v99
    v_pk_mul_f32 v[96:97], v[220:221], v[38:39] op_sel:[0,1] op_sel_hi:[1,1]
    v_pk_mul_f32 v[98:99], v[212:213], v[38:39] op_sel:[0,1] op_sel_hi:[1,1]
    v_pk_fma_f32 v[96:97], v[212:213], v[38:39], v[96:97] op_sel:[0,0,0] op_sel_hi:[1,0,1] neg_lo:[0,0,1] neg_hi:[0,0,1]
    v_pk_fma_f32 v[98:99], v[220:221], v[38:39], v[98:99] op_sel:[0,0,0] op_sel_hi:[1,0,1] neg_lo:[1,0,1] neg_hi:[1,0,1]
    v_cvt_pk_bf16_f32 v66, v96, v97
    v_cvt_pk_bf16_f32 v70, v98, v99
    v_pk_mul_f32 v[96:97], v[222:223], v[38:39] op_sel:[0,1] op_sel_hi:[1,1]
    v_pk_mul_f32 v[98:99], v[214:215], v[38:39] op_sel:[0,1] op_sel_hi:[1,1]
    v_pk_fma_f32 v[96:97], v[214:215], v[38:39], v[96:97] op_sel:[0,0,0] op_sel_hi:[1,0,1] neg_lo:[0,0,1] neg_hi:[0,0,1]
    v_pk_fma_f32 v[98:99], v[222:223], v[38:39], v[98:99] op_sel:[0,0,0] op_sel_hi:[1,0,1] neg_lo:[1,0,1] neg_hi:[1,0,1]
    v_cvt_pk_bf16_f32 v67, v96, v97
    v_cvt_pk_bf16_f32 v71, v98, v99
    s_add_u32 s59, s58, 6144
    buffer_store_dwordx4 v[64:67], v62, s[64:67], s59 offen sc1
    s_add_u32 s59, s59, 262144
    buffer_store_dwordx4 v[68:71], v62, s[64:67], s59 offen sc1
    v_pk_mul_f32 v[96:97], v[236:237], v[38:39] op_sel:[0,1] op_sel_hi:[1,1]
    v_pk_mul_f32 v[98:99], v[228:229], v[38:39] op_sel:[0,1] op_sel_hi:[1,1]
    v_pk_fma_f32 v[96:97], v[228:229], v[38:39], v[96:97] op_sel:[0,0,0] op_sel_hi:[1,0,1] neg_lo:[0,0,1] neg_hi:[0,0,1]
    v_pk_fma_f32 v[98:99], v[236:237], v[38:39], v[98:99] op_sel:[0,0,0] op_sel_hi:[1,0,1] neg_lo:[1,0,1] neg_hi:[1,0,1]
    v_cvt_pk_bf16_f32 v72, v96, v97
    v_cvt_pk_bf16_f32 v76, v98, v99
    v_pk_mul_f32 v[96:97], v[238:239], v[38:39] op_sel:[0,1] op_sel_hi:[1,1]
    v_pk_mul_f32 v[98:99], v[230:231], v[38:39] op_sel:[0,1] op_sel_hi:[1,1]
    v_pk_fma_f32 v[96:97], v[230:231], v[38:39], v[96:97] op_sel:[0,0,0] op_sel_hi:[1,0,1] neg_lo:[0,0,1] neg_hi:[0,0,1]
    v_pk_fma_f32 v[98:99], v[238:239], v[38:39], v[98:99] op_sel:[0,0,0] op_sel_hi:[1,0,1] neg_lo:[1,0,1] neg_hi:[1,0,1]
    v_cvt_pk_bf16_f32 v73, v96, v97
    v_cvt_pk_bf16_f32 v77, v98, v99
    v_pk_mul_f32 v[96:97], v[252:253], v[38:39] op_sel:[0,1] op_sel_hi:[1,1]
    v_pk_mul_f32 v[98:99], v[244:245], v[38:39] op_sel:[0,1] op_sel_hi:[1,1]
    v_pk_fma_f32 v[96:97], v[244:245], v[38:39], v[96:97] op_sel:[0,0,0] op_sel_hi:[1,0,1] neg_lo:[0,0,1] neg_hi:[0,0,1]
    v_pk_fma_f32 v[98:99], v[252:253], v[38:39], v[98:99] op_sel:[0,0,0] op_sel_hi:[1,0,1] neg_lo:[1,0,1] neg_hi:[1,0,1]
    v_cvt_pk_bf16_f32 v74, v96, v97
    v_cvt_pk_bf16_f32 v78, v98, v99
    v_pk_mul_f32 v[96:97], v[254:255], v[38:39] op_sel:[0,1] op_sel_hi:[1,1]
    v_pk_mul_f32 v[98:99], v[246:247], v[38:39] op_sel:[0,1] op_sel_hi:[1,1]
    v_pk_fma_f32 v[96:97], v[246:247], v[38:39], v[96:97] op_sel:[0,0,0] op_sel_hi:[1,0,1] neg_lo:[0,0,1] neg_hi:[0,0,1]
    v_pk_fma_f32 v[98:99], v[254:255], v[38:39], v[98:99] op_sel:[0,0,0] op_sel_hi:[1,0,1] neg_lo:[1,0,1] neg_hi:[1,0,1]
    v_cvt_pk_bf16_f32 v75, v96, v97
    v_cvt_pk_bf16_f32 v79, v98, v99
    s_add_u32 s59, s58, 7168
    buffer_store_dwordx4 v[72:75], v63, s[64:67], s59 offen sc1
    s_add_u32 s59, s59, 262144
    buffer_store_dwordx4 v[76:79], v63, s[64:67], s59 offen sc1
    s_lshl_b32 s58, s32, 4
    s_add_u32 s58, s58, s33
    s_lshl_b32 s58, s58, 7
    s_lshl_b32 s59, s35, 2
    s_add_u32 s58, s58, s59
    s_add_u32 s58, s58, 12783616
    s_waitcnt vmcnt(0)
    v_mov_b32 v96, s91
    v_mov_b32 v97, 0
    v_cmp_eq_u32 vcc, 0, v0
    s_and_saveexec_b64 s[60:61], vcc
    buffer_store_dword v96, v97, s[64:67], s58 offen sc1
    s_mov_b64 exec, s[60:61]
    s_and_b32 s32, s30, 1
    s_lshl_b32 s32, s32, 3
    s_bfe_u32 s33, s30, 0x10001
    s_lshl_b32 s33, s33, 2
    s_add_u32 s32, s32, s33
    s_and_b32 s33, s31, 3
    s_add_u32 s32, s32, s33
    s_lshr_b32 s33, s30, 2
    s_lshl_b32 s33, s33, 2
    s_bfe_u32 s34, s31, 0x20002
    s_add_u32 s33, s33, s34
    s_waitcnt lgkmcnt(0)
    s_barrier
    v_lshlrev_b32 v2, 4, v0
    s_lshl_b32 s16, s35, 12
    s_lshl_b32 s48, s35, 12
    s_add_u32 s49, s48, 16384
    s_mov_b32 s11, 0x20000
    s_mov_b32 s15, 0x20000
    s_mov_b32 s14, 2097152
    s_lshl_b32 s36, s32, 19
    s_add_u32 s36, s36, 0
    s_add_u32 s88, s78, s36
    s_addc_u32 s89, s79, 0
    s_and_b32 s89, s89, 0xffff
    s_lshl_b32 s90, s32, 1
    s_lshl_b32 s76, s90, 14
    s_add_u32 s8, s88, s76
    s_addc_u32 s9, s89, 0
    s_mov_b32 s10, 524288
    s_and_b32 s69, s69, 0xffff
    s_and_b32 s71, s71, 0xffff
    s_and_b32 s73, s73, 0xffff
    s_cmp_lt_u32 s90, 16
    s_cselect_b32 s12, s68, s70
    s_cselect_b32 s13, s69, s71
    s_and_b32 s77, s90, 15
    s_lshl_b32 s77, s77, 7
    s_add_u32 s12, s12, s77
    s_addc_u32 s13, s13, 0
    v_lshrrev_b32 v4, 3, v0
    v_lshlrev_b32 v4, 11, v4
    v_and_b32 v5, 7, v0
    v_lshrrev_b32 v6, 4, v0
    v_xor_b32 v5, v5, v6
    v_lshlrev_b32 v5, 4, v5
    v_add_u32 v4, v4, v5
    v_xor_b32 v5, 64, v4
    s_lshl_b32 s36, s33, 7
    s_lshl_b32 s37, s35, 5
    s_add_u32 s36, s36, s37
    s_lshl_b32 s36, s36, 11
    s_add_u32 s24, s36, 0
    s_add_u32 s25, s36, 15360
    s_add_u32 s26, s36, 30720
    s_add_u32 s27, s36, 46080
    s_add_u32 m0, s49, 0
    s_nop 0
    buffer_load_dwordx4 v4, s[12:15], s24 offen offset:0 lds
    buffer_load_dwordx4 v5, s[12:15], s25 offen offset:1024 lds
    buffer_load_dwordx4 v4, s[12:15], s26 offen offset:2048 lds
    buffer_load_dwordx4 v5, s[12:15], s27 offen offset:3072 lds
    s_add_u32 s90, s90, 1
    s_and_b32 s90, s90, 31
    s_cmp_lt_u32 s90, 16
    s_cselect_b32 s12, s68, s70
    s_cselect_b32 s13, s69, s71
    s_and_b32 s77, s90, 15
    s_lshl_b32 s77, s77, 7
    s_add_u32 s12, s12, s77
    s_addc_u32 s13, s13, 0
    s_add_u32 m0, s49, 32768
    s_nop 0
    buffer_load_dwordx4 v4, s[12:15], s24 offen offset:0 lds
    buffer_load_dwordx4 v5, s[12:15], s25 offen offset:1024 lds
    buffer_load_dwordx4 v4, s[12:15], s26 offen offset:2048 lds
    buffer_load_dwordx4 v5, s[12:15], s27 offen offset:3072 lds
    s_add_u32 s90, s90, 1
    s_and_b32 s90, s90, 31
    s_cmp_lt_u32 s90, 16
    s_cselect_b32 s12, s68, s70
    s_cselect_b32 s13, s69, s71
    s_and_b32 s77, s90, 15
    s_lshl_b32 s77, s77, 7
    s_add_u32 s12, s12, s77
    s_addc_u32 s13, s13, 0
    s_add_u32 m0, s49, 65536
    s_nop 0
    buffer_load_dwordx4 v4, s[12:15], s24 offen offset:0 lds
    buffer_load_dwordx4 v5, s[12:15], s25 offen offset:1024 lds
    buffer_load_dwordx4 v4, s[12:15], s26 offen offset:2048 lds
    buffer_load_dwordx4 v5, s[12:15], s27 offen offset:3072 lds
    s_add_u32 s90, s90, 1
    s_and_b32 s90, s90, 31
    s_cmp_lt_u32 s90, 16
    s_cselect_b32 s12, s68, s70
    s_cselect_b32 s13, s69, s71
    s_and_b32 s77, s90, 15
    s_lshl_b32 s77, s77, 7
    s_add_u32 s12, s12, s77
    s_addc_u32 s13, s13, 0
    v_and_b32 v14, 15, v0
    v_lshlrev_b32 v14, 7, v14
    v_lshrrev_b32 v15, 4, v0
    v_bfe_u32 v16, v0, 1, 3
    v_xor_b32 v15, v15, v16
    v_lshlrev_b32 v15, 4, v15
    v_add_u32 v14, v14, v15
    s_lshl_b32 s52, s50, 13
    s_add_u32 s52, s52, 16384
    v_add_u32 v32, s52, v14
    v_xor_b32 v33, 64, v32
    v_add_u32 v34, 0x10000, v32
    v_add_u32 v35, 0x10000, v33
    v_lshrrev_b32 v14, 5, v0
    v_lshlrev_b32 v14, 12, v14
    v_bfe_u32 v15, v0, 1, 1
    v_lshlrev_b32 v16, 10, v15
    v_add_u32 v14, v14, v16
    v_bfe_u32 v16, v0, 4, 1
    v_lshlrev_b32 v16, 3, v16
    v_bfe_u32 v19, v0, 2, 2
    v_add_u32 v16, v16, v19
    v_lshlrev_b32 v15, 2, v15
    v_xor_b32 v16, v16, v15
    v_lshlrev_b32 v16, 4, v16
    v_add_u32 v14, v14, v16
    v_and_b32 v16, 1, v0
    v_lshlrev_b32 v16, 3, v16
    v_add_u32 v14, v14, v16
    s_lshl_b32 s53, s51, 9
    v_add_u32 v36, s53, v14
    v_xor_b32 v37, 64, v36
    v_add_u32 v38, 0x10000, v36
    v_add_u32 v39, 0x10000, v37
    v_and_b32 v20, 15, v0
    s_lshl_b32 s36, s32, 7
    s_lshl_b32 s37, s51, 6
    s_add_u32 s36, s36, s37
    v_add_u32 v20, s36, v20
    v_lshlrev_b32 v22, 2, v20
    v_lshrrev_b32 v28, 4, v0
    v_lshlrev_b32 v28, 3, v28
    s_lshl_b32 s36, s33, 7
    s_lshl_b32 s37, s50, 6
    s_add_u32 s36, s36, s37
    s_lshl_b32 s36, s36, 1
    v_add_u32 v28, s36, v28
    s_lshr_b32 s36, s32, 1
    s_lshl_b32 s36, s36, 11
    s_add_u32 s37, s36, 12783616
    s_add_u32 s96, s36, 12800000
    v_lshrrev_b32 v23, 2, v0
    v_lshlrev_b32 v23, 7, v23
    v_and_b32 v24, 3, v0
    v_lshlrev_b32 v24, 2, v24
    v_add_u32 v23, v23, v24
    s_mov_b32 s63, 0
Lpoll_7:
    buffer_load_dword v24, v23, s[64:67], s37 offen sc1
    s_waitcnt vmcnt(0)
    v_cmp_ne_u32 vcc, s91, v24
    s_add_u32 s63, s63, 1
    s_cbranch_vccz Lpolldone_8
    s_sleep 2
    s_cmp_lt_u32 s63, 0x100000
    s_cbranch_scc1 Lpoll_7
Lpolldone_8:
    s_add_u32 m0, s48, 0
    s_nop 0
    buffer_load_dwordx4 v2, s[8:11], s16 offen offset:0 lds
    buffer_load_dwordx4 v2, s[8:11], s16 offen offset:1024 lds
    buffer_load_dwordx4 v2, s[8:11], s16 offen offset:2048 lds
    buffer_load_dwordx4 v2, s[8:11], s16 offen offset:3072 lds
    s_add_u32 s76, s76, 16384
    s_and_b32 s76, s76, 524287
    s_add_u32 s8, s88, s76
    s_addc_u32 s9, s89, 0
    s_add_u32 m0, s48, 32768
    s_nop 0
    buffer_load_dwordx4 v2, s[8:11], s16 offen offset:0 lds
    buffer_load_dwordx4 v2, s[8:11], s16 offen offset:1024 lds
    buffer_load_dwordx4 v2, s[8:11], s16 offen offset:2048 lds
    buffer_load_dwordx4 v2, s[8:11], s16 offen offset:3072 lds
    s_add_u32 s76, s76, 16384
    s_and_b32 s76, s76, 524287
    s_add_u32 s8, s88, s76
    s_addc_u32 s9, s89, 0
    s_add_u32 m0, s48, 65536
    s_nop 0
    buffer_load_dwordx4 v2, s[8:11], s16 offen offset:0 lds
    buffer_load_dwordx4 v2, s[8:11], s16 offen offset:1024 lds
    buffer_load_dwordx4 v2, s[8:11], s16 offen offset:2048 lds
    buffer_load_dwordx4 v2, s[8:11], s16 offen offset:3072 lds
    s_add_u32 s76, s76, 16384
    s_and_b32 s76, s76, 524287
    s_add_u32 s8, s88, s76
    s_addc_u32 s9, s89, 0
    s_mov_b32 s84, s80
    s_and_b32 s85, s81, 0xffff
    s_mov_b32 s86, 4194304
    s_mov_b32 s87, 0x20000
    v_lshrrev_b32 v6, 4, v0
    v_and_b32 v7, 15, v0
    v_xor_b32 v7, v7, v6
    v_lshlrev_b32 v7, 4, v7
    v_lshlrev_b32 v6, 11, v6
    v_add_u32 v8, v6, v7
    v_xor_b32 v9, 64, v8
    v_xor_b32 v10, 128, v8
    v_xor_b32 v11, 192, v8
    s_lshl_b32 s36, s32, 7
    s_lshl_b32 s37, s35, 5
    s_add_u32 s36, s36, s37
    s_lshl_b32 s36, s36, 11
    s_lshl_b32 s37, s33, 8
    s_add_u32 s36, s36, s37
    s_lshl_b32 s37, s35, 13
    s_add_u32 s37, s37, 131072
    s_add_u32 m0, s37, 0
    s_add_u32 s38, s36, 0
    buffer_load_dwordx4 v8, s[84:87], s38 offen offset:0 lds
    s_add_u32 s38, s36, 7168
    buffer_load_dwordx4 v9, s[84:87], s38 offen offset:1024 lds
    s_add_u32 s38, s36, 14336
    buffer_load_dwordx4 v10, s[84:87], s38 offen offset:2048 lds
    s_add_u32 s38, s36, 21504
    buffer_load_dwordx4 v11, s[84:87], s38 offen offset:3072 lds
    s_add_u32 m0, s37, 4096
    s_add_u32 s38, s36, 32768
    buffer_load_dwordx4 v8, s[84:87], s38 offen offset:0 lds
    s_add_u32 s38, s36, 39936
    buffer_load_dwordx4 v9, s[84:87], s38 offen offset:1024 lds
    s_add_u32 s38, s36, 47104
    buffer_load_dwordx4 v10, s[84:87], s38 offen offset:2048 lds
    s_add_u32 s38, s36, 54272
    buffer_load_dwordx4 v11, s[84:87], s38 offen offset:3072 lds
    s_mov_b32 s58, 12582912
    buffer_load_dword v24, v22, s[64:67], s58 offen offset:0 sc1
    buffer_load_dword v25, v22, s[64:67], s58 offen offset:64 sc1
    buffer_load_dword v26, v22, s[64:67], s58 offen offset:128 sc1
    buffer_load_dword v27, v22, s[64:67], s58 offen offset:192 sc1
    s_lshl_b32 s58, s32, 3
    s_add_u32 s58, s58, s33
    s_lshl_b32 s97, s58, 7
    s_lshl_b32 s36, s35, 2
    s_add_u32 s97, s97, s36
    s_add_u32 s97, s97, 12849152
    s_lshl_b32 s40, s58, 16
    s_lshl_b32 s36, s35, 14
    s_add_u32 s40, s40, s36
    s_add_u32 s40, s40, 14680064
    s_add_u32 s41, s40, 4096
    s_add_u32 s42, s40, 8192
    s_add_u32 s43, s40, 12288
    s_mov_b32 s84, s82
    s_and_b32 s85, s83, 0xffff
    s_mov_b32 s86, 2048
    s_mov_b32 s87, 0x20000
    buffer_load_dwordx2 v[48:49], v28, s[84:87], 0 offen offset:0
    buffer_load_dwordx2 v[50:51], v28, s[84:87], 0 offen offset:32
    buffer_load_dwordx2 v[52:53], v28, s[84:87], 0 offen offset:64
    buffer_load_dwordx2 v[54:55], v28, s[84:87], 0 offen offset:96
    v_and_b32 v14, 15, v0
    s_lshl_b32 s36, s51, 6
    v_add_u32 v15, s36, v14
    v_lshlrev_b32 v15, 8, v15
    v_lshrrev_b32 v16, 5, v0
    s_lshl_b32 s36, s50, 3
    v_add_u32 v16, s36, v16
    v_xor_b32 v16, v16, v14
    v_lshlrev_b32 v16, 4, v16
    v_add_u32 v15, v15, v16
    v_bfe_u32 v16, v0, 4, 1
    v_lshlrev_b32 v16, 3, v16
    v_add_u32 v15, v15, v16
    v_add_u32 v56, 131072, v15
    v_xor_b32 v57, 32, v56
    v_xor_b32 v58, 64, v56
    v_xor_b32 v59, 96, v56
    s_waitcnt vmcnt(24)
    s_barrier
    ds_read_b128 a[0:3], v32 offset:0
    ds_read_b64_tr_b16 a[16:17], v36 offset:0
    ds_read_b64_tr_b16 a[18:19], v37 offset:0
    ds_read_b128 a[4:7], v32 offset:2048
    ds_read_b128 a[8:11], v32 offset:4096
    ds_read_b128 a[12:15], v32 offset:6144
    ds_read_b64_tr_b16 a[20:21], v36 offset:2048
    ds_read_b64_tr_b16 a[22:23], v37 offset:2048
    ds_read_b64_tr_b16 a[24:25], v36 offset:256
    ds_read_b64_tr_b16 a[26:27], v37 offset:256
    ds_read_b64_tr_b16 a[28:29], v36 offset:2304
    ds_read_b64_tr_b16 a[30:31], v37 offset:2304
    s_waitcnt lgkmcnt(9)
    v_mfma_f32_16x16x32_bf16 v[192:195], a[0:3], a[16:19], 0
    ds_read_b128 a[32:35], v33 offset:0
    ds_read_b64_tr_b16 a[48:49], v36 offset:8192
    s_waitcnt lgkmcnt(10)
    v_mfma_f32_16x16x32_bf16 v[208:211], a[4:7], a[16:19], 0
    ds_read_b64_tr_b16 a[50:51], v37 offset:8192
    s_waitcnt lgkmcnt(10)
    v_mfma_f32_16x16x32_bf16 v[224:227], a[8:11], a[16:19], 0
    ds_read_b128 a[36:39], v33 offset:2048
    s_waitcnt lgkmcnt(10)
    v_mfma_f32_16x16x32_bf16 v[240:243], a[12:15], a[16:19], 0
    ds_read_b128 a[40:43], v33 offset:4096
    ds_read_b128 a[44:47], v33 offset:6144
    s_waitcnt lgkmcnt(10)
    v_mfma_f32_16x16x32_bf16 v[196:199], a[0:3], a[20:23], 0
    ds_read_b64_tr_b16 a[52:53], v36 offset:10240
    v_mfma_f32_16x16x32_bf16 v[212:215], a[4:7], a[20:23], 0
    ds_read_b64_tr_b16 a[54:55], v37 offset:10240
    v_mfma_f32_16x16x32_bf16 v[228:231], a[8:11], a[20:23], 0
    ds_read_b64_tr_b16 a[56:57], v36 offset:8448
    ds_read_b64_tr_b16 a[58:59], v37 offset:8448
    v_mfma_f32_16x16x32_bf16 v[244:247], a[12:15], a[20:23], 0
    ds_read_b64_tr_b16 a[60:61], v36 offset:10496
    s_waitcnt lgkmcnt(13)
    v_mfma_f32_16x16x32_bf16 v[200:203], a[0:3], a[24:27], 0
    ds_read_b64_tr_b16 a[62:63], v37 offset:10496
    v_mfma_f32_16x16x32_bf16 v[216:219], a[4:7], a[24:27], 0
    v_mfma_f32_16x16x32_bf16 v[232:235], a[8:11], a[24:27], 0
    v_mfma_f32_16x16x32_bf16 v[248:251], a[12:15], a[24:27], 0
    s_waitcnt lgkmcnt(12)
    v_mfma_f32_16x16x32_bf16 v[204:207], a[0:3], a[28:31], 0
    v_mfma_f32_16x16x32_bf16 v[220:223], a[4:7], a[28:31], 0
    v_mfma_f32_16x16x32_bf16 v[236:239], a[8:11], a[28:31], 0
    v_mfma_f32_16x16x32_bf16 v[252:255], a[12:15], a[28:31], 0
    s_waitcnt lgkmcnt(9)
    v_mfma_f32_16x16x32_bf16 v[192:195], a[32:35], a[48:51], v[192:195]
    s_waitcnt lgkmcnt(8)
    v_mfma_f32_16x16x32_bf16 v[208:211], a[36:39], a[48:51], v[208:211]
    s_waitcnt lgkmcnt(7)
    v_mfma_f32_16x16x32_bf16 v[224:227], a[40:43], a[48:51], v[224:227]
    s_waitcnt lgkmcnt(0)
    s_waitcnt vmcnt(20)
    s_barrier
    v_mfma_f32_16x16x32_bf16 v[240:243], a[44:47], a[48:51], v[240:243]
    ds_read_b128 a[0:3], v32 offset:32768
    ds_read_b64_tr_b16 a[16:17], v36 offset:32768
    v_mfma_f32_16x16x32_bf16 v[196:199], a[32:35], a[52:55], v[196:199]
    ds_read_b64_tr_b16 a[18:19], v37 offset:32768
    ds_read_b128 a[4:7], v32 offset:34816
    s_add_u32 m0, s49, 98304
    s_nop 0
    buffer_load_dwordx4 v4, s[12:15], s24 offen offset:0 lds
    v_mfma_f32_16x16x32_bf16 v[212:215], a[36:39], a[52:55], v[212:215]
    ds_read_b128 a[8:11], v32 offset:36864
    ds_read_b128 a[12:15], v32 offset:38912
    buffer_load_dwordx4 v5, s[12:15], s25 offen offset:1024 lds
    v_mfma_f32_16x16x32_bf16 v[228:231], a[40:43], a[52:55], v[228:231]
    ds_read_b64_tr_b16 a[20:21], v36 offset:34816
    buffer_load_dwordx4 v4, s[12:15], s26 offen offset:2048 lds
    v_mfma_f32_16x16x32_bf16 v[244:247], a[44:47], a[52:55], v[244:247]
    ds_read_b64_tr_b16 a[22:23], v37 offset:34816
    ds_read_b64_tr_b16 a[24:25], v36 offset:33024
    buffer_load_dwordx4 v5, s[12:15], s27 offen offset:3072 lds
    s_add_u32 s90, s90, 1
    v_mfma_f32_16x16x32_bf16 v[200:203], a[32:35], a[56:59], v[200:203]
    ds_read_b64_tr_b16 a[26:27], v37 offset:33024
    ds_read_b64_tr_b16 a[28:29], v36 offset:35072
    s_and_b32 s90, s90, 31
    v_mfma_f32_16x16x32_bf16 v[216:219], a[36:39], a[56:59], v[216:219]
    ds_read_b64_tr_b16 a[30:31], v37 offset:35072
    s_cmp_lt_u32 s90, 16
    v_mfma_f32_16x16x32_bf16 v[232:235], a[40:43], a[56:59], v[232:235]
    s_cselect_b32 s12, s68, s70
    v_mfma_f32_16x16x32_bf16 v[248:251], a[44:47], a[56:59], v[248:251]
    s_cselect_b32 s13, s69, s71
    s_and_b32 s77, s90, 15
    v_mfma_f32_16x16x32_bf16 v[204:207], a[32:35], a[60:63], v[204:207]
    s_lshl_b32 s77, s77, 7
    v_mfma_f32_16x16x32_bf16 v[220:223], a[36:39], a[60:63], v[220:223]
    s_add_u32 s12, s12, s77
    v_mfma_f32_16x16x32_bf16 v[236:239], a[40:43], a[60:63], v[236:239]
    s_addc_u32 s13, s13, 0
    v_mfma_f32_16x16x32_bf16 v[252:255], a[44:47], a[60:63], v[252:255]
    s_waitcnt lgkmcnt(9)
    v_mfma_f32_16x16x32_bf16 v[192:195], a[0:3], a[16:19], v[192:195]
    ds_read_b128 a[32:35], v33 offset:32768
    ds_read_b64_tr_b16 a[48:49], v36 offset:40960
    s_waitcnt lgkmcnt(10)
    v_mfma_f32_16x16x32_bf16 v[208:211], a[4:7], a[16:19], v[208:211]
    ds_read_b64_tr_b16 a[50:51], v37 offset:40960
    s_add_u32 m0, s48, 98304
    s_waitcnt lgkmcnt(10)
    v_mfma_f32_16x16x32_bf16 v[224:227], a[8:11], a[16:19], v[224:227]
    ds_read_b128 a[36:39], v33 offset:34816
    buffer_load_dwordx4 v2, s[8:11], s16 offen offset:0 lds
    s_waitcnt lgkmcnt(10)
    v_mfma_f32_16x16x32_bf16 v[240:243], a[12:15], a[16:19], v[240:243]
    ds_read_b128 a[40:43], v33 offset:36864
    ds_read_b128 a[44:47], v33 offset:38912
    s_waitcnt lgkmcnt(10)
    v_mfma_f32_16x16x32_bf16 v[196:199], a[0:3], a[20:23], v[196:199]
    ds_read_b64_tr_b16 a[52:53], v36 offset:43008
    buffer_load_dwordx4 v2, s[8:11], s16 offen offset:1024 lds
    v_mfma_f32_16x16x32_bf16 v[212:215], a[4:7], a[20:23], v[212:215]
    ds_read_b64_tr_b16 a[54:55], v37 offset:43008
    buffer_load_dwordx4 v2, s[8:11], s16 offen offset:2048 lds
    v_mfma_f32_16x16x32_bf16 v[228:231], a[8:11], a[20:23], v[228:231]
    ds_read_b64_tr_b16 a[56:57], v36 offset:41216
    ds_read_b64_tr_b16 a[58:59], v37 offset:41216
    v_mfma_f32_16x16x32_bf16 v[244:247], a[12:15], a[20:23], v[244:247]
    ds_read_b64_tr_b16 a[60:61], v36 offset:43264
    buffer_load_dwordx4 v2, s[8:11], s16 offen offset:3072 lds
    s_waitcnt lgkmcnt(13)
    v_mfma_f32_16x16x32_bf16 v[200:203], a[0:3], a[24:27], v[200:203]
    ds_read_b64_tr_b16 a[62:63], v37 offset:43264
    s_add_u32 s76, s76, 16384
    v_mfma_f32_16x16x32_bf16 v[216:219], a[4:7], a[24:27], v[216:219]
    v_mfma_f32_16x16x32_bf16 v[232:235], a[8:11], a[24:27], v[232:235]
    s_and_b32 s76, s76, 524287
    v_mfma_f32_16x16x32_bf16 v[248:251], a[12:15], a[24:27], v[248:251]
    s_add_u32 s8, s88, s76
    s_waitcnt lgkmcnt(12)
    v_mfma_f32_16x16x32_bf16 v[204:207], a[0:3], a[28:31], v[204:207]
    v_mfma_f32_16x16x32_bf16 v[220:223], a[4:7], a[28:31], v[220:223]
    s_addc_u32 s9, s89, 0
    v_mfma_f32_16x16x32_bf16 v[236:239], a[8:11], a[28:31], v[236:239]
    v_mfma_f32_16x16x32_bf16 v[252:255], a[12:15], a[28:31], v[252:255]
    s_waitcnt lgkmcnt(9)
    v_mfma_f32_16x16x32_bf16 v[192:195], a[32:35], a[48:51], v[192:195]
    s_waitcnt lgkmcnt(8)
    v_mfma_f32_16x16x32_bf16 v[208:211], a[36:39], a[48:51], v[208:211]
    s_waitcnt lgkmcnt(7)
    v_mfma_f32_16x16x32_bf16 v[224:227], a[40:43], a[48:51], v[224:227]
    s_waitcnt lgkmcnt(0)
    s_waitcnt vmcnt(24)
    s_barrier
    v_mfma_f32_16x16x32_bf16 v[240:243], a[44:47], a[48:51], v[240:243]
    ds_read_b128 a[0:3], v34 offset:0
    ds_read_b64_tr_b16 a[16:17], v38 offset:0
    v_mfma_f32_16x16x32_bf16 v[196:199], a[32:35], a[52:55], v[196:199]
    ds_read_b64_tr_b16 a[18:19], v39 offset:0
    ds_read_b128 a[4:7], v34 offset:2048
    s_add_u32 m0, s49, 0
    s_nop 0
    buffer_load_dwordx4 v4, s[12:15], s24 offen offset:0 lds
    v_mfma_f32_16x16x32_bf16 v[212:215], a[36:39], a[52:55], v[212:215]
    ds_read_b128 a[8:11], v34 offset:4096
    ds_read_b128 a[12:15], v34 offset:6144
    buffer_load_dwordx4 v5, s[12:15], s25 offen offset:1024 lds
    v_mfma_f32_16x16x32_bf16 v[228:231], a[40:43], a[52:55], v[228:231]
    ds_read_b64_tr_b16 a[20:21], v38 offset:2048
    buffer_load_dwordx4 v4, s[12:15], s26 offen offset:2048 lds
    v_mfma_f32_16x16x32_bf16 v[244:247], a[44:47], a[52:55], v[244:247]
    ds_read_b64_tr_b16 a[22:23], v39 offset:2048
    ds_read_b64_tr_b16 a[24:25], v38 offset:256
    buffer_load_dwordx4 v5, s[12:15], s27 offen offset:3072 lds
    s_add_u32 s90, s90, 1
    v_mfma_f32_16x16x32_bf16 v[200:203], a[32:35], a[56:59], v[200:203]
    ds_read_b64_tr_b16 a[26:27], v39 offset:256
    ds_read_b64_tr_b16 a[28:29], v38 offset:2304
    s_and_b32 s90, s90, 31
    v_mfma_f32_16x16x32_bf16 v[216:219], a[36:39], a[56:59], v[216:219]
    ds_read_b64_tr_b16 a[30:31], v39 offset:2304
    s_cmp_lt_u32 s90, 16
    v_mfma_f32_16x16x32_bf16 v[232:235], a[40:43], a[56:59], v[232:235]
    s_cselect_b32 s12, s68, s70
    v_mfma_f32_16x16x32_bf16 v[248:251], a[44:47], a[56:59], v[248:251]
    s_cselect_b32 s13, s69, s71
    s_and_b32 s77, s90, 15
    v_mfma_f32_16x16x32_bf16 v[204:207], a[32:35], a[60:63], v[204:207]
    s_lshl_b32 s77, s77, 7
    v_mfma_f32_16x16x32_bf16 v[220:223], a[36:39], a[60:63], v[220:223]
    s_add_u32 s12, s12, s77
    v_mfma_f32_16x16x32_bf16 v[236:239], a[40:43], a[60:63], v[236:239]
    s_addc_u32 s13, s13, 0
    v_mfma_f32_16x16x32_bf16 v[252:255], a[44:47], a[60:63], v[252:255]
    s_waitcnt lgkmcnt(9)
    v_mfma_f32_16x16x32_bf16 v[192:195], a[0:3], a[16:19], v[192:195]
    ds_read_b128 a[32:35], v35 offset:0
    ds_read_b64_tr_b16 a[48:49], v38 offset:8192
    s_waitcnt lgkmcnt(10)
    v_mfma_f32_16x16x32_bf16 v[208:211], a[4:7], a[16:19], v[208:211]
    ds_read_b64_tr_b16 a[50:51], v39 offset:8192
    s_add_u32 m0, s48, 0
    s_waitcnt lgkmcnt(10)
    v_mfma_f32_16x16x32_bf16 v[224:227], a[8:11], a[16:19], v[224:227]
    ds_read_b128 a[36:39], v35 offset:2048
    buffer_load_dwordx4 v2, s[8:11], s16 offen offset:0 lds
    s_waitcnt lgkmcnt(10)
    v_mfma_f32_16x16x32_bf16 v[240:243], a[12:15], a[16:19], v[240:243]
    ds_read_b128 a[40:43], v35 offset:4096
    ds_read_b128 a[44:47], v35 offset:6144
    s_waitcnt lgkmcnt(10)
    v_mfma_f32_16x16x32_bf16 v[196:199], a[0:3], a[20:23], v[196:199]
    ds_read_b64_tr_b16 a[52:53], v38 offset:10240
    buffer_load_dwordx4 v2, s[8:11], s16 offen offset:1024 lds
    v_mfma_f32_16x16x32_bf16 v[212:215], a[4:7], a[20:23], v[212:215]
    ds_read_b64_tr_b16 a[54:55], v39 offset:10240
    buffer_load_dwordx4 v2, s[8:11], s16 offen offset:2048 lds
    v_mfma_f32_16x16x32_bf16 v[228:231], a[8:11], a[20:23], v[228:231]
    ds_read_b64_tr_b16 a[56:57], v38 offset:8448
    ds_read_b64_tr_b16 a[58:59], v39 offset:8448
    v_mfma_f32_16x16x32_bf16 v[244:247], a[12:15], a[20:23], v[244:247]
    ds_read_b64_tr_b16 a[60:61], v38 offset:10496
    buffer_load_dwordx4 v2, s[8:11], s16 offen offset:3072 lds
    s_waitcnt lgkmcnt(13)
    v_mfma_f32_16x16x32_bf16 v[200:203], a[0:3], a[24:27], v[200:203]
    ds_read_b64_tr_b16 a[62:63], v39 offset:10496
    s_add_u32 s76, s76, 16384
    v_mfma_f32_16x16x32_bf16 v[216:219], a[4:7], a[24:27], v[216:219]
    v_mfma_f32_16x16x32_bf16 v[232:235], a[8:11], a[24:27], v[232:235]
    s_and_b32 s76, s76, 524287
    v_mfma_f32_16x16x32_bf16 v[248:251], a[12:15], a[24:27], v[248:251]
    s_add_u32 s8, s88, s76
    s_waitcnt lgkmcnt(12)
    v_mfma_f32_16x16x32_bf16 v[204:207], a[0:3], a[28:31], v[204:207]
    v_mfma_f32_16x16x32_bf16 v[220:223], a[4:7], a[28:31], v[220:223]
    s_addc_u32 s9, s89, 0
    v_mfma_f32_16x16x32_bf16 v[236:239], a[8:11], a[28:31], v[236:239]
    v_mfma_f32_16x16x32_bf16 v[252:255], a[12:15], a[28:31], v[252:255]
    s_waitcnt lgkmcnt(9)
    v_mfma_f32_16x16x32_bf16 v[192:195], a[32:35], a[48:51], v[192:195]
    s_waitcnt lgkmcnt(8)
    v_mfma_f32_16x16x32_bf16 v[208:211], a[36:39], a[48:51], v[208:211]
    s_waitcnt lgkmcnt(7)
    v_mfma_f32_16x16x32_bf16 v[224:227], a[40:43], a[48:51], v[224:227]
    s_waitcnt lgkmcnt(0)
    s_waitcnt vmcnt(8)
    s_barrier
    v_mfma_f32_16x16x32_bf16 v[240:243], a[44:47], a[48:51], v[240:243]
    ds_read_b128 a[0:3], v34 offset:32768
    ds_read_b64_tr_b16 a[16:17], v38 offset:32768
    v_mfma_f32_16x16x32_bf16 v[196:199], a[32:35], a[52:55], v[196:199]
    ds_read_b64_tr_b16 a[18:19], v39 offset:32768
    ds_read_b128 a[4:7], v34 offset:34816
    s_add_u32 m0, s49, 32768
    s_nop 0
    buffer_load_dwordx4 v4, s[12:15], s24 offen offset:0 lds
    v_mfma_f32_16x16x32_bf16 v[212:215], a[36:39], a[52:55], v[212:215]
    ds_read_b128 a[8:11], v34 offset:36864
    ds_read_b128 a[12:15], v34 offset:38912
    buffer_load_dwordx4 v5, s[12:15], s25 offen offset:1024 lds
    v_mfma_f32_16x16x32_bf16 v[228:231], a[40:43], a[52:55], v[228:231]
    ds_read_b64_tr_b16 a[20:21], v38 offset:34816
    buffer_load_dwordx4 v4, s[12:15], s26 offen offset:2048 lds
    v_mfma_f32_16x16x32_bf16 v[244:247], a[44:47], a[52:55], v[244:247]
    ds_read_b64_tr_b16 a[22:23], v39 offset:34816
    ds_read_b64_tr_b16 a[24:25], v38 offset:33024
    buffer_load_dwordx4 v5, s[12:15], s27 offen offset:3072 lds
    s_add_u32 s90, s90, 1
    v_mfma_f32_16x16x32_bf16 v[200:203], a[32:35], a[56:59], v[200:203]
    ds_read_b64_tr_b16 a[26:27], v39 offset:33024
    ds_read_b64_tr_b16 a[28:29], v38 offset:35072
    s_and_b32 s90, s90, 31
    v_mfma_f32_16x16x32_bf16 v[216:219], a[36:39], a[56:59], v[216:219]
    ds_read_b64_tr_b16 a[30:31], v39 offset:35072
    s_cmp_lt_u32 s90, 16
    v_mfma_f32_16x16x32_bf16 v[232:235], a[40:43], a[56:59], v[232:235]
    s_cselect_b32 s12, s68, s70
    v_mfma_f32_16x16x32_bf16 v[248:251], a[44:47], a[56:59], v[248:251]
    s_cselect_b32 s13, s69, s71
    s_and_b32 s77, s90, 15
    v_mfma_f32_16x16x32_bf16 v[204:207], a[32:35], a[60:63], v[204:207]
    s_lshl_b32 s77, s77, 7
    v_mfma_f32_16x16x32_bf16 v[220:223], a[36:39], a[60:63], v[220:223]
    s_add_u32 s12, s12, s77
    v_mfma_f32_16x16x32_bf16 v[236:239], a[40:43], a[60:63], v[236:239]
    s_addc_u32 s13, s13, 0
    v_mfma_f32_16x16x32_bf16 v[252:255], a[44:47], a[60:63], v[252:255]
    s_waitcnt lgkmcnt(9)
    v_mfma_f32_16x16x32_bf16 v[192:195], a[0:3], a[16:19], v[192:195]
    ds_read_b128 a[32:35], v35 offset:32768
    ds_read_b64_tr_b16 a[48:49], v38 offset:40960
    s_waitcnt lgkmcnt(10)
    v_mfma_f32_16x16x32_bf16 v[208:211], a[4:7], a[16:19], v[208:211]
    ds_read_b64_tr_b16 a[50:51], v39 offset:40960
    s_add_u32 m0, s48, 32768
    s_waitcnt lgkmcnt(10)
    v_mfma_f32_16x16x32_bf16 v[224:227], a[8:11], a[16:19], v[224:227]
    ds_read_b128 a[36:39], v35 offset:34816
    buffer_load_dwordx4 v2, s[8:11], s16 offen offset:0 lds
    s_waitcnt lgkmcnt(10)
    v_mfma_f32_16x16x32_bf16 v[240:243], a[12:15], a[16:19], v[240:243]
    ds_read_b128 a[40:43], v35 offset:36864
    ds_read_b128 a[44:47], v35 offset:38912
    s_waitcnt lgkmcnt(10)
    v_mfma_f32_16x16x32_bf16 v[196:199], a[0:3], a[20:23], v[196:199]
    ds_read_b64_tr_b16 a[52:53], v38 offset:43008
    buffer_load_dwordx4 v2, s[8:11], s16 offen offset:1024 lds
    v_mfma_f32_16x16x32_bf16 v[212:215], a[4:7], a[20:23], v[212:215]
    ds_read_b64_tr_b16 a[54:55], v39 offset:43008
    buffer_load_dwordx4 v2, s[8:11], s16 offen offset:2048 lds
    v_mfma_f32_16x16x32_bf16 v[228:231], a[8:11], a[20:23], v[228:231]
    ds_read_b64_tr_b16 a[56:57], v38 offset:41216
    ds_read_b64_tr_b16 a[58:59], v39 offset:41216
    v_mfma_f32_16x16x32_bf16 v[244:247], a[12:15], a[20:23], v[244:247]
    ds_read_b64_tr_b16 a[60:61], v38 offset:43264
    buffer_load_dwordx4 v2, s[8:11], s16 offen offset:3072 lds
    s_waitcnt lgkmcnt(13)
    v_mfma_f32_16x16x32_bf16 v[200:203], a[0:3], a[24:27], v[200:203]
    ds_read_b64_tr_b16 a[62:63], v39 offset:43264
    s_add_u32 s76, s76, 16384
    v_mfma_f32_16x16x32_bf16 v[216:219], a[4:7], a[24:27], v[216:219]
    v_mfma_f32_16x16x32_bf16 v[232:235], a[8:11], a[24:27], v[232:235]
    s_and_b32 s76, s76, 524287
    v_mfma_f32_16x16x32_bf16 v[248:251], a[12:15], a[24:27], v[248:251]
    s_add_u32 s8, s88, s76
    s_waitcnt lgkmcnt(12)
    v_mfma_f32_16x16x32_bf16 v[204:207], a[0:3], a[28:31], v[204:207]
    v_mfma_f32_16x16x32_bf16 v[220:223], a[4:7], a[28:31], v[220:223]
    s_addc_u32 s9, s89, 0
    v_mfma_f32_16x16x32_bf16 v[236:239], a[8:11], a[28:31], v[236:239]
    v_mfma_f32_16x16x32_bf16 v[252:255], a[12:15], a[28:31], v[252:255]
    s_waitcnt lgkmcnt(9)
    v_mfma_f32_16x16x32_bf16 v[192:195], a[32:35], a[48:51], v[192:195]
    s_waitcnt lgkmcnt(8)
    v_mfma_f32_16x16x32_bf16 v[208:211], a[36:39], a[48:51], v[208:211]
    s_waitcnt lgkmcnt(7)
    v_mfma_f32_16x16x32_bf16 v[224:227], a[40:43], a[48:51], v[224:227]
    s_waitcnt lgkmcnt(0)
    s_waitcnt vmcnt(8)
    s_barrier
    v_mfma_f32_16x16x32_bf16 v[240:243], a[44:47], a[48:51], v[240:243]
    ds_read_b128 a[0:3], v32 offset:0
    ds_read_b64_tr_b16 a[16:17], v36 offset:0
    v_mfma_f32_16x16x32_bf16 v[196:199], a[32:35], a[52:55], v[196:199]
    ds_read_b64_tr_b16 a[18:19], v37 offset:0
    ds_read_b128 a[4:7], v32 offset:2048
    s_add_u32 m0, s49, 65536
    s_nop 0
    buffer_load_dwordx4 v4, s[12:15], s24 offen offset:0 lds
    v_mfma_f32_16x16x32_bf16 v[212:215], a[36:39], a[52:55], v[212:215]
    ds_read_b128 a[8:11], v32 offset:4096
    ds_read_b128 a[12:15], v32 offset:6144
    buffer_load_dwordx4 v5, s[12:15], s25 offen offset:1024 lds
    v_mfma_f32_16x16x32_bf16 v[228:231], a[40:43], a[52:55], v[228:231]
    ds_read_b64_tr_b16 a[20:21], v36 offset:2048
    buffer_load_dwordx4 v4, s[12:15], s26 offen offset:2048 lds
    v_mfma_f32_16x16x32_bf16 v[244:247], a[44:47], a[52:55], v[244:247]
    ds_read_b64_tr_b16 a[22:23], v37 offset:2048
    ds_read_b64_tr_b16 a[24:25], v36 offset:256
    buffer_load_dwordx4 v5, s[12:15], s27 offen offset:3072 lds
    s_add_u32 s90, s90, 1
    v_mfma_f32_16x16x32_bf16 v[200:203], a[32:35], a[56:59], v[200:203]
    ds_read_b64_tr_b16 a[26:27], v37 offset:256
    ds_read_b64_tr_b16 a[28:29], v36 offset:2304
    s_and_b32 s90, s90, 31
    v_mfma_f32_16x16x32_bf16 v[216:219], a[36:39], a[56:59], v[216:219]
    ds_read_b64_tr_b16 a[30:31], v37 offset:2304
    s_cmp_lt_u32 s90, 16
    v_mfma_f32_16x16x32_bf16 v[232:235], a[40:43], a[56:59], v[232:235]
    s_cselect_b32 s12, s68, s70
    v_mfma_f32_16x16x32_bf16 v[248:251], a[44:47], a[56:59], v[248:251]
    s_cselect_b32 s13, s69, s71
    s_and_b32 s77, s90, 15
    v_mfma_f32_16x16x32_bf16 v[204:207], a[32:35], a[60:63], v[204:207]
    s_lshl_b32 s77, s77, 7
    v_mfma_f32_16x16x32_bf16 v[220:223], a[36:39], a[60:63], v[220:223]
    s_add_u32 s12, s12, s77
    v_mfma_f32_16x16x32_bf16 v[236:239], a[40:43], a[60:63], v[236:239]
    s_addc_u32 s13, s13, 0
    v_mfma_f32_16x16x32_bf16 v[252:255], a[44:47], a[60:63], v[252:255]
    s_waitcnt lgkmcnt(9)
    v_mfma_f32_16x16x32_bf16 v[192:195], a[0:3], a[16:19], v[192:195]
    ds_read_b128 a[32:35], v33 offset:0
    ds_read_b64_tr_b16 a[48:49], v36 offset:8192
    s_waitcnt lgkmcnt(10)
    v_mfma_f32_16x16x32_bf16 v[208:211], a[4:7], a[16:19], v[208:211]
    ds_read_b64_tr_b16 a[50:51], v37 offset:8192
    s_add_u32 m0, s48, 65536
    s_waitcnt lgkmcnt(10)
    v_mfma_f32_16x16x32_bf16 v[224:227], a[8:11], a[16:19], v[224:227]
    ds_read_b128 a[36:39], v33 offset:2048
    buffer_load_dwordx4 v2, s[8:11], s16 offen offset:0 lds
    s_waitcnt lgkmcnt(10)
    v_mfma_f32_16x16x32_bf16 v[240:243], a[12:15], a[16:19], v[240:243]
    ds_read_b128 a[40:43], v33 offset:4096
    ds_read_b128 a[44:47], v33 offset:6144
    s_waitcnt lgkmcnt(10)
    v_mfma_f32_16x16x32_bf16 v[196:199], a[0:3], a[20:23], v[196:199]
    ds_read_b64_tr_b16 a[52:53], v36 offset:10240
    buffer_load_dwordx4 v2, s[8:11], s16 offen offset:1024 lds
    v_mfma_f32_16x16x32_bf16 v[212:215], a[4:7], a[20:23], v[212:215]
    ds_read_b64_tr_b16 a[54:55], v37 offset:10240
    buffer_load_dwordx4 v2, s[8:11], s16 offen offset:2048 lds
    v_mfma_f32_16x16x32_bf16 v[228:231], a[8:11], a[20:23], v[228:231]
    ds_read_b64_tr_b16 a[56:57], v36 offset:8448
    ds_read_b64_tr_b16 a[58:59], v37 offset:8448
    v_mfma_f32_16x16x32_bf16 v[244:247], a[12:15], a[20:23], v[244:247]
    ds_read_b64_tr_b16 a[60:61], v36 offset:10496
    buffer_load_dwordx4 v2, s[8:11], s16 offen offset:3072 lds
    s_waitcnt lgkmcnt(13)
    v_mfma_f32_16x16x32_bf16 v[200:203], a[0:3], a[24:27], v[200:203]
    ds_read_b64_tr_b16 a[62:63], v37 offset:10496
    s_add_u32 s76, s76, 16384
    v_mfma_f32_16x16x32_bf16 v[216:219], a[4:7], a[24:27], v[216:219]
    v_mfma_f32_16x16x32_bf16 v[232:235], a[8:11], a[24:27], v[232:235]
    s_and_b32 s76, s76, 524287
    v_mfma_f32_16x16x32_bf16 v[248:251], a[12:15], a[24:27], v[248:251]
    s_add_u32 s8, s88, s76
    s_waitcnt lgkmcnt(12)
    v_mfma_f32_16x16x32_bf16 v[204:207], a[0:3], a[28:31], v[204:207]
    v_mfma_f32_16x16x32_bf16 v[220:223], a[4:7], a[28:31], v[220:223]
    s_addc_u32 s9, s89, 0
    v_mfma_f32_16x16x32_bf16 v[236:239], a[8:11], a[28:31], v[236:239]
    v_mfma_f32_16x16x32_bf16 v[252:255], a[12:15], a[28:31], v[252:255]
    s_waitcnt lgkmcnt(9)
    v_mfma_f32_16x16x32_bf16 v[192:195], a[32:35], a[48:51], v[192:195]
    s_waitcnt lgkmcnt(8)
    v_mfma_f32_16x16x32_bf16 v[208:211], a[36:39], a[48:51], v[208:211]
    s_waitcnt lgkmcnt(7)
    v_mfma_f32_16x16x32_bf16 v[224:227], a[40:43], a[48:51], v[224:227]
    s_waitcnt lgkmcnt(0)
    s_waitcnt vmcnt(8)
    s_barrier
    v_mfma_f32_16x16x32_bf16 v[240:243], a[44:47], a[48:51], v[240:243]
    ds_read_b128 a[0:3], v32 offset:32768
    ds_read_b64_tr_b16 a[16:17], v36 offset:32768
    v_mfma_f32_16x16x32_bf16 v[196:199], a[32:35], a[52:55], v[196:199]
    ds_read_b64_tr_b16 a[18:19], v37 offset:32768
    ds_read_b128 a[4:7], v32 offset:34816
    s_add_u32 m0, s49, 98304
    s_nop 0
    buffer_load_dwordx4 v4, s[12:15], s24 offen offset:0 lds
    v_mfma_f32_16x16x32_bf16 v[212:215], a[36:39], a[52:55], v[212:215]
    ds_read_b128 a[8:11], v32 offset:36864
    ds_read_b128 a[12:15], v32 offset:38912
    buffer_load_dwordx4 v5, s[12:15], s25 offen offset:1024 lds
    v_mfma_f32_16x16x32_bf16 v[228:231], a[40:43], a[52:55], v[228:231]
    ds_read_b64_tr_b16 a[20:21], v36 offset:34816
    buffer_load_dwordx4 v4, s[12:15], s26 offen offset:2048 lds
    v_mfma_f32_16x16x32_bf16 v[244:247], a[44:47], a[52:55], v[244:247]
    ds_read_b64_tr_b16 a[22:23], v37 offset:34816
    ds_read_b64_tr_b16 a[24:25], v36 offset:33024
    buffer_load_dwordx4 v5, s[12:15], s27 offen offset:3072 lds
    s_add_u32 s90, s90, 1
    v_mfma_f32_16x16x32_bf16 v[200:203], a[32:35], a[56:59], v[200:203]
    ds_read_b64_tr_b16 a[26:27], v37 offset:33024
    ds_read_b64_tr_b16 a[28:29], v36 offset:35072
    s_and_b32 s90, s90, 31
    v_mfma_f32_16x16x32_bf16 v[216:219], a[36:39], a[56:59], v[216:219]
    ds_read_b64_tr_b16 a[30:31], v37 offset:35072
    s_cmp_lt_u32 s90, 16
    v_mfma_f32_16x16x32_bf16 v[232:235], a[40:43], a[56:59], v[232:235]
    s_cselect_b32 s12, s68, s70
    v_mfma_f32_16x16x32_bf16 v[248:251], a[44:47], a[56:59], v[248:251]
    s_cselect_b32 s13, s69, s71
    s_and_b32 s77, s90, 15
    v_mfma_f32_16x16x32_bf16 v[204:207], a[32:35], a[60:63], v[204:207]
    s_lshl_b32 s77, s77, 7
    v_mfma_f32_16x16x32_bf16 v[220:223], a[36:39], a[60:63], v[220:223]
    s_add_u32 s12, s12, s77
    v_mfma_f32_16x16x32_bf16 v[236:239], a[40:43], a[60:63], v[236:239]
    s_addc_u32 s13, s13, 0
    v_mfma_f32_16x16x32_bf16 v[252:255], a[44:47], a[60:63], v[252:255]
    s_waitcnt lgkmcnt(9)
    v_mfma_f32_16x16x32_bf16 v[192:195], a[0:3], a[16:19], v[192:195]
    ds_read_b128 a[32:35], v33 offset:32768
    ds_read_b64_tr_b16 a[48:49], v36 offset:40960
    s_waitcnt lgkmcnt(10)
    v_mfma_f32_16x16x32_bf16 v[208:211], a[4:7], a[16:19], v[208:211]
    ds_read_b64_tr_b16 a[50:51], v37 offset:40960
    s_add_u32 m0, s48, 98304
    ds_read_b64 v[64:65], v56 offset:0
    ds_read_b64 v[66:67], v56 offset:4096
    s_waitcnt lgkmcnt(12)
    v_mfma_f32_16x16x32_bf16 v[224:227], a[8:11], a[16:19], v[224:227]
    ds_read_b128 a[36:39], v33 offset:34816
    buffer_load_dwordx4 v2, s[8:11], s16 offen offset:0 lds
    ds_read_b64 v[68:69], v56 offset:8192
    s_waitcnt lgkmcnt(13)
    v_mfma_f32_16x16x32_bf16 v[240:243], a[12:15], a[16:19], v[240:243]
    ds_read_b128 a[40:43], v33 offset:36864
    ds_read_b128 a[44:47], v33 offset:38912
    ds_read_b64 v[70:71], v56 offset:12288
    s_waitcnt lgkmcnt(14)
    v_mfma_f32_16x16x32_bf16 v[196:199], a[0:3], a[20:23], v[196:199]
    ds_read_b64_tr_b16 a[52:53], v36 offset:43008
    buffer_load_dwordx4 v2, s[8:11], s16 offen offset:1024 lds
    ds_read_b64 v[72:73], v57 offset:0
    v_mfma_f32_16x16x32_bf16 v[212:215], a[4:7], a[20:23], v[212:215]
    ds_read_b64_tr_b16 a[54:55], v37 offset:43008
    buffer_load_dwordx4 v2, s[8:11], s16 offen offset:2048 lds
    ds_read_b64 v[74:75], v57 offset:4096
    v_mfma_f32_16x16x32_bf16 v[228:231], a[8:11], a[20:23], v[228:231]
    ds_read_b64_tr_b16 a[56:57], v36 offset:41216
    ds_read_b64_tr_b16 a[58:59], v37 offset:41216
    ds_read_b64 v[76:77], v57 offset:8192
    v_mfma_f32_16x16x32_bf16 v[244:247], a[12:15], a[20:23], v[244:247]
    ds_read_b64_tr_b16 a[60:61], v36 offset:43264
    buffer_load_dwordx4 v2, s[8:11], s16 offen offset:3072 lds
    ds_read_b64 v[78:79], v57 offset:12288
    s_waitcnt lgkmcnt(15)
    v_mfma_f32_16x16x32_bf16 v[200:203], a[0:3], a[24:27], v[200:203]
    ds_read_b64_tr_b16 a[62:63], v37 offset:43264
    s_add_u32 s76, s76, 16384
    ds_read_b64 v[80:81], v58 offset:0
    ds_read_b64 v[82:83], v58 offset:4096
    v_mfma_f32_16x16x32_bf16 v[216:219], a[4:7], a[24:27], v[216:219]
    ds_read_b64 v[84:85], v58 offset:8192
    v_mfma_f32_16x16x32_bf16 v[232:235], a[8:11], a[24:27], v[232:235]
    s_and_b32 s76, s76, 524287
    ds_read_b64 v[86:87], v58 offset:12288
    v_mfma_f32_16x16x32_bf16 v[248:251], a[12:15], a[24:27], v[248:251]
    s_add_u32 s8, s88, s76
    ds_read_b64 v[88:89], v59 offset:0
    v_mfma_f32_16x16x32_bf16 v[204:207], a[0:3], a[28:31], v[204:207]
    ds_read_b64 v[90:91], v59 offset:4096
    v_mfma_f32_16x16x32_bf16 v[220:223], a[4:7], a[28:31], v[220:223]
    s_addc_u32 s9, s89, 0
    ds_read_b64 v[92:93], v59 offset:8192
    v_mfma_f32_16x16x32_bf16 v[236:239], a[8:11], a[28:31], v[236:239]
    ds_read_b64 v[94:95], v59 offset:12288
    v_mfma_f32_16x16x32_bf16 v[252:255], a[12:15], a[28:31], v[252:255]
    v_mfma_f32_16x16x32_bf16 v[192:195], a[32:35], a[48:51], v[192:195]
    s_waitcnt lgkmcnt(15)
    v_mfma_f32_16x16x32_bf16 v[208:211], a[36:39], a[48:51], v[208:211]
    v_mfma_f32_16x16x32_bf16 v[224:227], a[40:43], a[48:51], v[224:227]
    s_waitcnt lgkmcnt(0)
    s_waitcnt vmcnt(8)
    s_barrier
    v_mfma_f32_16x16x32_bf16 v[240:243], a[44:47], a[48:51], v[240:243]
    ds_read_b128 a[0:3], v34 offset:0
    ds_read_b64_tr_b16 a[16:17], v38 offset:0
    v_mfma_f32_16x16x32_bf16 v[196:199], a[32:35], a[52:55], v[196:199]
    ds_read_b64_tr_b16 a[18:19], v39 offset:0
    ds_read_b128 a[4:7], v34 offset:2048
    s_add_u32 m0, s49, 0
    s_nop 0
    buffer_load_dwordx4 v4, s[12:15], s24 offen offset:0 lds
    v_mfma_f32_16x16x32_bf16 v[212:215], a[36:39], a[52:55], v[212:215]
    ds_read_b128 a[8:11], v34 offset:4096
    ds_read_b128 a[12:15], v34 offset:6144
    buffer_load_dwordx4 v5, s[12:15], s25 offen offset:1024 lds
    v_mfma_f32_16x16x32_bf16 v[228:231], a[40:43], a[52:55], v[228:231]
    ds_read_b64_tr_b16 a[20:21], v38 offset:2048
    buffer_load_dwordx4 v4, s[12:15], s26 offen offset:2048 lds
    v_mfma_f32_16x16x32_bf16 v[244:247], a[44:47], a[52:55], v[244:247]
    ds_read_b64_tr_b16 a[22:23], v39 offset:2048
    ds_read_b64_tr_b16 a[24:25], v38 offset:256
    buffer_load_dwordx4 v5, s[12:15], s27 offen offset:3072 lds
    s_add_u32 s90, s90, 1
    v_mfma_f32_16x16x32_bf16 v[200:203], a[32:35], a[56:59], v[200:203]
    ds_read_b64_tr_b16 a[26:27], v39 offset:256
    ds_read_b64_tr_b16 a[28:29], v38 offset:2304
    s_and_b32 s90, s90, 31
    v_mfma_f32_16x16x32_bf16 v[216:219], a[36:39], a[56:59], v[216:219]
    ds_read_b64_tr_b16 a[30:31], v39 offset:2304
    s_cmp_lt_u32 s90, 16
    v_mfma_f32_16x16x32_bf16 v[232:235], a[40:43], a[56:59], v[232:235]
    s_cselect_b32 s12, s68, s70
    v_mfma_f32_16x16x32_bf16 v[248:251], a[44:47], a[56:59], v[248:251]
    s_cselect_b32 s13, s69, s71
    s_and_b32 s77, s90, 15
    v_mfma_f32_16x16x32_bf16 v[204:207], a[32:35], a[60:63], v[204:207]
    s_lshl_b32 s77, s77, 7
    v_mfma_f32_16x16x32_bf16 v[220:223], a[36:39], a[60:63], v[220:223]
    s_add_u32 s12, s12, s77
    v_mfma_f32_16x16x32_bf16 v[236:239], a[40:43], a[60:63], v[236:239]
    s_addc_u32 s13, s13, 0
    v_mfma_f32_16x16x32_bf16 v[252:255], a[44:47], a[60:63], v[252:255]
    s_waitcnt lgkmcnt(9)
    v_mfma_f32_16x16x32_bf16 v[192:195], a[0:3], a[16:19], v[192:195]
    ds_read_b128 a[32:35], v35 offset:0
    ds_read_b64_tr_b16 a[48:49], v38 offset:8192
    s_waitcnt lgkmcnt(10)
    v_mfma_f32_16x16x32_bf16 v[208:211], a[4:7], a[16:19], v[208:211]
    ds_read_b64_tr_b16 a[50:51], v39 offset:8192
    s_add_u32 m0, s48, 0
    v_lshlrev_b32 v112, 16, v48
    s_waitcnt lgkmcnt(10)
    v_mfma_f32_16x16x32_bf16 v[224:227], a[8:11], a[16:19], v[224:227]
    ds_read_b128 a[36:39], v35 offset:2048
    buffer_load_dwordx4 v2, s[8:11], s16 offen offset:0 lds
    v_and_b32 v113, 0xffff0000, v48
    s_waitcnt lgkmcnt(10)
    v_mfma_f32_16x16x32_bf16 v[240:243], a[12:15], a[16:19], v[240:243]
    ds_read_b128 a[40:43], v35 offset:4096
    ds_read_b128 a[44:47], v35 offset:6144
    v_lshlrev_b32 v114, 16, v49
    s_waitcnt lgkmcnt(10)
    v_mfma_f32_16x16x32_bf16 v[196:199], a[0:3], a[20:23], v[196:199]
    ds_read_b64_tr_b16 a[52:53], v38 offset:10240
    buffer_load_dwordx4 v2, s[8:11], s16 offen offset:1024 lds
    v_mfma_f32_16x16x32_bf16 v[212:215], a[4:7], a[20:23], v[212:215]
    ds_read_b64_tr_b16 a[54:55], v39 offset:10240
    buffer_load_dwordx4 v2, s[8:11], s16 offen offset:2048 lds
    v_and_b32 v115, 0xffff0000, v49
    v_mfma_f32_16x16x32_bf16 v[228:231], a[8:11], a[20:23], v[228:231]
    ds_read_b64_tr_b16 a[56:57], v38 offset:8448
    ds_read_b64_tr_b16 a[58:59], v39 offset:8448
    v_lshlrev_b32 v116, 16, v50
    v_mfma_f32_16x16x32_bf16 v[244:247], a[12:15], a[20:23], v[244:247]
    ds_read_b64_tr_b16 a[60:61], v38 offset:10496
    buffer_load_dwordx4 v2, s[8:11], s16 offen offset:3072 lds
    s_waitcnt lgkmcnt(13)
    v_mfma_f32_16x16x32_bf16 v[200:203], a[0:3], a[24:27], v[200:203]
    ds_read_b64_tr_b16 a[62:63], v39 offset:10496
    s_add_u32 s76, s76, 16384
    v_and_b32 v117, 0xffff0000, v50
    v_mfma_f32_16x16x32_bf16 v[216:219], a[4:7], a[24:27], v[216:219]
    v_lshlrev_b32 v118, 16, v51
    v_mfma_f32_16x16x32_bf16 v[232:235], a[8:11], a[24:27], v[232:235]
    s_and_b32 s76, s76, 524287
    v_and_b32 v119, 0xffff0000, v51
    v_mfma_f32_16x16x32_bf16 v[248:251], a[12:15], a[24:27], v[248:251]
    s_add_u32 s8, s88, s76
    s_waitcnt lgkmcnt(12)
    v_mfma_f32_16x16x32_bf16 v[204:207], a[0:3], a[28:31], v[204:207]
    v_lshlrev_b32 v120, 16, v52
    v_mfma_f32_16x16x32_bf16 v[220:223], a[4:7], a[28:31], v[220:223]
    s_addc_u32 s9, s89, 0
    v_and_b32 v121, 0xffff0000, v52
    v_mfma_f32_16x16x32_bf16 v[236:239], a[8:11], a[28:31], v[236:239]
    v_mfma_f32_16x16x32_bf16 v[252:255], a[12:15], a[28:31], v[252:255]
    s_waitcnt lgkmcnt(9)
    v_mfma_f32_16x16x32_bf16 v[192:195], a[32:35], a[48:51], v[192:195]
    v_lshlrev_b32 v122, 16, v53
    s_waitcnt lgkmcnt(8)
    v_mfma_f32_16x16x32_bf16 v[208:211], a[36:39], a[48:51], v[208:211]
    s_waitcnt lgkmcnt(7)
    v_mfma_f32_16x16x32_bf16 v[224:227], a[40:43], a[48:51], v[224:227]
    s_waitcnt lgkmcnt(0)
    s_waitcnt vmcnt(8)
    s_barrier
    v_mfma_f32_16x16x32_bf16 v[240:243], a[44:47], a[48:51], v[240:243]
    ds_read_b128 a[0:3], v34 offset:32768
    ds_read_b64_tr_b16 a[16:17], v38 offset:32768
    v_mfma_f32_16x16x32_bf16 v[196:199], a[32:35], a[52:55], v[196:199]
    ds_read_b64_tr_b16 a[18:19], v39 offset:32768
    ds_read_b128 a[4:7], v34 offset:34816
    s_add_u32 m0, s49, 32768
    s_nop 0
    buffer_load_dwordx4 v4, s[12:15], s24 offen offset:0 lds
    v_and_b32 v123, 0xffff0000, v53
    v_mfma_f32_16x16x32_bf16 v[212:215], a[36:39], a[52:55], v[212:215]
    ds_read_b128 a[8:11], v34 offset:36864
    ds_read_b128 a[12:15], v34 offset:38912
    buffer_load_dwordx4 v5, s[12:15], s25 offen offset:1024 lds
    v_lshlrev_b32 v124, 16, v54
    v_mfma_f32_16x16x32_bf16 v[228:231], a[40:43], a[52:55], v[228:231]
    ds_read_b64_tr_b16 a[20:21], v38 offset:34816
    buffer_load_dwordx4 v4, s[12:15], s26 offen offset:2048 lds
    v_and_b32 v125, 0xffff0000, v54
    v_mfma_f32_16x16x32_bf16 v[244:247], a[44:47], a[52:55], v[244:247]
    ds_read_b64_tr_b16 a[22:23], v39 offset:34816
    ds_read_b64_tr_b16 a[24:25], v38 offset:33024
    buffer_load_dwordx4 v5, s[12:15], s27 offen offset:3072 lds
    s_add_u32 s90, s90, 1
    v_lshlrev_b32 v126, 16, v55
    v_mfma_f32_16x16x32_bf16 v[200:203], a[32:35], a[56:59], v[200:203]
    ds_read_b64_tr_b16 a[26:27], v39 offset:33024
    ds_read_b64_tr_b16 a[28:29], v38 offset:35072
    s_and_b32 s90, s90, 31
    v_and_b32 v127, 0xffff0000, v55
    v_mfma_f32_16x16x32_bf16 v[216:219], a[36:39], a[56:59], v[216:219]
    ds_read_b64_tr_b16 a[30:31], v39 offset:35072
    s_cmp_lt_u32 s90, 16
    v_mfma_f32_16x16x32_bf16 v[232:235], a[40:43], a[56:59], v[232:235]
    s_cselect_b32 s12, s68, s70
    v_lshlrev_b32 v128, 16, v64
    v_mfma_f32_16x16x32_bf16 v[248:251], a[44:47], a[56:59], v[248:251]
    s_cselect_b32 s13, s69, s71
    s_and_b32 s77, s90, 15
    v_and_b32 v129, 0xffff0000, v64
    v_mfma_f32_16x16x32_bf16 v[204:207], a[32:35], a[60:63], v[204:207]
    s_lshl_b32 s77, s77, 7
    v_lshlrev_b32 v130, 16, v65
    v_mfma_f32_16x16x32_bf16 v[220:223], a[36:39], a[60:63], v[220:223]
    s_add_u32 s12, s12, s77
    v_and_b32 v131, 0xffff0000, v65
    v_mfma_f32_16x16x32_bf16 v[236:239], a[40:43], a[60:63], v[236:239]
    s_addc_u32 s13, s13, 0
    v_mfma_f32_16x16x32_bf16 v[252:255], a[44:47], a[60:63], v[252:255]
    s_waitcnt lgkmcnt(9)
    v_mfma_f32_16x16x32_bf16 v[192:195], a[0:3], a[16:19], v[192:195]
    ds_read_b128 a[32:35], v35 offset:32768
    ds_read_b64_tr_b16 a[48:49], v38 offset:40960
    s_waitcnt lgkmcnt(10)
    v_mfma_f32_16x16x32_bf16 v[208:211], a[4:7], a[16:19], v[208:211]
    ds_read_b64_tr_b16 a[50:51], v39 offset:40960
    s_add_u32 m0, s48, 32768
    v_mul_f32 v128, v128, v112
    s_waitcnt lgkmcnt(10)
    v_mfma_f32_16x16x32_bf16 v[224:227], a[8:11], a[16:19], v[224:227]
    ds_read_b128 a[36:39], v35 offset:34816
    buffer_load_dwordx4 v2, s[8:11], s16 offen offset:0 lds
    v_mul_f32 v129, v129, v113
    s_waitcnt lgkmcnt(10)
    v_mfma_f32_16x16x32_bf16 v[240:243], a[12:15], a[16:19], v[240:243]
    ds_read_b128 a[40:43], v35 offset:36864
    ds_read_b128 a[44:47], v35 offset:38912
    v_mul_f32 v130, v130, v114
    s_waitcnt lgkmcnt(10)
    v_mfma_f32_16x16x32_bf16 v[196:199], a[0:3], a[20:23], v[196:199]
    ds_read_b64_tr_b16 a[52:53], v38 offset:43008
    buffer_load_dwordx4 v2, s[8:11], s16 offen offset:1024 lds
    v_mfma_f32_16x16x32_bf16 v[212:215], a[4:7], a[20:23], v[212:215]
    ds_read_b64_tr_b16 a[54:55], v39 offset:43008
    buffer_load_dwordx4 v2, s[8:11], s16 offen offset:2048 lds
    v_mul_f32 v131, v131, v115
    v_mfma_f32_16x16x32_bf16 v[228:231], a[8:11], a[20:23], v[228:231]
    ds_read_b64_tr_b16 a[56:57], v38 offset:41216
    ds_read_b64_tr_b16 a[58:59], v39 offset:41216
    v_cvt_pk_bf16_f32 v64, v128, v129
    v_mfma_f32_16x16x32_bf16 v[244:247], a[12:15], a[20:23], v[244:247]
    ds_read_b64_tr_b16 a[60:61], v38 offset:43264
    buffer_load_dwordx4 v2, s[8:11], s16 offen offset:3072 lds
    s_waitcnt lgkmcnt(13)
    v_mfma_f32_16x16x32_bf16 v[200:203], a[0:3], a[24:27], v[200:203]
    ds_read_b64_tr_b16 a[62:63], v39 offset:43264
    s_add_u32 s76, s76, 16384
    v_cvt_pk_bf16_f32 v65, v130, v131
    v_mfma_f32_16x16x32_bf16 v[216:219], a[4:7], a[24:27], v[216:219]
    v_lshlrev_b32 v128, 16, v64
    v_mfma_f32_16x16x32_bf16 v[232:235], a[8:11], a[24:27], v[232:235]
    s_and_b32 s76, s76, 524287
    v_and_b32 v129, 0xffff0000, v64
    v_mfma_f32_16x16x32_bf16 v[248:251], a[12:15], a[24:27], v[248:251]
    s_add_u32 s8, s88, s76
    s_waitcnt lgkmcnt(12)
    v_mfma_f32_16x16x32_bf16 v[204:207], a[0:3], a[28:31], v[204:207]
    v_lshlrev_b32 v130, 16, v65
    v_mfma_f32_16x16x32_bf16 v[220:223], a[4:7], a[28:31], v[220:223]
    s_addc_u32 s9, s89, 0
    v_and_b32 v131, 0xffff0000, v65
    v_mfma_f32_16x16x32_bf16 v[236:239], a[8:11], a[28:31], v[236:239]
    v_mfma_f32_16x16x32_bf16 v[252:255], a[12:15], a[28:31], v[252:255]
    s_waitcnt lgkmcnt(9)
    v_mfma_f32_16x16x32_bf16 v[192:195], a[32:35], a[48:51], v[192:195]
    v_mul_f32 v128, v128, v24
    s_waitcnt lgkmcnt(8)
    v_mfma_f32_16x16x32_bf16 v[208:211], a[36:39], a[48:51], v[208:211]
    s_waitcnt lgkmcnt(7)
    v_mfma_f32_16x16x32_bf16 v[224:227], a[40:43], a[48:51], v[224:227]
    s_waitcnt lgkmcnt(0)
    s_waitcnt vmcnt(8)
    s_barrier
    v_mfma_f32_16x16x32_bf16 v[240:243], a[44:47], a[48:51], v[240:243]
    ds_read_b128 a[0:3], v32 offset:0
    ds_read_b64_tr_b16 a[16:17], v36 offset:0
    v_mfma_f32_16x16x32_bf16 v[196:199], a[32:35], a[52:55], v[196:199]
    ds_read_b64_tr_b16 a[18:19], v37 offset:0
    ds_read_b128 a[4:7], v32 offset:2048
    s_add_u32 m0, s49, 65536
    s_nop 0
    buffer_load_dwordx4 v4, s[12:15], s24 offen offset:0 lds
    v_mul_f32 v129, v129, v24
    v_mfma_f32_16x16x32_bf16 v[212:215], a[36:39], a[52:55], v[212:215]
    ds_read_b128 a[8:11], v32 offset:4096
    ds_read_b128 a[12:15], v32 offset:6144
    buffer_load_dwordx4 v5, s[12:15], s25 offen offset:1024 lds
    v_mul_f32 v130, v130, v24
    v_mfma_f32_16x16x32_bf16 v[228:231], a[40:43], a[52:55], v[228:231]
    ds_read_b64_tr_b16 a[20:21], v36 offset:2048
    buffer_load_dwordx4 v4, s[12:15], s26 offen offset:2048 lds
    v_mul_f32 v131, v131, v24
    v_mfma_f32_16x16x32_bf16 v[244:247], a[44:47], a[52:55], v[244:247]
    ds_read_b64_tr_b16 a[22:23], v37 offset:2048
    ds_read_b64_tr_b16 a[24:25], v36 offset:256
    buffer_load_dwordx4 v5, s[12:15], s27 offen offset:3072 lds
    s_add_u32 s90, s90, 1
    v_lshlrev_b32 v132, 16, v66
    v_mfma_f32_16x16x32_bf16 v[200:203], a[32:35], a[56:59], v[200:203]
    ds_read_b64_tr_b16 a[26:27], v37 offset:256
    ds_read_b64_tr_b16 a[28:29], v36 offset:2304
    s_and_b32 s90, s90, 31
    v_and_b32 v133, 0xffff0000, v66
    v_mfma_f32_16x16x32_bf16 v[216:219], a[36:39], a[56:59], v[216:219]
    ds_read_b64_tr_b16 a[30:31], v37 offset:2304
    s_cmp_lt_u32 s90, 16
    v_mfma_f32_16x16x32_bf16 v[232:235], a[40:43], a[56:59], v[232:235]
    s_cselect_b32 s12, s68, s70
    v_lshlrev_b32 v134, 16, v67
    v_mfma_f32_16x16x32_bf16 v[248:251], a[44:47], a[56:59], v[248:251]
    s_cselect_b32 s13, s69, s71
    s_and_b32 s77, s90, 15
    v_and_b32 v135, 0xffff0000, v67
    v_mfma_f32_16x16x32_bf16 v[204:207], a[32:35], a[60:63], v[204:207]
    s_lshl_b32 s77, s77, 7
    v_mul_f32 v132, v132, v112
    v_mfma_f32_16x16x32_bf16 v[220:223], a[36:39], a[60:63], v[220:223]
    s_add_u32 s12, s12, s77
    v_mul_f32 v133, v133, v113
    v_mfma_f32_16x16x32_bf16 v[236:239], a[40:43], a[60:63], v[236:239]
    s_addc_u32 s13, s13, 0
    v_mfma_f32_16x16x32_bf16 v[252:255], a[44:47], a[60:63], v[252:255]
    s_waitcnt lgkmcnt(9)
    v_mfma_f32_16x16x32_bf16 v[192:195], a[0:3], a[16:19], v[192:195]
    ds_read_b128 a[32:35], v33 offset:0
    ds_read_b64_tr_b16 a[48:49], v36 offset:8192
    s_waitcnt lgkmcnt(10)
    v_mfma_f32_16x16x32_bf16 v[208:211], a[4:7], a[16:19], v[208:211]
    ds_read_b64_tr_b16 a[50:51], v37 offset:8192
    s_add_u32 m0, s48, 65536
    v_mul_f32 v134, v134, v114
    s_waitcnt lgkmcnt(10)
    v_mfma_f32_16x16x32_bf16 v[224:227], a[8:11], a[16:19], v[224:227]
    ds_read_b128 a[36:39], v33 offset:2048
    buffer_load_dwordx4 v2, s[8:11], s16 offen offset:0 lds
    v_mul_f32 v135, v135, v115
    s_waitcnt lgkmcnt(10)
    v_mfma_f32_16x16x32_bf16 v[240:243], a[12:15], a[16:19], v[240:243]
    ds_read_b128 a[40:43], v33 offset:4096
    ds_read_b128 a[44:47], v33 offset:6144
    v_cvt_pk_bf16_f32 v66, v132, v133
    s_waitcnt lgkmcnt(10)
    v_mfma_f32_16x16x32_bf16 v[196:199], a[0:3], a[20:23], v[196:199]
    ds_read_b64_tr_b16 a[52:53], v36 offset:10240
    buffer_load_dwordx4 v2, s[8:11], s16 offen offset:1024 lds
    v_mfma_f32_16x16x32_bf16 v[212:215], a[4:7], a[20:23], v[212:215]
    ds_read_b64_tr_b16 a[54:55], v37 offset:10240
    buffer_load_dwordx4 v2, s[8:11], s16 offen offset:2048 lds
    v_cvt_pk_bf16_f32 v67, v134, v135
    v_mfma_f32_16x16x32_bf16 v[228:231], a[8:11], a[20:23], v[228:231]
    ds_read_b64_tr_b16 a[56:57], v36 offset:8448
    ds_read_b64_tr_b16 a[58:59], v37 offset:8448
    v_lshlrev_b32 v132, 16, v66
    v_mfma_f32_16x16x32_bf16 v[244:247], a[12:15], a[20:23], v[244:247]
    ds_read_b64_tr_b16 a[60:61], v36 offset:10496
    buffer_load_dwordx4 v2, s[8:11], s16 offen offset:3072 lds
    s_waitcnt lgkmcnt(13)
    v_mfma_f32_16x16x32_bf16 v[200:203], a[0:3], a[24:27], v[200:203]
    ds_read_b64_tr_b16 a[62:63], v37 offset:10496
    s_add_u32 s76, s76, 16384
    v_and_b32 v133, 0xffff0000, v66
    v_mfma_f32_16x16x32_bf16 v[216:219], a[4:7], a[24:27], v[216:219]
    v_lshlrev_b32 v134, 16, v67
    v_mfma_f32_16x16x32_bf16 v[232:235], a[8:11], a[24:27], v[232:235]
    s_and_b32 s76, s76, 524287
    v_and_b32 v135, 0xffff0000, v67
    v_mfma_f32_16x16x32_bf16 v[248:251], a[12:15], a[24:27], v[248:251]
    s_add_u32 s8, s88, s76
    s_waitcnt lgkmcnt(12)
    v_mfma_f32_16x16x32_bf16 v[204:207], a[0:3], a[28:31], v[204:207]
    v_mul_f32 v132, v132, v25
    v_mfma_f32_16x16x32_bf16 v[220:223], a[4:7], a[28:31], v[220:223]
    s_addc_u32 s9, s89, 0
    v_mul_f32 v133, v133, v25
    v_mfma_f32_16x16x32_bf16 v[236:239], a[8:11], a[28:31], v[236:239]
    v_mfma_f32_16x16x32_bf16 v[252:255], a[12:15], a[28:31], v[252:255]
    s_waitcnt lgkmcnt(9)
    v_mfma_f32_16x16x32_bf16 v[192:195], a[32:35], a[48:51], v[192:195]
    v_mul_f32 v134, v134, v25
    s_waitcnt lgkmcnt(8)
    v_mfma_f32_16x16x32_bf16 v[208:211], a[36:39], a[48:51], v[208:211]
    s_waitcnt lgkmcnt(7)
    v_mfma_f32_16x16x32_bf16 v[224:227], a[40:43], a[48:51], v[224:227]
    s_waitcnt lgkmcnt(0)
    s_waitcnt vmcnt(8)
    s_barrier
    v_mfma_f32_16x16x32_bf16 v[240:243], a[44:47], a[48:51], v[240:243]
    ds_read_b128 a[0:3], v32 offset:32768
    ds_read_b64_tr_b16 a[16:17], v36 offset:32768
    v_mfma_f32_16x16x32_bf16 v[196:199], a[32:35], a[52:55], v[196:199]
    ds_read_b64_tr_b16 a[18:19], v37 offset:32768
    ds_read_b128 a[4:7], v32 offset:34816
    s_add_u32 m0, s49, 98304
    s_nop 0
    buffer_load_dwordx4 v4, s[12:15], s24 offen offset:0 lds
    v_mul_f32 v135, v135, v25
    v_mfma_f32_16x16x32_bf16 v[212:215], a[36:39], a[52:55], v[212:215]
    ds_read_b128 a[8:11], v32 offset:36864
    ds_read_b128 a[12:15], v32 offset:38912
    buffer_load_dwordx4 v5, s[12:15], s25 offen offset:1024 lds
    v_lshlrev_b32 v136, 16, v68
    v_mfma_f32_16x16x32_bf16 v[228:231], a[40:43], a[52:55], v[228:231]
    ds_read_b64_tr_b16 a[20:21], v36 offset:34816
    buffer_load_dwordx4 v4, s[12:15], s26 offen offset:2048 lds
    v_and_b32 v137, 0xffff0000, v68
    v_mfma_f32_16x16x32_bf16 v[244:247], a[44:47], a[52:55], v[244:247]
    ds_read_b64_tr_b16 a[22:23], v37 offset:34816
    ds_read_b64_tr_b16 a[24:25], v36 offset:33024
    buffer_load_dwordx4 v5, s[12:15], s27 offen offset:3072 lds
    s_add_u32 s90, s90, 1
    v_lshlrev_b32 v138, 16, v69
    v_mfma_f32_16x16x32_bf16 v[200:203], a[32:35], a[56:59], v[200:203]
    ds_read_b64_tr_b16 a[26:27], v37 offset:33024
    ds_read_b64_tr_b16 a[28:29], v36 offset:35072
    s_and_b32 s90, s90, 31
    v_and_b32 v139, 0xffff0000, v69
    v_mfma_f32_16x16x32_bf16 v[216:219], a[36:39], a[56:59], v[216:219]
    ds_read_b64_tr_b16 a[30:31], v37 offset:35072
    s_cmp_lt_u32 s90, 16
    v_mfma_f32_16x16x32_bf16 v[232:235], a[40:43], a[56:59], v[232:235]
    s_cselect_b32 s12, s68, s70
    v_mul_f32 v136, v136, v112
    v_mfma_f32_16x16x32_bf16 v[248:251], a[44:47], a[56:59], v[248:251]
    s_cselect_b32 s13, s69, s71
    s_and_b32 s77, s90, 15
    v_mul_f32 v137, v137, v113
    v_mfma_f32_16x16x32_bf16 v[204:207], a[32:35], a[60:63], v[204:207]
    s_lshl_b32 s77, s77, 7
    v_mul_f32 v138, v138, v114
    v_mfma_f32_16x16x32_bf16 v[220:223], a[36:39], a[60:63], v[220:223]
    s_add_u32 s12, s12, s77
    v_mul_f32 v139, v139, v115
    v_mfma_f32_16x16x32_bf16 v[236:239], a[40:43], a[60:63], v[236:239]
    s_addc_u32 s13, s13, 0
    v_mfma_f32_16x16x32_bf16 v[252:255], a[44:47], a[60:63], v[252:255]
    s_waitcnt lgkmcnt(9)
    v_mfma_f32_16x16x32_bf16 v[192:195], a[0:3], a[16:19], v[192:195]
    ds_read_b128 a[32:35], v33 offset:32768
    ds_read_b64_tr_b16 a[48:49], v36 offset:40960
    s_waitcnt lgkmcnt(10)
    v_mfma_f32_16x16x32_bf16 v[208:211], a[4:7], a[16:19], v[208:211]
    ds_read_b64_tr_b16 a[50:51], v37 offset:40960
    s_add_u32 m0, s48, 98304
    v_cvt_pk_bf16_f32 v68, v136, v137
    s_waitcnt lgkmcnt(10)
    v_mfma_f32_16x16x32_bf16 v[224:227], a[8:11], a[16:19], v[224:227]
    ds_read_b128 a[36:39], v33 offset:34816
    buffer_load_dwordx4 v2, s[8:11], s16 offen offset:0 lds
    v_cvt_pk_bf16_f32 v69, v138, v139
    s_waitcnt lgkmcnt(10)
    v_mfma_f32_16x16x32_bf16 v[240:243], a[12:15], a[16:19], v[240:243]
    ds_read_b128 a[40:43], v33 offset:36864
    ds_read_b128 a[44:47], v33 offset:38912
    v_lshlrev_b32 v136, 16, v68
    s_waitcnt lgkmcnt(10)
    v_mfma_f32_16x16x32_bf16 v[196:199], a[0:3], a[20:23], v[196:199]
    ds_read_b64_tr_b16 a[52:53], v36 offset:43008
    buffer_load_dwordx4 v2, s[8:11], s16 offen offset:1024 lds
    v_mfma_f32_16x16x32_bf16 v[212:215], a[4:7], a[20:23], v[212:215]
    ds_read_b64_tr_b16 a[54:55], v37 offset:43008
    buffer_load_dwordx4 v2, s[8:11], s16 offen offset:2048 lds
    v_and_b32 v137, 0xffff0000, v68
    v_mfma_f32_16x16x32_bf16 v[228:231], a[8:11], a[20:23], v[228:231]
    ds_read_b64_tr_b16 a[56:57], v36 offset:41216
    ds_read_b64_tr_b16 a[58:59], v37 offset:41216
    v_lshlrev_b32 v138, 16, v69
    v_mfma_f32_16x16x32_bf16 v[244:247], a[12:15], a[20:23], v[244:247]
    ds_read_b64_tr_b16 a[60:61], v36 offset:43264
    buffer_load_dwordx4 v2, s[8:11], s16 offen offset:3072 lds
    s_waitcnt lgkmcnt(13)
    v_mfma_f32_16x16x32_bf16 v[200:203], a[0:3], a[24:27], v[200:203]
    ds_read_b64_tr_b16 a[62:63], v37 offset:43264
    s_add_u32 s76, s76, 16384
    v_and_b32 v139, 0xffff0000, v69
    v_mfma_f32_16x16x32_bf16 v[216:219], a[4:7], a[24:27], v[216:219]
    v_mul_f32 v136, v136, v26
    v_mfma_f32_16x16x32_bf16 v[232:235], a[8:11], a[24:27], v[232:235]
    s_and_b32 s76, s76, 524287
    v_mul_f32 v137, v137, v26
    v_mfma_f32_16x16x32_bf16 v[248:251], a[12:15], a[24:27], v[248:251]
    s_add_u32 s8, s88, s76
    s_waitcnt lgkmcnt(12)
    v_mfma_f32_16x16x32_bf16 v[204:207], a[0:3], a[28:31], v[204:207]
    v_mul_f32 v138, v138, v26
    v_mfma_f32_16x16x32_bf16 v[220:223], a[4:7], a[28:31], v[220:223]
    s_addc_u32 s9, s89, 0
    v_mul_f32 v139, v139, v26
    v_mfma_f32_16x16x32_bf16 v[236:239], a[8:11], a[28:31], v[236:239]
    v_mfma_f32_16x16x32_bf16 v[252:255], a[12:15], a[28:31], v[252:255]
    s_waitcnt lgkmcnt(9)
    v_mfma_f32_16x16x32_bf16 v[192:195], a[32:35], a[48:51], v[192:195]
    v_lshlrev_b32 v140, 16, v70
    s_waitcnt lgkmcnt(8)
    v_mfma_f32_16x16x32_bf16 v[208:211], a[36:39], a[48:51], v[208:211]
    s_waitcnt lgkmcnt(7)
    v_mfma_f32_16x16x32_bf16 v[224:227], a[40:43], a[48:51], v[224:227]
    s_waitcnt lgkmcnt(0)
    s_waitcnt vmcnt(8)
    s_barrier
    v_mfma_f32_16x16x32_bf16 v[240:243], a[44:47], a[48:51], v[240:243]
    ds_read_b128 a[0:3], v34 offset:0
    ds_read_b64_tr_b16 a[16:17], v38 offset:0
    v_mfma_f32_16x16x32_bf16 v[196:199], a[32:35], a[52:55], v[196:199]
    ds_read_b64_tr_b16 a[18:19], v39 offset:0
    ds_read_b128 a[4:7], v34 offset:2048
    s_add_u32 m0, s49, 0
    s_nop 0
    buffer_load_dwordx4 v4, s[12:15], s24 offen offset:0 lds
    v_and_b32 v141, 0xffff0000, v70
    v_mfma_f32_16x16x32_bf16 v[212:215], a[36:39], a[52:55], v[212:215]
    ds_read_b128 a[8:11], v34 offset:4096
    ds_read_b128 a[12:15], v34 offset:6144
    buffer_load_dwordx4 v5, s[12:15], s25 offen offset:1024 lds
    v_lshlrev_b32 v142, 16, v71
    v_mfma_f32_16x16x32_bf16 v[228:231], a[40:43], a[52:55], v[228:231]
    ds_read_b64_tr_b16 a[20:21], v38 offset:2048
    buffer_load_dwordx4 v4, s[12:15], s26 offen offset:2048 lds
    v_and_b32 v143, 0xffff0000, v71
    v_mfma_f32_16x16x32_bf16 v[244:247], a[44:47], a[52:55], v[244:247]
    ds_read_b64_tr_b16 a[22:23], v39 offset:2048
    ds_read_b64_tr_b16 a[24:25], v38 offset:256
    buffer_load_dwordx4 v5, s[12:15], s27 offen offset:3072 lds
    s_add_u32 s90, s90, 1
    v_mul_f32 v140, v140, v112
    v_mfma_f32_16x16x32_bf16 v[200:203], a[32:35], a[56:59], v[200:203]
    ds_read_b64_tr_b16 a[26:27], v39 offset:256
    ds_read_b64_tr_b16 a[28:29], v38 offset:2304
    s_and_b32 s90, s90, 31
    v_mul_f32 v141, v141, v113
    v_mfma_f32_16x16x32_bf16 v[216:219], a[36:39], a[56:59], v[216:219]
    ds_read_b64_tr_b16 a[30:31], v39 offset:2304
    s_cmp_lt_u32 s90, 16
    v_mfma_f32_16x16x32_bf16 v[232:235], a[40:43], a[56:59], v[232:235]
    s_cselect_b32 s12, s68, s70
    v_mul_f32 v142, v142, v114
    v_mfma_f32_16x16x32_bf16 v[248:251], a[44:47], a[56:59], v[248:251]
    s_cselect_b32 s13, s69, s71
    s_and_b32 s77, s90, 15
    v_mul_f32 v143, v143, v115
    v_mfma_f32_16x16x32_bf16 v[204:207], a[32:35], a[60:63], v[204:207]
    s_lshl_b32 s77, s77, 7
    v_cvt_pk_bf16_f32 v70, v140, v141
    v_mfma_f32_16x16x32_bf16 v[220:223], a[36:39], a[60:63], v[220:223]
    s_add_u32 s12, s12, s77
    v_cvt_pk_bf16_f32 v71, v142, v143
    v_mfma_f32_16x16x32_bf16 v[236:239], a[40:43], a[60:63], v[236:239]
    s_addc_u32 s13, s13, 0
    v_mfma_f32_16x16x32_bf16 v[252:255], a[44:47], a[60:63], v[252:255]
    s_waitcnt lgkmcnt(9)
    v_mfma_f32_16x16x32_bf16 v[192:195], a[0:3], a[16:19], v[192:195]
    ds_read_b128 a[32:35], v35 offset:0
    ds_read_b64_tr_b16 a[48:49], v38 offset:8192
    s_waitcnt lgkmcnt(10)
    v_mfma_f32_16x16x32_bf16 v[208:211], a[4:7], a[16:19], v[208:211]
    ds_read_b64_tr_b16 a[50:51], v39 offset:8192
    s_add_u32 m0, s48, 0
    v_lshlrev_b32 v140, 16, v70
    s_waitcnt lgkmcnt(10)
    v_mfma_f32_16x16x32_bf16 v[224:227], a[8:11], a[16:19], v[224:227]
    ds_read_b128 a[36:39], v35 offset:2048
    buffer_load_dwordx4 v2, s[8:11], s16 offen offset:0 lds
    v_and_b32 v141, 0xffff0000, v70
    s_waitcnt lgkmcnt(10)
    v_mfma_f32_16x16x32_bf16 v[240:243], a[12:15], a[16:19], v[240:243]
    ds_read_b128 a[40:43], v35 offset:4096
    ds_read_b128 a[44:47], v35 offset:6144
    v_lshlrev_b32 v142, 16, v71
    s_waitcnt lgkmcnt(10)
    v_mfma_f32_16x16x32_bf16 v[196:199], a[0:3], a[20:23], v[196:199]
    ds_read_b64_tr_b16 a[52:53], v38 offset:10240
    buffer_load_dwordx4 v2, s[8:11], s16 offen offset:1024 lds
    v_mfma_f32_16x16x32_bf16 v[212:215], a[4:7], a[20:23], v[212:215]
    ds_read_b64_tr_b16 a[54:55], v39 offset:10240
    buffer_load_dwordx4 v2, s[8:11], s16 offen offset:2048 lds
    v_and_b32 v143, 0xffff0000, v71
    v_mfma_f32_16x16x32_bf16 v[228:231], a[8:11], a[20:23], v[228:231]
    ds_read_b64_tr_b16 a[56:57], v38 offset:8448
    ds_read_b64_tr_b16 a[58:59], v39 offset:8448
    v_mul_f32 v140, v140, v27
    v_mfma_f32_16x16x32_bf16 v[244:247], a[12:15], a[20:23], v[244:247]
    ds_read_b64_tr_b16 a[60:61], v38 offset:10496
    buffer_load_dwordx4 v2, s[8:11], s16 offen offset:3072 lds
    s_waitcnt lgkmcnt(13)
    v_mfma_f32_16x16x32_bf16 v[200:203], a[0:3], a[24:27], v[200:203]
    ds_read_b64_tr_b16 a[62:63], v39 offset:10496
    s_add_u32 s76, s76, 16384
    v_mul_f32 v141, v141, v27
    v_mfma_f32_16x16x32_bf16 v[216:219], a[4:7], a[24:27], v[216:219]
    v_mul_f32 v142, v142, v27
    v_mfma_f32_16x16x32_bf16 v[232:235], a[8:11], a[24:27], v[232:235]
    s_and_b32 s76, s76, 524287
    v_mul_f32 v143, v143, v27
    v_mfma_f32_16x16x32_bf16 v[248:251], a[12:15], a[24:27], v[248:251]
    s_add_u32 s8, s88, s76
    s_waitcnt lgkmcnt(12)
    v_mfma_f32_16x16x32_bf16 v[204:207], a[0:3], a[28:31], v[204:207]
    v_lshlrev_b32 v144, 16, v72
    v_mfma_f32_16x16x32_bf16 v[220:223], a[4:7], a[28:31], v[220:223]
    s_addc_u32 s9, s89, 0
    v_and_b32 v145, 0xffff0000, v72
    v_mfma_f32_16x16x32_bf16 v[236:239], a[8:11], a[28:31], v[236:239]
    v_mfma_f32_16x16x32_bf16 v[252:255], a[12:15], a[28:31], v[252:255]
    s_waitcnt lgkmcnt(9)
    v_mfma_f32_16x16x32_bf16 v[192:195], a[32:35], a[48:51], v[192:195]
    v_lshlrev_b32 v146, 16, v73
    s_waitcnt lgkmcnt(8)
    v_mfma_f32_16x16x32_bf16 v[208:211], a[36:39], a[48:51], v[208:211]
    s_waitcnt lgkmcnt(7)
    v_mfma_f32_16x16x32_bf16 v[224:227], a[40:43], a[48:51], v[224:227]
    s_waitcnt lgkmcnt(0)
    s_waitcnt vmcnt(8)
    s_barrier
    v_mfma_f32_16x16x32_bf16 v[240:243], a[44:47], a[48:51], v[240:243]
    ds_read_b128 a[0:3], v34 offset:32768
    ds_read_b64_tr_b16 a[16:17], v38 offset:32768
    v_mfma_f32_16x16x32_bf16 v[196:199], a[32:35], a[52:55], v[196:199]
    ds_read_b64_tr_b16 a[18:19], v39 offset:32768
    ds_read_b128 a[4:7], v34 offset:34816
    s_add_u32 m0, s49, 32768
    s_nop 0
    buffer_load_dwordx4 v4, s[12:15], s24 offen offset:0 lds
    v_and_b32 v147, 0xffff0000, v73
    v_mfma_f32_16x16x32_bf16 v[212:215], a[36:39], a[52:55], v[212:215]
    ds_read_b128 a[8:11], v34 offset:36864
    ds_read_b128 a[12:15], v34 offset:38912
    buffer_load_dwordx4 v5, s[12:15], s25 offen offset:1024 lds
    v_mul_f32 v144, v144, v116
    v_mfma_f32_16x16x32_bf16 v[228:231], a[40:43], a[52:55], v[228:231]
    ds_read_b64_tr_b16 a[20:21], v38 offset:34816
    buffer_load_dwordx4 v4, s[12:15], s26 offen offset:2048 lds
    v_mul_f32 v145, v145, v117
    v_mfma_f32_16x16x32_bf16 v[244:247], a[44:47], a[52:55], v[244:247]
    ds_read_b64_tr_b16 a[22:23], v39 offset:34816
    ds_read_b64_tr_b16 a[24:25], v38 offset:33024
    buffer_load_dwordx4 v5, s[12:15], s27 offen offset:3072 lds
    s_add_u32 s90, s90, 1
    v_mul_f32 v146, v146, v118
    v_mfma_f32_16x16x32_bf16 v[200:203], a[32:35], a[56:59], v[200:203]
    ds_read_b64_tr_b16 a[26:27], v39 offset:33024
    ds_read_b64_tr_b16 a[28:29], v38 offset:35072
    s_and_b32 s90, s90, 31
    v_mul_f32 v147, v147, v119
    v_mfma_f32_16x16x32_bf16 v[216:219], a[36:39], a[56:59], v[216:219]
    ds_read_b64_tr_b16 a[30:31], v39 offset:35072
    s_cmp_lt_u32 s90, 16
    v_mfma_f32_16x16x32_bf16 v[232:235], a[40:43], a[56:59], v[232:235]
    s_cselect_b32 s12, s68, s70
    v_cvt_pk_bf16_f32 v72, v144, v145
    v_mfma_f32_16x16x32_bf16 v[248:251], a[44:47], a[56:59], v[248:251]
    s_cselect_b32 s13, s69, s71
    s_and_b32 s77, s90, 15
    v_cvt_pk_bf16_f32 v73, v146, v147
    v_mfma_f32_16x16x32_bf16 v[204:207], a[32:35], a[60:63], v[204:207]
    s_lshl_b32 s77, s77, 7
    v_lshlrev_b32 v144, 16, v72
    v_mfma_f32_16x16x32_bf16 v[220:223], a[36:39], a[60:63], v[220:223]
    s_add_u32 s12, s12, s77
    v_and_b32 v145, 0xffff0000, v72
    v_mfma_f32_16x16x32_bf16 v[236:239], a[40:43], a[60:63], v[236:239]
    s_addc_u32 s13, s13, 0
    v_mfma_f32_16x16x32_bf16 v[252:255], a[44:47], a[60:63], v[252:255]
    s_waitcnt lgkmcnt(9)
    v_mfma_f32_16x16x32_bf16 v[192:195], a[0:3], a[16:19], v[192:195]
    ds_read_b128 a[32:35], v35 offset:32768
    ds_read_b64_tr_b16 a[48:49], v38 offset:40960
    s_waitcnt lgkmcnt(10)
    v_mfma_f32_16x16x32_bf16 v[208:211], a[4:7], a[16:19], v[208:211]
    ds_read_b64_tr_b16 a[50:51], v39 offset:40960
    s_add_u32 m0, s48, 32768
    v_lshlrev_b32 v146, 16, v73
    s_waitcnt lgkmcnt(10)
    v_mfma_f32_16x16x32_bf16 v[224:227], a[8:11], a[16:19], v[224:227]
    ds_read_b128 a[36:39], v35 offset:34816
    buffer_load_dwordx4 v2, s[8:11], s16 offen offset:0 lds
    v_and_b32 v147, 0xffff0000, v73
    s_waitcnt lgkmcnt(10)
    v_mfma_f32_16x16x32_bf16 v[240:243], a[12:15], a[16:19], v[240:243]
    ds_read_b128 a[40:43], v35 offset:36864
    ds_read_b128 a[44:47], v35 offset:38912
    v_mul_f32 v144, v144, v24
    s_waitcnt lgkmcnt(10)
    v_mfma_f32_16x16x32_bf16 v[196:199], a[0:3], a[20:23], v[196:199]
    ds_read_b64_tr_b16 a[52:53], v38 offset:43008
    buffer_load_dwordx4 v2, s[8:11], s16 offen offset:1024 lds
    v_mfma_f32_16x16x32_bf16 v[212:215], a[4:7], a[20:23], v[212:215]
    ds_read_b64_tr_b16 a[54:55], v39 offset:43008
    buffer_load_dwordx4 v2, s[8:11], s16 offen offset:2048 lds
    v_mul_f32 v145, v145, v24
    v_mfma_f32_16x16x32_bf16 v[228:231], a[8:11], a[20:23], v[228:231]
    ds_read_b64_tr_b16 a[56:57], v38 offset:41216
    ds_read_b64_tr_b16 a[58:59], v39 offset:41216
    v_mul_f32 v146, v146, v24
    v_mfma_f32_16x16x32_bf16 v[244:247], a[12:15], a[20:23], v[244:247]
    ds_read_b64_tr_b16 a[60:61], v38 offset:43264
    buffer_load_dwordx4 v2, s[8:11], s16 offen offset:3072 lds
    s_waitcnt lgkmcnt(13)
    v_mfma_f32_16x16x32_bf16 v[200:203], a[0:3], a[24:27], v[200:203]
    ds_read_b64_tr_b16 a[62:63], v39 offset:43264
    s_add_u32 s76, s76, 16384
    v_mul_f32 v147, v147, v24
    v_mfma_f32_16x16x32_bf16 v[216:219], a[4:7], a[24:27], v[216:219]
    v_lshlrev_b32 v148, 16, v74
    v_mfma_f32_16x16x32_bf16 v[232:235], a[8:11], a[24:27], v[232:235]
    s_and_b32 s76, s76, 524287
    v_and_b32 v149, 0xffff0000, v74
    v_mfma_f32_16x16x32_bf16 v[248:251], a[12:15], a[24:27], v[248:251]
    s_add_u32 s8, s88, s76
    s_waitcnt lgkmcnt(12)
    v_mfma_f32_16x16x32_bf16 v[204:207], a[0:3], a[28:31], v[204:207]
    v_lshlrev_b32 v150, 16, v75
    v_mfma_f32_16x16x32_bf16 v[220:223], a[4:7], a[28:31], v[220:223]
    s_addc_u32 s9, s89, 0
    v_and_b32 v151, 0xffff0000, v75
    v_mfma_f32_16x16x32_bf16 v[236:239], a[8:11], a[28:31], v[236:239]
    v_mfma_f32_16x16x32_bf16 v[252:255], a[12:15], a[28:31], v[252:255]
    s_waitcnt lgkmcnt(9)
    v_mfma_f32_16x16x32_bf16 v[192:195], a[32:35], a[48:51], v[192:195]
    v_mul_f32 v148, v148, v116
    s_waitcnt lgkmcnt(8)
    v_mfma_f32_16x16x32_bf16 v[208:211], a[36:39], a[48:51], v[208:211]
    s_waitcnt lgkmcnt(7)
    v_mfma_f32_16x16x32_bf16 v[224:227], a[40:43], a[48:51], v[224:227]
    s_waitcnt lgkmcnt(0)
    s_waitcnt vmcnt(8)
    s_barrier
    v_mfma_f32_16x16x32_bf16 v[240:243], a[44:47], a[48:51], v[240:243]
    ds_read_b128 a[0:3], v32 offset:0
    ds_read_b64_tr_b16 a[16:17], v36 offset:0
    v_mfma_f32_16x16x32_bf16 v[196:199], a[32:35], a[52:55], v[196:199]
    ds_read_b64_tr_b16 a[18:19], v37 offset:0
    ds_read_b128 a[4:7], v32 offset:2048
    s_add_u32 m0, s49, 65536
    s_nop 0
    buffer_load_dwordx4 v4, s[12:15], s24 offen offset:0 lds
    v_mul_f32 v149, v149, v117
    v_mfma_f32_16x16x32_bf16 v[212:215], a[36:39], a[52:55], v[212:215]
    ds_read_b128 a[8:11], v32 offset:4096
    ds_read_b128 a[12:15], v32 offset:6144
    buffer_load_dwordx4 v5, s[12:15], s25 offen offset:1024 lds
    v_mul_f32 v150, v150, v118
    v_mfma_f32_16x16x32_bf16 v[228:231], a[40:43], a[52:55], v[228:231]
    ds_read_b64_tr_b16 a[20:21], v36 offset:2048
    buffer_load_dwordx4 v4, s[12:15], s26 offen offset:2048 lds
    v_mul_f32 v151, v151, v119
    v_mfma_f32_16x16x32_bf16 v[244:247], a[44:47], a[52:55], v[244:247]
    ds_read_b64_tr_b16 a[22:23], v37 offset:2048
    ds_read_b64_tr_b16 a[24:25], v36 offset:256
    buffer_load_dwordx4 v5, s[12:15], s27 offen offset:3072 lds
    s_add_u32 s90, s90, 1
    v_cvt_pk_bf16_f32 v74, v148, v149
    v_mfma_f32_16x16x32_bf16 v[200:203], a[32:35], a[56:59], v[200:203]
    ds_read_b64_tr_b16 a[26:27], v37 offset:256
    ds_read_b64_tr_b16 a[28:29], v36 offset:2304
    s_and_b32 s90, s90, 31
    v_cvt_pk_bf16_f32 v75, v150, v151
    v_mfma_f32_16x16x32_bf16 v[216:219], a[36:39], a[56:59], v[216:219]
    ds_read_b64_tr_b16 a[30:31], v37 offset:2304
    s_cmp_lt_u32 s90, 16
    v_mfma_f32_16x16x32_bf16 v[232:235], a[40:43], a[56:59], v[232:235]
    s_cselect_b32 s12, s68, s70
    v_lshlrev_b32 v148, 16, v74
    v_mfma_f32_16x16x32_bf16 v[248:251], a[44:47], a[56:59], v[248:251]
    s_cselect_b32 s13, s69, s71
    s_and_b32 s77, s90, 15
    v_and_b32 v149, 0xffff0000, v74
    v_mfma_f32_16x16x32_bf16 v[204:207], a[32:35], a[60:63], v[204:207]
    s_lshl_b32 s77, s77, 7
    v_lshlrev_b32 v150, 16, v75
    v_mfma_f32_16x16x32_bf16 v[220:223], a[36:39], a[60:63], v[220:223]
    s_add_u32 s12, s12, s77
    v_and_b32 v151, 0xffff0000, v75
    v_mfma_f32_16x16x32_bf16 v[236:239], a[40:43], a[60:63], v[236:239]
    s_addc_u32 s13, s13, 0
    v_mfma_f32_16x16x32_bf16 v[252:255], a[44:47], a[60:63], v[252:255]
    s_waitcnt lgkmcnt(9)
    v_mfma_f32_16x16x32_bf16 v[192:195], a[0:3], a[16:19], v[192:195]
    ds_read_b128 a[32:35], v33 offset:0
    ds_read_b64_tr_b16 a[48:49], v36 offset:8192
    s_waitcnt lgkmcnt(10)
    v_mfma_f32_16x16x32_bf16 v[208:211], a[4:7], a[16:19], v[208:211]
    ds_read_b64_tr_b16 a[50:51], v37 offset:8192
    s_add_u32 m0, s48, 65536
    v_mul_f32 v148, v148, v25
    s_waitcnt lgkmcnt(10)
    v_mfma_f32_16x16x32_bf16 v[224:227], a[8:11], a[16:19], v[224:227]
    ds_read_b128 a[36:39], v33 offset:2048
    buffer_load_dwordx4 v2, s[8:11], s16 offen offset:0 lds
    v_mul_f32 v149, v149, v25
    s_waitcnt lgkmcnt(10)
    v_mfma_f32_16x16x32_bf16 v[240:243], a[12:15], a[16:19], v[240:243]
    ds_read_b128 a[40:43], v33 offset:4096
    ds_read_b128 a[44:47], v33 offset:6144
    v_mul_f32 v150, v150, v25
    s_waitcnt lgkmcnt(10)
    v_mfma_f32_16x16x32_bf16 v[196:199], a[0:3], a[20:23], v[196:199]
    ds_read_b64_tr_b16 a[52:53], v36 offset:10240
    buffer_load_dwordx4 v2, s[8:11], s16 offen offset:1024 lds
    v_mfma_f32_16x16x32_bf16 v[212:215], a[4:7], a[20:23], v[212:215]
    ds_read_b64_tr_b16 a[54:55], v37 offset:10240
    buffer_load_dwordx4 v2, s[8:11], s16 offen offset:2048 lds
    v_mul_f32 v151, v151, v25
    v_mfma_f32_16x16x32_bf16 v[228:231], a[8:11], a[20:23], v[228:231]
    ds_read_b64_tr_b16 a[56:57], v36 offset:8448
    ds_read_b64_tr_b16 a[58:59], v37 offset:8448
    v_lshlrev_b32 v152, 16, v76
    v_mfma_f32_16x16x32_bf16 v[244:247], a[12:15], a[20:23], v[244:247]
    ds_read_b64_tr_b16 a[60:61], v36 offset:10496
    buffer_load_dwordx4 v2, s[8:11], s16 offen offset:3072 lds
    s_waitcnt lgkmcnt(13)
    v_mfma_f32_16x16x32_bf16 v[200:203], a[0:3], a[24:27], v[200:203]
    ds_read_b64_tr_b16 a[62:63], v37 offset:10496
    s_add_u32 s76, s76, 16384
    v_and_b32 v153, 0xffff0000, v76
    v_mfma_f32_16x16x32_bf16 v[216:219], a[4:7], a[24:27], v[216:219]
    v_lshlrev_b32 v154, 16, v77
    v_mfma_f32_16x16x32_bf16 v[232:235], a[8:11], a[24:27], v[232:235]
    s_and_b32 s76, s76, 524287
    v_and_b32 v155, 0xffff0000, v77
    v_mfma_f32_16x16x32_bf16 v[248:251], a[12:15], a[24:27], v[248:251]
    s_add_u32 s8, s88, s76
    s_waitcnt lgkmcnt(12)
    v_mfma_f32_16x16x32_bf16 v[204:207], a[0:3], a[28:31], v[204:207]
    v_mul_f32 v152, v152, v116
    v_mfma_f32_16x16x32_bf16 v[220:223], a[4:7], a[28:31], v[220:223]
    s_addc_u32 s9, s89, 0
    v_mul_f32 v153, v153, v117
    v_mfma_f32_16x16x32_bf16 v[236:239], a[8:11], a[28:31], v[236:239]
    v_mfma_f32_16x16x32_bf16 v[252:255], a[12:15], a[28:31], v[252:255]
    s_waitcnt lgkmcnt(9)
    v_mfma_f32_16x16x32_bf16 v[192:195], a[32:35], a[48:51], v[192:195]
    v_mul_f32 v154, v154, v118
    s_waitcnt lgkmcnt(8)
    v_mfma_f32_16x16x32_bf16 v[208:211], a[36:39], a[48:51], v[208:211]
    s_waitcnt lgkmcnt(7)
    v_mfma_f32_16x16x32_bf16 v[224:227], a[40:43], a[48:51], v[224:227]
    s_waitcnt lgkmcnt(0)
    s_waitcnt vmcnt(8)
    s_barrier
    v_mfma_f32_16x16x32_bf16 v[240:243], a[44:47], a[48:51], v[240:243]
    ds_read_b128 a[0:3], v32 offset:32768
    ds_read_b64_tr_b16 a[16:17], v36 offset:32768
    v_mfma_f32_16x16x32_bf16 v[196:199], a[32:35], a[52:55], v[196:199]
    ds_read_b64_tr_b16 a[18:19], v37 offset:32768
    ds_read_b128 a[4:7], v32 offset:34816
    s_add_u32 m0, s49, 98304
    s_nop 0
    buffer_load_dwordx4 v4, s[12:15], s24 offen offset:0 lds
    v_mul_f32 v155, v155, v119
    v_mfma_f32_16x16x32_bf16 v[212:215], a[36:39], a[52:55], v[212:215]
    ds_read_b128 a[8:11], v32 offset:36864
    ds_read_b128 a[12:15], v32 offset:38912
    buffer_load_dwordx4 v5, s[12:15], s25 offen offset:1024 lds
    v_cvt_pk_bf16_f32 v76, v152, v153
    v_mfma_f32_16x16x32_bf16 v[228:231], a[40:43], a[52:55], v[228:231]
    ds_read_b64_tr_b16 a[20:21], v36 offset:34816
    buffer_load_dwordx4 v4, s[12:15], s26 offen offset:2048 lds
    v_cvt_pk_bf16_f32 v77, v154, v155
    v_mfma_f32_16x16x32_bf16 v[244:247], a[44:47], a[52:55], v[244:247]
    ds_read_b64_tr_b16 a[22:23], v37 offset:34816
    ds_read_b64_tr_b16 a[24:25], v36 offset:33024
    buffer_load_dwordx4 v5, s[12:15], s27 offen offset:3072 lds
    s_add_u32 s90, s90, 1
    v_lshlrev_b32 v152, 16, v76
    v_mfma_f32_16x16x32_bf16 v[200:203], a[32:35], a[56:59], v[200:203]
    ds_read_b64_tr_b16 a[26:27], v37 offset:33024
    ds_read_b64_tr_b16 a[28:29], v36 offset:35072
    s_and_b32 s90, s90, 31
    v_and_b32 v153, 0xffff0000, v76
    v_mfma_f32_16x16x32_bf16 v[216:219], a[36:39], a[56:59], v[216:219]
    ds_read_b64_tr_b16 a[30:31], v37 offset:35072
    s_cmp_lt_u32 s90, 16
    v_mfma_f32_16x16x32_bf16 v[232:235], a[40:43], a[56:59], v[232:235]
    s_cselect_b32 s12, s68, s70
    v_lshlrev_b32 v154, 16, v77
    v_mfma_f32_16x16x32_bf16 v[248:251], a[44:47], a[56:59], v[248:251]
    s_cselect_b32 s13, s69, s71
    s_and_b32 s77, s90, 15
    v_and_b32 v155, 0xffff0000, v77
    v_mfma_f32_16x16x32_bf16 v[204:207], a[32:35], a[60:63], v[204:207]
    s_lshl_b32 s77, s77, 7
    v_mul_f32 v152, v152, v26
    v_mfma_f32_16x16x32_bf16 v[220:223], a[36:39], a[60:63], v[220:223]
    s_add_u32 s12, s12, s77
    v_mul_f32 v153, v153, v26
    v_mfma_f32_16x16x32_bf16 v[236:239], a[40:43], a[60:63], v[236:239]
    s_addc_u32 s13, s13, 0
    v_mfma_f32_16x16x32_bf16 v[252:255], a[44:47], a[60:63], v[252:255]
    s_waitcnt lgkmcnt(9)
    v_mfma_f32_16x16x32_bf16 v[192:195], a[0:3], a[16:19], v[192:195]
    ds_read_b128 a[32:35], v33 offset:32768
    ds_read_b64_tr_b16 a[48:49], v36 offset:40960
    s_waitcnt lgkmcnt(10)
    v_mfma_f32_16x16x32_bf16 v[208:211], a[4:7], a[16:19], v[208:211]
    ds_read_b64_tr_b16 a[50:51], v37 offset:40960
    s_add_u32 m0, s48, 98304
    v_mul_f32 v154, v154, v26
    s_waitcnt lgkmcnt(10)
    v_mfma_f32_16x16x32_bf16 v[224:227], a[8:11], a[16:19], v[224:227]
    ds_read_b128 a[36:39], v33 offset:34816
    buffer_load_dwordx4 v2, s[8:11], s16 offen offset:0 lds
    v_mul_f32 v155, v155, v26
    s_waitcnt lgkmcnt(10)
    v_mfma_f32_16x16x32_bf16 v[240:243], a[12:15], a[16:19], v[240:243]
    ds_read_b128 a[40:43], v33 offset:36864
    ds_read_b128 a[44:47], v33 offset:38912
    v_lshlrev_b32 v156, 16, v78
    s_waitcnt lgkmcnt(10)
    v_mfma_f32_16x16x32_bf16 v[196:199], a[0:3], a[20:23], v[196:199]
    ds_read_b64_tr_b16 a[52:53], v36 offset:43008
    buffer_load_dwordx4 v2, s[8:11], s16 offen offset:1024 lds
    v_mfma_f32_16x16x32_bf16 v[212:215], a[4:7], a[20:23], v[212:215]
    ds_read_b64_tr_b16 a[54:55], v37 offset:43008
    buffer_load_dwordx4 v2, s[8:11], s16 offen offset:2048 lds
    v_and_b32 v157, 0xffff0000, v78
    v_mfma_f32_16x16x32_bf16 v[228:231], a[8:11], a[20:23], v[228:231]
    ds_read_b64_tr_b16 a[56:57], v36 offset:41216
    ds_read_b64_tr_b16 a[58:59], v37 offset:41216
    v_lshlrev_b32 v158, 16, v79
    v_mfma_f32_16x16x32_bf16 v[244:247], a[12:15], a[20:23], v[244:247]
    ds_read_b64_tr_b16 a[60:61], v36 offset:43264
    buffer_load_dwordx4 v2, s[8:11], s16 offen offset:3072 lds
    s_waitcnt lgkmcnt(13)
    v_mfma_f32_16x16x32_bf16 v[200:203], a[0:3], a[24:27], v[200:203]
    ds_read_b64_tr_b16 a[62:63], v37 offset:43264
    s_add_u32 s76, s76, 16384
    v_and_b32 v159, 0xffff0000, v79
    v_mfma_f32_16x16x32_bf16 v[216:219], a[4:7], a[24:27], v[216:219]
    v_mul_f32 v156, v156, v116
    v_mfma_f32_16x16x32_bf16 v[232:235], a[8:11], a[24:27], v[232:235]
    s_and_b32 s76, s76, 524287
    v_mul_f32 v157, v157, v117
    v_mfma_f32_16x16x32_bf16 v[248:251], a[12:15], a[24:27], v[248:251]
    s_add_u32 s8, s88, s76
    s_waitcnt lgkmcnt(12)
    v_mfma_f32_16x16x32_bf16 v[204:207], a[0:3], a[28:31], v[204:207]
    v_mul_f32 v158, v158, v118
    v_mfma_f32_16x16x32_bf16 v[220:223], a[4:7], a[28:31], v[220:223]
    s_addc_u32 s9, s89, 0
    v_mul_f32 v159, v159, v119
    v_mfma_f32_16x16x32_bf16 v[236:239], a[8:11], a[28:31], v[236:239]
    v_mfma_f32_16x16x32_bf16 v[252:255], a[12:15], a[28:31], v[252:255]
    s_waitcnt lgkmcnt(9)
    v_mfma_f32_16x16x32_bf16 v[192:195], a[32:35], a[48:51], v[192:195]
    v_cvt_pk_bf16_f32 v78, v156, v157
    s_waitcnt lgkmcnt(8)
    v_mfma_f32_16x16x32_bf16 v[208:211], a[36:39], a[48:51], v[208:211]
    s_waitcnt lgkmcnt(7)
    v_mfma_f32_16x16x32_bf16 v[224:227], a[40:43], a[48:51], v[224:227]
    s_waitcnt lgkmcnt(0)
    s_waitcnt vmcnt(8)
    s_barrier
    v_mfma_f32_16x16x32_bf16 v[240:243], a[44:47], a[48:51], v[240:243]
    ds_read_b128 a[0:3], v34 offset:0
    ds_read_b64_tr_b16 a[16:17], v38 offset:0
    v_mfma_f32_16x16x32_bf16 v[196:199], a[32:35], a[52:55], v[196:199]
    ds_read_b64_tr_b16 a[18:19], v39 offset:0
    ds_read_b128 a[4:7], v34 offset:2048
    s_add_u32 m0, s49, 0
    s_nop 0
    buffer_load_dwordx4 v4, s[12:15], s24 offen offset:0 lds
    v_cvt_pk_bf16_f32 v79, v158, v159
    v_mfma_f32_16x16x32_bf16 v[212:215], a[36:39], a[52:55], v[212:215]
    ds_read_b128 a[8:11], v34 offset:4096
    ds_read_b128 a[12:15], v34 offset:6144
    buffer_load_dwordx4 v5, s[12:15], s25 offen offset:1024 lds
    v_lshlrev_b32 v156, 16, v78
    v_mfma_f32_16x16x32_bf16 v[228:231], a[40:43], a[52:55], v[228:231]
    ds_read_b64_tr_b16 a[20:21], v38 offset:2048
    buffer_load_dwordx4 v4, s[12:15], s26 offen offset:2048 lds
    v_and_b32 v157, 0xffff0000, v78
    v_mfma_f32_16x16x32_bf16 v[244:247], a[44:47], a[52:55], v[244:247]
    ds_read_b64_tr_b16 a[22:23], v39 offset:2048
    ds_read_b64_tr_b16 a[24:25], v38 offset:256
    buffer_load_dwordx4 v5, s[12:15], s27 offen offset:3072 lds
    s_add_u32 s90, s90, 1
    v_lshlrev_b32 v158, 16, v79
    v_mfma_f32_16x16x32_bf16 v[200:203], a[32:35], a[56:59], v[200:203]
    ds_read_b64_tr_b16 a[26:27], v39 offset:256
    ds_read_b64_tr_b16 a[28:29], v38 offset:2304
    s_and_b32 s90, s90, 31
    v_and_b32 v159, 0xffff0000, v79
    v_mfma_f32_16x16x32_bf16 v[216:219], a[36:39], a[56:59], v[216:219]
    ds_read_b64_tr_b16 a[30:31], v39 offset:2304
    s_cmp_lt_u32 s90, 16
    v_mfma_f32_16x16x32_bf16 v[232:235], a[40:43], a[56:59], v[232:235]
    s_cselect_b32 s12, s68, s70
    v_mul_f32 v156, v156, v27
    v_mfma_f32_16x16x32_bf16 v[248:251], a[44:47], a[56:59], v[248:251]
    s_cselect_b32 s13, s69, s71
    s_and_b32 s77, s90, 15
    v_mul_f32 v157, v157, v27
    v_mfma_f32_16x16x32_bf16 v[204:207], a[32:35], a[60:63], v[204:207]
    s_lshl_b32 s77, s77, 7
    v_mul_f32 v158, v158, v27
    v_mfma_f32_16x16x32_bf16 v[220:223], a[36:39], a[60:63], v[220:223]
    s_add_u32 s12, s12, s77
    v_mul_f32 v159, v159, v27
    v_mfma_f32_16x16x32_bf16 v[236:239], a[40:43], a[60:63], v[236:239]
    s_addc_u32 s13, s13, 0
    v_mfma_f32_16x16x32_bf16 v[252:255], a[44:47], a[60:63], v[252:255]
    s_waitcnt lgkmcnt(9)
    v_mfma_f32_16x16x32_bf16 v[192:195], a[0:3], a[16:19], v[192:195]
    ds_read_b128 a[32:35], v35 offset:0
    ds_read_b64_tr_b16 a[48:49], v38 offset:8192
    s_waitcnt lgkmcnt(10)
    v_mfma_f32_16x16x32_bf16 v[208:211], a[4:7], a[16:19], v[208:211]
    ds_read_b64_tr_b16 a[50:51], v39 offset:8192
    s_add_u32 m0, s48, 0
    v_lshlrev_b32 v160, 16, v80
    s_waitcnt lgkmcnt(10)
    v_mfma_f32_16x16x32_bf16 v[224:227], a[8:11], a[16:19], v[224:227]
    ds_read_b128 a[36:39], v35 offset:2048
    buffer_load_dwordx4 v2, s[8:11], s16 offen offset:0 lds
    v_and_b32 v161, 0xffff0000, v80
    s_waitcnt lgkmcnt(10)
    v_mfma_f32_16x16x32_bf16 v[240:243], a[12:15], a[16:19], v[240:243]
    ds_read_b128 a[40:43], v35 offset:4096
    ds_read_b128 a[44:47], v35 offset:6144
    v_lshlrev_b32 v162, 16, v81
    s_waitcnt lgkmcnt(10)
    v_mfma_f32_16x16x32_bf16 v[196:199], a[0:3], a[20:23], v[196:199]
    ds_read_b64_tr_b16 a[52:53], v38 offset:10240
    buffer_load_dwordx4 v2, s[8:11], s16 offen offset:1024 lds
    v_mfma_f32_16x16x32_bf16 v[212:215], a[4:7], a[20:23], v[212:215]
    ds_read_b64_tr_b16 a[54:55], v39 offset:10240
    buffer_load_dwordx4 v2, s[8:11], s16 offen offset:2048 lds
    v_and_b32 v163, 0xffff0000, v81
    v_mfma_f32_16x16x32_bf16 v[228:231], a[8:11], a[20:23], v[228:231]
    ds_read_b64_tr_b16 a[56:57], v38 offset:8448
    ds_read_b64_tr_b16 a[58:59], v39 offset:8448
    v_mul_f32 v160, v160, v120
    v_mfma_f32_16x16x32_bf16 v[244:247], a[12:15], a[20:23], v[244:247]
    ds_read_b64_tr_b16 a[60:61], v38 offset:10496
    buffer_load_dwordx4 v2, s[8:11], s16 offen offset:3072 lds
    s_waitcnt lgkmcnt(13)
    v_mfma_f32_16x16x32_bf16 v[200:203], a[0:3], a[24:27], v[200:203]
    ds_read_b64_tr_b16 a[62:63], v39 offset:10496
    s_add_u32 s76, s76, 16384
    v_mul_f32 v161, v161, v121
    v_mfma_f32_16x16x32_bf16 v[216:219], a[4:7], a[24:27], v[216:219]
    v_mul_f32 v162, v162, v122
    v_mfma_f32_16x16x32_bf16 v[232:235], a[8:11], a[24:27], v[232:235]
    s_and_b32 s76, s76, 524287
    v_mul_f32 v163, v163, v123
    v_mfma_f32_16x16x32_bf16 v[248:251], a[12:15], a[24:27], v[248:251]
    s_add_u32 s8, s88, s76
    s_waitcnt lgkmcnt(12)
    v_mfma_f32_16x16x32_bf16 v[204:207], a[0:3], a[28:31], v[204:207]
    v_cvt_pk_bf16_f32 v80, v160, v161
    v_mfma_f32_16x16x32_bf16 v[220:223], a[4:7], a[28:31], v[220:223]
    s_addc_u32 s9, s89, 0
    v_cvt_pk_bf16_f32 v81, v162, v163
    v_mfma_f32_16x16x32_bf16 v[236:239], a[8:11], a[28:31], v[236:239]
    v_mfma_f32_16x16x32_bf16 v[252:255], a[12:15], a[28:31], v[252:255]
    s_waitcnt lgkmcnt(9)
    v_mfma_f32_16x16x32_bf16 v[192:195], a[32:35], a[48:51], v[192:195]
    v_lshlrev_b32 v160, 16, v80
    s_waitcnt lgkmcnt(8)
    v_mfma_f32_16x16x32_bf16 v[208:211], a[36:39], a[48:51], v[208:211]
    s_waitcnt lgkmcnt(7)
    v_mfma_f32_16x16x32_bf16 v[224:227], a[40:43], a[48:51], v[224:227]
    s_waitcnt lgkmcnt(0)
    s_waitcnt vmcnt(8)
    s_barrier
    v_mfma_f32_16x16x32_bf16 v[240:243], a[44:47], a[48:51], v[240:243]
    ds_read_b128 a[0:3], v34 offset:32768
    ds_read_b64_tr_b16 a[16:17], v38 offset:32768
    v_mfma_f32_16x16x32_bf16 v[196:199], a[32:35], a[52:55], v[196:199]
    ds_read_b64_tr_b16 a[18:19], v39 offset:32768
    ds_read_b128 a[4:7], v34 offset:34816
    s_add_u32 m0, s49, 32768
    s_nop 0
    buffer_load_dwordx4 v4, s[12:15], s24 offen offset:0 lds
    v_and_b32 v161, 0xffff0000, v80
    v_mfma_f32_16x16x32_bf16 v[212:215], a[36:39], a[52:55], v[212:215]
    ds_read_b128 a[8:11], v34 offset:36864
    ds_read_b128 a[12:15], v34 offset:38912
    buffer_load_dwordx4 v5, s[12:15], s25 offen offset:1024 lds
    v_lshlrev_b32 v162, 16, v81
    v_mfma_f32_16x16x32_bf16 v[228:231], a[40:43], a[52:55], v[228:231]
    ds_read_b64_tr_b16 a[20:21], v38 offset:34816
    buffer_load_dwordx4 v4, s[12:15], s26 offen offset:2048 lds
    v_and_b32 v163, 0xffff0000, v81
    v_mfma_f32_16x16x32_bf16 v[244:247], a[44:47], a[52:55], v[244:247]
    ds_read_b64_tr_b16 a[22:23], v39 offset:34816
    ds_read_b64_tr_b16 a[24:25], v38 offset:33024
    buffer_load_dwordx4 v5, s[12:15], s27 offen offset:3072 lds
    s_add_u32 s90, s90, 1
    v_mul_f32 v160, v160, v24
    v_mfma_f32_16x16x32_bf16 v[200:203], a[32:35], a[56:59], v[200:203]
    ds_read_b64_tr_b16 a[26:27], v39 offset:33024
    ds_read_b64_tr_b16 a[28:29], v38 offset:35072
    s_and_b32 s90, s90, 31
    v_mul_f32 v161, v161, v24
    v_mfma_f32_16x16x32_bf16 v[216:219], a[36:39], a[56:59], v[216:219]
    ds_read_b64_tr_b16 a[30:31], v39 offset:35072
    s_cmp_lt_u32 s90, 16
    v_mfma_f32_16x16x32_bf16 v[232:235], a[40:43], a[56:59], v[232:235]
    s_cselect_b32 s12, s68, s70
    v_mul_f32 v162, v162, v24
    v_mfma_f32_16x16x32_bf16 v[248:251], a[44:47], a[56:59], v[248:251]
    s_cselect_b32 s13, s69, s71
    s_and_b32 s77, s90, 15
    v_mul_f32 v163, v163, v24
    v_mfma_f32_16x16x32_bf16 v[204:207], a[32:35], a[60:63], v[204:207]
    s_lshl_b32 s77, s77, 7
    v_lshlrev_b32 v164, 16, v82
    v_mfma_f32_16x16x32_bf16 v[220:223], a[36:39], a[60:63], v[220:223]
    s_add_u32 s12, s12, s77
    v_and_b32 v165, 0xffff0000, v82
    v_mfma_f32_16x16x32_bf16 v[236:239], a[40:43], a[60:63], v[236:239]
    s_addc_u32 s13, s13, 0
    v_mfma_f32_16x16x32_bf16 v[252:255], a[44:47], a[60:63], v[252:255]
    s_waitcnt lgkmcnt(9)
    v_mfma_f32_16x16x32_bf16 v[192:195], a[0:3], a[16:19], v[192:195]
    ds_read_b128 a[32:35], v35 offset:32768
    ds_read_b64_tr_b16 a[48:49], v38 offset:40960
    s_waitcnt lgkmcnt(10)
    v_mfma_f32_16x16x32_bf16 v[208:211], a[4:7], a[16:19], v[208:211]
    ds_read_b64_tr_b16 a[50:51], v39 offset:40960
    s_add_u32 m0, s48, 32768
    v_lshlrev_b32 v166, 16, v83
    s_waitcnt lgkmcnt(10)
    v_mfma_f32_16x16x32_bf16 v[224:227], a[8:11], a[16:19], v[224:227]
    ds_read_b128 a[36:39], v35 offset:34816
    buffer_load_dwordx4 v2, s[8:11], s16 offen offset:0 lds
    v_and_b32 v167, 0xffff0000, v83
    s_waitcnt lgkmcnt(10)
    v_mfma_f32_16x16x32_bf16 v[240:243], a[12:15], a[16:19], v[240:243]
    ds_read_b128 a[40:43], v35 offset:36864
    ds_read_b128 a[44:47], v35 offset:38912
    v_mul_f32 v164, v164, v120
    s_waitcnt lgkmcnt(10)
    v_mfma_f32_16x16x32_bf16 v[196:199], a[0:3], a[20:23], v[196:199]
    ds_read_b64_tr_b16 a[52:53], v38 offset:43008
    buffer_load_dwordx4 v2, s[8:11], s16 offen offset:1024 lds
    v_mfma_f32_16x16x32_bf16 v[212:215], a[4:7], a[20:23], v[212:215]
    ds_read_b64_tr_b16 a[54:55], v39 offset:43008
    buffer_load_dwordx4 v2, s[8:11], s16 offen offset:2048 lds
    v_mul_f32 v165, v165, v121
    v_mfma_f32_16x16x32_bf16 v[228:231], a[8:11], a[20:23], v[228:231]
    ds_read_b64_tr_b16 a[56:57], v38 offset:41216
    ds_read_b64_tr_b16 a[58:59], v39 offset:41216
    v_mul_f32 v166, v166, v122
    v_mfma_f32_16x16x32_bf16 v[244:247], a[12:15], a[20:23], v[244:247]
    ds_read_b64_tr_b16 a[60:61], v38 offset:43264
    buffer_load_dwordx4 v2, s[8:11], s16 offen offset:3072 lds
    s_waitcnt lgkmcnt(13)
    v_mfma_f32_16x16x32_bf16 v[200:203], a[0:3], a[24:27], v[200:203]
    ds_read_b64_tr_b16 a[62:63], v39 offset:43264
    s_add_u32 s76, s76, 16384
    v_mul_f32 v167, v167, v123
    v_mfma_f32_16x16x32_bf16 v[216:219], a[4:7], a[24:27], v[216:219]
    v_cvt_pk_bf16_f32 v82, v164, v165
    v_mfma_f32_16x16x32_bf16 v[232:235], a[8:11], a[24:27], v[232:235]
    s_and_b32 s76, s76, 524287
    v_cvt_pk_bf16_f32 v83, v166, v167
    v_mfma_f32_16x16x32_bf16 v[248:251], a[12:15], a[24:27], v[248:251]
    s_add_u32 s8, s88, s76
    s_waitcnt lgkmcnt(12)
    v_mfma_f32_16x16x32_bf16 v[204:207], a[0:3], a[28:31], v[204:207]
    v_lshlrev_b32 v164, 16, v82
    v_mfma_f32_16x16x32_bf16 v[220:223], a[4:7], a[28:31], v[220:223]
    s_addc_u32 s9, s89, 0
    v_and_b32 v165, 0xffff0000, v82
    v_mfma_f32_16x16x32_bf16 v[236:239], a[8:11], a[28:31], v[236:239]
    v_mfma_f32_16x16x32_bf16 v[252:255], a[12:15], a[28:31], v[252:255]
    s_waitcnt lgkmcnt(9)
    v_mfma_f32_16x16x32_bf16 v[192:195], a[32:35], a[48:51], v[192:195]
    v_lshlrev_b32 v166, 16, v83
    s_waitcnt lgkmcnt(8)
    v_mfma_f32_16x16x32_bf16 v[208:211], a[36:39], a[48:51], v[208:211]
    s_waitcnt lgkmcnt(7)
    v_mfma_f32_16x16x32_bf16 v[224:227], a[40:43], a[48:51], v[224:227]
    s_waitcnt lgkmcnt(0)
    s_waitcnt vmcnt(8)
    s_barrier
    v_mfma_f32_16x16x32_bf16 v[240:243], a[44:47], a[48:51], v[240:243]
    ds_read_b128 a[0:3], v32 offset:0
    ds_read_b64_tr_b16 a[16:17], v36 offset:0
    v_mfma_f32_16x16x32_bf16 v[196:199], a[32:35], a[52:55], v[196:199]
    ds_read_b64_tr_b16 a[18:19], v37 offset:0
    ds_read_b128 a[4:7], v32 offset:2048
    s_add_u32 m0, s49, 65536
    s_nop 0
    buffer_load_dwordx4 v4, s[12:15], s24 offen offset:0 lds
    v_and_b32 v167, 0xffff0000, v83
    v_mfma_f32_16x16x32_bf16 v[212:215], a[36:39], a[52:55], v[212:215]
    ds_read_b128 a[8:11], v32 offset:4096
    ds_read_b128 a[12:15], v32 offset:6144
    buffer_load_dwordx4 v5, s[12:15], s25 offen offset:1024 lds
    v_mul_f32 v164, v164, v25
    v_mfma_f32_16x16x32_bf16 v[228:231], a[40:43], a[52:55], v[228:231]
    ds_read_b64_tr_b16 a[20:21], v36 offset:2048
    buffer_load_dwordx4 v4, s[12:15], s26 offen offset:2048 lds
    v_mul_f32 v165, v165, v25
    v_mfma_f32_16x16x32_bf16 v[244:247], a[44:47], a[52:55], v[244:247]
    ds_read_b64_tr_b16 a[22:23], v37 offset:2048
    ds_read_b64_tr_b16 a[24:25], v36 offset:256
    buffer_load_dwordx4 v5, s[12:15], s27 offen offset:3072 lds
    s_add_u32 s90, s90, 1
    v_mul_f32 v166, v166, v25
    v_mfma_f32_16x16x32_bf16 v[200:203], a[32:35], a[56:59], v[200:203]
    ds_read_b64_tr_b16 a[26:27], v37 offset:256
    ds_read_b64_tr_b16 a[28:29], v36 offset:2304
    s_and_b32 s90, s90, 31
    v_mul_f32 v167, v167, v25
    v_mfma_f32_16x16x32_bf16 v[216:219], a[36:39], a[56:59], v[216:219]
    ds_read_b64_tr_b16 a[30:31], v37 offset:2304
    s_cmp_lt_u32 s90, 16
    v_mfma_f32_16x16x32_bf16 v[232:235], a[40:43], a[56:59], v[232:235]
    s_cselect_b32 s12, s68, s70
    v_lshlrev_b32 v168, 16, v84
    v_mfma_f32_16x16x32_bf16 v[248:251], a[44:47], a[56:59], v[248:251]
    s_cselect_b32 s13, s69, s71
    s_and_b32 s77, s90, 15
    v_and_b32 v169, 0xffff0000, v84
    v_mfma_f32_16x16x32_bf16 v[204:207], a[32:35], a[60:63], v[204:207]
    s_lshl_b32 s77, s77, 7
    v_lshlrev_b32 v170, 16, v85
    v_mfma_f32_16x16x32_bf16 v[220:223], a[36:39], a[60:63], v[220:223]
    s_add_u32 s12, s12, s77
    v_and_b32 v171, 0xffff0000, v85
    v_mfma_f32_16x16x32_bf16 v[236:239], a[40:43], a[60:63], v[236:239]
    s_addc_u32 s13, s13, 0
    v_mfma_f32_16x16x32_bf16 v[252:255], a[44:47], a[60:63], v[252:255]
    s_waitcnt lgkmcnt(9)
    v_mfma_f32_16x16x32_bf16 v[192:195], a[0:3], a[16:19], v[192:195]
    ds_read_b128 a[32:35], v33 offset:0
    ds_read_b64_tr_b16 a[48:49], v36 offset:8192
    s_waitcnt lgkmcnt(10)
    v_mfma_f32_16x16x32_bf16 v[208:211], a[4:7], a[16:19], v[208:211]
    ds_read_b64_tr_b16 a[50:51], v37 offset:8192
    s_add_u32 m0, s48, 65536
    v_mul_f32 v168, v168, v120
    s_waitcnt lgkmcnt(10)
    v_mfma_f32_16x16x32_bf16 v[224:227], a[8:11], a[16:19], v[224:227]
    ds_read_b128 a[36:39], v33 offset:2048
    buffer_load_dwordx4 v2, s[8:11], s16 offen offset:0 lds
    v_mul_f32 v169, v169, v121
    s_waitcnt lgkmcnt(10)
    v_mfma_f32_16x16x32_bf16 v[240:243], a[12:15], a[16:19], v[240:243]
    ds_read_b128 a[40:43], v33 offset:4096
    ds_read_b128 a[44:47], v33 offset:6144
    v_mul_f32 v170, v170, v122
    s_waitcnt lgkmcnt(10)
    v_mfma_f32_16x16x32_bf16 v[196:199], a[0:3], a[20:23], v[196:199]
    ds_read_b64_tr_b16 a[52:53], v36 offset:10240
    buffer_load_dwordx4 v2, s[8:11], s16 offen offset:1024 lds
    v_mfma_f32_16x16x32_bf16 v[212:215], a[4:7], a[20:23], v[212:215]
    ds_read_b64_tr_b16 a[54:55], v37 offset:10240
    buffer_load_dwordx4 v2, s[8:11], s16 offen offset:2048 lds
    v_mul_f32 v171, v171, v123
    v_mfma_f32_16x16x32_bf16 v[228:231], a[8:11], a[20:23], v[228:231]
    ds_read_b64_tr_b16 a[56:57], v36 offset:8448
    ds_read_b64_tr_b16 a[58:59], v37 offset:8448
    v_cvt_pk_bf16_f32 v84, v168, v169
    v_mfma_f32_16x16x32_bf16 v[244:247], a[12:15], a[20:23], v[244:247]
    ds_read_b64_tr_b16 a[60:61], v36 offset:10496
    buffer_load_dwordx4 v2, s[8:11], s16 offen offset:3072 lds
    s_waitcnt lgkmcnt(13)
    v_mfma_f32_16x16x32_bf16 v[200:203], a[0:3], a[24:27], v[200:203]
    ds_read_b64_tr_b16 a[62:63], v37 offset:10496
    s_add_u32 s76, s76, 16384
    v_cvt_pk_bf16_f32 v85, v170, v171
    v_mfma_f32_16x16x32_bf16 v[216:219], a[4:7], a[24:27], v[216:219]
    v_lshlrev_b32 v168, 16, v84
    v_mfma_f32_16x16x32_bf16 v[232:235], a[8:11], a[24:27], v[232:235]
    s_and_b32 s76, s76, 524287
    v_and_b32 v169, 0xffff0000, v84
    v_mfma_f32_16x16x32_bf16 v[248:251], a[12:15], a[24:27], v[248:251]
    s_add_u32 s8, s88, s76
    s_waitcnt lgkmcnt(12)
    v_mfma_f32_16x16x32_bf16 v[204:207], a[0:3], a[28:31], v[204:207]
    v_lshlrev_b32 v170, 16, v85
    v_mfma_f32_16x16x32_bf16 v[220:223], a[4:7], a[28:31], v[220:223]
    s_addc_u32 s9, s89, 0
    v_and_b32 v171, 0xffff0000, v85
    v_mfma_f32_16x16x32_bf16 v[236:239], a[8:11], a[28:31], v[236:239]
    v_mfma_f32_16x16x32_bf16 v[252:255], a[12:15], a[28:31], v[252:255]
    s_waitcnt lgkmcnt(9)
    v_mfma_f32_16x16x32_bf16 v[192:195], a[32:35], a[48:51], v[192:195]
    v_mul_f32 v168, v168, v26
    s_waitcnt lgkmcnt(8)
    v_mfma_f32_16x16x32_bf16 v[208:211], a[36:39], a[48:51], v[208:211]
    s_waitcnt lgkmcnt(7)
    v_mfma_f32_16x16x32_bf16 v[224:227], a[40:43], a[48:51], v[224:227]
    s_waitcnt lgkmcnt(0)
    s_waitcnt vmcnt(8)
    s_barrier
    v_mfma_f32_16x16x32_bf16 v[240:243], a[44:47], a[48:51], v[240:243]
    ds_read_b128 a[0:3], v32 offset:32768
    ds_read_b64_tr_b16 a[16:17], v36 offset:32768
    v_mfma_f32_16x16x32_bf16 v[196:199], a[32:35], a[52:55], v[196:199]
    ds_read_b64_tr_b16 a[18:19], v37 offset:32768
    ds_read_b128 a[4:7], v32 offset:34816
    s_add_u32 m0, s49, 98304
    s_nop 0
    buffer_load_dwordx4 v4, s[12:15], s24 offen offset:0 lds
    v_mul_f32 v169, v169, v26
    v_mfma_f32_16x16x32_bf16 v[212:215], a[36:39], a[52:55], v[212:215]
    ds_read_b128 a[8:11], v32 offset:36864
    ds_read_b128 a[12:15], v32 offset:38912
    buffer_load_dwordx4 v5, s[12:15], s25 offen offset:1024 lds
    v_mul_f32 v170, v170, v26
    v_mfma_f32_16x16x32_bf16 v[228:231], a[40:43], a[52:55], v[228:231]
    ds_read_b64_tr_b16 a[20:21], v36 offset:34816
    buffer_load_dwordx4 v4, s[12:15], s26 offen offset:2048 lds
    v_mul_f32 v171, v171, v26
    v_mfma_f32_16x16x32_bf16 v[244:247], a[44:47], a[52:55], v[244:247]
    ds_read_b64_tr_b16 a[22:23], v37 offset:34816
    ds_read_b64_tr_b16 a[24:25], v36 offset:33024
    buffer_load_dwordx4 v5, s[12:15], s27 offen offset:3072 lds
    s_add_u32 s90, s90, 1
    v_lshlrev_b32 v172, 16, v86
    v_mfma_f32_16x16x32_bf16 v[200:203], a[32:35], a[56:59], v[200:203]
    ds_read_b64_tr_b16 a[26:27], v37 offset:33024
    ds_read_b64_tr_b16 a[28:29], v36 offset:35072
    s_and_b32 s90, s90, 31
    v_and_b32 v173, 0xffff0000, v86
    v_mfma_f32_16x16x32_bf16 v[216:219], a[36:39], a[56:59], v[216:219]
    ds_read_b64_tr_b16 a[30:31], v37 offset:35072
    s_cmp_lt_u32 s90, 16
    v_mfma_f32_16x16x32_bf16 v[232:235], a[40:43], a[56:59], v[232:235]
    s_cselect_b32 s12, s68, s70
    v_lshlrev_b32 v174, 16, v87
    v_mfma_f32_16x16x32_bf16 v[248:251], a[44:47], a[56:59], v[248:251]
    s_cselect_b32 s13, s69, s71
    s_and_b32 s77, s90, 15
    v_and_b32 v175, 0xffff0000, v87
    v_mfma_f32_16x16x32_bf16 v[204:207], a[32:35], a[60:63], v[204:207]
    s_lshl_b32 s77, s77, 7
    v_mul_f32 v172, v172, v120
    v_mfma_f32_16x16x32_bf16 v[220:223], a[36:39], a[60:63], v[220:223]
    s_add_u32 s12, s12, s77
    v_mul_f32 v173, v173, v121
    v_mfma_f32_16x16x32_bf16 v[236:239], a[40:43], a[60:63], v[236:239]
    s_addc_u32 s13, s13, 0
    v_mfma_f32_16x16x32_bf16 v[252:255], a[44:47], a[60:63], v[252:255]
    s_waitcnt lgkmcnt(9)
    v_mfma_f32_16x16x32_bf16 v[192:195], a[0:3], a[16:19], v[192:195]
    ds_read_b128 a[32:35], v33 offset:32768
    ds_read_b64_tr_b16 a[48:49], v36 offset:40960
    s_waitcnt lgkmcnt(10)
    v_mfma_f32_16x16x32_bf16 v[208:211], a[4:7], a[16:19], v[208:211]
    ds_read_b64_tr_b16 a[50:51], v37 offset:40960
    s_add_u32 m0, s48, 98304
    v_mul_f32 v174, v174, v122
    s_waitcnt lgkmcnt(10)
    v_mfma_f32_16x16x32_bf16 v[224:227], a[8:11], a[16:19], v[224:227]
    ds_read_b128 a[36:39], v33 offset:34816
    buffer_load_dwordx4 v2, s[8:11], s16 offen offset:0 lds
    v_mul_f32 v175, v175, v123
    s_waitcnt lgkmcnt(10)
    v_mfma_f32_16x16x32_bf16 v[240:243], a[12:15], a[16:19], v[240:243]
    ds_read_b128 a[40:43], v33 offset:36864
    ds_read_b128 a[44:47], v33 offset:38912
    v_cvt_pk_bf16_f32 v86, v172, v173
    s_waitcnt lgkmcnt(10)
    v_mfma_f32_16x16x32_bf16 v[196:199], a[0:3], a[20:23], v[196:199]
    ds_read_b64_tr_b16 a[52:53], v36 offset:43008
    buffer_load_dwordx4 v2, s[8:11], s16 offen offset:1024 lds
    v_mfma_f32_16x16x32_bf16 v[212:215], a[4:7], a[20:23], v[212:215]
    ds_read_b64_tr_b16 a[54:55], v37 offset:43008
    buffer_load_dwordx4 v2, s[8:11], s16 offen offset:2048 lds
    v_cvt_pk_bf16_f32 v87, v174, v175
    v_mfma_f32_16x16x32_bf16 v[228:231], a[8:11], a[20:23], v[228:231]
    ds_read_b64_tr_b16 a[56:57], v36 offset:41216
    ds_read_b64_tr_b16 a[58:59], v37 offset:41216
    v_lshlrev_b32 v172, 16, v86
    v_mfma_f32_16x16x32_bf16 v[244:247], a[12:15], a[20:23], v[244:247]
    ds_read_b64_tr_b16 a[60:61], v36 offset:43264
    buffer_load_dwordx4 v2, s[8:11], s16 offen offset:3072 lds
    s_waitcnt lgkmcnt(13)
    v_mfma_f32_16x16x32_bf16 v[200:203], a[0:3], a[24:27], v[200:203]
    ds_read_b64_tr_b16 a[62:63], v37 offset:43264
    s_add_u32 s76, s76, 16384
    v_and_b32 v173, 0xffff0000, v86
    v_mfma_f32_16x16x32_bf16 v[216:219], a[4:7], a[24:27], v[216:219]
    v_lshlrev_b32 v174, 16, v87
    v_mfma_f32_16x16x32_bf16 v[232:235], a[8:11], a[24:27], v[232:235]
    s_and_b32 s76, s76, 524287
    v_and_b32 v175, 0xffff0000, v87
    v_mfma_f32_16x16x32_bf16 v[248:251], a[12:15], a[24:27], v[248:251]
    s_add_u32 s8, s88, s76
    s_waitcnt lgkmcnt(12)
    v_mfma_f32_16x16x32_bf16 v[204:207], a[0:3], a[28:31], v[204:207]
    v_mul_f32 v172, v172, v27
    v_mfma_f32_16x16x32_bf16 v[220:223], a[4:7], a[28:31], v[220:223]
    s_addc_u32 s9, s89, 0
    v_mul_f32 v173, v173, v27
    v_mfma_f32_16x16x32_bf16 v[236:239], a[8:11], a[28:31], v[236:239]
    v_mfma_f32_16x16x32_bf16 v[252:255], a[12:15], a[28:31], v[252:255]
    s_waitcnt lgkmcnt(9)
    v_mfma_f32_16x16x32_bf16 v[192:195], a[32:35], a[48:51], v[192:195]
    v_mul_f32 v174, v174, v27
    s_waitcnt lgkmcnt(8)
    v_mfma_f32_16x16x32_bf16 v[208:211], a[36:39], a[48:51], v[208:211]
    s_waitcnt lgkmcnt(7)
    v_mfma_f32_16x16x32_bf16 v[224:227], a[40:43], a[48:51], v[224:227]
    s_waitcnt lgkmcnt(0)
    s_waitcnt vmcnt(8)
    s_barrier
    v_mfma_f32_16x16x32_bf16 v[240:243], a[44:47], a[48:51], v[240:243]
    ds_read_b128 a[0:3], v34 offset:0
    ds_read_b64_tr_b16 a[16:17], v38 offset:0
    v_mfma_f32_16x16x32_bf16 v[196:199], a[32:35], a[52:55], v[196:199]
    ds_read_b64_tr_b16 a[18:19], v39 offset:0
    ds_read_b128 a[4:7], v34 offset:2048
    s_add_u32 m0, s49, 0
    s_nop 0
    buffer_load_dwordx4 v4, s[12:15], s24 offen offset:0 lds
    v_mul_f32 v175, v175, v27
    v_mfma_f32_16x16x32_bf16 v[212:215], a[36:39], a[52:55], v[212:215]
    ds_read_b128 a[8:11], v34 offset:4096
    ds_read_b128 a[12:15], v34 offset:6144
    buffer_load_dwordx4 v5, s[12:15], s25 offen offset:1024 lds
    v_lshlrev_b32 v176, 16, v88
    v_mfma_f32_16x16x32_bf16 v[228:231], a[40:43], a[52:55], v[228:231]
    ds_read_b64_tr_b16 a[20:21], v38 offset:2048
    buffer_load_dwordx4 v4, s[12:15], s26 offen offset:2048 lds
    v_and_b32 v177, 0xffff0000, v88
    v_mfma_f32_16x16x32_bf16 v[244:247], a[44:47], a[52:55], v[244:247]
    ds_read_b64_tr_b16 a[22:23], v39 offset:2048
    ds_read_b64_tr_b16 a[24:25], v38 offset:256
    buffer_load_dwordx4 v5, s[12:15], s27 offen offset:3072 lds
    s_add_u32 s90, s90, 1
    v_lshlrev_b32 v178, 16, v89
    v_mfma_f32_16x16x32_bf16 v[200:203], a[32:35], a[56:59], v[200:203]
    ds_read_b64_tr_b16 a[26:27], v39 offset:256
    ds_read_b64_tr_b16 a[28:29], v38 offset:2304
    s_and_b32 s90, s90, 31
    v_and_b32 v179, 0xffff0000, v89
    v_mfma_f32_16x16x32_bf16 v[216:219], a[36:39], a[56:59], v[216:219]
    ds_read_b64_tr_b16 a[30:31], v39 offset:2304
    s_cmp_lt_u32 s90, 16
    v_mfma_f32_16x16x32_bf16 v[232:235], a[40:43], a[56:59], v[232:235]
    s_cselect_b32 s12, s68, s70
    v_mul_f32 v176, v176, v124
    v_mfma_f32_16x16x32_bf16 v[248:251], a[44:47], a[56:59], v[248:251]
    s_cselect_b32 s13, s69, s71
    s_and_b32 s77, s90, 15
    v_mul_f32 v177, v177, v125
    v_mfma_f32_16x16x32_bf16 v[204:207], a[32:35], a[60:63], v[204:207]
    s_lshl_b32 s77, s77, 7
    v_mul_f32 v178, v178, v126
    v_mfma_f32_16x16x32_bf16 v[220:223], a[36:39], a[60:63], v[220:223]
    s_add_u32 s12, s12, s77
    v_mul_f32 v179, v179, v127
    v_mfma_f32_16x16x32_bf16 v[236:239], a[40:43], a[60:63], v[236:239]
    s_addc_u32 s13, s13, 0
    v_mfma_f32_16x16x32_bf16 v[252:255], a[44:47], a[60:63], v[252:255]
    s_waitcnt lgkmcnt(9)
    v_mfma_f32_16x16x32_bf16 v[192:195], a[0:3], a[16:19], v[192:195]
    ds_read_b128 a[32:35], v35 offset:0
    ds_read_b64_tr_b16 a[48:49], v38 offset:8192
    s_waitcnt lgkmcnt(10)
    v_mfma_f32_16x16x32_bf16 v[208:211], a[4:7], a[16:19], v[208:211]
    ds_read_b64_tr_b16 a[50:51], v39 offset:8192
    s_add_u32 m0, s48, 0
    v_cvt_pk_bf16_f32 v88, v176, v177
    s_waitcnt lgkmcnt(10)
    v_mfma_f32_16x16x32_bf16 v[224:227], a[8:11], a[16:19], v[224:227]
    ds_read_b128 a[36:39], v35 offset:2048
    buffer_load_dwordx4 v2, s[8:11], s16 offen offset:0 lds
    v_cvt_pk_bf16_f32 v89, v178, v179
    s_waitcnt lgkmcnt(10)
    v_mfma_f32_16x16x32_bf16 v[240:243], a[12:15], a[16:19], v[240:243]
    ds_read_b128 a[40:43], v35 offset:4096
    ds_read_b128 a[44:47], v35 offset:6144
    v_lshlrev_b32 v176, 16, v88
    s_waitcnt lgkmcnt(10)
    v_mfma_f32_16x16x32_bf16 v[196:199], a[0:3], a[20:23], v[196:199]
    ds_read_b64_tr_b16 a[52:53], v38 offset:10240
    buffer_load_dwordx4 v2, s[8:11], s16 offen offset:1024 lds
    v_mfma_f32_16x16x32_bf16 v[212:215], a[4:7], a[20:23], v[212:215]
    ds_read_b64_tr_b16 a[54:55], v39 offset:10240
    buffer_load_dwordx4 v2, s[8:11], s16 offen offset:2048 lds
    v_and_b32 v177, 0xffff0000, v88
    v_mfma_f32_16x16x32_bf16 v[228:231], a[8:11], a[20:23], v[228:231]
    ds_read_b64_tr_b16 a[56:57], v38 offset:8448
    ds_read_b64_tr_b16 a[58:59], v39 offset:8448
    v_lshlrev_b32 v178, 16, v89
    v_mfma_f32_16x16x32_bf16 v[244:247], a[12:15], a[20:23], v[244:247]
    ds_read_b64_tr_b16 a[60:61], v38 offset:10496
    buffer_load_dwordx4 v2, s[8:11], s16 offen offset:3072 lds
    s_waitcnt lgkmcnt(13)
    v_mfma_f32_16x16x32_bf16 v[200:203], a[0:3], a[24:27], v[200:203]
    ds_read_b64_tr_b16 a[62:63], v39 offset:10496
    s_add_u32 s76, s76, 16384
    v_and_b32 v179, 0xffff0000, v89
    v_mfma_f32_16x16x32_bf16 v[216:219], a[4:7], a[24:27], v[216:219]
    v_mul_f32 v176, v176, v24
    v_mfma_f32_16x16x32_bf16 v[232:235], a[8:11], a[24:27], v[232:235]
    s_and_b32 s76, s76, 524287
    v_mul_f32 v177, v177, v24
    v_mfma_f32_16x16x32_bf16 v[248:251], a[12:15], a[24:27], v[248:251]
    s_add_u32 s8, s88, s76
    s_waitcnt lgkmcnt(12)
    v_mfma_f32_16x16x32_bf16 v[204:207], a[0:3], a[28:31], v[204:207]
    v_mul_f32 v178, v178, v24
    v_mfma_f32_16x16x32_bf16 v[220:223], a[4:7], a[28:31], v[220:223]
    s_addc_u32 s9, s89, 0
    v_mul_f32 v179, v179, v24
    v_mfma_f32_16x16x32_bf16 v[236:239], a[8:11], a[28:31], v[236:239]
    v_mfma_f32_16x16x32_bf16 v[252:255], a[12:15], a[28:31], v[252:255]
    s_waitcnt lgkmcnt(9)
    v_mfma_f32_16x16x32_bf16 v[192:195], a[32:35], a[48:51], v[192:195]
    v_lshlrev_b32 v180, 16, v90
    s_waitcnt lgkmcnt(8)
    v_mfma_f32_16x16x32_bf16 v[208:211], a[36:39], a[48:51], v[208:211]
    s_waitcnt lgkmcnt(7)
    v_mfma_f32_16x16x32_bf16 v[224:227], a[40:43], a[48:51], v[224:227]
    s_waitcnt lgkmcnt(0)
    s_waitcnt vmcnt(8)
    s_barrier
    v_mfma_f32_16x16x32_bf16 v[240:243], a[44:47], a[48:51], v[240:243]
    ds_read_b128 a[0:3], v34 offset:32768
    ds_read_b64_tr_b16 a[16:17], v38 offset:32768
    v_mfma_f32_16x16x32_bf16 v[196:199], a[32:35], a[52:55], v[196:199]
    ds_read_b64_tr_b16 a[18:19], v39 offset:32768
    ds_read_b128 a[4:7], v34 offset:34816
    s_add_u32 m0, s49, 32768
    s_nop 0
    buffer_load_dwordx4 v4, s[12:15], s24 offen offset:0 lds
    v_and_b32 v181, 0xffff0000, v90
    v_mfma_f32_16x16x32_bf16 v[212:215], a[36:39], a[52:55], v[212:215]
    ds_read_b128 a[8:11], v34 offset:36864
    ds_read_b128 a[12:15], v34 offset:38912
    buffer_load_dwordx4 v5, s[12:15], s25 offen offset:1024 lds
    v_lshlrev_b32 v182, 16, v91
    v_mfma_f32_16x16x32_bf16 v[228:231], a[40:43], a[52:55], v[228:231]
    ds_read_b64_tr_b16 a[20:21], v38 offset:34816
    buffer_load_dwordx4 v4, s[12:15], s26 offen offset:2048 lds
    v_and_b32 v183, 0xffff0000, v91
    v_mfma_f32_16x16x32_bf16 v[244:247], a[44:47], a[52:55], v[244:247]
    ds_read_b64_tr_b16 a[22:23], v39 offset:34816
    ds_read_b64_tr_b16 a[24:25], v38 offset:33024
    buffer_load_dwordx4 v5, s[12:15], s27 offen offset:3072 lds
    s_add_u32 s90, s90, 1
    v_mul_f32 v180, v180, v124
    v_mfma_f32_16x16x32_bf16 v[200:203], a[32:35], a[56:59], v[200:203]
    ds_read_b64_tr_b16 a[26:27], v39 offset:33024
    ds_read_b64_tr_b16 a[28:29], v38 offset:35072
    s_and_b32 s90, s90, 31
    v_mul_f32 v181, v181, v125
    v_mfma_f32_16x16x32_bf16 v[216:219], a[36:39], a[56:59], v[216:219]
    ds_read_b64_tr_b16 a[30:31], v39 offset:35072
    s_cmp_lt_u32 s90, 16
    v_mfma_f32_16x16x32_bf16 v[232:235], a[40:43], a[56:59], v[232:235]
    s_cselect_b32 s12, s68, s70
    v_mul_f32 v182, v182, v126
    v_mfma_f32_16x16x32_bf16 v[248:251], a[44:47], a[56:59], v[248:251]
    s_cselect_b32 s13, s69, s71
    s_and_b32 s77, s90, 15
    v_mul_f32 v183, v183, v127
    v_mfma_f32_16x16x32_bf16 v[204:207], a[32:35], a[60:63], v[204:207]
    s_lshl_b32 s77, s77, 7
    v_cvt_pk_bf16_f32 v90, v180, v181
    v_mfma_f32_16x16x32_bf16 v[220:223], a[36:39], a[60:63], v[220:223]
    s_add_u32 s12, s12, s77
    v_cvt_pk_bf16_f32 v91, v182, v183
    v_mfma_f32_16x16x32_bf16 v[236:239], a[40:43], a[60:63], v[236:239]
    s_addc_u32 s13, s13, 0
    v_mfma_f32_16x16x32_bf16 v[252:255], a[44:47], a[60:63], v[252:255]
    s_waitcnt lgkmcnt(9)
    v_mfma_f32_16x16x32_bf16 v[192:195], a[0:3], a[16:19], v[192:195]
    ds_read_b128 a[32:35], v35 offset:32768
    ds_read_b64_tr_b16 a[48:49], v38 offset:40960
    s_waitcnt lgkmcnt(10)
    v_mfma_f32_16x16x32_bf16 v[208:211], a[4:7], a[16:19], v[208:211]
    ds_read_b64_tr_b16 a[50:51], v39 offset:40960
    s_add_u32 m0, s48, 32768
    v_lshlrev_b32 v180, 16, v90
    s_waitcnt lgkmcnt(10)
    v_mfma_f32_16x16x32_bf16 v[224:227], a[8:11], a[16:19], v[224:227]
    ds_read_b128 a[36:39], v35 offset:34816
    buffer_load_dwordx4 v2, s[8:11], s16 offen offset:0 lds
    v_and_b32 v181, 0xffff0000, v90
    s_waitcnt lgkmcnt(10)
    v_mfma_f32_16x16x32_bf16 v[240:243], a[12:15], a[16:19], v[240:243]
    ds_read_b128 a[40:43], v35 offset:36864
    ds_read_b128 a[44:47], v35 offset:38912
    v_lshlrev_b32 v182, 16, v91
    s_waitcnt lgkmcnt(10)
    v_mfma_f32_16x16x32_bf16 v[196:199], a[0:3], a[20:23], v[196:199]
    ds_read_b64_tr_b16 a[52:53], v38 offset:43008
    buffer_load_dwordx4 v2, s[8:11], s16 offen offset:1024 lds
    v_mfma_f32_16x16x32_bf16 v[212:215], a[4:7], a[20:23], v[212:215]
    ds_read_b64_tr_b16 a[54:55], v39 offset:43008
    buffer_load_dwordx4 v2, s[8:11], s16 offen offset:2048 lds
    v_and_b32 v183, 0xffff0000, v91
    v_mfma_f32_16x16x32_bf16 v[228:231], a[8:11], a[20:23], v[228:231]
    ds_read_b64_tr_b16 a[56:57], v38 offset:41216
    ds_read_b64_tr_b16 a[58:59], v39 offset:41216
    v_mul_f32 v180, v180, v25
    v_mfma_f32_16x16x32_bf16 v[244:247], a[12:15], a[20:23], v[244:247]
    ds_read_b64_tr_b16 a[60:61], v38 offset:43264
    buffer_load_dwordx4 v2, s[8:11], s16 offen offset:3072 lds
    s_waitcnt lgkmcnt(13)
    v_mfma_f32_16x16x32_bf16 v[200:203], a[0:3], a[24:27], v[200:203]
    ds_read_b64_tr_b16 a[62:63], v39 offset:43264
    s_add_u32 s76, s76, 16384
    v_mul_f32 v181, v181, v25
    v_mfma_f32_16x16x32_bf16 v[216:219], a[4:7], a[24:27], v[216:219]
    v_mul_f32 v182, v182, v25
    v_mfma_f32_16x16x32_bf16 v[232:235], a[8:11], a[24:27], v[232:235]
    s_and_b32 s76, s76, 524287
    v_mul_f32 v183, v183, v25
    v_mfma_f32_16x16x32_bf16 v[248:251], a[12:15], a[24:27], v[248:251]
    s_add_u32 s8, s88, s76
    s_waitcnt lgkmcnt(12)
    v_mfma_f32_16x16x32_bf16 v[204:207], a[0:3], a[28:31], v[204:207]
    v_lshlrev_b32 v184, 16, v92
    v_mfma_f32_16x16x32_bf16 v[220:223], a[4:7], a[28:31], v[220:223]
    s_addc_u32 s9, s89, 0
    v_and_b32 v185, 0xffff0000, v92
    v_mfma_f32_16x16x32_bf16 v[236:239], a[8:11], a[28:31], v[236:239]
    v_mfma_f32_16x16x32_bf16 v[252:255], a[12:15], a[28:31], v[252:255]
    s_waitcnt lgkmcnt(9)
    v_mfma_f32_16x16x32_bf16 v[192:195], a[32:35], a[48:51], v[192:195]
    v_lshlrev_b32 v186, 16, v93
    s_waitcnt lgkmcnt(8)
    v_mfma_f32_16x16x32_bf16 v[208:211], a[36:39], a[48:51], v[208:211]
    s_waitcnt lgkmcnt(7)
    v_mfma_f32_16x16x32_bf16 v[224:227], a[40:43], a[48:51], v[224:227]
    s_waitcnt lgkmcnt(0)
    s_waitcnt vmcnt(8)
    s_barrier
    v_mfma_f32_16x16x32_bf16 v[240:243], a[44:47], a[48:51], v[240:243]
    ds_read_b128 a[0:3], v32 offset:0
    ds_read_b64_tr_b16 a[16:17], v36 offset:0
    v_mfma_f32_16x16x32_bf16 v[196:199], a[32:35], a[52:55], v[196:199]
    ds_read_b64_tr_b16 a[18:19], v37 offset:0
    ds_read_b128 a[4:7], v32 offset:2048
    s_add_u32 m0, s49, 65536
    s_nop 0
    buffer_load_dwordx4 v4, s[12:15], s24 offen offset:0 lds
    v_and_b32 v187, 0xffff0000, v93
    v_mfma_f32_16x16x32_bf16 v[212:215], a[36:39], a[52:55], v[212:215]
    ds_read_b128 a[8:11], v32 offset:4096
    ds_read_b128 a[12:15], v32 offset:6144
    buffer_load_dwordx4 v5, s[12:15], s25 offen offset:1024 lds
    v_mul_f32 v184, v184, v124
    v_mfma_f32_16x16x32_bf16 v[228:231], a[40:43], a[52:55], v[228:231]
    ds_read_b64_tr_b16 a[20:21], v36 offset:2048
    buffer_load_dwordx4 v4, s[12:15], s26 offen offset:2048 lds
    v_mul_f32 v185, v185, v125
    v_mfma_f32_16x16x32_bf16 v[244:247], a[44:47], a[52:55], v[244:247]
    ds_read_b64_tr_b16 a[22:23], v37 offset:2048
    ds_read_b64_tr_b16 a[24:25], v36 offset:256
    buffer_load_dwordx4 v5, s[12:15], s27 offen offset:3072 lds
    s_add_u32 s90, s90, 1
    v_mul_f32 v186, v186, v126
    v_mfma_f32_16x16x32_bf16 v[200:203], a[32:35], a[56:59], v[200:203]
    ds_read_b64_tr_b16 a[26:27], v37 offset:256
    ds_read_b64_tr_b16 a[28:29], v36 offset:2304
    s_and_b32 s90, s90, 31
    v_mul_f32 v187, v187, v127
    v_mfma_f32_16x16x32_bf16 v[216:219], a[36:39], a[56:59], v[216:219]
    ds_read_b64_tr_b16 a[30:31], v37 offset:2304
    s_cmp_lt_u32 s90, 16
    v_mfma_f32_16x16x32_bf16 v[232:235], a[40:43], a[56:59], v[232:235]
    s_cselect_b32 s12, s68, s70
    v_cvt_pk_bf16_f32 v92, v184, v185
    v_mfma_f32_16x16x32_bf16 v[248:251], a[44:47], a[56:59], v[248:251]
    s_cselect_b32 s13, s69, s71
    s_and_b32 s77, s90, 15
    v_cvt_pk_bf16_f32 v93, v186, v187
    v_mfma_f32_16x16x32_bf16 v[204:207], a[32:35], a[60:63], v[204:207]
    s_lshl_b32 s77, s77, 7
    v_lshlrev_b32 v184, 16, v92
    v_mfma_f32_16x16x32_bf16 v[220:223], a[36:39], a[60:63], v[220:223]
    s_add_u32 s12, s12, s77
    v_and_b32 v185, 0xffff0000, v92
    v_mfma_f32_16x16x32_bf16 v[236:239], a[40:43], a[60:63], v[236:239]
    s_addc_u32 s13, s13, 0
    v_mfma_f32_16x16x32_bf16 v[252:255], a[44:47], a[60:63], v[252:255]
    s_waitcnt lgkmcnt(9)
    v_mfma_f32_16x16x32_bf16 v[192:195], a[0:3], a[16:19], v[192:195]
    ds_read_b128 a[32:35], v33 offset:0
    ds_read_b64_tr_b16 a[48:49], v36 offset:8192
    s_waitcnt lgkmcnt(10)
    v_mfma_f32_16x16x32_bf16 v[208:211], a[4:7], a[16:19], v[208:211]
    ds_read_b64_tr_b16 a[50:51], v37 offset:8192
    s_add_u32 m0, s48, 65536
    v_lshlrev_b32 v186, 16, v93
    s_waitcnt lgkmcnt(10)
    v_mfma_f32_16x16x32_bf16 v[224:227], a[8:11], a[16:19], v[224:227]
    ds_read_b128 a[36:39], v33 offset:2048
    buffer_load_dwordx4 v2, s[8:11], s16 offen offset:0 lds
    v_and_b32 v187, 0xffff0000, v93
    s_waitcnt lgkmcnt(10)
    v_mfma_f32_16x16x32_bf16 v[240:243], a[12:15], a[16:19], v[240:243]
    ds_read_b128 a[40:43], v33 offset:4096
    ds_read_b128 a[44:47], v33 offset:6144
    v_mul_f32 v184, v184, v26
    s_waitcnt lgkmcnt(10)
    v_mfma_f32_16x16x32_bf16 v[196:199], a[0:3], a[20:23], v[196:199]
    ds_read_b64_tr_b16 a[52:53], v36 offset:10240
    buffer_load_dwordx4 v2, s[8:11], s16 offen offset:1024 lds
    v_mfma_f32_16x16x32_bf16 v[212:215], a[4:7], a[20:23], v[212:215]
    ds_read_b64_tr_b16 a[54:55], v37 offset:10240
    buffer_load_dwordx4 v2, s[8:11], s16 offen offset:2048 lds
    v_mul_f32 v185, v185, v26
    v_mfma_f32_16x16x32_bf16 v[228:231], a[8:11], a[20:23], v[228:231]
    ds_read_b64_tr_b16 a[56:57], v36 offset:8448
    ds_read_b64_tr_b16 a[58:59], v37 offset:8448
    v_mul_f32 v186, v186, v26
    v_mfma_f32_16x16x32_bf16 v[244:247], a[12:15], a[20:23], v[244:247]
    ds_read_b64_tr_b16 a[60:61], v36 offset:10496
    buffer_load_dwordx4 v2, s[8:11], s16 offen offset:3072 lds
    s_waitcnt lgkmcnt(13)
    v_mfma_f32_16x16x32_bf16 v[200:203], a[0:3], a[24:27], v[200:203]
    ds_read_b64_tr_b16 a[62:63], v37 offset:10496
    s_add_u32 s76, s76, 16384
    v_mul_f32 v187, v187, v26
    v_mfma_f32_16x16x32_bf16 v[216:219], a[4:7], a[24:27], v[216:219]
    v_lshlrev_b32 v188, 16, v94
    v_mfma_f32_16x16x32_bf16 v[232:235], a[8:11], a[24:27], v[232:235]
    s_and_b32 s76, s76, 524287
    v_and_b32 v189, 0xffff0000, v94
    v_mfma_f32_16x16x32_bf16 v[248:251], a[12:15], a[24:27], v[248:251]
    s_add_u32 s8, s88, s76
    s_waitcnt lgkmcnt(12)
    v_mfma_f32_16x16x32_bf16 v[204:207], a[0:3], a[28:31], v[204:207]
    v_lshlrev_b32 v190, 16, v95
    v_mfma_f32_16x16x32_bf16 v[220:223], a[4:7], a[28:31], v[220:223]
    s_addc_u32 s9, s89, 0
    v_and_b32 v191, 0xffff0000, v95
    v_mfma_f32_16x16x32_bf16 v[236:239], a[8:11], a[28:31], v[236:239]
    v_mfma_f32_16x16x32_bf16 v[252:255], a[12:15], a[28:31], v[252:255]
    s_waitcnt lgkmcnt(9)
    v_mfma_f32_16x16x32_bf16 v[192:195], a[32:35], a[48:51], v[192:195]
    v_mul_f32 v188, v188, v124
    s_waitcnt lgkmcnt(8)
    v_mfma_f32_16x16x32_bf16 v[208:211], a[36:39], a[48:51], v[208:211]
    s_waitcnt lgkmcnt(7)
    v_mfma_f32_16x16x32_bf16 v[224:227], a[40:43], a[48:51], v[224:227]
    s_waitcnt lgkmcnt(0)
    s_waitcnt vmcnt(8)
    s_barrier
    v_mfma_f32_16x16x32_bf16 v[240:243], a[44:47], a[48:51], v[240:243]
    ds_read_b128 a[0:3], v32 offset:32768
    ds_read_b64_tr_b16 a[16:17], v36 offset:32768
    v_mfma_f32_16x16x32_bf16 v[196:199], a[32:35], a[52:55], v[196:199]
    ds_read_b64_tr_b16 a[18:19], v37 offset:32768
    ds_read_b128 a[4:7], v32 offset:34816
    s_add_u32 m0, s49, 98304
    s_nop 0
    buffer_load_dwordx4 v4, s[12:15], s24 offen offset:0 lds
    v_mul_f32 v189, v189, v125
    v_mfma_f32_16x16x32_bf16 v[212:215], a[36:39], a[52:55], v[212:215]
    ds_read_b128 a[8:11], v32 offset:36864
    ds_read_b128 a[12:15], v32 offset:38912
    buffer_load_dwordx4 v5, s[12:15], s25 offen offset:1024 lds
    v_mul_f32 v190, v190, v126
    v_mfma_f32_16x16x32_bf16 v[228:231], a[40:43], a[52:55], v[228:231]
    ds_read_b64_tr_b16 a[20:21], v36 offset:34816
    buffer_load_dwordx4 v4, s[12:15], s26 offen offset:2048 lds
    v_mul_f32 v191, v191, v127
    v_mfma_f32_16x16x32_bf16 v[244:247], a[44:47], a[52:55], v[244:247]
    ds_read_b64_tr_b16 a[22:23], v37 offset:34816
    ds_read_b64_tr_b16 a[24:25], v36 offset:33024
    buffer_load_dwordx4 v5, s[12:15], s27 offen offset:3072 lds
    s_add_u32 s90, s90, 1
    v_cvt_pk_bf16_f32 v94, v188, v189
    v_mfma_f32_16x16x32_bf16 v[200:203], a[32:35], a[56:59], v[200:203]
    ds_read_b64_tr_b16 a[26:27], v37 offset:33024
    ds_read_b64_tr_b16 a[28:29], v36 offset:35072
    s_and_b32 s90, s90, 31
    v_cvt_pk_bf16_f32 v95, v190, v191
    v_mfma_f32_16x16x32_bf16 v[216:219], a[36:39], a[56:59], v[216:219]
    ds_read_b64_tr_b16 a[30:31], v37 offset:35072
    s_cmp_lt_u32 s90, 16
    v_mfma_f32_16x16x32_bf16 v[232:235], a[40:43], a[56:59], v[232:235]
    s_cselect_b32 s12, s68, s70
    v_lshlrev_b32 v188, 16, v94
    v_mfma_f32_16x16x32_bf16 v[248:251], a[44:47], a[56:59], v[248:251]
    s_cselect_b32 s13, s69, s71
    s_and_b32 s77, s90, 15
    v_and_b32 v189, 0xffff0000, v94
    v_mfma_f32_16x16x32_bf16 v[204:207], a[32:35], a[60:63], v[204:207]
    s_lshl_b32 s77, s77, 7
    v_lshlrev_b32 v190, 16, v95
    v_mfma_f32_16x16x32_bf16 v[220:223], a[36:39], a[60:63], v[220:223]
    s_add_u32 s12, s12, s77
    v_and_b32 v191, 0xffff0000, v95
    v_mfma_f32_16x16x32_bf16 v[236:239], a[40:43], a[60:63], v[236:239]
    s_addc_u32 s13, s13, 0
    v_mfma_f32_16x16x32_bf16 v[252:255], a[44:47], a[60:63], v[252:255]
    s_waitcnt lgkmcnt(9)
    v_mfma_f32_16x16x32_bf16 v[192:195], a[0:3], a[16:19], v[192:195]
    ds_read_b128 a[32:35], v33 offset:32768
    ds_read_b64_tr_b16 a[48:49], v36 offset:40960
    s_waitcnt lgkmcnt(10)
    v_mfma_f32_16x16x32_bf16 v[208:211], a[4:7], a[16:19], v[208:211]
    ds_read_b64_tr_b16 a[50:51], v37 offset:40960
    s_add_u32 m0, s48, 98304
    v_mul_f32 v188, v188, v27
    s_waitcnt lgkmcnt(10)
    v_mfma_f32_16x16x32_bf16 v[224:227], a[8:11], a[16:19], v[224:227]
    ds_read_b128 a[36:39], v33 offset:34816
    buffer_load_dwordx4 v2, s[8:11], s16 offen offset:0 lds
    s_waitcnt lgkmcnt(10)
    v_mfma_f32_16x16x32_bf16 v[240:243], a[12:15], a[16:19], v[240:243]
    ds_read_b128 a[40:43], v33 offset:36864
    ds_read_b128 a[44:47], v33 offset:38912
    s_waitcnt lgkmcnt(10)
    v_mfma_f32_16x16x32_bf16 v[196:199], a[0:3], a[20:23], v[196:199]
    ds_read_b64_tr_b16 a[52:53], v36 offset:43008
    buffer_load_dwordx4 v2, s[8:11], s16 offen offset:1024 lds
    v_mul_f32 v189, v189, v27
    v_mfma_f32_16x16x32_bf16 v[212:215], a[4:7], a[20:23], v[212:215]
    ds_read_b64_tr_b16 a[54:55], v37 offset:43008
    buffer_load_dwordx4 v2, s[8:11], s16 offen offset:2048 lds
    v_mfma_f32_16x16x32_bf16 v[228:231], a[8:11], a[20:23], v[228:231]
    ds_read_b64_tr_b16 a[56:57], v36 offset:41216
    ds_read_b64_tr_b16 a[58:59], v37 offset:41216
    v_mfma_f32_16x16x32_bf16 v[244:247], a[12:15], a[20:23], v[244:247]
    ds_read_b64_tr_b16 a[60:61], v36 offset:43264
    buffer_load_dwordx4 v2, s[8:11], s16 offen offset:3072 lds
    s_waitcnt lgkmcnt(13)
    v_mfma_f32_16x16x32_bf16 v[200:203], a[0:3], a[24:27], v[200:203]
    ds_read_b64_tr_b16 a[62:63], v37 offset:43264
    s_add_u32 s76, s76, 16384
    v_mul_f32 v190, v190, v27
    v_mfma_f32_16x16x32_bf16 v[216:219], a[4:7], a[24:27], v[216:219]
    v_mfma_f32_16x16x32_bf16 v[232:235], a[8:11], a[24:27], v[232:235]
    s_and_b32 s76, s76, 524287
    v_mfma_f32_16x16x32_bf16 v[248:251], a[12:15], a[24:27], v[248:251]
    s_add_u32 s8, s88, s76
    v_mul_f32 v191, v191, v27
    s_waitcnt lgkmcnt(12)
    v_mfma_f32_16x16x32_bf16 v[204:207], a[0:3], a[28:31], v[204:207]
    v_mfma_f32_16x16x32_bf16 v[220:223], a[4:7], a[28:31], v[220:223]
    s_addc_u32 s9, s89, 0
    v_mfma_f32_16x16x32_bf16 v[236:239], a[8:11], a[28:31], v[236:239]
    v_mfma_f32_16x16x32_bf16 v[252:255], a[12:15], a[28:31], v[252:255]
    s_waitcnt lgkmcnt(9)
    v_mfma_f32_16x16x32_bf16 v[192:195], a[32:35], a[48:51], v[192:195]
    s_waitcnt lgkmcnt(8)
    v_mfma_f32_16x16x32_bf16 v[208:211], a[36:39], a[48:51], v[208:211]
    s_waitcnt lgkmcnt(7)
    v_mfma_f32_16x16x32_bf16 v[224:227], a[40:43], a[48:51], v[224:227]
    s_waitcnt lgkmcnt(0)
    s_waitcnt vmcnt(8)
    s_barrier
    v_mfma_f32_16x16x32_bf16 v[240:243], a[44:47], a[48:51], v[240:243]
    ds_read_b128 a[0:3], v34 offset:0
    ds_read_b64_tr_b16 a[16:17], v38 offset:0
    v_mfma_f32_16x16x32_bf16 v[196:199], a[32:35], a[52:55], v[196:199]
    ds_read_b64_tr_b16 a[18:19], v39 offset:0
    ds_read_b128 a[4:7], v34 offset:2048
    s_add_u32 m0, s49, 0
    s_nop 0
    buffer_load_dwordx4 v4, s[12:15], s24 offen offset:0 lds
    v_mfma_f32_16x16x32_bf16 v[212:215], a[36:39], a[52:55], v[212:215]
    ds_read_b128 a[8:11], v34 offset:4096
    ds_read_b128 a[12:15], v34 offset:6144
    buffer_load_dwordx4 v5, s[12:15], s25 offen offset:1024 lds
    v_mfma_f32_16x16x32_bf16 v[228:231], a[40:43], a[52:55], v[228:231]
    ds_read_b64_tr_b16 a[20:21], v38 offset:2048
    buffer_load_dwordx4 v4, s[12:15], s26 offen offset:2048 lds
    v_mfma_f32_16x16x32_bf16 v[244:247], a[44:47], a[52:55], v[244:247]
    ds_read_b64_tr_b16 a[22:23], v39 offset:2048
    ds_read_b64_tr_b16 a[24:25], v38 offset:256
    buffer_load_dwordx4 v5, s[12:15], s27 offen offset:3072 lds
    s_add_u32 s90, s90, 1
    v_mfma_f32_16x16x32_bf16 v[200:203], a[32:35], a[56:59], v[200:203]
    ds_read_b64_tr_b16 a[26:27], v39 offset:256
    ds_read_b64_tr_b16 a[28:29], v38 offset:2304
    s_and_b32 s90, s90, 31
    v_mfma_f32_16x16x32_bf16 v[216:219], a[36:39], a[56:59], v[216:219]
    ds_read_b64_tr_b16 a[30:31], v39 offset:2304
    s_cmp_lt_u32 s90, 16
    v_mfma_f32_16x16x32_bf16 v[232:235], a[40:43], a[56:59], v[232:235]
    s_cselect_b32 s12, s68, s70
    v_mfma_f32_16x16x32_bf16 v[248:251], a[44:47], a[56:59], v[248:251]
    s_cselect_b32 s13, s69, s71
    s_and_b32 s77, s90, 15
    v_mfma_f32_16x16x32_bf16 v[204:207], a[32:35], a[60:63], v[204:207]
    s_lshl_b32 s77, s77, 7
    v_mfma_f32_16x16x32_bf16 v[220:223], a[36:39], a[60:63], v[220:223]
    s_add_u32 s12, s12, s77
    v_mfma_f32_16x16x32_bf16 v[236:239], a[40:43], a[60:63], v[236:239]
    s_addc_u32 s13, s13, 0
    v_mfma_f32_16x16x32_bf16 v[252:255], a[44:47], a[60:63], v[252:255]
    s_waitcnt lgkmcnt(9)
    v_mfma_f32_16x16x32_bf16 v[192:195], a[0:3], a[16:19], v[192:195]
    ds_read_b128 a[32:35], v35 offset:0
    ds_read_b64_tr_b16 a[48:49], v38 offset:8192
    s_waitcnt lgkmcnt(10)
    v_mfma_f32_16x16x32_bf16 v[208:211], a[4:7], a[16:19], v[208:211]
    ds_read_b64_tr_b16 a[50:51], v39 offset:8192
    s_add_u32 m0, s48, 0
    s_waitcnt lgkmcnt(10)
    v_mfma_f32_16x16x32_bf16 v[224:227], a[8:11], a[16:19], v[224:227]
    ds_read_b128 a[36:39], v35 offset:2048
    buffer_load_dwordx4 v2, s[8:11], s16 offen offset:0 lds
    s_waitcnt lgkmcnt(10)
    v_mfma_f32_16x16x32_bf16 v[240:243], a[12:15], a[16:19], v[240:243]
    ds_read_b128 a[40:43], v35 offset:4096
    ds_read_b128 a[44:47], v35 offset:6144
    s_waitcnt lgkmcnt(10)
    v_mfma_f32_16x16x32_bf16 v[196:199], a[0:3], a[20:23], v[196:199]
    ds_read_b64_tr_b16 a[52:53], v38 offset:10240
    buffer_load_dwordx4 v2, s[8:11], s16 offen offset:1024 lds
    v_mfma_f32_16x16x32_bf16 v[212:215], a[4:7], a[20:23], v[212:215]
    ds_read_b64_tr_b16 a[54:55], v39 offset:10240
    buffer_load_dwordx4 v2, s[8:11], s16 offen offset:2048 lds
    v_mfma_f32_16x16x32_bf16 v[228:231], a[8:11], a[20:23], v[228:231]
    ds_read_b64_tr_b16 a[56:57], v38 offset:8448
    ds_read_b64_tr_b16 a[58:59], v39 offset:8448
    v_mfma_f32_16x16x32_bf16 v[244:247], a[12:15], a[20:23], v[244:247]
    ds_read_b64_tr_b16 a[60:61], v38 offset:10496
    buffer_load_dwordx4 v2, s[8:11], s16 offen offset:3072 lds
    s_waitcnt lgkmcnt(13)
    v_mfma_f32_16x16x32_bf16 v[200:203], a[0:3], a[24:27], v[200:203]
    ds_read_b64_tr_b16 a[62:63], v39 offset:10496
    s_add_u32 s76, s76, 16384
    v_mfma_f32_16x16x32_bf16 v[216:219], a[4:7], a[24:27], v[216:219]
    v_mfma_f32_16x16x32_bf16 v[232:235], a[8:11], a[24:27], v[232:235]
    s_and_b32 s76, s76, 524287
    v_mfma_f32_16x16x32_bf16 v[248:251], a[12:15], a[24:27], v[248:251]
    s_add_u32 s8, s88, s76
    s_waitcnt lgkmcnt(12)
    v_mfma_f32_16x16x32_bf16 v[204:207], a[0:3], a[28:31], v[204:207]
    v_mfma_f32_16x16x32_bf16 v[220:223], a[4:7], a[28:31], v[220:223]
    s_addc_u32 s9, s89, 0
    v_mfma_f32_16x16x32_bf16 v[236:239], a[8:11], a[28:31], v[236:239]
    v_mfma_f32_16x16x32_bf16 v[252:255], a[12:15], a[28:31], v[252:255]
    s_waitcnt lgkmcnt(9)
    v_mfma_f32_16x16x32_bf16 v[192:195], a[32:35], a[48:51], v[192:195]
    s_waitcnt lgkmcnt(8)
    v_mfma_f32_16x16x32_bf16 v[208:211], a[36:39], a[48:51], v[208:211]
    s_waitcnt lgkmcnt(7)
    v_mfma_f32_16x16x32_bf16 v[224:227], a[40:43], a[48:51], v[224:227]
    s_waitcnt lgkmcnt(0)
    s_waitcnt vmcnt(8)
    s_barrier
    v_mfma_f32_16x16x32_bf16 v[240:243], a[44:47], a[48:51], v[240:243]
    ds_read_b128 a[0:3], v34 offset:32768
    ds_read_b64_tr_b16 a[16:17], v38 offset:32768
    v_mfma_f32_16x16x32_bf16 v[196:199], a[32:35], a[52:55], v[196:199]
    ds_read_b64_tr_b16 a[18:19], v39 offset:32768
    ds_read_b128 a[4:7], v34 offset:34816
    s_add_u32 m0, s49, 32768
    v_mfma_f32_16x16x32_bf16 v[212:215], a[36:39], a[52:55], v[212:215]
    ds_read_b128 a[8:11], v34 offset:36864
    ds_read_b128 a[12:15], v34 offset:38912
    buffer_load_dwordx4 v4, s[12:15], s24 offen offset:0 lds
    v_mfma_f32_16x16x32_bf16 v[228:231], a[40:43], a[52:55], v[228:231]
    ds_read_b64_tr_b16 a[20:21], v38 offset:34816
    v_mfma_f32_16x16x32_bf16 v[244:247], a[44:47], a[52:55], v[244:247]
    ds_read_b64_tr_b16 a[22:23], v39 offset:34816
    ds_read_b64_tr_b16 a[24:25], v38 offset:33024
    buffer_load_dwordx4 v5, s[12:15], s25 offen offset:1024 lds
    v_mfma_f32_16x16x32_bf16 v[200:203], a[32:35], a[56:59], v[200:203]
    ds_read_b64_tr_b16 a[26:27], v39 offset:33024
    ds_read_b64_tr_b16 a[28:29], v38 offset:35072
    v_mfma_f32_16x16x32_bf16 v[216:219], a[36:39], a[56:59], v[216:219]
    ds_read_b64_tr_b16 a[30:31], v39 offset:35072
    buffer_load_dwordx4 v4, s[12:15], s26 offen offset:2048 lds
    v_mfma_f32_16x16x32_bf16 v[232:235], a[40:43], a[56:59], v[232:235]
    v_mfma_f32_16x16x32_bf16 v[248:251], a[44:47], a[56:59], v[248:251]
    buffer_load_dwordx4 v5, s[12:15], s27 offen offset:3072 lds
    v_mfma_f32_16x16x32_bf16 v[204:207], a[32:35], a[60:63], v[204:207]
    v_mfma_f32_16x16x32_bf16 v[220:223], a[36:39], a[60:63], v[220:223]
    s_add_u32 m0, s48, 32768
    v_mfma_f32_16x16x32_bf16 v[236:239], a[40:43], a[60:63], v[236:239]
    v_mfma_f32_16x16x32_bf16 v[252:255], a[44:47], a[60:63], v[252:255]
    s_waitcnt lgkmcnt(9)
    v_mfma_f32_16x16x32_bf16 v[192:195], a[0:3], a[16:19], v[192:195]
    ds_read_b128 a[32:35], v35 offset:32768
    ds_read_b64_tr_b16 a[48:49], v38 offset:40960
    s_waitcnt lgkmcnt(10)
    v_mfma_f32_16x16x32_bf16 v[208:211], a[4:7], a[16:19], v[208:211]
    ds_read_b64_tr_b16 a[50:51], v39 offset:40960
    buffer_load_dwordx4 v2, s[8:11], s16 offen offset:0 lds
    s_waitcnt lgkmcnt(10)
    v_mfma_f32_16x16x32_bf16 v[224:227], a[8:11], a[16:19], v[224:227]
    ds_read_b128 a[36:39], v35 offset:34816
    s_waitcnt lgkmcnt(10)
    v_mfma_f32_16x16x32_bf16 v[240:243], a[12:15], a[16:19], v[240:243]
    ds_read_b128 a[40:43], v35 offset:36864
    ds_read_b128 a[44:47], v35 offset:38912
    s_waitcnt lgkmcnt(10)
    v_mfma_f32_16x16x32_bf16 v[196:199], a[0:3], a[20:23], v[196:199]
    ds_read_b64_tr_b16 a[52:53], v38 offset:43008
    buffer_load_dwordx4 v2, s[8:11], s16 offen offset:1024 lds
    v_mfma_f32_16x16x32_bf16 v[212:215], a[4:7], a[20:23], v[212:215]
    ds_read_b64_tr_b16 a[54:55], v39 offset:43008
    v_mfma_f32_16x16x32_bf16 v[228:231], a[8:11], a[20:23], v[228:231]
    ds_read_b64_tr_b16 a[56:57], v38 offset:41216
    ds_read_b64_tr_b16 a[58:59], v39 offset:41216
    v_mfma_f32_16x16x32_bf16 v[244:247], a[12:15], a[20:23], v[244:247]
    ds_read_b64_tr_b16 a[60:61], v38 offset:43264
    s_waitcnt lgkmcnt(13)
    v_mfma_f32_16x16x32_bf16 v[200:203], a[0:3], a[24:27], v[200:203]
    ds_read_b64_tr_b16 a[62:63], v39 offset:43264
    buffer_load_dwordx4 v2, s[8:11], s16 offen offset:2048 lds
    v_mfma_f32_16x16x32_bf16 v[216:219], a[4:7], a[24:27], v[216:219]
    v_mfma_f32_16x16x32_bf16 v[232:235], a[8:11], a[24:27], v[232:235]
    v_mfma_f32_16x16x32_bf16 v[248:251], a[12:15], a[24:27], v[248:251]
    buffer_load_dwordx4 v2, s[8:11], s16 offen offset:3072 lds
    s_waitcnt lgkmcnt(12)
    v_mfma_f32_16x16x32_bf16 v[204:207], a[0:3], a[28:31], v[204:207]
    v_mfma_f32_16x16x32_bf16 v[220:223], a[4:7], a[28:31], v[220:223]
    v_mfma_f32_16x16x32_bf16 v[236:239], a[8:11], a[28:31], v[236:239]
    v_mfma_f32_16x16x32_bf16 v[252:255], a[12:15], a[28:31], v[252:255]
    s_waitcnt lgkmcnt(9)
    v_mfma_f32_16x16x32_bf16 v[192:195], a[32:35], a[48:51], v[192:195]
    s_waitcnt lgkmcnt(8)
    v_mfma_f32_16x16x32_bf16 v[208:211], a[36:39], a[48:51], v[208:211]
    s_waitcnt lgkmcnt(7)
    v_mfma_f32_16x16x32_bf16 v[224:227], a[40:43], a[48:51], v[224:227]
    s_waitcnt lgkmcnt(0)
    s_waitcnt vmcnt(8)
    s_barrier
    v_mfma_f32_16x16x32_bf16 v[240:243], a[44:47], a[48:51], v[240:243]
    ds_read_b128 a[0:3], v32 offset:0
    ds_read_b64_tr_b16 a[16:17], v36 offset:0
    v_mfma_f32_16x16x32_bf16 v[196:199], a[32:35], a[52:55], v[196:199]
    ds_read_b64_tr_b16 a[18:19], v37 offset:0
    ds_read_b128 a[4:7], v32 offset:2048
    v_mfma_f32_16x16x32_bf16 v[212:215], a[36:39], a[52:55], v[212:215]
    ds_read_b128 a[8:11], v32 offset:4096
    ds_read_b128 a[12:15], v32 offset:6144
    v_mfma_f32_16x16x32_bf16 v[228:231], a[40:43], a[52:55], v[228:231]
    ds_read_b64_tr_b16 a[20:21], v36 offset:2048
    v_mfma_f32_16x16x32_bf16 v[244:247], a[44:47], a[52:55], v[244:247]
    ds_read_b64_tr_b16 a[22:23], v37 offset:2048
    ds_read_b64_tr_b16 a[24:25], v36 offset:256
    v_mfma_f32_16x16x32_bf16 v[200:203], a[32:35], a[56:59], v[200:203]
    ds_read_b64_tr_b16 a[26:27], v37 offset:256
    ds_read_b64_tr_b16 a[28:29], v36 offset:2304
    v_mfma_f32_16x16x32_bf16 v[216:219], a[36:39], a[56:59], v[216:219]
    ds_read_b64_tr_b16 a[30:31], v37 offset:2304
    v_mfma_f32_16x16x32_bf16 v[232:235], a[40:43], a[56:59], v[232:235]
    v_mfma_f32_16x16x32_bf16 v[248:251], a[44:47], a[56:59], v[248:251]
    v_mfma_f32_16x16x32_bf16 v[204:207], a[32:35], a[60:63], v[204:207]
    v_mfma_f32_16x16x32_bf16 v[220:223], a[36:39], a[60:63], v[220:223]
    v_mfma_f32_16x16x32_bf16 v[236:239], a[40:43], a[60:63], v[236:239]
    v_mfma_f32_16x16x32_bf16 v[252:255], a[44:47], a[60:63], v[252:255]
    s_waitcnt lgkmcnt(9)
    v_mfma_f32_16x16x32_bf16 v[192:195], a[0:3], a[16:19], v[192:195]
    ds_read_b128 a[32:35], v33 offset:0
    ds_read_b64_tr_b16 a[48:49], v36 offset:8192
    s_waitcnt lgkmcnt(10)
    v_mfma_f32_16x16x32_bf16 v[208:211], a[4:7], a[16:19], v[208:211]
    ds_read_b64_tr_b16 a[50:51], v37 offset:8192
    s_waitcnt lgkmcnt(10)
    v_mfma_f32_16x16x32_bf16 v[224:227], a[8:11], a[16:19], v[224:227]
    ds_read_b128 a[36:39], v33 offset:2048
    s_waitcnt lgkmcnt(10)
    v_mfma_f32_16x16x32_bf16 v[240:243], a[12:15], a[16:19], v[240:243]
    ds_read_b128 a[40:43], v33 offset:4096
    ds_read_b128 a[44:47], v33 offset:6144
    s_waitcnt lgkmcnt(10)
    v_mfma_f32_16x16x32_bf16 v[196:199], a[0:3], a[20:23], v[196:199]
    ds_read_b64_tr_b16 a[52:53], v36 offset:10240
    v_mfma_f32_16x16x32_bf16 v[212:215], a[4:7], a[20:23], v[212:215]
    ds_read_b64_tr_b16 a[54:55], v37 offset:10240
    v_mfma_f32_16x16x32_bf16 v[228:231], a[8:11], a[20:23], v[228:231]
    ds_read_b64_tr_b16 a[56:57], v36 offset:8448
    ds_read_b64_tr_b16 a[58:59], v37 offset:8448
    v_mfma_f32_16x16x32_bf16 v[244:247], a[12:15], a[20:23], v[244:247]
    ds_read_b64_tr_b16 a[60:61], v36 offset:10496
    s_waitcnt lgkmcnt(13)
    v_mfma_f32_16x16x32_bf16 v[200:203], a[0:3], a[24:27], v[200:203]
    ds_read_b64_tr_b16 a[62:63], v37 offset:10496
    v_mfma_f32_16x16x32_bf16 v[216:219], a[4:7], a[24:27], v[216:219]
    v_mfma_f32_16x16x32_bf16 v[232:235], a[8:11], a[24:27], v[232:235]
    v_mfma_f32_16x16x32_bf16 v[248:251], a[12:15], a[24:27], v[248:251]
    s_waitcnt lgkmcnt(12)
    v_mfma_f32_16x16x32_bf16 v[204:207], a[0:3], a[28:31], v[204:207]
    v_mfma_f32_16x16x32_bf16 v[220:223], a[4:7], a[28:31], v[220:223]
    v_mfma_f32_16x16x32_bf16 v[236:239], a[8:11], a[28:31], v[236:239]
    v_mfma_f32_16x16x32_bf16 v[252:255], a[12:15], a[28:31], v[252:255]
    s_waitcnt lgkmcnt(9)
    v_mfma_f32_16x16x32_bf16 v[192:195], a[32:35], a[48:51], v[192:195]
    s_waitcnt lgkmcnt(8)
    v_mfma_f32_16x16x32_bf16 v[208:211], a[36:39], a[48:51], v[208:211]
    s_waitcnt lgkmcnt(7)
    v_mfma_f32_16x16x32_bf16 v[224:227], a[40:43], a[48:51], v[224:227]
    s_waitcnt lgkmcnt(0)
    s_waitcnt vmcnt(0)
    s_barrier
    v_mfma_f32_16x16x32_bf16 v[240:243], a[44:47], a[48:51], v[240:243]
    ds_read_b128 a[0:3], v32 offset:32768
    ds_read_b64_tr_b16 a[16:17], v36 offset:32768
    v_mfma_f32_16x16x32_bf16 v[196:199], a[32:35], a[52:55], v[196:199]
    ds_read_b64_tr_b16 a[18:19], v37 offset:32768
    ds_read_b128 a[4:7], v32 offset:34816
    v_mfma_f32_16x16x32_bf16 v[212:215], a[36:39], a[52:55], v[212:215]
    ds_read_b128 a[8:11], v32 offset:36864
    ds_read_b128 a[12:15], v32 offset:38912
    v_mfma_f32_16x16x32_bf16 v[228:231], a[40:43], a[52:55], v[228:231]
    ds_read_b64_tr_b16 a[20:21], v36 offset:34816
    v_mfma_f32_16x16x32_bf16 v[244:247], a[44:47], a[52:55], v[244:247]
    ds_read_b64_tr_b16 a[22:23], v37 offset:34816
    ds_read_b64_tr_b16 a[24:25], v36 offset:33024
    v_mfma_f32_16x16x32_bf16 v[200:203], a[32:35], a[56:59], v[200:203]
    ds_read_b64_tr_b16 a[26:27], v37 offset:33024
    ds_read_b64_tr_b16 a[28:29], v36 offset:35072
    v_mfma_f32_16x16x32_bf16 v[216:219], a[36:39], a[56:59], v[216:219]
    ds_read_b64_tr_b16 a[30:31], v37 offset:35072
    v_mfma_f32_16x16x32_bf16 v[232:235], a[40:43], a[56:59], v[232:235]
    v_mfma_f32_16x16x32_bf16 v[248:251], a[44:47], a[56:59], v[248:251]
    v_mfma_f32_16x16x32_bf16 v[204:207], a[32:35], a[60:63], v[204:207]
    v_mfma_f32_16x16x32_bf16 v[220:223], a[36:39], a[60:63], v[220:223]
    v_mfma_f32_16x16x32_bf16 v[236:239], a[40:43], a[60:63], v[236:239]
    v_mfma_f32_16x16x32_bf16 v[252:255], a[44:47], a[60:63], v[252:255]
    s_waitcnt lgkmcnt(9)
    v_mfma_f32_16x16x32_bf16 v[192:195], a[0:3], a[16:19], v[192:195]
    ds_read_b128 a[32:35], v33 offset:32768
    ds_read_b64_tr_b16 a[48:49], v36 offset:40960
    s_waitcnt lgkmcnt(10)
    v_mfma_f32_16x16x32_bf16 v[208:211], a[4:7], a[16:19], v[208:211]
    ds_read_b64_tr_b16 a[50:51], v37 offset:40960
    s_waitcnt lgkmcnt(10)
    v_mfma_f32_16x16x32_bf16 v[224:227], a[8:11], a[16:19], v[224:227]
    ds_read_b128 a[36:39], v33 offset:34816
    s_waitcnt lgkmcnt(10)
    v_mfma_f32_16x16x32_bf16 v[240:243], a[12:15], a[16:19], v[240:243]
    ds_read_b128 a[40:43], v33 offset:36864
    ds_read_b128 a[44:47], v33 offset:38912
    s_waitcnt lgkmcnt(10)
    v_mfma_f32_16x16x32_bf16 v[196:199], a[0:3], a[20:23], v[196:199]
    ds_read_b64_tr_b16 a[52:53], v36 offset:43008
    v_mfma_f32_16x16x32_bf16 v[212:215], a[4:7], a[20:23], v[212:215]
    ds_read_b64_tr_b16 a[54:55], v37 offset:43008
    v_mfma_f32_16x16x32_bf16 v[228:231], a[8:11], a[20:23], v[228:231]
    ds_read_b64_tr_b16 a[56:57], v36 offset:41216
    ds_read_b64_tr_b16 a[58:59], v37 offset:41216
    v_mfma_f32_16x16x32_bf16 v[244:247], a[12:15], a[20:23], v[244:247]
    ds_read_b64_tr_b16 a[60:61], v36 offset:43264
    s_waitcnt lgkmcnt(13)
    v_mfma_f32_16x16x32_bf16 v[200:203], a[0:3], a[24:27], v[200:203]
    ds_read_b64_tr_b16 a[62:63], v37 offset:43264
    v_mfma_f32_16x16x32_bf16 v[216:219], a[4:7], a[24:27], v[216:219]
    v_mfma_f32_16x16x32_bf16 v[232:235], a[8:11], a[24:27], v[232:235]
    v_mfma_f32_16x16x32_bf16 v[248:251], a[12:15], a[24:27], v[248:251]
    s_waitcnt lgkmcnt(12)
    v_mfma_f32_16x16x32_bf16 v[204:207], a[0:3], a[28:31], v[204:207]
    v_mfma_f32_16x16x32_bf16 v[220:223], a[4:7], a[28:31], v[220:223]
    v_mfma_f32_16x16x32_bf16 v[236:239], a[8:11], a[28:31], v[236:239]
    v_mfma_f32_16x16x32_bf16 v[252:255], a[12:15], a[28:31], v[252:255]
    s_waitcnt lgkmcnt(9)
    v_mfma_f32_16x16x32_bf16 v[192:195], a[32:35], a[48:51], v[192:195]
    s_waitcnt lgkmcnt(8)
    v_mfma_f32_16x16x32_bf16 v[208:211], a[36:39], a[48:51], v[208:211]
    s_waitcnt lgkmcnt(7)
    v_mfma_f32_16x16x32_bf16 v[224:227], a[40:43], a[48:51], v[224:227]
    s_waitcnt lgkmcnt(6)
    v_mfma_f32_16x16x32_bf16 v[240:243], a[44:47], a[48:51], v[240:243]
    s_waitcnt lgkmcnt(4)
    v_mfma_f32_16x16x32_bf16 v[196:199], a[32:35], a[52:55], v[196:199]
    v_mfma_f32_16x16x32_bf16 v[212:215], a[36:39], a[52:55], v[212:215]
    v_mfma_f32_16x16x32_bf16 v[228:231], a[40:43], a[52:55], v[228:231]
    v_mfma_f32_16x16x32_bf16 v[244:247], a[44:47], a[52:55], v[244:247]
    s_waitcnt lgkmcnt(2)
    v_mfma_f32_16x16x32_bf16 v[200:203], a[32:35], a[56:59], v[200:203]
    v_mfma_f32_16x16x32_bf16 v[216:219], a[36:39], a[56:59], v[216:219]
    v_mfma_f32_16x16x32_bf16 v[232:235], a[40:43], a[56:59], v[232:235]
    v_mfma_f32_16x16x32_bf16 v[248:251], a[44:47], a[56:59], v[248:251]
    s_waitcnt lgkmcnt(0)
    v_mfma_f32_16x16x32_bf16 v[204:207], a[32:35], a[60:63], v[204:207]
    v_mfma_f32_16x16x32_bf16 v[220:223], a[36:39], a[60:63], v[220:223]
    v_mfma_f32_16x16x32_bf16 v[236:239], a[40:43], a[60:63], v[236:239]
    v_mfma_f32_16x16x32_bf16 v[252:255], a[44:47], a[60:63], v[252:255]
LtailP:
    s_nop 7
    v_add_f32 v24, v24, v24
    v_add_f32 v25, v25, v25
    v_add_f32 v26, v26, v26
    v_add_f32 v27, v27, v27
    v_fma_f32 v192, v192, v24, v128
    v_fma_f32 v193, v193, v24, v129
    v_fma_f32 v194, v194, v24, v130
    v_fma_f32 v195, v195, v24, v131
    buffer_store_dwordx4 v[192:195], v2, s[64:67], s40 offen offset:0 sc1
    v_fma_f32 v196, v196, v25, v132
    v_fma_f32 v197, v197, v25, v133
    v_fma_f32 v198, v198, v25, v134
    v_fma_f32 v199, v199, v25, v135
    buffer_store_dwordx4 v[196:199], v2, s[64:67], s40 offen offset:1024 sc1
    v_fma_f32 v200, v200, v26, v136
    v_fma_f32 v201, v201, v26, v137
    v_fma_f32 v202, v202, v26, v138
    v_fma_f32 v203, v203, v26, v139
    buffer_store_dwordx4 v[200:203], v2, s[64:67], s40 offen offset:2048 sc1
    v_fma_f32 v204, v204, v27, v140
    v_fma_f32 v205, v205, v27, v141
    v_fma_f32 v206, v206, v27, v142
    v_fma_f32 v207, v207, v27, v143
    buffer_store_dwordx4 v[204:207], v2, s[64:67], s40 offen offset:3072 sc1
    v_fma_f32 v208, v208, v24, v144
    v_fma_f32 v209, v209, v24, v145
    v_fma_f32 v210, v210, v24, v146
    v_fma_f32 v211, v211, v24, v147
    buffer_store_dwordx4 v[208:211], v2, s[64:67], s41 offen offset:0 sc1
    v_fma_f32 v212, v212, v25, v148
    v_fma_f32 v213, v213, v25, v149
    v_fma_f32 v214, v214, v25, v150
    v_fma_f32 v215, v215, v25, v151
    buffer_store_dwordx4 v[212:215], v2, s[64:67], s41 offen offset:1024 sc1
    v_fma_f32 v216, v216, v26, v152
    v_fma_f32 v217, v217, v26, v153
    v_fma_f32 v218, v218, v26, v154
    v_fma_f32 v219, v219, v26, v155
    buffer_store_dwordx4 v[216:219], v2, s[64:67], s41 offen offset:2048 sc1
    v_fma_f32 v220, v220, v27, v156
    v_fma_f32 v221, v221, v27, v157
    v_fma_f32 v222, v222, v27, v158
    v_fma_f32 v223, v223, v27, v159
    buffer_store_dwordx4 v[220:223], v2, s[64:67], s41 offen offset:3072 sc1
    v_fma_f32 v224, v224, v24, v160
    v_fma_f32 v225, v225, v24, v161
    v_fma_f32 v226, v226, v24, v162
    v_fma_f32 v227, v227, v24, v163
    buffer_store_dwordx4 v[224:227], v2, s[64:67], s42 offen offset:0 sc1
    v_fma_f32 v228, v228, v25, v164
    v_fma_f32 v229, v229, v25, v165
    v_fma_f32 v230, v230, v25, v166
    v_fma_f32 v231, v231, v25, v167
    buffer_store_dwordx4 v[228:231], v2, s[64:67], s42 offen offset:1024 sc1
    v_fma_f32 v232, v232, v26, v168
    v_fma_f32 v233, v233, v26, v169
    v_fma_f32 v234, v234, v26, v170
    v_fma_f32 v235, v235, v26, v171
    buffer_store_dwordx4 v[232:235], v2, s[64:67], s42 offen offset:2048 sc1
    v_fma_f32 v236, v236, v27, v172
    v_fma_f32 v237, v237, v27, v173
    v_fma_f32 v238, v238, v27, v174
    v_fma_f32 v239, v239, v27, v175
    buffer_store_dwordx4 v[236:239], v2, s[64:67], s42 offen offset:3072 sc1
    v_fma_f32 v240, v240, v24, v176
    v_fma_f32 v241, v241, v24, v177
    v_fma_f32 v242, v242, v24, v178
    v_fma_f32 v243, v243, v24, v179
    buffer_store_dwordx4 v[240:243], v2, s[64:67], s43 offen offset:0 sc1
    v_fma_f32 v244, v244, v25, v180
    v_fma_f32 v245, v245, v25, v181
    v_fma_f32 v246, v246, v25, v182
    v_fma_f32 v247, v247, v25, v183
    buffer_store_dwordx4 v[244:247], v2, s[64:67], s43 offen offset:1024 sc1
    v_fma_f32 v248, v248, v26, v184
    v_fma_f32 v249, v249, v26, v185
    v_fma_f32 v250, v250, v26, v186
    v_fma_f32 v251, v251, v26, v187
    buffer_store_dwordx4 v[248:251], v2, s[64:67], s43 offen offset:2048 sc1
    v_fma_f32 v252, v252, v27, v188
    v_fma_f32 v253, v253, v27, v189
    v_fma_f32 v254, v254, v27, v190
    v_fma_f32 v255, v255, v27, v191
    buffer_store_dwordx4 v[252:255], v2, s[64:67], s43 offen offset:3072 sc1
    s_waitcnt vmcnt(0)
    v_mov_b32 v48, s91
    v_mov_b32 v49, 0
    v_cmp_eq_u32 vcc, 0, v0
    s_and_saveexec_b64 s[60:61], vcc
    buffer_store_dword v48, v49, s[64:67], s97 offen sc1
    s_mov_b64 exec, s[60:61]
    s_endpgm
L_B:
    v_lshrrev_b32 v4, 3, v0
    v_lshlrev_b32 v4, 11, v4
    v_and_b32 v5, 7, v0
    v_lshrrev_b32 v6, 4, v0
    v_xor_b32 v5, v5, v6
    v_lshlrev_b32 v5, 4, v5
    v_add_u32 v2, v4, v5
    v_xor_b32 v3, 64, v2
    s_lshl_b32 s36, s32, 8
    s_lshl_b32 s37, s35, 6
    s_add_u32 s36, s36, s37
    s_lshl_b32 s36, s36, 11
    s_add_u32 s16, s36, 0
    s_add_u32 s17, s36, 15360
    s_add_u32 s18, s36, 30720
    s_add_u32 s19, s36, 46080
    s_add_u32 s20, s36, 65536
    s_add_u32 s21, s36, 80896
    s_add_u32 s22, s36, 96256
    s_add_u32 s23, s36, 111616
    v_lshrrev_b32 v4, 3, v0
    v_mul_u32_u24 v4, 6144, v4
    v_and_b32 v5, 7, v0
    v_bfe_u32 v6, v0, 4, 1
    v_lshlrev_b32 v6, 1, v6
    v_xor_b32 v5, v5, v6
    v_lshlrev_b32 v5, 4, v5
    v_add_u32 v4, v4, v5
    v_xor_b32 v5, 64, v4
    s_lshl_b32 s38, s33, 7
    s_mul_i32 s39, s35, 6
    s_add_u32 s58, s39, 0
    s_lshr_b32 s59, s58, 3
    s_and_b32 s58, s58, 7
    s_mul_i32 s58, s58, 49152
    s_lshl_b32 s59, s59, 11
    s_add_u32 s58, s58, s59
    s_add_u32 s58, s58, s38
    s_sub_u32 s24, s58, 0
    s_add_u32 s58, s39, 1
    s_lshr_b32 s59, s58, 3
    s_and_b32 s58, s58, 7
    s_mul_i32 s58, s58, 49152
    s_lshl_b32 s59, s59, 11
    s_add_u32 s58, s58, s59
    s_add_u32 s58, s58, s38
    s_sub_u32 s25, s58, 1024
    s_add_u32 s58, s39, 2
    s_lshr_b32 s59, s58, 3
    s_and_b32 s58, s58, 7
    s_mul_i32 s58, s58, 49152
    s_lshl_b32 s59, s59, 11
    s_add_u32 s58, s58, s59
    s_add_u32 s58, s58, s38
    s_sub_u32 s26, s58, 2048
    s_add_u32 s58, s39, 3
    s_lshr_b32 s59, s58, 3
    s_and_b32 s58, s58, 7
    s_mul_i32 s58, s58, 49152
    s_lshl_b32 s59, s59, 11
    s_add_u32 s58, s58, s59
    s_add_u32 s58, s58, s38
    s_sub_u32 s27, s58, 3072
    s_add_u32 s58, s39, 4
    s_lshr_b32 s59, s58, 3
    s_and_b32 s58, s58, 7
    s_mul_i32 s58, s58, 49152
    s_lshl_b32 s59, s59, 11
    s_add_u32 s58, s58, s59
    s_add_u32 s58, s58, s38
    s_sub_u32 s28, s58, 0
    s_add_u32 s58, s39, 5
    s_lshr_b32 s59, s58, 3
    s_and_b32 s58, s58, 7
    s_mul_i32 s58, s58, 49152
    s_lshl_b32 s59, s59, 11
    s_add_u32 s58, s58, s59
    s_add_u32 s58, s58, s38
    s_sub_u32 s29, s58, 1024
    s_lshl_b32 s48, s35, 13
    s_mul_i32 s49, s35, 6144
    s_add_u32 s49, s49, 98304
    s_waitcnt lgkmcnt(0)
    s_and_b32 s9, s9, 0xffff
    s_mov_b32 s60, s68
    s_mov_b32 s61, s69
    s_mov_b32 s62, s70
    s_mov_b32 s63, s71
    s_mov_b32 s64, s78
    s_and_b32 s65, s79, 0xffff
    s_mov_b32 s36, 12779520
    s_load_dword s91, s[78:79], s36
    s_mov_b32 s12, s72
    s_and_b32 s13, s73, 0xffff
    s_mov_b32 s14, 6291456
    s_mov_b32 s15, 0x20000
    s_mov_b32 s80, s8
    s_mov_b32 s81, s9
    s_and_b32 s76, s33, 1
    s_mul_i32 s76, s76, 1
    s_mov_b32 s99, s76
    s_lshl_b32 s76, s76, 7
    s_add_u32 s8, s80, s76
    s_addc_u32 s9, s81, 0
    s_mov_b32 s68, s12
    s_mov_b32 s69, s13
    s_mul_i32 s77, s99, 393216
    s_add_u32 s12, s68, s77
    s_addc_u32 s13, s69, 0
    s_add_u32 m0, s49, 0
    s_nop 0
    buffer_load_dwordx4 v4, s[12:15], s24 offen offset:0 lds
    buffer_load_dwordx4 v5, s[12:15], s25 offen offset:1024 lds
    buffer_load_dwordx4 v4, s[12:15], s26 offen offset:2048 lds
    buffer_load_dwordx4 v5, s[12:15], s27 offen offset:3072 lds
    s_add_u32 m0, s49, 4096
    s_nop 0
    buffer_load_dwordx4 v4, s[12:15], s28 offen offset:0 lds
    buffer_load_dwordx4 v5, s[12:15], s29 offen offset:1024 lds
    s_add_u32 m0, s48, 0
    s_nop 0
    buffer_load_dwordx4 v2, s[8:11], s16 offen offset:0 lds
    buffer_load_dwordx4 v3, s[8:11], s17 offen offset:1024 lds
    buffer_load_dwordx4 v2, s[8:11], s18 offen offset:2048 lds
    buffer_load_dwordx4 v3, s[8:11], s19 offen offset:3072 lds
    s_add_u32 m0, s48, 4096
    s_nop 0
    buffer_load_dwordx4 v2, s[8:11], s20 offen offset:0 lds
    buffer_load_dwordx4 v3, s[8:11], s21 offen offset:1024 lds
    buffer_load_dwordx4 v2, s[8:11], s22 offen offset:2048 lds
    buffer_load_dwordx4 v3, s[8:11], s23 offen offset:3072 lds
    s_add_u32 s77, s77, 393216
    s_cmp_eq_u32 s77, 6291456
    s_cselect_b32 s77, 0, s77
    s_add_u32 s12, s68, s77
    s_addc_u32 s13, s69, 0
    s_add_u32 s76, s76, 128
    s_and_b32 s76, s76, 2047
    s_add_u32 s8, s80, s76
    s_addc_u32 s9, s81, 0
    s_add_u32 m0, s49, 24576
    s_nop 0
    buffer_load_dwordx4 v4, s[12:15], s24 offen offset:0 lds
    buffer_load_dwordx4 v5, s[12:15], s25 offen offset:1024 lds
    buffer_load_dwordx4 v4, s[12:15], s26 offen offset:2048 lds
    buffer_load_dwordx4 v5, s[12:15], s27 offen offset:3072 lds
    s_add_u32 m0, s49, 28672
    s_nop 0
    buffer_load_dwordx4 v4, s[12:15], s28 offen offset:0 lds
    buffer_load_dwordx4 v5, s[12:15], s29 offen offset:1024 lds
    s_add_u32 m0, s48, 32768
    s_nop 0
    buffer_load_dwordx4 v2, s[8:11], s16 offen offset:0 lds
    buffer_load_dwordx4 v3, s[8:11], s17 offen offset:1024 lds
    buffer_load_dwordx4 v2, s[8:11], s18 offen offset:2048 lds
    buffer_load_dwordx4 v3, s[8:11], s19 offen offset:3072 lds
    s_add_u32 m0, s48, 36864
    s_nop 0
    buffer_load_dwordx4 v2, s[8:11], s20 offen offset:0 lds
    buffer_load_dwordx4 v3, s[8:11], s21 offen offset:1024 lds
    buffer_load_dwordx4 v2, s[8:11], s22 offen offset:2048 lds
    buffer_load_dwordx4 v3, s[8:11], s23 offen offset:3072 lds
    s_add_u32 s77, s77, 393216
    s_cmp_eq_u32 s77, 6291456
    s_cselect_b32 s77, 0, s77
    s_add_u32 s12, s68, s77
    s_addc_u32 s13, s69, 0
    s_add_u32 s76, s76, 128
    s_and_b32 s76, s76, 2047
    s_add_u32 s8, s80, s76
    s_addc_u32 s9, s81, 0
    s_add_u32 m0, s48, 65536
    s_nop 0
    buffer_load_dwordx4 v2, s[8:11], s16 offen offset:0 lds
    buffer_load_dwordx4 v3, s[8:11], s17 offen offset:1024 lds
    buffer_load_dwordx4 v2, s[8:11], s18 offen offset:2048 lds
    buffer_load_dwordx4 v3, s[8:11], s19 offen offset:3072 lds
    s_add_u32 m0, s48, 69632
    s_nop 0
    buffer_load_dwordx4 v2, s[8:11], s20 offen offset:0 lds
    buffer_load_dwordx4 v3, s[8:11], s21 offen offset:1024 lds
    buffer_load_dwordx4 v2, s[8:11], s22 offen offset:2048 lds
    buffer_load_dwordx4 v3, s[8:11], s23 offen offset:3072 lds
    s_add_u32 s76, s76, 128
    s_and_b32 s76, s76, 2047
    s_add_u32 s8, s80, s76
    s_addc_u32 s9, s81, 0
    s_lshl_b32 s38, s2, 2
    s_add_u32 s38, s38, s35
    s_lshl_b32 s38, s38, 13
    s_mov_b32 s40, s72
    s_and_b32 s41, s73, 0xffff
    s_mov_b32 s42, 6291456
    s_mov_b32 s43, 0x20000
    v_lshlrev_b32 v22, 7, v0
    buffer_load_dword v21, v22, s[40:43], s38 offen
    v_and_b32 v14, 15, v0
    v_lshlrev_b32 v14, 7, v14
    v_lshrrev_b32 v15, 4, v0
    v_bfe_u32 v16, v0, 1, 3
    v_xor_b32 v15, v15, v16
    v_lshlrev_b32 v15, 4, v15
    v_add_u32 v14, v14, v15
    s_lshl_b32 s52, s50, 14
    v_add_u32 v8, s52, v14
    v_xor_b32 v9, 64, v8
    v_add_u32 v10, 0x10000, v8
    v_add_u32 v11, 0x10000, v9
    v_lshrrev_b32 v15, 4, v0
    v_lshlrev_b32 v16, 3, v15
    v_bfe_u32 v19, v0, 2, 2
    v_add_u32 v16, v16, v19
    v_lshlrev_b32 v16, 7, v16
    v_bfe_u32 v20, v0, 1, 1
    s_lshl_b32 s53, s51, 2
    v_add_u32 v20, s53, v20
    v_lshrrev_b32 v19, 1, v19
    v_lshlrev_b32 v19, 1, v19
    v_xor_b32 v20, v20, v19
    v_and_b32 v15, 1, v15
    v_lshlrev_b32 v15, 2, v15
    v_xor_b32 v20, v20, v15
    v_lshlrev_b32 v20, 4, v20
    v_add_u32 v16, v16, v20
    v_and_b32 v20, 1, v0
    v_lshlrev_b32 v20, 3, v20
    v_add_u32 v16, v16, v20
    v_add_u32 v12, 98304, v16
    v_xor_b32 v13, 32, v12
    v_add_u32 v17, 24576, v12
    v_add_u32 v18, 24576, v13
    s_waitcnt vmcnt(23)
    s_barrier
    ds_read_b128 a[0:3], v8 offset:0
    ds_read_b64_tr_b16 a[32:33], v12 offset:0
    ds_read_b64_tr_b16 a[34:35], v12 offset:512
    ds_read_b64_tr_b16 a[36:37], v13 offset:0
    ds_read_b64_tr_b16 a[38:39], v13 offset:512
    ds_read_b64_tr_b16 a[40:41], v12 offset:8192
    ds_read_b64_tr_b16 a[42:43], v12 offset:8704
    ds_read_b64_tr_b16 a[44:45], v13 offset:8192
    ds_read_b64_tr_b16 a[46:47], v13 offset:8704
    ds_read_b64_tr_b16 a[48:49], v12 offset:16384
    ds_read_b64_tr_b16 a[50:51], v12 offset:16896
    ds_read_b64_tr_b16 a[52:53], v13 offset:16384
    ds_read_b64_tr_b16 a[54:55], v13 offset:16896
    ds_read_b128 a[4:7], v8 offset:2048
    ds_read_b128 a[8:11], v8 offset:4096
    ds_read_b128 a[12:15], v8 offset:6144
    ds_read_b128 a[16:19], v8 offset:8192
    ds_read_b128 a[20:23], v8 offset:10240
    ds_read_b128 a[24:27], v8 offset:12288
    ds_read_b128 a[28:31], v8 offset:14336
    s_waitcnt lgkmcnt(0)
    v_mfma_f32_16x16x32_bf16 v[64:67], a[32:35], a[0:3], 0
    ds_read_b128 a[56:59], v9 offset:0
    v_mfma_f32_16x16x32_bf16 v[68:71], a[36:39], a[0:3], 0
    ds_read_b64_tr_b16 a[88:89], v12 offset:4096
    v_mfma_f32_16x16x32_bf16 v[72:75], a[0:3], a[40:43], 0
    ds_read_b64_tr_b16 a[90:91], v12 offset:4608
    v_mfma_f32_16x16x32_bf16 v[76:79], a[0:3], a[44:47], 0
    v_mfma_f32_16x16x32_bf16 v[80:83], a[0:3], a[48:51], 0
    ds_read_b64_tr_b16 a[92:93], v13 offset:4096
    v_mfma_f32_16x16x32_bf16 v[84:87], a[0:3], a[52:55], 0
    ds_read_b64_tr_b16 a[94:95], v13 offset:4608
    v_mfma_f32_16x16x32_bf16 v[88:91], a[32:35], a[4:7], 0
    v_mfma_f32_16x16x32_bf16 v[92:95], a[36:39], a[4:7], 0
    ds_read_b64_tr_b16 a[96:97], v12 offset:12288
    v_mfma_f32_16x16x32_bf16 v[96:99], a[4:7], a[40:43], 0
    ds_read_b64_tr_b16 a[98:99], v12 offset:12800
    v_mfma_f32_16x16x32_bf16 v[100:103], a[4:7], a[44:47], 0
    ds_read_b64_tr_b16 a[100:101], v13 offset:12288
    v_mfma_f32_16x16x32_bf16 v[104:107], a[4:7], a[48:51], 0
    v_mfma_f32_16x16x32_bf16 v[108:111], a[4:7], a[52:55], 0
    ds_read_b64_tr_b16 a[102:103], v13 offset:12800
    v_mfma_f32_16x16x32_bf16 v[112:115], a[32:35], a[8:11], 0
    ds_read_b64_tr_b16 a[104:105], v12 offset:20480
    v_mfma_f32_16x16x32_bf16 v[116:119], a[36:39], a[8:11], 0
    v_mfma_f32_16x16x32_bf16 v[120:123], a[8:11], a[40:43], 0
    ds_read_b64_tr_b16 a[106:107], v12 offset:20992
    v_mfma_f32_16x16x32_bf16 v[124:127], a[8:11], a[44:47], 0
    ds_read_b64_tr_b16 a[108:109], v13 offset:20480
    v_mfma_f32_16x16x32_bf16 v[128:131], a[8:11], a[48:51], 0
    ds_read_b64_tr_b16 a[110:111], v13 offset:20992
    v_mfma_f32_16x16x32_bf16 v[132:135], a[8:11], a[52:55], 0
    v_mfma_f32_16x16x32_bf16 v[136:139], a[32:35], a[12:15], 0
    ds_read_b128 a[60:63], v9 offset:2048
    v_mfma_f32_16x16x32_bf16 v[140:143], a[36:39], a[12:15], 0
    ds_read_b128 a[64:67], v9 offset:4096
    v_mfma_f32_16x16x32_bf16 v[144:147], a[12:15], a[40:43], 0
    v_mfma_f32_16x16x32_bf16 v[148:151], a[12:15], a[44:47], 0
    ds_read_b128 a[68:71], v9 offset:6144
    v_mfma_f32_16x16x32_bf16 v[152:155], a[12:15], a[48:51], 0
    ds_read_b128 a[72:75], v9 offset:8192
    v_mfma_f32_16x16x32_bf16 v[156:159], a[12:15], a[52:55], 0
    ds_read_b128 a[76:79], v9 offset:10240
    v_mfma_f32_16x16x32_bf16 v[160:163], a[32:35], a[16:19], 0
    v_mfma_f32_16x16x32_bf16 v[164:167], a[36:39], a[16:19], 0
    ds_read_b128 a[80:83], v9 offset:12288
    v_mfma_f32_16x16x32_bf16 v[168:171], a[16:19], a[40:43], 0
    ds_read_b128 a[84:87], v9 offset:14336
    v_mfma_f32_16x16x32_bf16 v[172:175], a[16:19], a[44:47], 0
    v_mfma_f32_16x16x32_bf16 v[176:179], a[16:19], a[48:51], 0
    v_mfma_f32_16x16x32_bf16 v[180:183], a[16:19], a[52:55], 0
    v_mfma_f32_16x16x32_bf16 v[184:187], a[32:35], a[20:23], 0
    v_mfma_f32_16x16x32_bf16 v[188:191], a[36:39], a[20:23], 0
    v_mfma_f32_16x16x32_bf16 v[192:195], a[20:23], a[40:43], 0
    v_mfma_f32_16x16x32_bf16 v[196:199], a[20:23], a[44:47], 0
    v_mfma_f32_16x16x32_bf16 v[200:203], a[20:23], a[48:51], 0
    v_mfma_f32_16x16x32_bf16 v[204:207], a[20:23], a[52:55], 0
    v_mfma_f32_16x16x32_bf16 v[208:211], a[32:35], a[24:27], 0
    v_mfma_f32_16x16x32_bf16 v[212:215], a[36:39], a[24:27], 0
    v_mfma_f32_16x16x32_bf16 v[216:219], a[24:27], a[40:43], 0
    v_mfma_f32_16x16x32_bf16 v[220:223], a[24:27], a[44:47], 0
    v_mfma_f32_16x16x32_bf16 v[224:227], a[24:27], a[48:51], 0
    v_mfma_f32_16x16x32_bf16 v[228:231], a[24:27], a[52:55], 0
    v_mfma_f32_16x16x32_bf16 v[232:235], a[32:35], a[28:31], 0
    v_mfma_f32_16x16x32_bf16 v[236:239], a[36:39], a[28:31], 0
    v_mfma_f32_16x16x32_bf16 v[240:243], a[28:31], a[40:43], 0
    v_mfma_f32_16x16x32_bf16 v[244:247], a[28:31], a[44:47], 0
    v_mfma_f32_16x16x32_bf16 v[248:251], a[28:31], a[48:51], 0
    v_mfma_f32_16x16x32_bf16 v[252:255], a[28:31], a[52:55], 0
    s_waitcnt lgkmcnt(15)
    v_mfma_f32_16x16x32_bf16 v[64:67], a[88:91], a[56:59], v[64:67]
    v_mfma_f32_16x16x32_bf16 v[68:71], a[92:95], a[56:59], v[68:71]
    s_waitcnt lgkmcnt(13)
    v_mfma_f32_16x16x32_bf16 v[72:75], a[56:59], a[96:99], v[72:75]
    s_waitcnt lgkmcnt(11)
    v_mfma_f32_16x16x32_bf16 v[76:79], a[56:59], a[100:103], v[76:79]
    s_waitcnt lgkmcnt(9)
    v_mfma_f32_16x16x32_bf16 v[80:83], a[56:59], a[104:107], v[80:83]
    s_waitcnt lgkmcnt(7)
    v_mfma_f32_16x16x32_bf16 v[84:87], a[56:59], a[108:111], v[84:87]
    s_waitcnt lgkmcnt(6)
    v_mfma_f32_16x16x32_bf16 v[88:91], a[88:91], a[60:63], v[88:91]
    v_mfma_f32_16x16x32_bf16 v[92:95], a[92:95], a[60:63], v[92:95]
    s_waitcnt lgkmcnt(0)
    s_waitcnt vmcnt(9)
    s_barrier
    v_mfma_f32_16x16x32_bf16 v[96:99], a[60:63], a[96:99], v[96:99]
    ds_read_b128 a[0:3], v8 offset:32768
    v_mfma_f32_16x16x32_bf16 v[100:103], a[60:63], a[100:103], v[100:103]
    ds_read_b64_tr_b16 a[32:33], v17 offset:0
    s_add_u32 m0, s49, 0
    v_mfma_f32_16x16x32_bf16 v[104:107], a[60:63], a[104:107], v[104:107]
    ds_read_b64_tr_b16 a[34:35], v17 offset:512
    v_mfma_f32_16x16x32_bf16 v[108:111], a[60:63], a[108:111], v[108:111]
    ds_read_b64_tr_b16 a[36:37], v18 offset:0
    buffer_load_dwordx4 v4, s[12:15], s24 offen offset:0 lds
    v_mfma_f32_16x16x32_bf16 v[112:115], a[88:91], a[64:67], v[112:115]
    ds_read_b64_tr_b16 a[38:39], v18 offset:512
    v_mfma_f32_16x16x32_bf16 v[116:119], a[92:95], a[64:67], v[116:119]
    buffer_load_dwordx4 v5, s[12:15], s25 offen offset:1024 lds
    v_mfma_f32_16x16x32_bf16 v[120:123], a[64:67], a[96:99], v[120:123]
    ds_read_b64_tr_b16 a[40:41], v17 offset:8192
    v_mfma_f32_16x16x32_bf16 v[124:127], a[64:67], a[100:103], v[124:127]
    ds_read_b64_tr_b16 a[42:43], v17 offset:8704
    buffer_load_dwordx4 v4, s[12:15], s26 offen offset:2048 lds
    v_mfma_f32_16x16x32_bf16 v[128:131], a[64:67], a[104:107], v[128:131]
    ds_read_b64_tr_b16 a[44:45], v18 offset:8192
    v_mfma_f32_16x16x32_bf16 v[132:135], a[64:67], a[108:111], v[132:135]
    ds_read_b64_tr_b16 a[46:47], v18 offset:8704
    buffer_load_dwordx4 v5, s[12:15], s27 offen offset:3072 lds
    v_mfma_f32_16x16x32_bf16 v[136:139], a[88:91], a[68:71], v[136:139]
    ds_read_b64_tr_b16 a[48:49], v17 offset:16384
    v_mfma_f32_16x16x32_bf16 v[140:143], a[92:95], a[68:71], v[140:143]
    v_mfma_f32_16x16x32_bf16 v[144:147], a[68:71], a[96:99], v[144:147]
    ds_read_b64_tr_b16 a[50:51], v17 offset:16896
    s_add_u32 m0, s49, 4096
    v_mfma_f32_16x16x32_bf16 v[148:151], a[68:71], a[100:103], v[148:151]
    ds_read_b64_tr_b16 a[52:53], v18 offset:16384
    v_mfma_f32_16x16x32_bf16 v[152:155], a[68:71], a[104:107], v[152:155]
    ds_read_b64_tr_b16 a[54:55], v18 offset:16896
    buffer_load_dwordx4 v4, s[12:15], s28 offen offset:0 lds
    v_mfma_f32_16x16x32_bf16 v[156:159], a[68:71], a[108:111], v[156:159]
    ds_read_b128 a[4:7], v8 offset:34816
    v_mfma_f32_16x16x32_bf16 v[160:163], a[88:91], a[72:75], v[160:163]
    ds_read_b128 a[8:11], v8 offset:36864
    buffer_load_dwordx4 v5, s[12:15], s29 offen offset:1024 lds
    v_mfma_f32_16x16x32_bf16 v[164:167], a[92:95], a[72:75], v[164:167]
    v_mfma_f32_16x16x32_bf16 v[168:171], a[72:75], a[96:99], v[168:171]
    ds_read_b128 a[12:15], v8 offset:38912
    s_add_u32 s77, s77, 393216
    v_mfma_f32_16x16x32_bf16 v[172:175], a[72:75], a[100:103], v[172:175]
    ds_read_b128 a[16:19], v8 offset:40960
    v_mfma_f32_16x16x32_bf16 v[176:179], a[72:75], a[104:107], v[176:179]
    ds_read_b128 a[20:23], v8 offset:43008
    v_mfma_f32_16x16x32_bf16 v[180:183], a[72:75], a[108:111], v[180:183]
    ds_read_b128 a[24:27], v8 offset:45056
    s_cmp_eq_u32 s77, 6291456
    v_mfma_f32_16x16x32_bf16 v[184:187], a[88:91], a[76:79], v[184:187]
    ds_read_b128 a[28:31], v8 offset:47104
    v_mfma_f32_16x16x32_bf16 v[188:191], a[92:95], a[76:79], v[188:191]
    s_cselect_b32 s77, 0, s77
    v_mfma_f32_16x16x32_bf16 v[192:195], a[76:79], a[96:99], v[192:195]
    v_mfma_f32_16x16x32_bf16 v[196:199], a[76:79], a[100:103], v[196:199]
    s_add_u32 s12, s68, s77
    v_mfma_f32_16x16x32_bf16 v[200:203], a[76:79], a[104:107], v[200:203]
    v_mfma_f32_16x16x32_bf16 v[204:207], a[76:79], a[108:111], v[204:207]
    s_addc_u32 s13, s69, 0
    v_mfma_f32_16x16x32_bf16 v[208:211], a[88:91], a[80:83], v[208:211]
    v_mfma_f32_16x16x32_bf16 v[212:215], a[92:95], a[80:83], v[212:215]
    v_mfma_f32_16x16x32_bf16 v[216:219], a[80:83], a[96:99], v[216:219]
    s_add_u32 m0, s48, 0
    v_mfma_f32_16x16x32_bf16 v[220:223], a[80:83], a[100:103], v[220:223]
    v_mfma_f32_16x16x32_bf16 v[224:227], a[80:83], a[104:107], v[224:227]
    buffer_load_dwordx4 v2, s[8:11], s16 offen offset:0 lds
    v_mfma_f32_16x16x32_bf16 v[228:231], a[80:83], a[108:111], v[228:231]
    v_mfma_f32_16x16x32_bf16 v[232:235], a[88:91], a[84:87], v[232:235]
    buffer_load_dwordx4 v3, s[8:11], s17 offen offset:1024 lds
    v_mfma_f32_16x16x32_bf16 v[236:239], a[92:95], a[84:87], v[236:239]
    v_mfma_f32_16x16x32_bf16 v[240:243], a[84:87], a[96:99], v[240:243]
    buffer_load_dwordx4 v2, s[8:11], s18 offen offset:2048 lds
    v_mfma_f32_16x16x32_bf16 v[244:247], a[84:87], a[100:103], v[244:247]
    v_mfma_f32_16x16x32_bf16 v[248:251], a[84:87], a[104:107], v[248:251]
    v_mfma_f32_16x16x32_bf16 v[252:255], a[84:87], a[108:111], v[252:255]
    s_waitcnt lgkmcnt(15)
    v_mfma_f32_16x16x32_bf16 v[64:67], a[32:35], a[0:3], v[64:67]
    ds_read_b128 a[56:59], v9 offset:32768
    v_mfma_f32_16x16x32_bf16 v[68:71], a[36:39], a[0:3], v[68:71]
    ds_read_b64_tr_b16 a[88:89], v17 offset:4096
    buffer_load_dwordx4 v3, s[8:11], s19 offen offset:3072 lds
    s_waitcnt lgkmcnt(15)
    v_mfma_f32_16x16x32_bf16 v[72:75], a[0:3], a[40:43], v[72:75]
    ds_read_b64_tr_b16 a[90:91], v17 offset:4608
    s_waitcnt lgkmcnt(14)
    v_mfma_f32_16x16x32_bf16 v[76:79], a[0:3], a[44:47], v[76:79]
    s_waitcnt lgkmcnt(12)
    v_mfma_f32_16x16x32_bf16 v[80:83], a[0:3], a[48:51], v[80:83]
    ds_read_b64_tr_b16 a[92:93], v18 offset:4096
    s_waitcnt lgkmcnt(11)
    v_mfma_f32_16x16x32_bf16 v[84:87], a[0:3], a[52:55], v[84:87]
    ds_read_b64_tr_b16 a[94:95], v18 offset:4608
    s_add_u32 m0, s48, 4096
    s_waitcnt lgkmcnt(11)
    v_mfma_f32_16x16x32_bf16 v[88:91], a[32:35], a[4:7], v[88:91]
    v_mfma_f32_16x16x32_bf16 v[92:95], a[36:39], a[4:7], v[92:95]
    ds_read_b64_tr_b16 a[96:97], v17 offset:12288
    v_mfma_f32_16x16x32_bf16 v[96:99], a[4:7], a[40:43], v[96:99]
    ds_read_b64_tr_b16 a[98:99], v17 offset:12800
    v_mfma_f32_16x16x32_bf16 v[100:103], a[4:7], a[44:47], v[100:103]
    ds_read_b64_tr_b16 a[100:101], v18 offset:12288
    v_mfma_f32_16x16x32_bf16 v[104:107], a[4:7], a[48:51], v[104:107]
    buffer_load_dwordx4 v2, s[8:11], s20 offen offset:0 lds
    v_mfma_f32_16x16x32_bf16 v[108:111], a[4:7], a[52:55], v[108:111]
    ds_read_b64_tr_b16 a[102:103], v18 offset:12800
    s_waitcnt lgkmcnt(14)
    v_mfma_f32_16x16x32_bf16 v[112:115], a[32:35], a[8:11], v[112:115]
    ds_read_b64_tr_b16 a[104:105], v17 offset:20480
    v_mfma_f32_16x16x32_bf16 v[116:119], a[36:39], a[8:11], v[116:119]
    v_mfma_f32_16x16x32_bf16 v[120:123], a[8:11], a[40:43], v[120:123]
    ds_read_b64_tr_b16 a[106:107], v17 offset:20992
    buffer_load_dwordx4 v3, s[8:11], s21 offen offset:1024 lds
    v_mfma_f32_16x16x32_bf16 v[124:127], a[8:11], a[44:47], v[124:127]
    ds_read_b64_tr_b16 a[108:109], v18 offset:20480
    v_mfma_f32_16x16x32_bf16 v[128:131], a[8:11], a[48:51], v[128:131]
    ds_read_b64_tr_b16 a[110:111], v18 offset:20992
    v_mfma_f32_16x16x32_bf16 v[132:135], a[8:11], a[52:55], v[132:135]
    s_waitcnt lgkmcnt(15)
    v_mfma_f32_16x16x32_bf16 v[136:139], a[32:35], a[12:15], v[136:139]
    ds_read_b128 a[60:63], v9 offset:34816
    v_mfma_f32_16x16x32_bf16 v[140:143], a[36:39], a[12:15], v[140:143]
    ds_read_b128 a[64:67], v9 offset:36864
    buffer_load_dwordx4 v2, s[8:11], s22 offen offset:2048 lds
    v_mfma_f32_16x16x32_bf16 v[144:147], a[12:15], a[40:43], v[144:147]
    v_mfma_f32_16x16x32_bf16 v[148:151], a[12:15], a[44:47], v[148:151]
    ds_read_b128 a[68:71], v9 offset:38912
    v_mfma_f32_16x16x32_bf16 v[152:155], a[12:15], a[48:51], v[152:155]
    ds_read_b128 a[72:75], v9 offset:40960
    v_mfma_f32_16x16x32_bf16 v[156:159], a[12:15], a[52:55], v[156:159]
    ds_read_b128 a[76:79], v9 offset:43008
    v_mfma_f32_16x16x32_bf16 v[160:163], a[32:35], a[16:19], v[160:163]
    buffer_load_dwordx4 v3, s[8:11], s23 offen offset:3072 lds
    v_mfma_f32_16x16x32_bf16 v[164:167], a[36:39], a[16:19], v[164:167]
    ds_read_b128 a[80:83], v9 offset:45056
    v_mfma_f32_16x16x32_bf16 v[168:171], a[16:19], a[40:43], v[168:171]
    ds_read_b128 a[84:87], v9 offset:47104
    v_mfma_f32_16x16x32_bf16 v[172:175], a[16:19], a[44:47], v[172:175]
    v_mfma_f32_16x16x32_bf16 v[176:179], a[16:19], a[48:51], v[176:179]
    s_add_u32 s76, s76, 128
    v_mfma_f32_16x16x32_bf16 v[180:183], a[16:19], a[52:55], v[180:183]
    v_mfma_f32_16x16x32_bf16 v[184:187], a[32:35], a[20:23], v[184:187]
    v_mfma_f32_16x16x32_bf16 v[188:191], a[36:39], a[20:23], v[188:191]
    v_mfma_f32_16x16x32_bf16 v[192:195], a[20:23], a[40:43], v[192:195]
    v_mfma_f32_16x16x32_bf16 v[196:199], a[20:23], a[44:47], v[196:199]
    s_and_b32 s76, s76, 2047
    v_mfma_f32_16x16x32_bf16 v[200:203], a[20:23], a[48:51], v[200:203]
    v_mfma_f32_16x16x32_bf16 v[204:207], a[20:23], a[52:55], v[204:207]
    s_waitcnt lgkmcnt(15)
    v_mfma_f32_16x16x32_bf16 v[208:211], a[32:35], a[24:27], v[208:211]
    v_mfma_f32_16x16x32_bf16 v[212:215], a[36:39], a[24:27], v[212:215]
    s_add_u32 s8, s80, s76
    v_mfma_f32_16x16x32_bf16 v[216:219], a[24:27], a[40:43], v[216:219]
    v_mfma_f32_16x16x32_bf16 v[220:223], a[24:27], a[44:47], v[220:223]
    v_mfma_f32_16x16x32_bf16 v[224:227], a[24:27], a[48:51], v[224:227]
    v_mfma_f32_16x16x32_bf16 v[228:231], a[24:27], a[52:55], v[228:231]
    v_mfma_f32_16x16x32_bf16 v[232:235], a[32:35], a[28:31], v[232:235]
    s_addc_u32 s9, s81, 0
    v_mfma_f32_16x16x32_bf16 v[236:239], a[36:39], a[28:31], v[236:239]
    v_mfma_f32_16x16x32_bf16 v[240:243], a[28:31], a[40:43], v[240:243]
    v_mfma_f32_16x16x32_bf16 v[244:247], a[28:31], a[44:47], v[244:247]
    v_mfma_f32_16x16x32_bf16 v[248:251], a[28:31], a[48:51], v[248:251]
    v_mfma_f32_16x16x32_bf16 v[252:255], a[28:31], a[52:55], v[252:255]
    v_mfma_f32_16x16x32_bf16 v[64:67], a[88:91], a[56:59], v[64:67]
    v_mfma_f32_16x16x32_bf16 v[68:71], a[92:95], a[56:59], v[68:71]
    s_waitcnt lgkmcnt(13)
    v_mfma_f32_16x16x32_bf16 v[72:75], a[56:59], a[96:99], v[72:75]
    s_waitcnt lgkmcnt(11)
    v_mfma_f32_16x16x32_bf16 v[76:79], a[56:59], a[100:103], v[76:79]
    s_waitcnt lgkmcnt(9)
    v_mfma_f32_16x16x32_bf16 v[80:83], a[56:59], a[104:107], v[80:83]
    s_waitcnt lgkmcnt(7)
    v_mfma_f32_16x16x32_bf16 v[84:87], a[56:59], a[108:111], v[84:87]
    s_waitcnt lgkmcnt(6)
    v_mfma_f32_16x16x32_bf16 v[88:91], a[88:91], a[60:63], v[88:91]
    v_mfma_f32_16x16x32_bf16 v[92:95], a[92:95], a[60:63], v[92:95]
    s_waitcnt lgkmcnt(0)
    s_waitcnt vmcnt(8)
    s_barrier
    v_mfma_f32_16x16x32_bf16 v[96:99], a[60:63], a[96:99], v[96:99]
    ds_read_b128 a[0:3], v10 offset:0
    v_mfma_f32_16x16x32_bf16 v[100:103], a[60:63], a[100:103], v[100:103]
    ds_read_b64_tr_b16 a[32:33], v12 offset:0
    s_add_u32 m0, s49, 24576
    v_mfma_f32_16x16x32_bf16 v[104:107], a[60:63], a[104:107], v[104:107]
    ds_read_b64_tr_b16 a[34:35], v12 offset:512
    v_mfma_f32_16x16x32_bf16 v[108:111], a[60:63], a[108:111], v[108:111]
    ds_read_b64_tr_b16 a[36:37], v13 offset:0
    buffer_load_dwordx4 v4, s[12:15], s24 offen offset:0 lds
    v_mfma_f32_16x16x32_bf16 v[112:115], a[88:91], a[64:67], v[112:115]
    ds_read_b64_tr_b16 a[38:39], v13 offset:512
    v_mfma_f32_16x16x32_bf16 v[116:119], a[92:95], a[64:67], v[116:119]
    buffer_load_dwordx4 v5, s[12:15], s25 offen offset:1024 lds
    v_mfma_f32_16x16x32_bf16 v[120:123], a[64:67], a[96:99], v[120:123]
    ds_read_b64_tr_b16 a[40:41], v12 offset:8192
    v_mfma_f32_16x16x32_bf16 v[124:127], a[64:67], a[100:103], v[124:127]
    ds_read_b64_tr_b16 a[42:43], v12 offset:8704
    buffer_load_dwordx4 v4, s[12:15], s26 offen offset:2048 lds
    v_mfma_f32_16x16x32_bf16 v[128:131], a[64:67], a[104:107], v[128:131]
    ds_read_b64_tr_b16 a[44:45], v13 offset:8192
    v_mfma_f32_16x16x32_bf16 v[132:135], a[64:67], a[108:111], v[132:135]
    ds_read_b64_tr_b16 a[46:47], v13 offset:8704
    buffer_load_dwordx4 v5, s[12:15], s27 offen offset:3072 lds
    v_mfma_f32_16x16x32_bf16 v[136:139], a[88:91], a[68:71], v[136:139]
    ds_read_b64_tr_b16 a[48:49], v12 offset:16384
    v_mfma_f32_16x16x32_bf16 v[140:143], a[92:95], a[68:71], v[140:143]
    v_mfma_f32_16x16x32_bf16 v[144:147], a[68:71], a[96:99], v[144:147]
    ds_read_b64_tr_b16 a[50:51], v12 offset:16896
    s_add_u32 m0, s49, 28672
    v_mfma_f32_16x16x32_bf16 v[148:151], a[68:71], a[100:103], v[148:151]
    ds_read_b64_tr_b16 a[52:53], v13 offset:16384
    v_mfma_f32_16x16x32_bf16 v[152:155], a[68:71], a[104:107], v[152:155]
    ds_read_b64_tr_b16 a[54:55], v13 offset:16896
    buffer_load_dwordx4 v4, s[12:15], s28 offen offset:0 lds
    v_mfma_f32_16x16x32_bf16 v[156:159], a[68:71], a[108:111], v[156:159]
    ds_read_b128 a[4:7], v10 offset:2048
    v_mfma_f32_16x16x32_bf16 v[160:163], a[88:91], a[72:75], v[160:163]
    ds_read_b128 a[8:11], v10 offset:4096
    buffer_load_dwordx4 v5, s[12:15], s29 offen offset:1024 lds
    v_mfma_f32_16x16x32_bf16 v[164:167], a[92:95], a[72:75], v[164:167]
    v_mfma_f32_16x16x32_bf16 v[168:171], a[72:75], a[96:99], v[168:171]
    ds_read_b128 a[12:15], v10 offset:6144
    s_add_u32 s77, s77, 393216
    v_mfma_f32_16x16x32_bf16 v[172:175], a[72:75], a[100:103], v[172:175]
    ds_read_b128 a[16:19], v10 offset:8192
    v_mfma_f32_16x16x32_bf16 v[176:179], a[72:75], a[104:107], v[176:179]
    ds_read_b128 a[20:23], v10 offset:10240
    v_mfma_f32_16x16x32_bf16 v[180:183], a[72:75], a[108:111], v[180:183]
    ds_read_b128 a[24:27], v10 offset:12288
    s_cmp_eq_u32 s77, 6291456
    v_mfma_f32_16x16x32_bf16 v[184:187], a[88:91], a[76:79], v[184:187]
    ds_read_b128 a[28:31], v10 offset:14336
    v_mfma_f32_16x16x32_bf16 v[188:191], a[92:95], a[76:79], v[188:191]
    s_cselect_b32 s77, 0, s77
    v_mfma_f32_16x16x32_bf16 v[192:195], a[76:79], a[96:99], v[192:195]
    v_mfma_f32_16x16x32_bf16 v[196:199], a[76:79], a[100:103], v[196:199]
    s_add_u32 s12, s68, s77
    v_mfma_f32_16x16x32_bf16 v[200:203], a[76:79], a[104:107], v[200:203]
    v_mfma_f32_16x16x32_bf16 v[204:207], a[76:79], a[108:111], v[204:207]
    s_addc_u32 s13, s69, 0
    v_mfma_f32_16x16x32_bf16 v[208:211], a[88:91], a[80:83], v[208:211]
    v_mfma_f32_16x16x32_bf16 v[212:215], a[92:95], a[80:83], v[212:215]
    v_mfma_f32_16x16x32_bf16 v[216:219], a[80:83], a[96:99], v[216:219]
    s_add_u32 m0, s48, 32768
    v_mfma_f32_16x16x32_bf16 v[220:223], a[80:83], a[100:103], v[220:223]
    v_mfma_f32_16x16x32_bf16 v[224:227], a[80:83], a[104:107], v[224:227]
    buffer_load_dwordx4 v2, s[8:11], s16 offen offset:0 lds
    v_mfma_f32_16x16x32_bf16 v[228:231], a[80:83], a[108:111], v[228:231]
    v_mfma_f32_16x16x32_bf16 v[232:235], a[88:91], a[84:87], v[232:235]
    buffer_load_dwordx4 v3, s[8:11], s17 offen offset:1024 lds
    v_mfma_f32_16x16x32_bf16 v[236:239], a[92:95], a[84:87], v[236:239]
    v_mfma_f32_16x16x32_bf16 v[240:243], a[84:87], a[96:99], v[240:243]
    buffer_load_dwordx4 v2, s[8:11], s18 offen offset:2048 lds
    v_mfma_f32_16x16x32_bf16 v[244:247], a[84:87], a[100:103], v[244:247]
    v_mfma_f32_16x16x32_bf16 v[248:251], a[84:87], a[104:107], v[248:251]
    v_mfma_f32_16x16x32_bf16 v[252:255], a[84:87], a[108:111], v[252:255]
    s_waitcnt lgkmcnt(15)
    v_mfma_f32_16x16x32_bf16 v[64:67], a[32:35], a[0:3], v[64:67]
    ds_read_b128 a[56:59], v11 offset:0
    v_mfma_f32_16x16x32_bf16 v[68:71], a[36:39], a[0:3], v[68:71]
    ds_read_b64_tr_b16 a[88:89], v12 offset:4096
    buffer_load_dwordx4 v3, s[8:11], s19 offen offset:3072 lds
    s_waitcnt lgkmcnt(15)
    v_mfma_f32_16x16x32_bf16 v[72:75], a[0:3], a[40:43], v[72:75]
    ds_read_b64_tr_b16 a[90:91], v12 offset:4608
    s_waitcnt lgkmcnt(14)
    v_mfma_f32_16x16x32_bf16 v[76:79], a[0:3], a[44:47], v[76:79]
    s_waitcnt lgkmcnt(12)
    v_mfma_f32_16x16x32_bf16 v[80:83], a[0:3], a[48:51], v[80:83]
    ds_read_b64_tr_b16 a[92:93], v13 offset:4096
    s_waitcnt lgkmcnt(11)
    v_mfma_f32_16x16x32_bf16 v[84:87], a[0:3], a[52:55], v[84:87]
    ds_read_b64_tr_b16 a[94:95], v13 offset:4608
    s_add_u32 m0, s48, 36864
    s_waitcnt lgkmcnt(11)
    v_mfma_f32_16x16x32_bf16 v[88:91], a[32:35], a[4:7], v[88:91]
    v_mfma_f32_16x16x32_bf16 v[92:95], a[36:39], a[4:7], v[92:95]
    ds_read_b64_tr_b16 a[96:97], v12 offset:12288
    v_mfma_f32_16x16x32_bf16 v[96:99], a[4:7], a[40:43], v[96:99]
    ds_read_b64_tr_b16 a[98:99], v12 offset:12800
    v_mfma_f32_16x16x32_bf16 v[100:103], a[4:7], a[44:47], v[100:103]
    ds_read_b64_tr_b16 a[100:101], v13 offset:12288
    v_mfma_f32_16x16x32_bf16 v[104:107], a[4:7], a[48:51], v[104:107]
    buffer_load_dwordx4 v2, s[8:11], s20 offen offset:0 lds
    v_mfma_f32_16x16x32_bf16 v[108:111], a[4:7], a[52:55], v[108:111]
    ds_read_b64_tr_b16 a[102:103], v13 offset:12800
    s_waitcnt lgkmcnt(14)
    v_mfma_f32_16x16x32_bf16 v[112:115], a[32:35], a[8:11], v[112:115]
    ds_read_b64_tr_b16 a[104:105], v12 offset:20480
    v_mfma_f32_16x16x32_bf16 v[116:119], a[36:39], a[8:11], v[116:119]
    v_mfma_f32_16x16x32_bf16 v[120:123], a[8:11], a[40:43], v[120:123]
    ds_read_b64_tr_b16 a[106:107], v12 offset:20992
    buffer_load_dwordx4 v3, s[8:11], s21 offen offset:1024 lds
    v_mfma_f32_16x16x32_bf16 v[124:127], a[8:11], a[44:47], v[124:127]
    ds_read_b64_tr_b16 a[108:109], v13 offset:20480
    v_mfma_f32_16x16x32_bf16 v[128:131], a[8:11], a[48:51], v[128:131]
    ds_read_b64_tr_b16 a[110:111], v13 offset:20992
    v_mfma_f32_16x16x32_bf16 v[132:135], a[8:11], a[52:55], v[132:135]
    s_waitcnt lgkmcnt(15)
    v_mfma_f32_16x16x32_bf16 v[136:139], a[32:35], a[12:15], v[136:139]
    ds_read_b128 a[60:63], v11 offset:2048
    v_mfma_f32_16x16x32_bf16 v[140:143], a[36:39], a[12:15], v[140:143]
    ds_read_b128 a[64:67], v11 offset:4096
    buffer_load_dwordx4 v2, s[8:11], s22 offen offset:2048 lds
    v_mfma_f32_16x16x32_bf16 v[144:147], a[12:15], a[40:43], v[144:147]
    v_mfma_f32_16x16x32_bf16 v[148:151], a[12:15], a[44:47], v[148:151]
    ds_read_b128 a[68:71], v11 offset:6144
    v_mfma_f32_16x16x32_bf16 v[152:155], a[12:15], a[48:51], v[152:155]
    ds_read_b128 a[72:75], v11 offset:8192
    v_mfma_f32_16x16x32_bf16 v[156:159], a[12:15], a[52:55], v[156:159]
    ds_read_b128 a[76:79], v11 offset:10240
    v_mfma_f32_16x16x32_bf16 v[160:163], a[32:35], a[16:19], v[160:163]
    buffer_load_dwordx4 v3, s[8:11], s23 offen offset:3072 lds
    v_mfma_f32_16x16x32_bf16 v[164:167], a[36:39], a[16:19], v[164:167]
    ds_read_b128 a[80:83], v11 offset:12288
    v_mfma_f32_16x16x32_bf16 v[168:171], a[16:19], a[40:43], v[168:171]
    ds_read_b128 a[84:87], v11 offset:14336
    v_mfma_f32_16x16x32_bf16 v[172:175], a[16:19], a[44:47], v[172:175]
    v_mfma_f32_16x16x32_bf16 v[176:179], a[16:19], a[48:51], v[176:179]
    s_add_u32 s76, s76, 128
    v_mfma_f32_16x16x32_bf16 v[180:183], a[16:19], a[52:55], v[180:183]
    v_mfma_f32_16x16x32_bf16 v[184:187], a[32:35], a[20:23], v[184:187]
    v_mfma_f32_16x16x32_bf16 v[188:191], a[36:39], a[20:23], v[188:191]
    v_mfma_f32_16x16x32_bf16 v[192:195], a[20:23], a[40:43], v[192:195]
    v_mfma_f32_16x16x32_bf16 v[196:199], a[20:23], a[44:47], v[196:199]
    s_and_b32 s76, s76, 2047
    v_mfma_f32_16x16x32_bf16 v[200:203], a[20:23], a[48:51], v[200:203]
    v_mfma_f32_16x16x32_bf16 v[204:207], a[20:23], a[52:55], v[204:207]
    s_waitcnt lgkmcnt(15)
    v_mfma_f32_16x16x32_bf16 v[208:211], a[32:35], a[24:27], v[208:211]
    v_mfma_f32_16x16x32_bf16 v[212:215], a[36:39], a[24:27], v[212:215]
    s_add_u32 s8, s80, s76
    v_mfma_f32_16x16x32_bf16 v[216:219], a[24:27], a[40:43], v[216:219]
    v_mfma_f32_16x16x32_bf16 v[220:223], a[24:27], a[44:47], v[220:223]
    v_mfma_f32_16x16x32_bf16 v[224:227], a[24:27], a[48:51], v[224:227]
    v_mfma_f32_16x16x32_bf16 v[228:231], a[24:27], a[52:55], v[228:231]
    v_mfma_f32_16x16x32_bf16 v[232:235], a[32:35], a[28:31], v[232:235]
    s_addc_u32 s9, s81, 0
    v_mfma_f32_16x16x32_bf16 v[236:239], a[36:39], a[28:31], v[236:239]
    v_mfma_f32_16x16x32_bf16 v[240:243], a[28:31], a[40:43], v[240:243]
    v_mfma_f32_16x16x32_bf16 v[244:247], a[28:31], a[44:47], v[244:247]
    v_mfma_f32_16x16x32_bf16 v[248:251], a[28:31], a[48:51], v[248:251]
    v_mfma_f32_16x16x32_bf16 v[252:255], a[28:31], a[52:55], v[252:255]
    v_mfma_f32_16x16x32_bf16 v[64:67], a[88:91], a[56:59], v[64:67]
    v_mfma_f32_16x16x32_bf16 v[68:71], a[92:95], a[56:59], v[68:71]
    s_waitcnt lgkmcnt(13)
    v_mfma_f32_16x16x32_bf16 v[72:75], a[56:59], a[96:99], v[72:75]
    s_waitcnt lgkmcnt(11)
    v_mfma_f32_16x16x32_bf16 v[76:79], a[56:59], a[100:103], v[76:79]
    s_waitcnt lgkmcnt(9)
    v_mfma_f32_16x16x32_bf16 v[80:83], a[56:59], a[104:107], v[80:83]
    s_waitcnt lgkmcnt(7)
    v_mfma_f32_16x16x32_bf16 v[84:87], a[56:59], a[108:111], v[84:87]
    s_waitcnt lgkmcnt(6)
    v_mfma_f32_16x16x32_bf16 v[88:91], a[88:91], a[60:63], v[88:91]
    v_mfma_f32_16x16x32_bf16 v[92:95], a[92:95], a[60:63], v[92:95]
    s_waitcnt lgkmcnt(0)
    s_waitcnt vmcnt(8)
    s_barrier
    v_mfma_f32_16x16x32_bf16 v[96:99], a[60:63], a[96:99], v[96:99]
    ds_read_b128 a[0:3], v8 offset:0
    v_mfma_f32_16x16x32_bf16 v[100:103], a[60:63], a[100:103], v[100:103]
    ds_read_b64_tr_b16 a[32:33], v17 offset:0
    s_add_u32 m0, s49, 0
    v_mfma_f32_16x16x32_bf16 v[104:107], a[60:63], a[104:107], v[104:107]
    ds_read_b64_tr_b16 a[34:35], v17 offset:512
    v_mfma_f32_16x16x32_bf16 v[108:111], a[60:63], a[108:111], v[108:111]
    ds_read_b64_tr_b16 a[36:37], v18 offset:0
    buffer_load_dwordx4 v4, s[12:15], s24 offen offset:0 lds
    v_mfma_f32_16x16x32_bf16 v[112:115], a[88:91], a[64:67], v[112:115]
    ds_read_b64_tr_b16 a[38:39], v18 offset:512
    v_mfma_f32_16x16x32_bf16 v[116:119], a[92:95], a[64:67], v[116:119]
    buffer_load_dwordx4 v5, s[12:15], s25 offen offset:1024 lds
    v_mfma_f32_16x16x32_bf16 v[120:123], a[64:67], a[96:99], v[120:123]
    ds_read_b64_tr_b16 a[40:41], v17 offset:8192
    v_mfma_f32_16x16x32_bf16 v[124:127], a[64:67], a[100:103], v[124:127]
    ds_read_b64_tr_b16 a[42:43], v17 offset:8704
    buffer_load_dwordx4 v4, s[12:15], s26 offen offset:2048 lds
    v_mfma_f32_16x16x32_bf16 v[128:131], a[64:67], a[104:107], v[128:131]
    ds_read_b64_tr_b16 a[44:45], v18 offset:8192
    v_mfma_f32_16x16x32_bf16 v[132:135], a[64:67], a[108:111], v[132:135]
    ds_read_b64_tr_b16 a[46:47], v18 offset:8704
    buffer_load_dwordx4 v5, s[12:15], s27 offen offset:3072 lds
    v_mfma_f32_16x16x32_bf16 v[136:139], a[88:91], a[68:71], v[136:139]
    ds_read_b64_tr_b16 a[48:49], v17 offset:16384
    v_mfma_f32_16x16x32_bf16 v[140:143], a[92:95], a[68:71], v[140:143]
    v_mfma_f32_16x16x32_bf16 v[144:147], a[68:71], a[96:99], v[144:147]
    ds_read_b64_tr_b16 a[50:51], v17 offset:16896
    s_add_u32 m0, s49, 4096
    v_mfma_f32_16x16x32_bf16 v[148:151], a[68:71], a[100:103], v[148:151]
    ds_read_b64_tr_b16 a[52:53], v18 offset:16384
    v_mfma_f32_16x16x32_bf16 v[152:155], a[68:71], a[104:107], v[152:155]
    ds_read_b64_tr_b16 a[54:55], v18 offset:16896
    buffer_load_dwordx4 v4, s[12:15], s28 offen offset:0 lds
    v_mfma_f32_16x16x32_bf16 v[156:159], a[68:71], a[108:111], v[156:159]
    ds_read_b128 a[4:7], v8 offset:2048
    v_mfma_f32_16x16x32_bf16 v[160:163], a[88:91], a[72:75], v[160:163]
    ds_read_b128 a[8:11], v8 offset:4096
    buffer_load_dwordx4 v5, s[12:15], s29 offen offset:1024 lds
    v_mfma_f32_16x16x32_bf16 v[164:167], a[92:95], a[72:75], v[164:167]
    v_mfma_f32_16x16x32_bf16 v[168:171], a[72:75], a[96:99], v[168:171]
    ds_read_b128 a[12:15], v8 offset:6144
    s_add_u32 s77, s77, 393216
    v_mfma_f32_16x16x32_bf16 v[172:175], a[72:75], a[100:103], v[172:175]
    ds_read_b128 a[16:19], v8 offset:8192
    v_mfma_f32_16x16x32_bf16 v[176:179], a[72:75], a[104:107], v[176:179]
    ds_read_b128 a[20:23], v8 offset:10240
    v_mfma_f32_16x16x32_bf16 v[180:183], a[72:75], a[108:111], v[180:183]
    ds_read_b128 a[24:27], v8 offset:12288
    s_cmp_eq_u32 s77, 6291456
    v_mfma_f32_16x16x32_bf16 v[184:187], a[88:91], a[76:79], v[184:187]
    ds_read_b128 a[28:31], v8 offset:14336
    v_mfma_f32_16x16x32_bf16 v[188:191], a[92:95], a[76:79], v[188:191]
    s_cselect_b32 s77, 0, s77
    v_mfma_f32_16x16x32_bf16 v[192:195], a[76:79], a[96:99], v[192:195]
    v_mfma_f32_16x16x32_bf16 v[196:199], a[76:79], a[100:103], v[196:199]
    s_add_u32 s12, s68, s77
    v_mfma_f32_16x16x32_bf16 v[200:203], a[76:79], a[104:107], v[200:203]
    v_mfma_f32_16x16x32_bf16 v[204:207], a[76:79], a[108:111], v[204:207]
    s_addc_u32 s13, s69, 0
    v_mfma_f32_16x16x32_bf16 v[208:211], a[88:91], a[80:83], v[208:211]
    v_mfma_f32_16x16x32_bf16 v[212:215], a[92:95], a[80:83], v[212:215]
    v_mfma_f32_16x16x32_bf16 v[216:219], a[80:83], a[96:99], v[216:219]
    s_add_u32 m0, s48, 65536
    v_mfma_f32_16x16x32_bf16 v[220:223], a[80:83], a[100:103], v[220:223]
    v_mfma_f32_16x16x32_bf16 v[224:227], a[80:83], a[104:107], v[224:227]
    buffer_load_dwordx4 v2, s[8:11], s16 offen offset:0 lds
    v_mfma_f32_16x16x32_bf16 v[228:231], a[80:83], a[108:111], v[228:231]
    v_mfma_f32_16x16x32_bf16 v[232:235], a[88:91], a[84:87], v[232:235]
    buffer_load_dwordx4 v3, s[8:11], s17 offen offset:1024 lds
    v_mfma_f32_16x16x32_bf16 v[236:239], a[92:95], a[84:87], v[236:239]
    v_mfma_f32_16x16x32_bf16 v[240:243], a[84:87], a[96:99], v[240:243]
    buffer_load_dwordx4 v2, s[8:11], s18 offen offset:2048 lds
    v_mfma_f32_16x16x32_bf16 v[244:247], a[84:87], a[100:103], v[244:247]
    v_mfma_f32_16x16x32_bf16 v[248:251], a[84:87], a[104:107], v[248:251]
    v_mfma_f32_16x16x32_bf16 v[252:255], a[84:87], a[108:111], v[252:255]
    s_waitcnt lgkmcnt(15)
    v_mfma_f32_16x16x32_bf16 v[64:67], a[32:35], a[0:3], v[64:67]
    ds_read_b128 a[56:59], v9 offset:0
    v_mfma_f32_16x16x32_bf16 v[68:71], a[36:39], a[0:3], v[68:71]
    ds_read_b64_tr_b16 a[88:89], v17 offset:4096
    buffer_load_dwordx4 v3, s[8:11], s19 offen offset:3072 lds
    s_waitcnt lgkmcnt(15)
    v_mfma_f32_16x16x32_bf16 v[72:75], a[0:3], a[40:43], v[72:75]
    ds_read_b64_tr_b16 a[90:91], v17 offset:4608
    s_waitcnt lgkmcnt(14)
    v_mfma_f32_16x16x32_bf16 v[76:79], a[0:3], a[44:47], v[76:79]
    s_waitcnt lgkmcnt(12)
    v_mfma_f32_16x16x32_bf16 v[80:83], a[0:3], a[48:51], v[80:83]
    ds_read_b64_tr_b16 a[92:93], v18 offset:4096
    s_waitcnt lgkmcnt(11)
    v_mfma_f32_16x16x32_bf16 v[84:87], a[0:3], a[52:55], v[84:87]
    ds_read_b64_tr_b16 a[94:95], v18 offset:4608
    s_add_u32 m0, s48, 69632
    s_waitcnt lgkmcnt(11)
    v_mfma_f32_16x16x32_bf16 v[88:91], a[32:35], a[4:7], v[88:91]
    v_mfma_f32_16x16x32_bf16 v[92:95], a[36:39], a[4:7], v[92:95]
    ds_read_b64_tr_b16 a[96:97], v17 offset:12288
    v_mfma_f32_16x16x32_bf16 v[96:99], a[4:7], a[40:43], v[96:99]
    ds_read_b64_tr_b16 a[98:99], v17 offset:12800
    v_mfma_f32_16x16x32_bf16 v[100:103], a[4:7], a[44:47], v[100:103]
    ds_read_b64_tr_b16 a[100:101], v18 offset:12288
    v_mfma_f32_16x16x32_bf16 v[104:107], a[4:7], a[48:51], v[104:107]
    buffer_load_dwordx4 v2, s[8:11], s20 offen offset:0 lds
    v_mfma_f32_16x16x32_bf16 v[108:111], a[4:7], a[52:55], v[108:111]
    ds_read_b64_tr_b16 a[102:103], v18 offset:12800
    s_waitcnt lgkmcnt(14)
    v_mfma_f32_16x16x32_bf16 v[112:115], a[32:35], a[8:11], v[112:115]
    ds_read_b64_tr_b16 a[104:105], v17 offset:20480
    v_mfma_f32_16x16x32_bf16 v[116:119], a[36:39], a[8:11], v[116:119]
    v_mfma_f32_16x16x32_bf16 v[120:123], a[8:11], a[40:43], v[120:123]
    ds_read_b64_tr_b16 a[106:107], v17 offset:20992
    buffer_load_dwordx4 v3, s[8:11], s21 offen offset:1024 lds
    v_mfma_f32_16x16x32_bf16 v[124:127], a[8:11], a[44:47], v[124:127]
    ds_read_b64_tr_b16 a[108:109], v18 offset:20480
    v_mfma_f32_16x16x32_bf16 v[128:131], a[8:11], a[48:51], v[128:131]
    ds_read_b64_tr_b16 a[110:111], v18 offset:20992
    v_mfma_f32_16x16x32_bf16 v[132:135], a[8:11], a[52:55], v[132:135]
    s_waitcnt lgkmcnt(15)
    v_mfma_f32_16x16x32_bf16 v[136:139], a[32:35], a[12:15], v[136:139]
    ds_read_b128 a[60:63], v9 offset:2048
    v_mfma_f32_16x16x32_bf16 v[140:143], a[36:39], a[12:15], v[140:143]
    ds_read_b128 a[64:67], v9 offset:4096
    buffer_load_dwordx4 v2, s[8:11], s22 offen offset:2048 lds
    v_mfma_f32_16x16x32_bf16 v[144:147], a[12:15], a[40:43], v[144:147]
    v_mfma_f32_16x16x32_bf16 v[148:151], a[12:15], a[44:47], v[148:151]
    ds_read_b128 a[68:71], v9 offset:6144
    v_mfma_f32_16x16x32_bf16 v[152:155], a[12:15], a[48:51], v[152:155]
    ds_read_b128 a[72:75], v9 offset:8192
    v_mfma_f32_16x16x32_bf16 v[156:159], a[12:15], a[52:55], v[156:159]
    ds_read_b128 a[76:79], v9 offset:10240
    v_mfma_f32_16x16x32_bf16 v[160:163], a[32:35], a[16:19], v[160:163]
    buffer_load_dwordx4 v3, s[8:11], s23 offen offset:3072 lds
    v_mfma_f32_16x16x32_bf16 v[164:167], a[36:39], a[16:19], v[164:167]
    ds_read_b128 a[80:83], v9 offset:12288
    v_mfma_f32_16x16x32_bf16 v[168:171], a[16:19], a[40:43], v[168:171]
    ds_read_b128 a[84:87], v9 offset:14336
    v_mfma_f32_16x16x32_bf16 v[172:175], a[16:19], a[44:47], v[172:175]
    v_mfma_f32_16x16x32_bf16 v[176:179], a[16:19], a[48:51], v[176:179]
    s_add_u32 s76, s76, 128
    v_mfma_f32_16x16x32_bf16 v[180:183], a[16:19], a[52:55], v[180:183]
    v_mfma_f32_16x16x32_bf16 v[184:187], a[32:35], a[20:23], v[184:187]
    v_mfma_f32_16x16x32_bf16 v[188:191], a[36:39], a[20:23], v[188:191]
    v_mfma_f32_16x16x32_bf16 v[192:195], a[20:23], a[40:43], v[192:195]
    v_mfma_f32_16x16x32_bf16 v[196:199], a[20:23], a[44:47], v[196:199]
    s_and_b32 s76, s76, 2047
    v_mfma_f32_16x16x32_bf16 v[200:203], a[20:23], a[48:51], v[200:203]
    v_mfma_f32_16x16x32_bf16 v[204:207], a[20:23], a[52:55], v[204:207]
    s_waitcnt lgkmcnt(15)
    v_mfma_f32_16x16x32_bf16 v[208:211], a[32:35], a[24:27], v[208:211]
    v_mfma_f32_16x16x32_bf16 v[212:215], a[36:39], a[24:27], v[212:215]
    s_add_u32 s8, s80, s76
    v_mfma_f32_16x16x32_bf16 v[216:219], a[24:27], a[40:43], v[216:219]
    v_mfma_f32_16x16x32_bf16 v[220:223], a[24:27], a[44:47], v[220:223]
    v_mfma_f32_16x16x32_bf16 v[224:227], a[24:27], a[48:51], v[224:227]
    v_mfma_f32_16x16x32_bf16 v[228:231], a[24:27], a[52:55], v[228:231]
    v_mfma_f32_16x16x32_bf16 v[232:235], a[32:35], a[28:31], v[232:235]
    s_addc_u32 s9, s81, 0
    v_mfma_f32_16x16x32_bf16 v[236:239], a[36:39], a[28:31], v[236:239]
    v_mfma_f32_16x16x32_bf16 v[240:243], a[28:31], a[40:43], v[240:243]
    v_mfma_f32_16x16x32_bf16 v[244:247], a[28:31], a[44:47], v[244:247]
    v_mfma_f32_16x16x32_bf16 v[248:251], a[28:31], a[48:51], v[248:251]
    v_mfma_f32_16x16x32_bf16 v[252:255], a[28:31], a[52:55], v[252:255]
    v_mfma_f32_16x16x32_bf16 v[64:67], a[88:91], a[56:59], v[64:67]
    v_mfma_f32_16x16x32_bf16 v[68:71], a[92:95], a[56:59], v[68:71]
    s_waitcnt lgkmcnt(13)
    v_mfma_f32_16x16x32_bf16 v[72:75], a[56:59], a[96:99], v[72:75]
    s_waitcnt lgkmcnt(11)
    v_mfma_f32_16x16x32_bf16 v[76:79], a[56:59], a[100:103], v[76:79]
    s_waitcnt lgkmcnt(9)
    v_mfma_f32_16x16x32_bf16 v[80:83], a[56:59], a[104:107], v[80:83]
    s_waitcnt lgkmcnt(7)
    v_mfma_f32_16x16x32_bf16 v[84:87], a[56:59], a[108:111], v[84:87]
    s_waitcnt lgkmcnt(6)
    v_mfma_f32_16x16x32_bf16 v[88:91], a[88:91], a[60:63], v[88:91]
    v_mfma_f32_16x16x32_bf16 v[92:95], a[92:95], a[60:63], v[92:95]
    s_waitcnt lgkmcnt(0)
    s_waitcnt vmcnt(8)
    s_barrier
    v_mfma_f32_16x16x32_bf16 v[96:99], a[60:63], a[96:99], v[96:99]
    ds_read_b128 a[0:3], v8 offset:32768
    v_mfma_f32_16x16x32_bf16 v[100:103], a[60:63], a[100:103], v[100:103]
    ds_read_b64_tr_b16 a[32:33], v12 offset:0
    s_add_u32 m0, s49, 24576
    v_mfma_f32_16x16x32_bf16 v[104:107], a[60:63], a[104:107], v[104:107]
    ds_read_b64_tr_b16 a[34:35], v12 offset:512
    v_mfma_f32_16x16x32_bf16 v[108:111], a[60:63], a[108:111], v[108:111]
    ds_read_b64_tr_b16 a[36:37], v13 offset:0
    buffer_load_dwordx4 v4, s[12:15], s24 offen offset:0 lds
    v_mfma_f32_16x16x32_bf16 v[112:115], a[88:91], a[64:67], v[112:115]
    ds_read_b64_tr_b16 a[38:39], v13 offset:512
    v_mfma_f32_16x16x32_bf16 v[116:119], a[92:95], a[64:67], v[116:119]
    buffer_load_dwordx4 v5, s[12:15], s25 offen offset:1024 lds
    v_mfma_f32_16x16x32_bf16 v[120:123], a[64:67], a[96:99], v[120:123]
    ds_read_b64_tr_b16 a[40:41], v12 offset:8192
    v_mfma_f32_16x16x32_bf16 v[124:127], a[64:67], a[100:103], v[124:127]
    ds_read_b64_tr_b16 a[42:43], v12 offset:8704
    buffer_load_dwordx4 v4, s[12:15], s26 offen offset:2048 lds
    v_mfma_f32_16x16x32_bf16 v[128:131], a[64:67], a[104:107], v[128:131]
    ds_read_b64_tr_b16 a[44:45], v13 offset:8192
    v_mfma_f32_16x16x32_bf16 v[132:135], a[64:67], a[108:111], v[132:135]
    ds_read_b64_tr_b16 a[46:47], v13 offset:8704
    buffer_load_dwordx4 v5, s[12:15], s27 offen offset:3072 lds
    v_mfma_f32_16x16x32_bf16 v[136:139], a[88:91], a[68:71], v[136:139]
    ds_read_b64_tr_b16 a[48:49], v12 offset:16384
    v_mfma_f32_16x16x32_bf16 v[140:143], a[92:95], a[68:71], v[140:143]
    v_mfma_f32_16x16x32_bf16 v[144:147], a[68:71], a[96:99], v[144:147]
    ds_read_b64_tr_b16 a[50:51], v12 offset:16896
    s_add_u32 m0, s49, 28672
    v_mfma_f32_16x16x32_bf16 v[148:151], a[68:71], a[100:103], v[148:151]
    ds_read_b64_tr_b16 a[52:53], v13 offset:16384
    v_mfma_f32_16x16x32_bf16 v[152:155], a[68:71], a[104:107], v[152:155]
    ds_read_b64_tr_b16 a[54:55], v13 offset:16896
    buffer_load_dwordx4 v4, s[12:15], s28 offen offset:0 lds
    v_mfma_f32_16x16x32_bf16 v[156:159], a[68:71], a[108:111], v[156:159]
    ds_read_b128 a[4:7], v8 offset:34816
    v_mfma_f32_16x16x32_bf16 v[160:163], a[88:91], a[72:75], v[160:163]
    ds_read_b128 a[8:11], v8 offset:36864
    buffer_load_dwordx4 v5, s[12:15], s29 offen offset:1024 lds
    v_mfma_f32_16x16x32_bf16 v[164:167], a[92:95], a[72:75], v[164:167]
    v_mfma_f32_16x16x32_bf16 v[168:171], a[72:75], a[96:99], v[168:171]
    ds_read_b128 a[12:15], v8 offset:38912
    s_add_u32 s77, s77, 393216
    v_mfma_f32_16x16x32_bf16 v[172:175], a[72:75], a[100:103], v[172:175]
    ds_read_b128 a[16:19], v8 offset:40960
    v_mfma_f32_16x16x32_bf16 v[176:179], a[72:75], a[104:107], v[176:179]
    ds_read_b128 a[20:23], v8 offset:43008
    v_mfma_f32_16x16x32_bf16 v[180:183], a[72:75], a[108:111], v[180:183]
    ds_read_b128 a[24:27], v8 offset:45056
    s_cmp_eq_u32 s77, 6291456
    v_mfma_f32_16x16x32_bf16 v[184:187], a[88:91], a[76:79], v[184:187]
    ds_read_b128 a[28:31], v8 offset:47104
    v_mfma_f32_16x16x32_bf16 v[188:191], a[92:95], a[76:79], v[188:191]
    s_cselect_b32 s77, 0, s77
    v_mfma_f32_16x16x32_bf16 v[192:195], a[76:79], a[96:99], v[192:195]
    v_mfma_f32_16x16x32_bf16 v[196:199], a[76:79], a[100:103], v[196:199]
    s_add_u32 s12, s68, s77
    v_mfma_f32_16x16x32_bf16 v[200:203], a[76:79], a[104:107], v[200:203]
    v_mfma_f32_16x16x32_bf16 v[204:207], a[76:79], a[108:111], v[204:207]
    s_addc_u32 s13, s69, 0
    v_mfma_f32_16x16x32_bf16 v[208:211], a[88:91], a[80:83], v[208:211]
    v_mfma_f32_16x16x32_bf16 v[212:215], a[92:95], a[80:83], v[212:215]
    v_mfma_f32_16x16x32_bf16 v[216:219], a[80:83], a[96:99], v[216:219]
    s_add_u32 m0, s48, 0
    v_mfma_f32_16x16x32_bf16 v[220:223], a[80:83], a[100:103], v[220:223]
    v_mfma_f32_16x16x32_bf16 v[224:227], a[80:83], a[104:107], v[224:227]
    buffer_load_dwordx4 v2, s[8:11], s16 offen offset:0 lds
    v_mfma_f32_16x16x32_bf16 v[228:231], a[80:83], a[108:111], v[228:231]
    v_mfma_f32_16x16x32_bf16 v[232:235], a[88:91], a[84:87], v[232:235]
    buffer_load_dwordx4 v3, s[8:11], s17 offen offset:1024 lds
    v_mfma_f32_16x16x32_bf16 v[236:239], a[92:95], a[84:87], v[236:239]
    v_mfma_f32_16x16x32_bf16 v[240:243], a[84:87], a[96:99], v[240:243]
    buffer_load_dwordx4 v2, s[8:11], s18 offen offset:2048 lds
    v_mfma_f32_16x16x32_bf16 v[244:247], a[84:87], a[100:103], v[244:247]
    v_mfma_f32_16x16x32_bf16 v[248:251], a[84:87], a[104:107], v[248:251]
    v_mfma_f32_16x16x32_bf16 v[252:255], a[84:87], a[108:111], v[252:255]
    s_waitcnt lgkmcnt(15)
    v_mfma_f32_16x16x32_bf16 v[64:67], a[32:35], a[0:3], v[64:67]
    ds_read_b128 a[56:59], v9 offset:32768
    v_mfma_f32_16x16x32_bf16 v[68:71], a[36:39], a[0:3], v[68:71]
    ds_read_b64_tr_b16 a[88:89], v12 offset:4096
    buffer_load_dwordx4 v3, s[8:11], s19 offen offset:3072 lds
    s_waitcnt lgkmcnt(15)
    v_mfma_f32_16x16x32_bf16 v[72:75], a[0:3], a[40:43], v[72:75]
    ds_read_b64_tr_b16 a[90:91], v12 offset:4608
    s_waitcnt lgkmcnt(14)
    v_mfma_f32_16x16x32_bf16 v[76:79], a[0:3], a[44:47], v[76:79]
    s_waitcnt lgkmcnt(12)
    v_mfma_f32_16x16x32_bf16 v[80:83], a[0:3], a[48:51], v[80:83]
    ds_read_b64_tr_b16 a[92:93], v13 offset:4096
    s_waitcnt lgkmcnt(11)
    v_mfma_f32_16x16x32_bf16 v[84:87], a[0:3], a[52:55], v[84:87]
    ds_read_b64_tr_b16 a[94:95], v13 offset:4608
    s_add_u32 m0, s48, 4096
    s_waitcnt lgkmcnt(11)
    v_mfma_f32_16x16x32_bf16 v[88:91], a[32:35], a[4:7], v[88:91]
    v_mfma_f32_16x16x32_bf16 v[92:95], a[36:39], a[4:7], v[92:95]
    ds_read_b64_tr_b16 a[96:97], v12 offset:12288
    v_mfma_f32_16x16x32_bf16 v[96:99], a[4:7], a[40:43], v[96:99]
    ds_read_b64_tr_b16 a[98:99], v12 offset:12800
    v_mfma_f32_16x16x32_bf16 v[100:103], a[4:7], a[44:47], v[100:103]
    ds_read_b64_tr_b16 a[100:101], v13 offset:12288
    v_mfma_f32_16x16x32_bf16 v[104:107], a[4:7], a[48:51], v[104:107]
    buffer_load_dwordx4 v2, s[8:11], s20 offen offset:0 lds
    v_mfma_f32_16x16x32_bf16 v[108:111], a[4:7], a[52:55], v[108:111]
    ds_read_b64_tr_b16 a[102:103], v13 offset:12800
    s_waitcnt lgkmcnt(14)
    v_mfma_f32_16x16x32_bf16 v[112:115], a[32:35], a[8:11], v[112:115]
    ds_read_b64_tr_b16 a[104:105], v12 offset:20480
    v_mfma_f32_16x16x32_bf16 v[116:119], a[36:39], a[8:11], v[116:119]
    v_mfma_f32_16x16x32_bf16 v[120:123], a[8:11], a[40:43], v[120:123]
    ds_read_b64_tr_b16 a[106:107], v12 offset:20992
    buffer_load_dwordx4 v3, s[8:11], s21 offen offset:1024 lds
    v_mfma_f32_16x16x32_bf16 v[124:127], a[8:11], a[44:47], v[124:127]
    ds_read_b64_tr_b16 a[108:109], v13 offset:20480
    v_mfma_f32_16x16x32_bf16 v[128:131], a[8:11], a[48:51], v[128:131]
    ds_read_b64_tr_b16 a[110:111], v13 offset:20992
    v_mfma_f32_16x16x32_bf16 v[132:135], a[8:11], a[52:55], v[132:135]
    s_waitcnt lgkmcnt(15)
    v_mfma_f32_16x16x32_bf16 v[136:139], a[32:35], a[12:15], v[136:139]
    ds_read_b128 a[60:63], v9 offset:34816
    v_mfma_f32_16x16x32_bf16 v[140:143], a[36:39], a[12:15], v[140:143]
    ds_read_b128 a[64:67], v9 offset:36864
    buffer_load_dwordx4 v2, s[8:11], s22 offen offset:2048 lds
    v_mfma_f32_16x16x32_bf16 v[144:147], a[12:15], a[40:43], v[144:147]
    v_mfma_f32_16x16x32_bf16 v[148:151], a[12:15], a[44:47], v[148:151]
    ds_read_b128 a[68:71], v9 offset:38912
    v_mfma_f32_16x16x32_bf16 v[152:155], a[12:15], a[48:51], v[152:155]
    ds_read_b128 a[72:75], v9 offset:40960
    v_mfma_f32_16x16x32_bf16 v[156:159], a[12:15], a[52:55], v[156:159]
    ds_read_b128 a[76:79], v9 offset:43008
    v_mfma_f32_16x16x32_bf16 v[160:163], a[32:35], a[16:19], v[160:163]
    buffer_load_dwordx4 v3, s[8:11], s23 offen offset:3072 lds
    v_mfma_f32_16x16x32_bf16 v[164:167], a[36:39], a[16:19], v[164:167]
    ds_read_b128 a[80:83], v9 offset:45056
    v_mfma_f32_16x16x32_bf16 v[168:171], a[16:19], a[40:43], v[168:171]
    ds_read_b128 a[84:87], v9 offset:47104
    v_mfma_f32_16x16x32_bf16 v[172:175], a[16:19], a[44:47], v[172:175]
    v_mfma_f32_16x16x32_bf16 v[176:179], a[16:19], a[48:51], v[176:179]
    s_add_u32 s76, s76, 128
    v_mfma_f32_16x16x32_bf16 v[180:183], a[16:19], a[52:55], v[180:183]
    v_mfma_f32_16x16x32_bf16 v[184:187], a[32:35], a[20:23], v[184:187]
    v_mfma_f32_16x16x32_bf16 v[188:191], a[36:39], a[20:23], v[188:191]
    v_mfma_f32_16x16x32_bf16 v[192:195], a[20:23], a[40:43], v[192:195]
    v_mfma_f32_16x16x32_bf16 v[196:199], a[20:23], a[44:47], v[196:199]
    s_and_b32 s76, s76, 2047
    v_mfma_f32_16x16x32_bf16 v[200:203], a[20:23], a[48:51], v[200:203]
    v_mfma_f32_16x16x32_bf16 v[204:207], a[20:23], a[52:55], v[204:207]
    s_waitcnt lgkmcnt(15)
    v_mfma_f32_16x16x32_bf16 v[208:211], a[32:35], a[24:27], v[208:211]
    v_mfma_f32_16x16x32_bf16 v[212:215], a[36:39], a[24:27], v[212:215]
    s_add_u32 s8, s80, s76
    v_mfma_f32_16x16x32_bf16 v[216:219], a[24:27], a[40:43], v[216:219]
    v_mfma_f32_16x16x32_bf16 v[220:223], a[24:27], a[44:47], v[220:223]
    v_mfma_f32_16x16x32_bf16 v[224:227], a[24:27], a[48:51], v[224:227]
    v_mfma_f32_16x16x32_bf16 v[228:231], a[24:27], a[52:55], v[228:231]
    v_mfma_f32_16x16x32_bf16 v[232:235], a[32:35], a[28:31], v[232:235]
    s_addc_u32 s9, s81, 0
    v_mfma_f32_16x16x32_bf16 v[236:239], a[36:39], a[28:31], v[236:239]
    v_mfma_f32_16x16x32_bf16 v[240:243], a[28:31], a[40:43], v[240:243]
    v_mfma_f32_16x16x32_bf16 v[244:247], a[28:31], a[44:47], v[244:247]
    v_mfma_f32_16x16x32_bf16 v[248:251], a[28:31], a[48:51], v[248:251]
    v_mfma_f32_16x16x32_bf16 v[252:255], a[28:31], a[52:55], v[252:255]
    v_mfma_f32_16x16x32_bf16 v[64:67], a[88:91], a[56:59], v[64:67]
    v_mfma_f32_16x16x32_bf16 v[68:71], a[92:95], a[56:59], v[68:71]
    s_waitcnt lgkmcnt(13)
    v_mfma_f32_16x16x32_bf16 v[72:75], a[56:59], a[96:99], v[72:75]
    s_waitcnt lgkmcnt(11)
    v_mfma_f32_16x16x32_bf16 v[76:79], a[56:59], a[100:103], v[76:79]
    s_waitcnt lgkmcnt(9)
    v_mfma_f32_16x16x32_bf16 v[80:83], a[56:59], a[104:107], v[80:83]
    s_waitcnt lgkmcnt(7)
    v_mfma_f32_16x16x32_bf16 v[84:87], a[56:59], a[108:111], v[84:87]
    s_waitcnt lgkmcnt(6)
    v_mfma_f32_16x16x32_bf16 v[88:91], a[88:91], a[60:63], v[88:91]
    v_mfma_f32_16x16x32_bf16 v[92:95], a[92:95], a[60:63], v[92:95]
    s_waitcnt lgkmcnt(0)
    s_waitcnt vmcnt(8)
    s_barrier
    v_mfma_f32_16x16x32_bf16 v[96:99], a[60:63], a[96:99], v[96:99]
    ds_read_b128 a[0:3], v10 offset:0
    v_mfma_f32_16x16x32_bf16 v[100:103], a[60:63], a[100:103], v[100:103]
    ds_read_b64_tr_b16 a[32:33], v17 offset:0
    s_add_u32 m0, s49, 0
    v_mfma_f32_16x16x32_bf16 v[104:107], a[60:63], a[104:107], v[104:107]
    ds_read_b64_tr_b16 a[34:35], v17 offset:512
    v_mfma_f32_16x16x32_bf16 v[108:111], a[60:63], a[108:111], v[108:111]
    ds_read_b64_tr_b16 a[36:37], v18 offset:0
    buffer_load_dwordx4 v4, s[12:15], s24 offen offset:0 lds
    v_mfma_f32_16x16x32_bf16 v[112:115], a[88:91], a[64:67], v[112:115]
    ds_read_b64_tr_b16 a[38:39], v18 offset:512
    v_mfma_f32_16x16x32_bf16 v[116:119], a[92:95], a[64:67], v[116:119]
    buffer_load_dwordx4 v5, s[12:15], s25 offen offset:1024 lds
    v_mfma_f32_16x16x32_bf16 v[120:123], a[64:67], a[96:99], v[120:123]
    ds_read_b64_tr_b16 a[40:41], v17 offset:8192
    v_mfma_f32_16x16x32_bf16 v[124:127], a[64:67], a[100:103], v[124:127]
    ds_read_b64_tr_b16 a[42:43], v17 offset:8704
    buffer_load_dwordx4 v4, s[12:15], s26 offen offset:2048 lds
    v_mfma_f32_16x16x32_bf16 v[128:131], a[64:67], a[104:107], v[128:131]
    ds_read_b64_tr_b16 a[44:45], v18 offset:8192
    v_mfma_f32_16x16x32_bf16 v[132:135], a[64:67], a[108:111], v[132:135]
    ds_read_b64_tr_b16 a[46:47], v18 offset:8704
    buffer_load_dwordx4 v5, s[12:15], s27 offen offset:3072 lds
    v_mfma_f32_16x16x32_bf16 v[136:139], a[88:91], a[68:71], v[136:139]
    ds_read_b64_tr_b16 a[48:49], v17 offset:16384
    v_mfma_f32_16x16x32_bf16 v[140:143], a[92:95], a[68:71], v[140:143]
    v_mfma_f32_16x16x32_bf16 v[144:147], a[68:71], a[96:99], v[144:147]
    ds_read_b64_tr_b16 a[50:51], v17 offset:16896
    s_add_u32 m0, s49, 4096
    v_mfma_f32_16x16x32_bf16 v[148:151], a[68:71], a[100:103], v[148:151]
    ds_read_b64_tr_b16 a[52:53], v18 offset:16384
    v_mfma_f32_16x16x32_bf16 v[152:155], a[68:71], a[104:107], v[152:155]
    ds_read_b64_tr_b16 a[54:55], v18 offset:16896
    buffer_load_dwordx4 v4, s[12:15], s28 offen offset:0 lds
    v_mfma_f32_16x16x32_bf16 v[156:159], a[68:71], a[108:111], v[156:159]
    ds_read_b128 a[4:7], v10 offset:2048
    v_mfma_f32_16x16x32_bf16 v[160:163], a[88:91], a[72:75], v[160:163]
    ds_read_b128 a[8:11], v10 offset:4096
    buffer_load_dwordx4 v5, s[12:15], s29 offen offset:1024 lds
    v_mfma_f32_16x16x32_bf16 v[164:167], a[92:95], a[72:75], v[164:167]
    v_mfma_f32_16x16x32_bf16 v[168:171], a[72:75], a[96:99], v[168:171]
    ds_read_b128 a[12:15], v10 offset:6144
    s_add_u32 s77, s77, 393216
    v_mfma_f32_16x16x32_bf16 v[172:175], a[72:75], a[100:103], v[172:175]
    ds_read_b128 a[16:19], v10 offset:8192
    v_mfma_f32_16x16x32_bf16 v[176:179], a[72:75], a[104:107], v[176:179]
    ds_read_b128 a[20:23], v10 offset:10240
    v_mfma_f32_16x16x32_bf16 v[180:183], a[72:75], a[108:111], v[180:183]
    ds_read_b128 a[24:27], v10 offset:12288
    s_cmp_eq_u32 s77, 6291456
    v_mfma_f32_16x16x32_bf16 v[184:187], a[88:91], a[76:79], v[184:187]
    ds_read_b128 a[28:31], v10 offset:14336
    v_mfma_f32_16x16x32_bf16 v[188:191], a[92:95], a[76:79], v[188:191]
    s_cselect_b32 s77, 0, s77
    v_mfma_f32_16x16x32_bf16 v[192:195], a[76:79], a[96:99], v[192:195]
    v_mfma_f32_16x16x32_bf16 v[196:199], a[76:79], a[100:103], v[196:199]
    s_add_u32 s12, s68, s77
    v_mfma_f32_16x16x32_bf16 v[200:203], a[76:79], a[104:107], v[200:203]
    v_mfma_f32_16x16x32_bf16 v[204:207], a[76:79], a[108:111], v[204:207]
    s_addc_u32 s13, s69, 0
    v_mfma_f32_16x16x32_bf16 v[208:211], a[88:91], a[80:83], v[208:211]
    v_mfma_f32_16x16x32_bf16 v[212:215], a[92:95], a[80:83], v[212:215]
    v_mfma_f32_16x16x32_bf16 v[216:219], a[80:83], a[96:99], v[216:219]
    s_add_u32 m0, s48, 32768
    v_mfma_f32_16x16x32_bf16 v[220:223], a[80:83], a[100:103], v[220:223]
    v_mfma_f32_16x16x32_bf16 v[224:227], a[80:83], a[104:107], v[224:227]
    buffer_load_dwordx4 v2, s[8:11], s16 offen offset:0 lds
    v_mfma_f32_16x16x32_bf16 v[228:231], a[80:83], a[108:111], v[228:231]
    v_mfma_f32_16x16x32_bf16 v[232:235], a[88:91], a[84:87], v[232:235]
    buffer_load_dwordx4 v3, s[8:11], s17 offen offset:1024 lds
    v_mfma_f32_16x16x32_bf16 v[236:239], a[92:95], a[84:87], v[236:239]
    v_mfma_f32_16x16x32_bf16 v[240:243], a[84:87], a[96:99], v[240:243]
    buffer_load_dwordx4 v2, s[8:11], s18 offen offset:2048 lds
    v_mfma_f32_16x16x32_bf16 v[244:247], a[84:87], a[100:103], v[244:247]
    v_mfma_f32_16x16x32_bf16 v[248:251], a[84:87], a[104:107], v[248:251]
    v_mfma_f32_16x16x32_bf16 v[252:255], a[84:87], a[108:111], v[252:255]
    s_waitcnt lgkmcnt(15)
    v_mfma_f32_16x16x32_bf16 v[64:67], a[32:35], a[0:3], v[64:67]
    ds_read_b128 a[56:59], v11 offset:0
    v_mfma_f32_16x16x32_bf16 v[68:71], a[36:39], a[0:3], v[68:71]
    ds_read_b64_tr_b16 a[88:89], v17 offset:4096
    buffer_load_dwordx4 v3, s[8:11], s19 offen offset:3072 lds
    s_waitcnt lgkmcnt(15)
    v_mfma_f32_16x16x32_bf16 v[72:75], a[0:3], a[40:43], v[72:75]
    ds_read_b64_tr_b16 a[90:91], v17 offset:4608
    s_waitcnt lgkmcnt(14)
    v_mfma_f32_16x16x32_bf16 v[76:79], a[0:3], a[44:47], v[76:79]
    s_waitcnt lgkmcnt(12)
    v_mfma_f32_16x16x32_bf16 v[80:83], a[0:3], a[48:51], v[80:83]
    ds_read_b64_tr_b16 a[92:93], v18 offset:4096
    s_waitcnt lgkmcnt(11)
    v_mfma_f32_16x16x32_bf16 v[84:87], a[0:3], a[52:55], v[84:87]
    ds_read_b64_tr_b16 a[94:95], v18 offset:4608
    s_add_u32 m0, s48, 36864
    s_waitcnt lgkmcnt(11)
    v_mfma_f32_16x16x32_bf16 v[88:91], a[32:35], a[4:7], v[88:91]
    v_mfma_f32_16x16x32_bf16 v[92:95], a[36:39], a[4:7], v[92:95]
    ds_read_b64_tr_b16 a[96:97], v17 offset:12288
    v_mfma_f32_16x16x32_bf16 v[96:99], a[4:7], a[40:43], v[96:99]
    ds_read_b64_tr_b16 a[98:99], v17 offset:12800
    v_mfma_f32_16x16x32_bf16 v[100:103], a[4:7], a[44:47], v[100:103]
    ds_read_b64_tr_b16 a[100:101], v18 offset:12288
    v_mfma_f32_16x16x32_bf16 v[104:107], a[4:7], a[48:51], v[104:107]
    buffer_load_dwordx4 v2, s[8:11], s20 offen offset:0 lds
    v_mfma_f32_16x16x32_bf16 v[108:111], a[4:7], a[52:55], v[108:111]
    ds_read_b64_tr_b16 a[102:103], v18 offset:12800
    s_waitcnt lgkmcnt(14)
    v_mfma_f32_16x16x32_bf16 v[112:115], a[32:35], a[8:11], v[112:115]
    ds_read_b64_tr_b16 a[104:105], v17 offset:20480
    v_mfma_f32_16x16x32_bf16 v[116:119], a[36:39], a[8:11], v[116:119]
    v_mfma_f32_16x16x32_bf16 v[120:123], a[8:11], a[40:43], v[120:123]
    ds_read_b64_tr_b16 a[106:107], v17 offset:20992
    buffer_load_dwordx4 v3, s[8:11], s21 offen offset:1024 lds
    v_mfma_f32_16x16x32_bf16 v[124:127], a[8:11], a[44:47], v[124:127]
    ds_read_b64_tr_b16 a[108:109], v18 offset:20480
    v_mfma_f32_16x16x32_bf16 v[128:131], a[8:11], a[48:51], v[128:131]
    ds_read_b64_tr_b16 a[110:111], v18 offset:20992
    v_mfma_f32_16x16x32_bf16 v[132:135], a[8:11], a[52:55], v[132:135]
    s_waitcnt lgkmcnt(15)
    v_mfma_f32_16x16x32_bf16 v[136:139], a[32:35], a[12:15], v[136:139]
    ds_read_b128 a[60:63], v11 offset:2048
    v_mfma_f32_16x16x32_bf16 v[140:143], a[36:39], a[12:15], v[140:143]
    ds_read_b128 a[64:67], v11 offset:4096
    buffer_load_dwordx4 v2, s[8:11], s22 offen offset:2048 lds
    v_mfma_f32_16x16x32_bf16 v[144:147], a[12:15], a[40:43], v[144:147]
    v_mfma_f32_16x16x32_bf16 v[148:151], a[12:15], a[44:47], v[148:151]
    ds_read_b128 a[68:71], v11 offset:6144
    v_mfma_f32_16x16x32_bf16 v[152:155], a[12:15], a[48:51], v[152:155]
    ds_read_b128 a[72:75], v11 offset:8192
    v_mfma_f32_16x16x32_bf16 v[156:159], a[12:15], a[52:55], v[156:159]
    ds_read_b128 a[76:79], v11 offset:10240
    v_mfma_f32_16x16x32_bf16 v[160:163], a[32:35], a[16:19], v[160:163]
    buffer_load_dwordx4 v3, s[8:11], s23 offen offset:3072 lds
    v_mfma_f32_16x16x32_bf16 v[164:167], a[36:39], a[16:19], v[164:167]
    ds_read_b128 a[80:83], v11 offset:12288
    v_mfma_f32_16x16x32_bf16 v[168:171], a[16:19], a[40:43], v[168:171]
    ds_read_b128 a[84:87], v11 offset:14336
    v_mfma_f32_16x16x32_bf16 v[172:175], a[16:19], a[44:47], v[172:175]
    v_mfma_f32_16x16x32_bf16 v[176:179], a[16:19], a[48:51], v[176:179]
    s_add_u32 s76, s76, 128
    v_mfma_f32_16x16x32_bf16 v[180:183], a[16:19], a[52:55], v[180:183]
    v_mfma_f32_16x16x32_bf16 v[184:187], a[32:35], a[20:23], v[184:187]
    v_mfma_f32_16x16x32_bf16 v[188:191], a[36:39], a[20:23], v[188:191]
    v_mfma_f32_16x16x32_bf16 v[192:195], a[20:23], a[40:43], v[192:195]
    v_mfma_f32_16x16x32_bf16 v[196:199], a[20:23], a[44:47], v[196:199]
    s_and_b32 s76, s76, 2047
    v_mfma_f32_16x16x32_bf16 v[200:203], a[20:23], a[48:51], v[200:203]
    v_mfma_f32_16x16x32_bf16 v[204:207], a[20:23], a[52:55], v[204:207]
    s_waitcnt lgkmcnt(15)
    v_mfma_f32_16x16x32_bf16 v[208:211], a[32:35], a[24:27], v[208:211]
    v_mfma_f32_16x16x32_bf16 v[212:215], a[36:39], a[24:27], v[212:215]
    s_add_u32 s8, s80, s76
    v_mfma_f32_16x16x32_bf16 v[216:219], a[24:27], a[40:43], v[216:219]
    v_mfma_f32_16x16x32_bf16 v[220:223], a[24:27], a[44:47], v[220:223]
    v_mfma_f32_16x16x32_bf16 v[224:227], a[24:27], a[48:51], v[224:227]
    v_mfma_f32_16x16x32_bf16 v[228:231], a[24:27], a[52:55], v[228:231]
    v_mfma_f32_16x16x32_bf16 v[232:235], a[32:35], a[28:31], v[232:235]
    s_addc_u32 s9, s81, 0
    v_mfma_f32_16x16x32_bf16 v[236:239], a[36:39], a[28:31], v[236:239]
    v_mfma_f32_16x16x32_bf16 v[240:243], a[28:31], a[40:43], v[240:243]
    v_mfma_f32_16x16x32_bf16 v[244:247], a[28:31], a[44:47], v[244:247]
    v_mfma_f32_16x16x32_bf16 v[248:251], a[28:31], a[48:51], v[248:251]
    v_mfma_f32_16x16x32_bf16 v[252:255], a[28:31], a[52:55], v[252:255]
    v_mfma_f32_16x16x32_bf16 v[64:67], a[88:91], a[56:59], v[64:67]
    v_mfma_f32_16x16x32_bf16 v[68:71], a[92:95], a[56:59], v[68:71]
    s_waitcnt lgkmcnt(13)
    v_mfma_f32_16x16x32_bf16 v[72:75], a[56:59], a[96:99], v[72:75]
    s_waitcnt lgkmcnt(11)
    v_mfma_f32_16x16x32_bf16 v[76:79], a[56:59], a[100:103], v[76:79]
    s_waitcnt lgkmcnt(9)
    v_mfma_f32_16x16x32_bf16 v[80:83], a[56:59], a[104:107], v[80:83]
    s_waitcnt lgkmcnt(7)
    v_mfma_f32_16x16x32_bf16 v[84:87], a[56:59], a[108:111], v[84:87]
    s_waitcnt lgkmcnt(6)
    v_mfma_f32_16x16x32_bf16 v[88:91], a[88:91], a[60:63], v[88:91]
    v_mfma_f32_16x16x32_bf16 v[92:95], a[92:95], a[60:63], v[92:95]
    s_waitcnt lgkmcnt(0)
    s_waitcnt vmcnt(8)
    s_barrier
    v_mfma_f32_16x16x32_bf16 v[96:99], a[60:63], a[96:99], v[96:99]
    ds_read_b128 a[0:3], v8 offset:0
    v_mfma_f32_16x16x32_bf16 v[100:103], a[60:63], a[100:103], v[100:103]
    ds_read_b64_tr_b16 a[32:33], v12 offset:0
    s_add_u32 m0, s49, 24576
    v_mfma_f32_16x16x32_bf16 v[104:107], a[60:63], a[104:107], v[104:107]
    ds_read_b64_tr_b16 a[34:35], v12 offset:512
    v_mfma_f32_16x16x32_bf16 v[108:111], a[60:63], a[108:111], v[108:111]
    ds_read_b64_tr_b16 a[36:37], v13 offset:0
    buffer_load_dwordx4 v4, s[12:15], s24 offen offset:0 lds
    v_mfma_f32_16x16x32_bf16 v[112:115], a[88:91], a[64:67], v[112:115]
    ds_read_b64_tr_b16 a[38:39], v13 offset:512
    v_mfma_f32_16x16x32_bf16 v[116:119], a[92:95], a[64:67], v[116:119]
    buffer_load_dwordx4 v5, s[12:15], s25 offen offset:1024 lds
    v_mfma_f32_16x16x32_bf16 v[120:123], a[64:67], a[96:99], v[120:123]
    ds_read_b64_tr_b16 a[40:41], v12 offset:8192
    v_mfma_f32_16x16x32_bf16 v[124:127], a[64:67], a[100:103], v[124:127]
    ds_read_b64_tr_b16 a[42:43], v12 offset:8704
    buffer_load_dwordx4 v4, s[12:15], s26 offen offset:2048 lds
    v_mfma_f32_16x16x32_bf16 v[128:131], a[64:67], a[104:107], v[128:131]
    ds_read_b64_tr_b16 a[44:45], v13 offset:8192
    v_mfma_f32_16x16x32_bf16 v[132:135], a[64:67], a[108:111], v[132:135]
    ds_read_b64_tr_b16 a[46:47], v13 offset:8704
    buffer_load_dwordx4 v5, s[12:15], s27 offen offset:3072 lds
    v_mfma_f32_16x16x32_bf16 v[136:139], a[88:91], a[68:71], v[136:139]
    ds_read_b64_tr_b16 a[48:49], v12 offset:16384
    v_mfma_f32_16x16x32_bf16 v[140:143], a[92:95], a[68:71], v[140:143]
    v_mfma_f32_16x16x32_bf16 v[144:147], a[68:71], a[96:99], v[144:147]
    ds_read_b64_tr_b16 a[50:51], v12 offset:16896
    s_add_u32 m0, s49, 28672
    v_mfma_f32_16x16x32_bf16 v[148:151], a[68:71], a[100:103], v[148:151]
    ds_read_b64_tr_b16 a[52:53], v13 offset:16384
    v_mfma_f32_16x16x32_bf16 v[152:155], a[68:71], a[104:107], v[152:155]
    ds_read_b64_tr_b16 a[54:55], v13 offset:16896
    buffer_load_dwordx4 v4, s[12:15], s28 offen offset:0 lds
    v_mfma_f32_16x16x32_bf16 v[156:159], a[68:71], a[108:111], v[156:159]
    ds_read_b128 a[4:7], v8 offset:2048
    v_mfma_f32_16x16x32_bf16 v[160:163], a[88:91], a[72:75], v[160:163]
    ds_read_b128 a[8:11], v8 offset:4096
    buffer_load_dwordx4 v5, s[12:15], s29 offen offset:1024 lds
    v_mfma_f32_16x16x32_bf16 v[164:167], a[92:95], a[72:75], v[164:167]
    v_mfma_f32_16x16x32_bf16 v[168:171], a[72:75], a[96:99], v[168:171]
    ds_read_b128 a[12:15], v8 offset:6144
    s_add_u32 s77, s77, 393216
    v_mfma_f32_16x16x32_bf16 v[172:175], a[72:75], a[100:103], v[172:175]
    ds_read_b128 a[16:19], v8 offset:8192
    v_mfma_f32_16x16x32_bf16 v[176:179], a[72:75], a[104:107], v[176:179]
    ds_read_b128 a[20:23], v8 offset:10240
    v_mfma_f32_16x16x32_bf16 v[180:183], a[72:75], a[108:111], v[180:183]
    ds_read_b128 a[24:27], v8 offset:12288
    s_cmp_eq_u32 s77, 6291456
    v_mfma_f32_16x16x32_bf16 v[184:187], a[88:91], a[76:79], v[184:187]
    ds_read_b128 a[28:31], v8 offset:14336
    v_mfma_f32_16x16x32_bf16 v[188:191], a[92:95], a[76:79], v[188:191]
    s_cselect_b32 s77, 0, s77
    v_mfma_f32_16x16x32_bf16 v[192:195], a[76:79], a[96:99], v[192:195]
    v_mfma_f32_16x16x32_bf16 v[196:199], a[76:79], a[100:103], v[196:199]
    s_add_u32 s12, s68, s77
    v_mfma_f32_16x16x32_bf16 v[200:203], a[76:79], a[104:107], v[200:203]
    v_mfma_f32_16x16x32_bf16 v[204:207], a[76:79], a[108:111], v[204:207]
    s_addc_u32 s13, s69, 0
    v_mfma_f32_16x16x32_bf16 v[208:211], a[88:91], a[80:83], v[208:211]
    v_mfma_f32_16x16x32_bf16 v[212:215], a[92:95], a[80:83], v[212:215]
    v_mfma_f32_16x16x32_bf16 v[216:219], a[80:83], a[96:99], v[216:219]
    s_add_u32 m0, s48, 65536
    v_mfma_f32_16x16x32_bf16 v[220:223], a[80:83], a[100:103], v[220:223]
    v_mfma_f32_16x16x32_bf16 v[224:227], a[80:83], a[104:107], v[224:227]
    buffer_load_dwordx4 v2, s[8:11], s16 offen offset:0 lds
    v_mfma_f32_16x16x32_bf16 v[228:231], a[80:83], a[108:111], v[228:231]
    v_mfma_f32_16x16x32_bf16 v[232:235], a[88:91], a[84:87], v[232:235]
    buffer_load_dwordx4 v3, s[8:11], s17 offen offset:1024 lds
    v_mfma_f32_16x16x32_bf16 v[236:239], a[92:95], a[84:87], v[236:239]
    v_mfma_f32_16x16x32_bf16 v[240:243], a[84:87], a[96:99], v[240:243]
    buffer_load_dwordx4 v2, s[8:11], s18 offen offset:2048 lds
    v_mfma_f32_16x16x32_bf16 v[244:247], a[84:87], a[100:103], v[244:247]
    v_mfma_f32_16x16x32_bf16 v[248:251], a[84:87], a[104:107], v[248:251]
    v_mfma_f32_16x16x32_bf16 v[252:255], a[84:87], a[108:111], v[252:255]
    s_waitcnt lgkmcnt(15)
    v_mfma_f32_16x16x32_bf16 v[64:67], a[32:35], a[0:3], v[64:67]
    ds_read_b128 a[56:59], v9 offset:0
    v_mfma_f32_16x16x32_bf16 v[68:71], a[36:39], a[0:3], v[68:71]
    ds_read_b64_tr_b16 a[88:89], v12 offset:4096
    buffer_load_dwordx4 v3, s[8:11], s19 offen offset:3072 lds
    s_waitcnt lgkmcnt(15)
    v_mfma_f32_16x16x32_bf16 v[72:75], a[0:3], a[40:43], v[72:75]
    ds_read_b64_tr_b16 a[90:91], v12 offset:4608
    s_waitcnt lgkmcnt(14)
    v_mfma_f32_16x16x32_bf16 v[76:79], a[0:3], a[44:47], v[76:79]
    s_waitcnt lgkmcnt(12)
    v_mfma_f32_16x16x32_bf16 v[80:83], a[0:3], a[48:51], v[80:83]
    ds_read_b64_tr_b16 a[92:93], v13 offset:4096
    s_waitcnt lgkmcnt(11)
    v_mfma_f32_16x16x32_bf16 v[84:87], a[0:3], a[52:55], v[84:87]
    ds_read_b64_tr_b16 a[94:95], v13 offset:4608
    s_add_u32 m0, s48, 69632
    s_waitcnt lgkmcnt(11)
    v_mfma_f32_16x16x32_bf16 v[88:91], a[32:35], a[4:7], v[88:91]
    v_mfma_f32_16x16x32_bf16 v[92:95], a[36:39], a[4:7], v[92:95]
    ds_read_b64_tr_b16 a[96:97], v12 offset:12288
    v_mfma_f32_16x16x32_bf16 v[96:99], a[4:7], a[40:43], v[96:99]
    ds_read_b64_tr_b16 a[98:99], v12 offset:12800
    v_mfma_f32_16x16x32_bf16 v[100:103], a[4:7], a[44:47], v[100:103]
    ds_read_b64_tr_b16 a[100:101], v13 offset:12288
    v_mfma_f32_16x16x32_bf16 v[104:107], a[4:7], a[48:51], v[104:107]
    buffer_load_dwordx4 v2, s[8:11], s20 offen offset:0 lds
    v_mfma_f32_16x16x32_bf16 v[108:111], a[4:7], a[52:55], v[108:111]
    ds_read_b64_tr_b16 a[102:103], v13 offset:12800
    s_waitcnt lgkmcnt(14)
    v_mfma_f32_16x16x32_bf16 v[112:115], a[32:35], a[8:11], v[112:115]
    ds_read_b64_tr_b16 a[104:105], v12 offset:20480
    v_mfma_f32_16x16x32_bf16 v[116:119], a[36:39], a[8:11], v[116:119]
    v_mfma_f32_16x16x32_bf16 v[120:123], a[8:11], a[40:43], v[120:123]
    ds_read_b64_tr_b16 a[106:107], v12 offset:20992
    buffer_load_dwordx4 v3, s[8:11], s21 offen offset:1024 lds
    v_mfma_f32_16x16x32_bf16 v[124:127], a[8:11], a[44:47], v[124:127]
    ds_read_b64_tr_b16 a[108:109], v13 offset:20480
    v_mfma_f32_16x16x32_bf16 v[128:131], a[8:11], a[48:51], v[128:131]
    ds_read_b64_tr_b16 a[110:111], v13 offset:20992
    v_mfma_f32_16x16x32_bf16 v[132:135], a[8:11], a[52:55], v[132:135]
    s_waitcnt lgkmcnt(15)
    v_mfma_f32_16x16x32_bf16 v[136:139], a[32:35], a[12:15], v[136:139]
    ds_read_b128 a[60:63], v9 offset:2048
    v_mfma_f32_16x16x32_bf16 v[140:143], a[36:39], a[12:15], v[140:143]
    ds_read_b128 a[64:67], v9 offset:4096
    buffer_load_dwordx4 v2, s[8:11], s22 offen offset:2048 lds
    v_mfma_f32_16x16x32_bf16 v[144:147], a[12:15], a[40:43], v[144:147]
    v_mfma_f32_16x16x32_bf16 v[148:151], a[12:15], a[44:47], v[148:151]
    ds_read_b128 a[68:71], v9 offset:6144
    v_mfma_f32_16x16x32_bf16 v[152:155], a[12:15], a[48:51], v[152:155]
    ds_read_b128 a[72:75], v9 offset:8192
    v_mfma_f32_16x16x32_bf16 v[156:159], a[12:15], a[52:55], v[156:159]
    ds_read_b128 a[76:79], v9 offset:10240
    v_mfma_f32_16x16x32_bf16 v[160:163], a[32:35], a[16:19], v[160:163]
    buffer_load_dwordx4 v3, s[8:11], s23 offen offset:3072 lds
    v_mfma_f32_16x16x32_bf16 v[164:167], a[36:39], a[16:19], v[164:167]
    ds_read_b128 a[80:83], v9 offset:12288
    v_mfma_f32_16x16x32_bf16 v[168:171], a[16:19], a[40:43], v[168:171]
    ds_read_b128 a[84:87], v9 offset:14336
    v_mfma_f32_16x16x32_bf16 v[172:175], a[16:19], a[44:47], v[172:175]
    v_mfma_f32_16x16x32_bf16 v[176:179], a[16:19], a[48:51], v[176:179]
    s_add_u32 s76, s76, 128
    v_mfma_f32_16x16x32_bf16 v[180:183], a[16:19], a[52:55], v[180:183]
    v_mfma_f32_16x16x32_bf16 v[184:187], a[32:35], a[20:23], v[184:187]
    v_mfma_f32_16x16x32_bf16 v[188:191], a[36:39], a[20:23], v[188:191]
    v_mfma_f32_16x16x32_bf16 v[192:195], a[20:23], a[40:43], v[192:195]
    v_mfma_f32_16x16x32_bf16 v[196:199], a[20:23], a[44:47], v[196:199]
    s_and_b32 s76, s76, 2047
    v_mfma_f32_16x16x32_bf16 v[200:203], a[20:23], a[48:51], v[200:203]
    v_mfma_f32_16x16x32_bf16 v[204:207], a[20:23], a[52:55], v[204:207]
    s_waitcnt lgkmcnt(15)
    v_mfma_f32_16x16x32_bf16 v[208:211], a[32:35], a[24:27], v[208:211]
    v_mfma_f32_16x16x32_bf16 v[212:215], a[36:39], a[24:27], v[212:215]
    s_add_u32 s8, s80, s76
    v_mfma_f32_16x16x32_bf16 v[216:219], a[24:27], a[40:43], v[216:219]
    v_mfma_f32_16x16x32_bf16 v[220:223], a[24:27], a[44:47], v[220:223]
    v_mfma_f32_16x16x32_bf16 v[224:227], a[24:27], a[48:51], v[224:227]
    v_mfma_f32_16x16x32_bf16 v[228:231], a[24:27], a[52:55], v[228:231]
    v_mfma_f32_16x16x32_bf16 v[232:235], a[32:35], a[28:31], v[232:235]
    s_addc_u32 s9, s81, 0
    v_mfma_f32_16x16x32_bf16 v[236:239], a[36:39], a[28:31], v[236:239]
    v_mfma_f32_16x16x32_bf16 v[240:243], a[28:31], a[40:43], v[240:243]
    v_mfma_f32_16x16x32_bf16 v[244:247], a[28:31], a[44:47], v[244:247]
    v_mfma_f32_16x16x32_bf16 v[248:251], a[28:31], a[48:51], v[248:251]
    v_mfma_f32_16x16x32_bf16 v[252:255], a[28:31], a[52:55], v[252:255]
    v_mfma_f32_16x16x32_bf16 v[64:67], a[88:91], a[56:59], v[64:67]
    v_mfma_f32_16x16x32_bf16 v[68:71], a[92:95], a[56:59], v[68:71]
    s_waitcnt lgkmcnt(13)
    v_mfma_f32_16x16x32_bf16 v[72:75], a[56:59], a[96:99], v[72:75]
    s_waitcnt lgkmcnt(11)
    v_mfma_f32_16x16x32_bf16 v[76:79], a[56:59], a[100:103], v[76:79]
    s_waitcnt lgkmcnt(9)
    v_mfma_f32_16x16x32_bf16 v[80:83], a[56:59], a[104:107], v[80:83]
    s_waitcnt lgkmcnt(7)
    v_mfma_f32_16x16x32_bf16 v[84:87], a[56:59], a[108:111], v[84:87]
    s_waitcnt lgkmcnt(6)
    v_mfma_f32_16x16x32_bf16 v[88:91], a[88:91], a[60:63], v[88:91]
    v_mfma_f32_16x16x32_bf16 v[92:95], a[92:95], a[60:63], v[92:95]
    s_waitcnt lgkmcnt(0)
    s_waitcnt vmcnt(8)
    s_barrier
    v_mfma_f32_16x16x32_bf16 v[96:99], a[60:63], a[96:99], v[96:99]
    ds_read_b128 a[0:3], v8 offset:32768
    v_mfma_f32_16x16x32_bf16 v[100:103], a[60:63], a[100:103], v[100:103]
    ds_read_b64_tr_b16 a[32:33], v17 offset:0
    s_add_u32 m0, s49, 0
    v_mfma_f32_16x16x32_bf16 v[104:107], a[60:63], a[104:107], v[104:107]
    ds_read_b64_tr_b16 a[34:35], v17 offset:512
    v_mfma_f32_16x16x32_bf16 v[108:111], a[60:63], a[108:111], v[108:111]
    ds_read_b64_tr_b16 a[36:37], v18 offset:0
    buffer_load_dwordx4 v4, s[12:15], s24 offen offset:0 lds
    v_mfma_f32_16x16x32_bf16 v[112:115], a[88:91], a[64:67], v[112:115]
    ds_read_b64_tr_b16 a[38:39], v18 offset:512
    v_mfma_f32_16x16x32_bf16 v[116:119], a[92:95], a[64:67], v[116:119]
    buffer_load_dwordx4 v5, s[12:15], s25 offen offset:1024 lds
    v_mfma_f32_16x16x32_bf16 v[120:123], a[64:67], a[96:99], v[120:123]
    ds_read_b64_tr_b16 a[40:41], v17 offset:8192
    v_mfma_f32_16x16x32_bf16 v[124:127], a[64:67], a[100:103], v[124:127]
    ds_read_b64_tr_b16 a[42:43], v17 offset:8704
    buffer_load_dwordx4 v4, s[12:15], s26 offen offset:2048 lds
    v_mfma_f32_16x16x32_bf16 v[128:131], a[64:67], a[104:107], v[128:131]
    ds_read_b64_tr_b16 a[44:45], v18 offset:8192
    v_mfma_f32_16x16x32_bf16 v[132:135], a[64:67], a[108:111], v[132:135]
    ds_read_b64_tr_b16 a[46:47], v18 offset:8704
    buffer_load_dwordx4 v5, s[12:15], s27 offen offset:3072 lds
    v_mfma_f32_16x16x32_bf16 v[136:139], a[88:91], a[68:71], v[136:139]
    ds_read_b64_tr_b16 a[48:49], v17 offset:16384
    v_mfma_f32_16x16x32_bf16 v[140:143], a[92:95], a[68:71], v[140:143]
    v_mfma_f32_16x16x32_bf16 v[144:147], a[68:71], a[96:99], v[144:147]
    ds_read_b64_tr_b16 a[50:51], v17 offset:16896
    s_add_u32 m0, s49, 4096
    v_mfma_f32_16x16x32_bf16 v[148:151], a[68:71], a[100:103], v[148:151]
    ds_read_b64_tr_b16 a[52:53], v18 offset:16384
    v_mfma_f32_16x16x32_bf16 v[152:155], a[68:71], a[104:107], v[152:155]
    ds_read_b64_tr_b16 a[54:55], v18 offset:16896
    buffer_load_dwordx4 v4, s[12:15], s28 offen offset:0 lds
    v_mfma_f32_16x16x32_bf16 v[156:159], a[68:71], a[108:111], v[156:159]
    ds_read_b128 a[4:7], v8 offset:34816
    v_mfma_f32_16x16x32_bf16 v[160:163], a[88:91], a[72:75], v[160:163]
    ds_read_b128 a[8:11], v8 offset:36864
    buffer_load_dwordx4 v5, s[12:15], s29 offen offset:1024 lds
    v_mfma_f32_16x16x32_bf16 v[164:167], a[92:95], a[72:75], v[164:167]
    v_mfma_f32_16x16x32_bf16 v[168:171], a[72:75], a[96:99], v[168:171]
    ds_read_b128 a[12:15], v8 offset:38912
    s_add_u32 s77, s77, 393216
    v_mfma_f32_16x16x32_bf16 v[172:175], a[72:75], a[100:103], v[172:175]
    ds_read_b128 a[16:19], v8 offset:40960
    v_mfma_f32_16x16x32_bf16 v[176:179], a[72:75], a[104:107], v[176:179]
    ds_read_b128 a[20:23], v8 offset:43008
    v_mfma_f32_16x16x32_bf16 v[180:183], a[72:75], a[108:111], v[180:183]
    ds_read_b128 a[24:27], v8 offset:45056
    s_cmp_eq_u32 s77, 6291456
    v_mfma_f32_16x16x32_bf16 v[184:187], a[88:91], a[76:79], v[184:187]
    ds_read_b128 a[28:31], v8 offset:47104
    v_mfma_f32_16x16x32_bf16 v[188:191], a[92:95], a[76:79], v[188:191]
    s_cselect_b32 s77, 0, s77
    v_mfma_f32_16x16x32_bf16 v[192:195], a[76:79], a[96:99], v[192:195]
    v_mfma_f32_16x16x32_bf16 v[196:199], a[76:79], a[100:103], v[196:199]
    s_add_u32 s12, s68, s77
    v_mfma_f32_16x16x32_bf16 v[200:203], a[76:79], a[104:107], v[200:203]
    v_mfma_f32_16x16x32_bf16 v[204:207], a[76:79], a[108:111], v[204:207]
    s_addc_u32 s13, s69, 0
    v_mfma_f32_16x16x32_bf16 v[208:211], a[88:91], a[80:83], v[208:211]
    v_mfma_f32_16x16x32_bf16 v[212:215], a[92:95], a[80:83], v[212:215]
    v_mfma_f32_16x16x32_bf16 v[216:219], a[80:83], a[96:99], v[216:219]
    s_add_u32 m0, s48, 0
    v_mfma_f32_16x16x32_bf16 v[220:223], a[80:83], a[100:103], v[220:223]
    v_mfma_f32_16x16x32_bf16 v[224:227], a[80:83], a[104:107], v[224:227]
    buffer_load_dwordx4 v2, s[8:11], s16 offen offset:0 lds
    v_mfma_f32_16x16x32_bf16 v[228:231], a[80:83], a[108:111], v[228:231]
    v_mfma_f32_16x16x32_bf16 v[232:235], a[88:91], a[84:87], v[232:235]
    buffer_load_dwordx4 v3, s[8:11], s17 offen offset:1024 lds
    v_mfma_f32_16x16x32_bf16 v[236:239], a[92:95], a[84:87], v[236:239]
    v_mfma_f32_16x16x32_bf16 v[240:243], a[84:87], a[96:99], v[240:243]
    buffer_load_dwordx4 v2, s[8:11], s18 offen offset:2048 lds
    v_mfma_f32_16x16x32_bf16 v[244:247], a[84:87], a[100:103], v[244:247]
    v_mfma_f32_16x16x32_bf16 v[248:251], a[84:87], a[104:107], v[248:251]
    v_mfma_f32_16x16x32_bf16 v[252:255], a[84:87], a[108:111], v[252:255]
    s_waitcnt lgkmcnt(15)
    v_mfma_f32_16x16x32_bf16 v[64:67], a[32:35], a[0:3], v[64:67]
    ds_read_b128 a[56:59], v9 offset:32768
    v_mfma_f32_16x16x32_bf16 v[68:71], a[36:39], a[0:3], v[68:71]
    ds_read_b64_tr_b16 a[88:89], v17 offset:4096
    buffer_load_dwordx4 v3, s[8:11], s19 offen offset:3072 lds
    s_waitcnt lgkmcnt(15)
    v_mfma_f32_16x16x32_bf16 v[72:75], a[0:3], a[40:43], v[72:75]
    ds_read_b64_tr_b16 a[90:91], v17 offset:4608
    s_waitcnt lgkmcnt(14)
    v_mfma_f32_16x16x32_bf16 v[76:79], a[0:3], a[44:47], v[76:79]
    s_waitcnt lgkmcnt(12)
    v_mfma_f32_16x16x32_bf16 v[80:83], a[0:3], a[48:51], v[80:83]
    ds_read_b64_tr_b16 a[92:93], v18 offset:4096
    s_waitcnt lgkmcnt(11)
    v_mfma_f32_16x16x32_bf16 v[84:87], a[0:3], a[52:55], v[84:87]
    ds_read_b64_tr_b16 a[94:95], v18 offset:4608
    s_add_u32 m0, s48, 4096
    s_waitcnt lgkmcnt(11)
    v_mfma_f32_16x16x32_bf16 v[88:91], a[32:35], a[4:7], v[88:91]
    v_mfma_f32_16x16x32_bf16 v[92:95], a[36:39], a[4:7], v[92:95]
    ds_read_b64_tr_b16 a[96:97], v17 offset:12288
    v_mfma_f32_16x16x32_bf16 v[96:99], a[4:7], a[40:43], v[96:99]
    ds_read_b64_tr_b16 a[98:99], v17 offset:12800
    v_mfma_f32_16x16x32_bf16 v[100:103], a[4:7], a[44:47], v[100:103]
    ds_read_b64_tr_b16 a[100:101], v18 offset:12288
    v_mfma_f32_16x16x32_bf16 v[104:107], a[4:7], a[48:51], v[104:107]
    buffer_load_dwordx4 v2, s[8:11], s20 offen offset:0 lds
    v_mfma_f32_16x16x32_bf16 v[108:111], a[4:7], a[52:55], v[108:111]
    ds_read_b64_tr_b16 a[102:103], v18 offset:12800
    s_waitcnt lgkmcnt(14)
    v_mfma_f32_16x16x32_bf16 v[112:115], a[32:35], a[8:11], v[112:115]
    ds_read_b64_tr_b16 a[104:105], v17 offset:20480
    v_mfma_f32_16x16x32_bf16 v[116:119], a[36:39], a[8:11], v[116:119]
    v_mfma_f32_16x16x32_bf16 v[120:123], a[8:11], a[40:43], v[120:123]
    ds_read_b64_tr_b16 a[106:107], v17 offset:20992
    buffer_load_dwordx4 v3, s[8:11], s21 offen offset:1024 lds
    v_mfma_f32_16x16x32_bf16 v[124:127], a[8:11], a[44:47], v[124:127]
    ds_read_b64_tr_b16 a[108:109], v18 offset:20480
    v_mfma_f32_16x16x32_bf16 v[128:131], a[8:11], a[48:51], v[128:131]
    ds_read_b64_tr_b16 a[110:111], v18 offset:20992
    v_mfma_f32_16x16x32_bf16 v[132:135], a[8:11], a[52:55], v[132:135]
    s_waitcnt lgkmcnt(15)
    v_mfma_f32_16x16x32_bf16 v[136:139], a[32:35], a[12:15], v[136:139]
    ds_read_b128 a[60:63], v9 offset:34816
    v_mfma_f32_16x16x32_bf16 v[140:143], a[36:39], a[12:15], v[140:143]
    ds_read_b128 a[64:67], v9 offset:36864
    buffer_load_dwordx4 v2, s[8:11], s22 offen offset:2048 lds
    v_mfma_f32_16x16x32_bf16 v[144:147], a[12:15], a[40:43], v[144:147]
    v_mfma_f32_16x16x32_bf16 v[148:151], a[12:15], a[44:47], v[148:151]
    ds_read_b128 a[68:71], v9 offset:38912
    v_mfma_f32_16x16x32_bf16 v[152:155], a[12:15], a[48:51], v[152:155]
    ds_read_b128 a[72:75], v9 offset:40960
    v_mfma_f32_16x16x32_bf16 v[156:159], a[12:15], a[52:55], v[156:159]
    ds_read_b128 a[76:79], v9 offset:43008
    v_mfma_f32_16x16x32_bf16 v[160:163], a[32:35], a[16:19], v[160:163]
    buffer_load_dwordx4 v3, s[8:11], s23 offen offset:3072 lds
    v_mfma_f32_16x16x32_bf16 v[164:167], a[36:39], a[16:19], v[164:167]
    ds_read_b128 a[80:83], v9 offset:45056
    v_mfma_f32_16x16x32_bf16 v[168:171], a[16:19], a[40:43], v[168:171]
    ds_read_b128 a[84:87], v9 offset:47104
    v_mfma_f32_16x16x32_bf16 v[172:175], a[16:19], a[44:47], v[172:175]
    v_mfma_f32_16x16x32_bf16 v[176:179], a[16:19], a[48:51], v[176:179]
    s_add_u32 s76, s76, 128
    v_mfma_f32_16x16x32_bf16 v[180:183], a[16:19], a[52:55], v[180:183]
    v_mfma_f32_16x16x32_bf16 v[184:187], a[32:35], a[20:23], v[184:187]
    v_mfma_f32_16x16x32_bf16 v[188:191], a[36:39], a[20:23], v[188:191]
    v_mfma_f32_16x16x32_bf16 v[192:195], a[20:23], a[40:43], v[192:195]
    v_mfma_f32_16x16x32_bf16 v[196:199], a[20:23], a[44:47], v[196:199]
    s_and_b32 s76, s76, 2047
    v_mfma_f32_16x16x32_bf16 v[200:203], a[20:23], a[48:51], v[200:203]
    v_mfma_f32_16x16x32_bf16 v[204:207], a[20:23], a[52:55], v[204:207]
    s_waitcnt lgkmcnt(15)
    v_mfma_f32_16x16x32_bf16 v[208:211], a[32:35], a[24:27], v[208:211]
    v_mfma_f32_16x16x32_bf16 v[212:215], a[36:39], a[24:27], v[212:215]
    s_add_u32 s8, s80, s76
    v_mfma_f32_16x16x32_bf16 v[216:219], a[24:27], a[40:43], v[216:219]
    v_mfma_f32_16x16x32_bf16 v[220:223], a[24:27], a[44:47], v[220:223]
    v_mfma_f32_16x16x32_bf16 v[224:227], a[24:27], a[48:51], v[224:227]
    v_mfma_f32_16x16x32_bf16 v[228:231], a[24:27], a[52:55], v[228:231]
    v_mfma_f32_16x16x32_bf16 v[232:235], a[32:35], a[28:31], v[232:235]
    s_addc_u32 s9, s81, 0
    v_mfma_f32_16x16x32_bf16 v[236:239], a[36:39], a[28:31], v[236:239]
    v_mfma_f32_16x16x32_bf16 v[240:243], a[28:31], a[40:43], v[240:243]
    v_mfma_f32_16x16x32_bf16 v[244:247], a[28:31], a[44:47], v[244:247]
    v_mfma_f32_16x16x32_bf16 v[248:251], a[28:31], a[48:51], v[248:251]
    v_mfma_f32_16x16x32_bf16 v[252:255], a[28:31], a[52:55], v[252:255]
    v_mfma_f32_16x16x32_bf16 v[64:67], a[88:91], a[56:59], v[64:67]
    v_mfma_f32_16x16x32_bf16 v[68:71], a[92:95], a[56:59], v[68:71]
    s_waitcnt lgkmcnt(13)
    v_mfma_f32_16x16x32_bf16 v[72:75], a[56:59], a[96:99], v[72:75]
    s_waitcnt lgkmcnt(11)
    v_mfma_f32_16x16x32_bf16 v[76:79], a[56:59], a[100:103], v[76:79]
    s_waitcnt lgkmcnt(9)
    v_mfma_f32_16x16x32_bf16 v[80:83], a[56:59], a[104:107], v[80:83]
    s_waitcnt lgkmcnt(7)
    v_mfma_f32_16x16x32_bf16 v[84:87], a[56:59], a[108:111], v[84:87]
    s_waitcnt lgkmcnt(6)
    v_mfma_f32_16x16x32_bf16 v[88:91], a[88:91], a[60:63], v[88:91]
    v_mfma_f32_16x16x32_bf16 v[92:95], a[92:95], a[60:63], v[92:95]
    s_waitcnt lgkmcnt(0)
    s_waitcnt vmcnt(8)
    s_barrier
    v_mfma_f32_16x16x32_bf16 v[96:99], a[60:63], a[96:99], v[96:99]
    ds_read_b128 a[0:3], v10 offset:0
    v_mfma_f32_16x16x32_bf16 v[100:103], a[60:63], a[100:103], v[100:103]
    ds_read_b64_tr_b16 a[32:33], v12 offset:0
    s_add_u32 m0, s49, 24576
    v_mfma_f32_16x16x32_bf16 v[104:107], a[60:63], a[104:107], v[104:107]
    ds_read_b64_tr_b16 a[34:35], v12 offset:512
    v_mfma_f32_16x16x32_bf16 v[108:111], a[60:63], a[108:111], v[108:111]
    ds_read_b64_tr_b16 a[36:37], v13 offset:0
    buffer_load_dwordx4 v4, s[12:15], s24 offen offset:0 lds
    v_mfma_f32_16x16x32_bf16 v[112:115], a[88:91], a[64:67], v[112:115]
    ds_read_b64_tr_b16 a[38:39], v13 offset:512
    v_mfma_f32_16x16x32_bf16 v[116:119], a[92:95], a[64:67], v[116:119]
    buffer_load_dwordx4 v5, s[12:15], s25 offen offset:1024 lds
    v_mfma_f32_16x16x32_bf16 v[120:123], a[64:67], a[96:99], v[120:123]
    ds_read_b64_tr_b16 a[40:41], v12 offset:8192
    v_mfma_f32_16x16x32_bf16 v[124:127], a[64:67], a[100:103], v[124:127]
    ds_read_b64_tr_b16 a[42:43], v12 offset:8704
    buffer_load_dwordx4 v4, s[12:15], s26 offen offset:2048 lds
    v_mfma_f32_16x16x32_bf16 v[128:131], a[64:67], a[104:107], v[128:131]
    ds_read_b64_tr_b16 a[44:45], v13 offset:8192
    v_mfma_f32_16x16x32_bf16 v[132:135], a[64:67], a[108:111], v[132:135]
    ds_read_b64_tr_b16 a[46:47], v13 offset:8704
    buffer_load_dwordx4 v5, s[12:15], s27 offen offset:3072 lds
    v_mfma_f32_16x16x32_bf16 v[136:139], a[88:91], a[68:71], v[136:139]
    ds_read_b64_tr_b16 a[48:49], v12 offset:16384
    v_mfma_f32_16x16x32_bf16 v[140:143], a[92:95], a[68:71], v[140:143]
    v_mfma_f32_16x16x32_bf16 v[144:147], a[68:71], a[96:99], v[144:147]
    ds_read_b64_tr_b16 a[50:51], v12 offset:16896
    s_add_u32 m0, s49, 28672
    v_mfma_f32_16x16x32_bf16 v[148:151], a[68:71], a[100:103], v[148:151]
    ds_read_b64_tr_b16 a[52:53], v13 offset:16384
    v_mfma_f32_16x16x32_bf16 v[152:155], a[68:71], a[104:107], v[152:155]
    ds_read_b64_tr_b16 a[54:55], v13 offset:16896
    buffer_load_dwordx4 v4, s[12:15], s28 offen offset:0 lds
    v_mfma_f32_16x16x32_bf16 v[156:159], a[68:71], a[108:111], v[156:159]
    ds_read_b128 a[4:7], v10 offset:2048
    v_mfma_f32_16x16x32_bf16 v[160:163], a[88:91], a[72:75], v[160:163]
    ds_read_b128 a[8:11], v10 offset:4096
    buffer_load_dwordx4 v5, s[12:15], s29 offen offset:1024 lds
    v_mfma_f32_16x16x32_bf16 v[164:167], a[92:95], a[72:75], v[164:167]
    v_mfma_f32_16x16x32_bf16 v[168:171], a[72:75], a[96:99], v[168:171]
    ds_read_b128 a[12:15], v10 offset:6144
    s_add_u32 s77, s77, 393216
    v_mfma_f32_16x16x32_bf16 v[172:175], a[72:75], a[100:103], v[172:175]
    ds_read_b128 a[16:19], v10 offset:8192
    v_mfma_f32_16x16x32_bf16 v[176:179], a[72:75], a[104:107], v[176:179]
    ds_read_b128 a[20:23], v10 offset:10240
    v_mfma_f32_16x16x32_bf16 v[180:183], a[72:75], a[108:111], v[180:183]
    ds_read_b128 a[24:27], v10 offset:12288
    s_cmp_eq_u32 s77, 6291456
    v_mfma_f32_16x16x32_bf16 v[184:187], a[88:91], a[76:79], v[184:187]
    ds_read_b128 a[28:31], v10 offset:14336
    v_mfma_f32_16x16x32_bf16 v[188:191], a[92:95], a[76:79], v[188:191]
    s_cselect_b32 s77, 0, s77
    v_mfma_f32_16x16x32_bf16 v[192:195], a[76:79], a[96:99], v[192:195]
    v_mfma_f32_16x16x32_bf16 v[196:199], a[76:79], a[100:103], v[196:199]
    s_add_u32 s12, s68, s77
    v_mfma_f32_16x16x32_bf16 v[200:203], a[76:79], a[104:107], v[200:203]
    v_mfma_f32_16x16x32_bf16 v[204:207], a[76:79], a[108:111], v[204:207]
    s_addc_u32 s13, s69, 0
    v_mfma_f32_16x16x32_bf16 v[208:211], a[88:91], a[80:83], v[208:211]
    v_mfma_f32_16x16x32_bf16 v[212:215], a[92:95], a[80:83], v[212:215]
    v_mfma_f32_16x16x32_bf16 v[216:219], a[80:83], a[96:99], v[216:219]
    s_add_u32 m0, s48, 32768
    v_mfma_f32_16x16x32_bf16 v[220:223], a[80:83], a[100:103], v[220:223]
    v_mfma_f32_16x16x32_bf16 v[224:227], a[80:83], a[104:107], v[224:227]
    buffer_load_dwordx4 v2, s[8:11], s16 offen offset:0 lds
    v_mfma_f32_16x16x32_bf16 v[228:231], a[80:83], a[108:111], v[228:231]
    v_mfma_f32_16x16x32_bf16 v[232:235], a[88:91], a[84:87], v[232:235]
    buffer_load_dwordx4 v3, s[8:11], s17 offen offset:1024 lds
    v_mfma_f32_16x16x32_bf16 v[236:239], a[92:95], a[84:87], v[236:239]
    v_mfma_f32_16x16x32_bf16 v[240:243], a[84:87], a[96:99], v[240:243]
    buffer_load_dwordx4 v2, s[8:11], s18 offen offset:2048 lds
    v_mfma_f32_16x16x32_bf16 v[244:247], a[84:87], a[100:103], v[244:247]
    v_mfma_f32_16x16x32_bf16 v[248:251], a[84:87], a[104:107], v[248:251]
    v_mfma_f32_16x16x32_bf16 v[252:255], a[84:87], a[108:111], v[252:255]
    s_waitcnt lgkmcnt(15)
    v_mfma_f32_16x16x32_bf16 v[64:67], a[32:35], a[0:3], v[64:67]
    ds_read_b128 a[56:59], v11 offset:0
    v_mfma_f32_16x16x32_bf16 v[68:71], a[36:39], a[0:3], v[68:71]
    ds_read_b64_tr_b16 a[88:89], v12 offset:4096
    buffer_load_dwordx4 v3, s[8:11], s19 offen offset:3072 lds
    s_waitcnt lgkmcnt(15)
    v_mfma_f32_16x16x32_bf16 v[72:75], a[0:3], a[40:43], v[72:75]
    ds_read_b64_tr_b16 a[90:91], v12 offset:4608
    s_waitcnt lgkmcnt(14)
    v_mfma_f32_16x16x32_bf16 v[76:79], a[0:3], a[44:47], v[76:79]
    s_waitcnt lgkmcnt(12)
    v_mfma_f32_16x16x32_bf16 v[80:83], a[0:3], a[48:51], v[80:83]
    ds_read_b64_tr_b16 a[92:93], v13 offset:4096
    s_waitcnt lgkmcnt(11)
    v_mfma_f32_16x16x32_bf16 v[84:87], a[0:3], a[52:55], v[84:87]
    ds_read_b64_tr_b16 a[94:95], v13 offset:4608
    s_add_u32 m0, s48, 36864
    s_waitcnt lgkmcnt(11)
    v_mfma_f32_16x16x32_bf16 v[88:91], a[32:35], a[4:7], v[88:91]
    v_mfma_f32_16x16x32_bf16 v[92:95], a[36:39], a[4:7], v[92:95]
    ds_read_b64_tr_b16 a[96:97], v12 offset:12288
    v_mfma_f32_16x16x32_bf16 v[96:99], a[4:7], a[40:43], v[96:99]
    ds_read_b64_tr_b16 a[98:99], v12 offset:12800
    v_mfma_f32_16x16x32_bf16 v[100:103], a[4:7], a[44:47], v[100:103]
    ds_read_b64_tr_b16 a[100:101], v13 offset:12288
    v_mfma_f32_16x16x32_bf16 v[104:107], a[4:7], a[48:51], v[104:107]
    buffer_load_dwordx4 v2, s[8:11], s20 offen offset:0 lds
    v_mfma_f32_16x16x32_bf16 v[108:111], a[4:7], a[52:55], v[108:111]
    ds_read_b64_tr_b16 a[102:103], v13 offset:12800
    s_waitcnt lgkmcnt(14)
    v_mfma_f32_16x16x32_bf16 v[112:115], a[32:35], a[8:11], v[112:115]
    ds_read_b64_tr_b16 a[104:105], v12 offset:20480
    v_mfma_f32_16x16x32_bf16 v[116:119], a[36:39], a[8:11], v[116:119]
    v_mfma_f32_16x16x32_bf16 v[120:123], a[8:11], a[40:43], v[120:123]
    ds_read_b64_tr_b16 a[106:107], v12 offset:20992
    buffer_load_dwordx4 v3, s[8:11], s21 offen offset:1024 lds
    v_mfma_f32_16x16x32_bf16 v[124:127], a[8:11], a[44:47], v[124:127]
    ds_read_b64_tr_b16 a[108:109], v13 offset:20480
    v_mfma_f32_16x16x32_bf16 v[128:131], a[8:11], a[48:51], v[128:131]
    ds_read_b64_tr_b16 a[110:111], v13 offset:20992
    v_mfma_f32_16x16x32_bf16 v[132:135], a[8:11], a[52:55], v[132:135]
    s_waitcnt lgkmcnt(15)
    v_mfma_f32_16x16x32_bf16 v[136:139], a[32:35], a[12:15], v[136:139]
    ds_read_b128 a[60:63], v11 offset:2048
    v_mfma_f32_16x16x32_bf16 v[140:143], a[36:39], a[12:15], v[140:143]
    ds_read_b128 a[64:67], v11 offset:4096
    buffer_load_dwordx4 v2, s[8:11], s22 offen offset:2048 lds
    v_mfma_f32_16x16x32_bf16 v[144:147], a[12:15], a[40:43], v[144:147]
    v_mfma_f32_16x16x32_bf16 v[148:151], a[12:15], a[44:47], v[148:151]
    ds_read_b128 a[68:71], v11 offset:6144
    v_mfma_f32_16x16x32_bf16 v[152:155], a[12:15], a[48:51], v[152:155]
    ds_read_b128 a[72:75], v11 offset:8192
    v_mfma_f32_16x16x32_bf16 v[156:159], a[12:15], a[52:55], v[156:159]
    ds_read_b128 a[76:79], v11 offset:10240
    v_mfma_f32_16x16x32_bf16 v[160:163], a[32:35], a[16:19], v[160:163]
    buffer_load_dwordx4 v3, s[8:11], s23 offen offset:3072 lds
    v_mfma_f32_16x16x32_bf16 v[164:167], a[36:39], a[16:19], v[164:167]
    ds_read_b128 a[80:83], v11 offset:12288
    v_mfma_f32_16x16x32_bf16 v[168:171], a[16:19], a[40:43], v[168:171]
    ds_read_b128 a[84:87], v11 offset:14336
    v_mfma_f32_16x16x32_bf16 v[172:175], a[16:19], a[44:47], v[172:175]
    v_mfma_f32_16x16x32_bf16 v[176:179], a[16:19], a[48:51], v[176:179]
    s_add_u32 s76, s76, 128
    v_mfma_f32_16x16x32_bf16 v[180:183], a[16:19], a[52:55], v[180:183]
    v_mfma_f32_16x16x32_bf16 v[184:187], a[32:35], a[20:23], v[184:187]
    v_mfma_f32_16x16x32_bf16 v[188:191], a[36:39], a[20:23], v[188:191]
    v_mfma_f32_16x16x32_bf16 v[192:195], a[20:23], a[40:43], v[192:195]
    v_mfma_f32_16x16x32_bf16 v[196:199], a[20:23], a[44:47], v[196:199]
    s_and_b32 s76, s76, 2047
    v_mfma_f32_16x16x32_bf16 v[200:203], a[20:23], a[48:51], v[200:203]
    v_mfma_f32_16x16x32_bf16 v[204:207], a[20:23], a[52:55], v[204:207]
    s_waitcnt lgkmcnt(15)
    v_mfma_f32_16x16x32_bf16 v[208:211], a[32:35], a[24:27], v[208:211]
    v_mfma_f32_16x16x32_bf16 v[212:215], a[36:39], a[24:27], v[212:215]
    s_add_u32 s8, s80, s76
    v_mfma_f32_16x16x32_bf16 v[216:219], a[24:27], a[40:43], v[216:219]
    v_mfma_f32_16x16x32_bf16 v[220:223], a[24:27], a[44:47], v[220:223]
    v_mfma_f32_16x16x32_bf16 v[224:227], a[24:27], a[48:51], v[224:227]
    v_mfma_f32_16x16x32_bf16 v[228:231], a[24:27], a[52:55], v[228:231]
    v_mfma_f32_16x16x32_bf16 v[232:235], a[32:35], a[28:31], v[232:235]
    s_addc_u32 s9, s81, 0
    v_mfma_f32_16x16x32_bf16 v[236:239], a[36:39], a[28:31], v[236:239]
    v_mfma_f32_16x16x32_bf16 v[240:243], a[28:31], a[40:43], v[240:243]
    v_mfma_f32_16x16x32_bf16 v[244:247], a[28:31], a[44:47], v[244:247]
    v_mfma_f32_16x16x32_bf16 v[248:251], a[28:31], a[48:51], v[248:251]
    v_mfma_f32_16x16x32_bf16 v[252:255], a[28:31], a[52:55], v[252:255]
    v_mfma_f32_16x16x32_bf16 v[64:67], a[88:91], a[56:59], v[64:67]
    v_mfma_f32_16x16x32_bf16 v[68:71], a[92:95], a[56:59], v[68:71]
    s_waitcnt lgkmcnt(13)
    v_mfma_f32_16x16x32_bf16 v[72:75], a[56:59], a[96:99], v[72:75]
    s_waitcnt lgkmcnt(11)
    v_mfma_f32_16x16x32_bf16 v[76:79], a[56:59], a[100:103], v[76:79]
    s_waitcnt lgkmcnt(9)
    v_mfma_f32_16x16x32_bf16 v[80:83], a[56:59], a[104:107], v[80:83]
    s_waitcnt lgkmcnt(7)
    v_mfma_f32_16x16x32_bf16 v[84:87], a[56:59], a[108:111], v[84:87]
    s_waitcnt lgkmcnt(6)
    v_mfma_f32_16x16x32_bf16 v[88:91], a[88:91], a[60:63], v[88:91]
    v_mfma_f32_16x16x32_bf16 v[92:95], a[92:95], a[60:63], v[92:95]
    s_waitcnt lgkmcnt(0)
    s_waitcnt vmcnt(8)
    s_barrier
    v_mfma_f32_16x16x32_bf16 v[96:99], a[60:63], a[96:99], v[96:99]
    ds_read_b128 a[0:3], v8 offset:0
    v_mfma_f32_16x16x32_bf16 v[100:103], a[60:63], a[100:103], v[100:103]
    ds_read_b64_tr_b16 a[32:33], v17 offset:0
    s_add_u32 m0, s49, 0
    v_mfma_f32_16x16x32_bf16 v[104:107], a[60:63], a[104:107], v[104:107]
    ds_read_b64_tr_b16 a[34:35], v17 offset:512
    v_mfma_f32_16x16x32_bf16 v[108:111], a[60:63], a[108:111], v[108:111]
    ds_read_b64_tr_b16 a[36:37], v18 offset:0
    buffer_load_dwordx4 v4, s[12:15], s24 offen offset:0 lds
    v_mfma_f32_16x16x32_bf16 v[112:115], a[88:91], a[64:67], v[112:115]
    ds_read_b64_tr_b16 a[38:39], v18 offset:512
    v_mfma_f32_16x16x32_bf16 v[116:119], a[92:95], a[64:67], v[116:119]
    buffer_load_dwordx4 v5, s[12:15], s25 offen offset:1024 lds
    v_mfma_f32_16x16x32_bf16 v[120:123], a[64:67], a[96:99], v[120:123]
    ds_read_b64_tr_b16 a[40:41], v17 offset:8192
    v_mfma_f32_16x16x32_bf16 v[124:127], a[64:67], a[100:103], v[124:127]
    ds_read_b64_tr_b16 a[42:43], v17 offset:8704
    buffer_load_dwordx4 v4, s[12:15], s26 offen offset:2048 lds
    v_mfma_f32_16x16x32_bf16 v[128:131], a[64:67], a[104:107], v[128:131]
    ds_read_b64_tr_b16 a[44:45], v18 offset:8192
    v_mfma_f32_16x16x32_bf16 v[132:135], a[64:67], a[108:111], v[132:135]
    ds_read_b64_tr_b16 a[46:47], v18 offset:8704
    buffer_load_dwordx4 v5, s[12:15], s27 offen offset:3072 lds
    v_mfma_f32_16x16x32_bf16 v[136:139], a[88:91], a[68:71], v[136:139]
    ds_read_b64_tr_b16 a[48:49], v17 offset:16384
    v_mfma_f32_16x16x32_bf16 v[140:143], a[92:95], a[68:71], v[140:143]
    v_mfma_f32_16x16x32_bf16 v[144:147], a[68:71], a[96:99], v[144:147]
    ds_read_b64_tr_b16 a[50:51], v17 offset:16896
    s_add_u32 m0, s49, 4096
    v_mfma_f32_16x16x32_bf16 v[148:151], a[68:71], a[100:103], v[148:151]
    ds_read_b64_tr_b16 a[52:53], v18 offset:16384
    v_mfma_f32_16x16x32_bf16 v[152:155], a[68:71], a[104:107], v[152:155]
    ds_read_b64_tr_b16 a[54:55], v18 offset:16896
    buffer_load_dwordx4 v4, s[12:15], s28 offen offset:0 lds
    v_mfma_f32_16x16x32_bf16 v[156:159], a[68:71], a[108:111], v[156:159]
    ds_read_b128 a[4:7], v8 offset:2048
    v_mfma_f32_16x16x32_bf16 v[160:163], a[88:91], a[72:75], v[160:163]
    ds_read_b128 a[8:11], v8 offset:4096
    buffer_load_dwordx4 v5, s[12:15], s29 offen offset:1024 lds
    v_mfma_f32_16x16x32_bf16 v[164:167], a[92:95], a[72:75], v[164:167]
    v_mfma_f32_16x16x32_bf16 v[168:171], a[72:75], a[96:99], v[168:171]
    ds_read_b128 a[12:15], v8 offset:6144
    s_add_u32 s77, s77, 393216
    v_mfma_f32_16x16x32_bf16 v[172:175], a[72:75], a[100:103], v[172:175]
    ds_read_b128 a[16:19], v8 offset:8192
    v_mfma_f32_16x16x32_bf16 v[176:179], a[72:75], a[104:107], v[176:179]
    ds_read_b128 a[20:23], v8 offset:10240
    v_mfma_f32_16x16x32_bf16 v[180:183], a[72:75], a[108:111], v[180:183]
    ds_read_b128 a[24:27], v8 offset:12288
    s_cmp_eq_u32 s77, 6291456
    v_mfma_f32_16x16x32_bf16 v[184:187], a[88:91], a[76:79], v[184:187]
    ds_read_b128 a[28:31], v8 offset:14336
    v_mfma_f32_16x16x32_bf16 v[188:191], a[92:95], a[76:79], v[188:191]
    s_cselect_b32 s77, 0, s77
    v_mfma_f32_16x16x32_bf16 v[192:195], a[76:79], a[96:99], v[192:195]
    v_mfma_f32_16x16x32_bf16 v[196:199], a[76:79], a[100:103], v[196:199]
    s_add_u32 s12, s68, s77
    v_mfma_f32_16x16x32_bf16 v[200:203], a[76:79], a[104:107], v[200:203]
    v_mfma_f32_16x16x32_bf16 v[204:207], a[76:79], a[108:111], v[204:207]
    s_addc_u32 s13, s69, 0
    v_mfma_f32_16x16x32_bf16 v[208:211], a[88:91], a[80:83], v[208:211]
    v_mfma_f32_16x16x32_bf16 v[212:215], a[92:95], a[80:83], v[212:215]
    v_mfma_f32_16x16x32_bf16 v[216:219], a[80:83], a[96:99], v[216:219]
    s_add_u32 m0, s48, 65536
    v_mfma_f32_16x16x32_bf16 v[220:223], a[80:83], a[100:103], v[220:223]
    v_mfma_f32_16x16x32_bf16 v[224:227], a[80:83], a[104:107], v[224:227]
    buffer_load_dwordx4 v2, s[8:11], s16 offen offset:0 lds
    v_mfma_f32_16x16x32_bf16 v[228:231], a[80:83], a[108:111], v[228:231]
    v_mfma_f32_16x16x32_bf16 v[232:235], a[88:91], a[84:87], v[232:235]
    buffer_load_dwordx4 v3, s[8:11], s17 offen offset:1024 lds
    v_mfma_f32_16x16x32_bf16 v[236:239], a[92:95], a[84:87], v[236:239]
    v_mfma_f32_16x16x32_bf16 v[240:243], a[84:87], a[96:99], v[240:243]
    buffer_load_dwordx4 v2, s[8:11], s18 offen offset:2048 lds
    v_mfma_f32_16x16x32_bf16 v[244:247], a[84:87], a[100:103], v[244:247]
    v_mfma_f32_16x16x32_bf16 v[248:251], a[84:87], a[104:107], v[248:251]
    v_mfma_f32_16x16x32_bf16 v[252:255], a[84:87], a[108:111], v[252:255]
    s_waitcnt lgkmcnt(15)
    v_mfma_f32_16x16x32_bf16 v[64:67], a[32:35], a[0:3], v[64:67]
    ds_read_b128 a[56:59], v9 offset:0
    v_mfma_f32_16x16x32_bf16 v[68:71], a[36:39], a[0:3], v[68:71]
    ds_read_b64_tr_b16 a[88:89], v17 offset:4096
    buffer_load_dwordx4 v3, s[8:11], s19 offen offset:3072 lds
    s_waitcnt lgkmcnt(15)
    v_mfma_f32_16x16x32_bf16 v[72:75], a[0:3], a[40:43], v[72:75]
    ds_read_b64_tr_b16 a[90:91], v17 offset:4608
    s_waitcnt lgkmcnt(14)
    v_mfma_f32_16x16x32_bf16 v[76:79], a[0:3], a[44:47], v[76:79]
    s_waitcnt lgkmcnt(12)
    v_mfma_f32_16x16x32_bf16 v[80:83], a[0:3], a[48:51], v[80:83]
    ds_read_b64_tr_b16 a[92:93], v18 offset:4096
    s_waitcnt lgkmcnt(11)
    v_mfma_f32_16x16x32_bf16 v[84:87], a[0:3], a[52:55], v[84:87]
    ds_read_b64_tr_b16 a[94:95], v18 offset:4608
    s_add_u32 m0, s48, 69632
    s_waitcnt lgkmcnt(11)
    v_mfma_f32_16x16x32_bf16 v[88:91], a[32:35], a[4:7], v[88:91]
    v_mfma_f32_16x16x32_bf16 v[92:95], a[36:39], a[4:7], v[92:95]
    ds_read_b64_tr_b16 a[96:97], v17 offset:12288
    v_mfma_f32_16x16x32_bf16 v[96:99], a[4:7], a[40:43], v[96:99]
    ds_read_b64_tr_b16 a[98:99], v17 offset:12800
    v_mfma_f32_16x16x32_bf16 v[100:103], a[4:7], a[44:47], v[100:103]
    ds_read_b64_tr_b16 a[100:101], v18 offset:12288
    v_mfma_f32_16x16x32_bf16 v[104:107], a[4:7], a[48:51], v[104:107]
    buffer_load_dwordx4 v2, s[8:11], s20 offen offset:0 lds
    v_mfma_f32_16x16x32_bf16 v[108:111], a[4:7], a[52:55], v[108:111]
    ds_read_b64_tr_b16 a[102:103], v18 offset:12800
    s_waitcnt lgkmcnt(14)
    v_mfma_f32_16x16x32_bf16 v[112:115], a[32:35], a[8:11], v[112:115]
    ds_read_b64_tr_b16 a[104:105], v17 offset:20480
    v_mfma_f32_16x16x32_bf16 v[116:119], a[36:39], a[8:11], v[116:119]
    v_mfma_f32_16x16x32_bf16 v[120:123], a[8:11], a[40:43], v[120:123]
    ds_read_b64_tr_b16 a[106:107], v17 offset:20992
    buffer_load_dwordx4 v3, s[8:11], s21 offen offset:1024 lds
    v_mfma_f32_16x16x32_bf16 v[124:127], a[8:11], a[44:47], v[124:127]
    ds_read_b64_tr_b16 a[108:109], v18 offset:20480
    v_mfma_f32_16x16x32_bf16 v[128:131], a[8:11], a[48:51], v[128:131]
    ds_read_b64_tr_b16 a[110:111], v18 offset:20992
    v_mfma_f32_16x16x32_bf16 v[132:135], a[8:11], a[52:55], v[132:135]
    s_waitcnt lgkmcnt(15)
    v_mfma_f32_16x16x32_bf16 v[136:139], a[32:35], a[12:15], v[136:139]
    ds_read_b128 a[60:63], v9 offset:2048
    v_mfma_f32_16x16x32_bf16 v[140:143], a[36:39], a[12:15], v[140:143]
    ds_read_b128 a[64:67], v9 offset:4096
    buffer_load_dwordx4 v2, s[8:11], s22 offen offset:2048 lds
    v_mfma_f32_16x16x32_bf16 v[144:147], a[12:15], a[40:43], v[144:147]
    v_mfma_f32_16x16x32_bf16 v[148:151], a[12:15], a[44:47], v[148:151]
    ds_read_b128 a[68:71], v9 offset:6144
    v_mfma_f32_16x16x32_bf16 v[152:155], a[12:15], a[48:51], v[152:155]
    ds_read_b128 a[72:75], v9 offset:8192
    v_mfma_f32_16x16x32_bf16 v[156:159], a[12:15], a[52:55], v[156:159]
    ds_read_b128 a[76:79], v9 offset:10240
    v_mfma_f32_16x16x32_bf16 v[160:163], a[32:35], a[16:19], v[160:163]
    buffer_load_dwordx4 v3, s[8:11], s23 offen offset:3072 lds
    v_mfma_f32_16x16x32_bf16 v[164:167], a[36:39], a[16:19], v[164:167]
    ds_read_b128 a[80:83], v9 offset:12288
    v_mfma_f32_16x16x32_bf16 v[168:171], a[16:19], a[40:43], v[168:171]
    ds_read_b128 a[84:87], v9 offset:14336
    v_mfma_f32_16x16x32_bf16 v[172:175], a[16:19], a[44:47], v[172:175]
    v_mfma_f32_16x16x32_bf16 v[176:179], a[16:19], a[48:51], v[176:179]
    s_add_u32 s76, s76, 128
    v_mfma_f32_16x16x32_bf16 v[180:183], a[16:19], a[52:55], v[180:183]
    v_mfma_f32_16x16x32_bf16 v[184:187], a[32:35], a[20:23], v[184:187]
    v_mfma_f32_16x16x32_bf16 v[188:191], a[36:39], a[20:23], v[188:191]
    v_mfma_f32_16x16x32_bf16 v[192:195], a[20:23], a[40:43], v[192:195]
    v_mfma_f32_16x16x32_bf16 v[196:199], a[20:23], a[44:47], v[196:199]
    s_and_b32 s76, s76, 2047
    v_mfma_f32_16x16x32_bf16 v[200:203], a[20:23], a[48:51], v[200:203]
    v_mfma_f32_16x16x32_bf16 v[204:207], a[20:23], a[52:55], v[204:207]
    s_waitcnt lgkmcnt(15)
    v_mfma_f32_16x16x32_bf16 v[208:211], a[32:35], a[24:27], v[208:211]
    v_mfma_f32_16x16x32_bf16 v[212:215], a[36:39], a[24:27], v[212:215]
    s_add_u32 s8, s80, s76
    v_mfma_f32_16x16x32_bf16 v[216:219], a[24:27], a[40:43], v[216:219]
    v_mfma_f32_16x16x32_bf16 v[220:223], a[24:27], a[44:47], v[220:223]
    v_mfma_f32_16x16x32_bf16 v[224:227], a[24:27], a[48:51], v[224:227]
    v_mfma_f32_16x16x32_bf16 v[228:231], a[24:27], a[52:55], v[228:231]
    v_mfma_f32_16x16x32_bf16 v[232:235], a[32:35], a[28:31], v[232:235]
    s_addc_u32 s9, s81, 0
    v_mfma_f32_16x16x32_bf16 v[236:239], a[36:39], a[28:31], v[236:239]
    v_mfma_f32_16x16x32_bf16 v[240:243], a[28:31], a[40:43], v[240:243]
    v_mfma_f32_16x16x32_bf16 v[244:247], a[28:31], a[44:47], v[244:247]
    v_mfma_f32_16x16x32_bf16 v[248:251], a[28:31], a[48:51], v[248:251]
    v_mfma_f32_16x16x32_bf16 v[252:255], a[28:31], a[52:55], v[252:255]
    v_mfma_f32_16x16x32_bf16 v[64:67], a[88:91], a[56:59], v[64:67]
    v_mfma_f32_16x16x32_bf16 v[68:71], a[92:95], a[56:59], v[68:71]
    s_waitcnt lgkmcnt(13)
    v_mfma_f32_16x16x32_bf16 v[72:75], a[56:59], a[96:99], v[72:75]
    s_waitcnt lgkmcnt(11)
    v_mfma_f32_16x16x32_bf16 v[76:79], a[56:59], a[100:103], v[76:79]
    s_waitcnt lgkmcnt(9)
    v_mfma_f32_16x16x32_bf16 v[80:83], a[56:59], a[104:107], v[80:83]
    s_waitcnt lgkmcnt(7)
    v_mfma_f32_16x16x32_bf16 v[84:87], a[56:59], a[108:111], v[84:87]
    s_waitcnt lgkmcnt(6)
    v_mfma_f32_16x16x32_bf16 v[88:91], a[88:91], a[60:63], v[88:91]
    v_mfma_f32_16x16x32_bf16 v[92:95], a[92:95], a[60:63], v[92:95]
    s_waitcnt lgkmcnt(0)
    s_waitcnt vmcnt(8)
    s_barrier
    v_mfma_f32_16x16x32_bf16 v[96:99], a[60:63], a[96:99], v[96:99]
    ds_read_b128 a[0:3], v8 offset:32768
    v_mfma_f32_16x16x32_bf16 v[100:103], a[60:63], a[100:103], v[100:103]
    ds_read_b64_tr_b16 a[32:33], v12 offset:0
    s_add_u32 m0, s49, 24576
    v_mfma_f32_16x16x32_bf16 v[104:107], a[60:63], a[104:107], v[104:107]
    ds_read_b64_tr_b16 a[34:35], v12 offset:512
    v_mfma_f32_16x16x32_bf16 v[108:111], a[60:63], a[108:111], v[108:111]
    ds_read_b64_tr_b16 a[36:37], v13 offset:0
    buffer_load_dwordx4 v4, s[12:15], s24 offen offset:0 lds
    v_mfma_f32_16x16x32_bf16 v[112:115], a[88:91], a[64:67], v[112:115]
    ds_read_b64_tr_b16 a[38:39], v13 offset:512
    v_mfma_f32_16x16x32_bf16 v[116:119], a[92:95], a[64:67], v[116:119]
    buffer_load_dwordx4 v5, s[12:15], s25 offen offset:1024 lds
    v_mfma_f32_16x16x32_bf16 v[120:123], a[64:67], a[96:99], v[120:123]
    ds_read_b64_tr_b16 a[40:41], v12 offset:8192
    v_mfma_f32_16x16x32_bf16 v[124:127], a[64:67], a[100:103], v[124:127]
    ds_read_b64_tr_b16 a[42:43], v12 offset:8704
    buffer_load_dwordx4 v4, s[12:15], s26 offen offset:2048 lds
    v_mfma_f32_16x16x32_bf16 v[128:131], a[64:67], a[104:107], v[128:131]
    ds_read_b64_tr_b16 a[44:45], v13 offset:8192
    v_mfma_f32_16x16x32_bf16 v[132:135], a[64:67], a[108:111], v[132:135]
    ds_read_b64_tr_b16 a[46:47], v13 offset:8704
    buffer_load_dwordx4 v5, s[12:15], s27 offen offset:3072 lds
    v_mfma_f32_16x16x32_bf16 v[136:139], a[88:91], a[68:71], v[136:139]
    ds_read_b64_tr_b16 a[48:49], v12 offset:16384
    v_mfma_f32_16x16x32_bf16 v[140:143], a[92:95], a[68:71], v[140:143]
    v_mfma_f32_16x16x32_bf16 v[144:147], a[68:71], a[96:99], v[144:147]
    ds_read_b64_tr_b16 a[50:51], v12 offset:16896
    s_add_u32 m0, s49, 28672
    v_mfma_f32_16x16x32_bf16 v[148:151], a[68:71], a[100:103], v[148:151]
    ds_read_b64_tr_b16 a[52:53], v13 offset:16384
    v_mfma_f32_16x16x32_bf16 v[152:155], a[68:71], a[104:107], v[152:155]
    ds_read_b64_tr_b16 a[54:55], v13 offset:16896
    buffer_load_dwordx4 v4, s[12:15], s28 offen offset:0 lds
    v_mfma_f32_16x16x32_bf16 v[156:159], a[68:71], a[108:111], v[156:159]
    ds_read_b128 a[4:7], v8 offset:34816
    v_mfma_f32_16x16x32_bf16 v[160:163], a[88:91], a[72:75], v[160:163]
    ds_read_b128 a[8:11], v8 offset:36864
    buffer_load_dwordx4 v5, s[12:15], s29 offen offset:1024 lds
    v_mfma_f32_16x16x32_bf16 v[164:167], a[92:95], a[72:75], v[164:167]
    v_mfma_f32_16x16x32_bf16 v[168:171], a[72:75], a[96:99], v[168:171]
    ds_read_b128 a[12:15], v8 offset:38912
    s_add_u32 s77, s77, 393216
    v_mfma_f32_16x16x32_bf16 v[172:175], a[72:75], a[100:103], v[172:175]
    ds_read_b128 a[16:19], v8 offset:40960
    v_mfma_f32_16x16x32_bf16 v[176:179], a[72:75], a[104:107], v[176:179]
    ds_read_b128 a[20:23], v8 offset:43008
    v_mfma_f32_16x16x32_bf16 v[180:183], a[72:75], a[108:111], v[180:183]
    ds_read_b128 a[24:27], v8 offset:45056
    s_cmp_eq_u32 s77, 6291456
    v_mfma_f32_16x16x32_bf16 v[184:187], a[88:91], a[76:79], v[184:187]
    ds_read_b128 a[28:31], v8 offset:47104
    v_mfma_f32_16x16x32_bf16 v[188:191], a[92:95], a[76:79], v[188:191]
    s_cselect_b32 s77, 0, s77
    v_mfma_f32_16x16x32_bf16 v[192:195], a[76:79], a[96:99], v[192:195]
    v_mfma_f32_16x16x32_bf16 v[196:199], a[76:79], a[100:103], v[196:199]
    s_add_u32 s12, s68, s77
    v_mfma_f32_16x16x32_bf16 v[200:203], a[76:79], a[104:107], v[200:203]
    v_mfma_f32_16x16x32_bf16 v[204:207], a[76:79], a[108:111], v[204:207]
    s_addc_u32 s13, s69, 0
    v_mfma_f32_16x16x32_bf16 v[208:211], a[88:91], a[80:83], v[208:211]
    v_mfma_f32_16x16x32_bf16 v[212:215], a[92:95], a[80:83], v[212:215]
    v_mfma_f32_16x16x32_bf16 v[216:219], a[80:83], a[96:99], v[216:219]
    s_add_u32 m0, s48, 0
    v_mfma_f32_16x16x32_bf16 v[220:223], a[80:83], a[100:103], v[220:223]
    v_mfma_f32_16x16x32_bf16 v[224:227], a[80:83], a[104:107], v[224:227]
    buffer_load_dwordx4 v2, s[8:11], s16 offen offset:0 lds
    v_mfma_f32_16x16x32_bf16 v[228:231], a[80:83], a[108:111], v[228:231]
    v_mfma_f32_16x16x32_bf16 v[232:235], a[88:91], a[84:87], v[232:235]
    buffer_load_dwordx4 v3, s[8:11], s17 offen offset:1024 lds
    v_mfma_f32_16x16x32_bf16 v[236:239], a[92:95], a[84:87], v[236:239]
    v_mfma_f32_16x16x32_bf16 v[240:243], a[84:87], a[96:99], v[240:243]
    buffer_load_dwordx4 v2, s[8:11], s18 offen offset:2048 lds
    v_mfma_f32_16x16x32_bf16 v[244:247], a[84:87], a[100:103], v[244:247]
    v_mfma_f32_16x16x32_bf16 v[248:251], a[84:87], a[104:107], v[248:251]
    v_mfma_f32_16x16x32_bf16 v[252:255], a[84:87], a[108:111], v[252:255]
    s_waitcnt lgkmcnt(15)
    v_mfma_f32_16x16x32_bf16 v[64:67], a[32:35], a[0:3], v[64:67]
    ds_read_b128 a[56:59], v9 offset:32768
    v_mfma_f32_16x16x32_bf16 v[68:71], a[36:39], a[0:3], v[68:71]
    ds_read_b64_tr_b16 a[88:89], v12 offset:4096
    buffer_load_dwordx4 v3, s[8:11], s19 offen offset:3072 lds
    s_waitcnt lgkmcnt(15)
    v_mfma_f32_16x16x32_bf16 v[72:75], a[0:3], a[40:43], v[72:75]
    ds_read_b64_tr_b16 a[90:91], v12 offset:4608
    s_waitcnt lgkmcnt(14)
    v_mfma_f32_16x16x32_bf16 v[76:79], a[0:3], a[44:47], v[76:79]
    s_waitcnt lgkmcnt(12)
    v_mfma_f32_16x16x32_bf16 v[80:83], a[0:3], a[48:51], v[80:83]
    ds_read_b64_tr_b16 a[92:93], v13 offset:4096
    s_waitcnt lgkmcnt(11)
    v_mfma_f32_16x16x32_bf16 v[84:87], a[0:3], a[52:55], v[84:87]
    ds_read_b64_tr_b16 a[94:95], v13 offset:4608
    s_add_u32 m0, s48, 4096
    s_waitcnt lgkmcnt(11)
    v_mfma_f32_16x16x32_bf16 v[88:91], a[32:35], a[4:7], v[88:91]
    v_mfma_f32_16x16x32_bf16 v[92:95], a[36:39], a[4:7], v[92:95]
    ds_read_b64_tr_b16 a[96:97], v12 offset:12288
    v_mfma_f32_16x16x32_bf16 v[96:99], a[4:7], a[40:43], v[96:99]
    ds_read_b64_tr_b16 a[98:99], v12 offset:12800
    v_mfma_f32_16x16x32_bf16 v[100:103], a[4:7], a[44:47], v[100:103]
    ds_read_b64_tr_b16 a[100:101], v13 offset:12288
    v_mfma_f32_16x16x32_bf16 v[104:107], a[4:7], a[48:51], v[104:107]
    buffer_load_dwordx4 v2, s[8:11], s20 offen offset:0 lds
    v_mfma_f32_16x16x32_bf16 v[108:111], a[4:7], a[52:55], v[108:111]
    ds_read_b64_tr_b16 a[102:103], v13 offset:12800
    s_waitcnt lgkmcnt(14)
    v_mfma_f32_16x16x32_bf16 v[112:115], a[32:35], a[8:11], v[112:115]
    ds_read_b64_tr_b16 a[104:105], v12 offset:20480
    v_mfma_f32_16x16x32_bf16 v[116:119], a[36:39], a[8:11], v[116:119]
    v_mfma_f32_16x16x32_bf16 v[120:123], a[8:11], a[40:43], v[120:123]
    ds_read_b64_tr_b16 a[106:107], v12 offset:20992
    buffer_load_dwordx4 v3, s[8:11], s21 offen offset:1024 lds
    v_mfma_f32_16x16x32_bf16 v[124:127], a[8:11], a[44:47], v[124:127]
    ds_read_b64_tr_b16 a[108:109], v13 offset:20480
    v_mfma_f32_16x16x32_bf16 v[128:131], a[8:11], a[48:51], v[128:131]
    ds_read_b64_tr_b16 a[110:111], v13 offset:20992
    v_mfma_f32_16x16x32_bf16 v[132:135], a[8:11], a[52:55], v[132:135]
    s_waitcnt lgkmcnt(15)
    v_mfma_f32_16x16x32_bf16 v[136:139], a[32:35], a[12:15], v[136:139]
    ds_read_b128 a[60:63], v9 offset:34816
    v_mfma_f32_16x16x32_bf16 v[140:143], a[36:39], a[12:15], v[140:143]
    ds_read_b128 a[64:67], v9 offset:36864
    buffer_load_dwordx4 v2, s[8:11], s22 offen offset:2048 lds
    v_mfma_f32_16x16x32_bf16 v[144:147], a[12:15], a[40:43], v[144:147]
    v_mfma_f32_16x16x32_bf16 v[148:151], a[12:15], a[44:47], v[148:151]
    ds_read_b128 a[68:71], v9 offset:38912
    v_mfma_f32_16x16x32_bf16 v[152:155], a[12:15], a[48:51], v[152:155]
    ds_read_b128 a[72:75], v9 offset:40960
    v_mfma_f32_16x16x32_bf16 v[156:159], a[12:15], a[52:55], v[156:159]
    ds_read_b128 a[76:79], v9 offset:43008
    v_mfma_f32_16x16x32_bf16 v[160:163], a[32:35], a[16:19], v[160:163]
    buffer_load_dwordx4 v3, s[8:11], s23 offen offset:3072 lds
    v_mfma_f32_16x16x32_bf16 v[164:167], a[36:39], a[16:19], v[164:167]
    ds_read_b128 a[80:83], v9 offset:45056
    v_mfma_f32_16x16x32_bf16 v[168:171], a[16:19], a[40:43], v[168:171]
    ds_read_b128 a[84:87], v9 offset:47104
    v_mfma_f32_16x16x32_bf16 v[172:175], a[16:19], a[44:47], v[172:175]
    v_mfma_f32_16x16x32_bf16 v[176:179], a[16:19], a[48:51], v[176:179]
    s_add_u32 s76, s76, 128
    v_mfma_f32_16x16x32_bf16 v[180:183], a[16:19], a[52:55], v[180:183]
    v_mfma_f32_16x16x32_bf16 v[184:187], a[32:35], a[20:23], v[184:187]
    v_mfma_f32_16x16x32_bf16 v[188:191], a[36:39], a[20:23], v[188:191]
    v_mfma_f32_16x16x32_bf16 v[192:195], a[20:23], a[40:43], v[192:195]
    v_mfma_f32_16x16x32_bf16 v[196:199], a[20:23], a[44:47], v[196:199]
    s_and_b32 s76, s76, 2047
    v_mfma_f32_16x16x32_bf16 v[200:203], a[20:23], a[48:51], v[200:203]
    v_mfma_f32_16x16x32_bf16 v[204:207], a[20:23], a[52:55], v[204:207]
    s_waitcnt lgkmcnt(15)
    v_mfma_f32_16x16x32_bf16 v[208:211], a[32:35], a[24:27], v[208:211]
    v_mfma_f32_16x16x32_bf16 v[212:215], a[36:39], a[24:27], v[212:215]
    s_add_u32 s8, s80, s76
    v_mfma_f32_16x16x32_bf16 v[216:219], a[24:27], a[40:43], v[216:219]
    v_mfma_f32_16x16x32_bf16 v[220:223], a[24:27], a[44:47], v[220:223]
    v_mfma_f32_16x16x32_bf16 v[224:227], a[24:27], a[48:51], v[224:227]
    v_mfma_f32_16x16x32_bf16 v[228:231], a[24:27], a[52:55], v[228:231]
    v_mfma_f32_16x16x32_bf16 v[232:235], a[32:35], a[28:31], v[232:235]
    s_addc_u32 s9, s81, 0
    v_mfma_f32_16x16x32_bf16 v[236:239], a[36:39], a[28:31], v[236:239]
    v_mfma_f32_16x16x32_bf16 v[240:243], a[28:31], a[40:43], v[240:243]
    v_mfma_f32_16x16x32_bf16 v[244:247], a[28:31], a[44:47], v[244:247]
    v_mfma_f32_16x16x32_bf16 v[248:251], a[28:31], a[48:51], v[248:251]
    v_mfma_f32_16x16x32_bf16 v[252:255], a[28:31], a[52:55], v[252:255]
    v_mfma_f32_16x16x32_bf16 v[64:67], a[88:91], a[56:59], v[64:67]
    v_mfma_f32_16x16x32_bf16 v[68:71], a[92:95], a[56:59], v[68:71]
    s_waitcnt lgkmcnt(13)
    v_mfma_f32_16x16x32_bf16 v[72:75], a[56:59], a[96:99], v[72:75]
    s_waitcnt lgkmcnt(11)
    v_mfma_f32_16x16x32_bf16 v[76:79], a[56:59], a[100:103], v[76:79]
    s_waitcnt lgkmcnt(9)
    v_mfma_f32_16x16x32_bf16 v[80:83], a[56:59], a[104:107], v[80:83]
    s_waitcnt lgkmcnt(7)
    v_mfma_f32_16x16x32_bf16 v[84:87], a[56:59], a[108:111], v[84:87]
    s_waitcnt lgkmcnt(6)
    v_mfma_f32_16x16x32_bf16 v[88:91], a[88:91], a[60:63], v[88:91]
    v_mfma_f32_16x16x32_bf16 v[92:95], a[92:95], a[60:63], v[92:95]
    s_waitcnt lgkmcnt(0)
    s_waitcnt vmcnt(8)
    s_barrier
    v_mfma_f32_16x16x32_bf16 v[96:99], a[60:63], a[96:99], v[96:99]
    ds_read_b128 a[0:3], v10 offset:0
    v_mfma_f32_16x16x32_bf16 v[100:103], a[60:63], a[100:103], v[100:103]
    ds_read_b64_tr_b16 a[32:33], v17 offset:0
    s_add_u32 m0, s49, 0
    v_mfma_f32_16x16x32_bf16 v[104:107], a[60:63], a[104:107], v[104:107]
    ds_read_b64_tr_b16 a[34:35], v17 offset:512
    v_mfma_f32_16x16x32_bf16 v[108:111], a[60:63], a[108:111], v[108:111]
    ds_read_b64_tr_b16 a[36:37], v18 offset:0
    buffer_load_dwordx4 v4, s[12:15], s24 offen offset:0 lds
    v_mfma_f32_16x16x32_bf16 v[112:115], a[88:91], a[64:67], v[112:115]
    ds_read_b64_tr_b16 a[38:39], v18 offset:512
    v_mfma_f32_16x16x32_bf16 v[116:119], a[92:95], a[64:67], v[116:119]
    buffer_load_dwordx4 v5, s[12:15], s25 offen offset:1024 lds
    v_mfma_f32_16x16x32_bf16 v[120:123], a[64:67], a[96:99], v[120:123]
    ds_read_b64_tr_b16 a[40:41], v17 offset:8192
    v_mfma_f32_16x16x32_bf16 v[124:127], a[64:67], a[100:103], v[124:127]
    ds_read_b64_tr_b16 a[42:43], v17 offset:8704
    buffer_load_dwordx4 v4, s[12:15], s26 offen offset:2048 lds
    v_mfma_f32_16x16x32_bf16 v[128:131], a[64:67], a[104:107], v[128:131]
    ds_read_b64_tr_b16 a[44:45], v18 offset:8192
    v_mfma_f32_16x16x32_bf16 v[132:135], a[64:67], a[108:111], v[132:135]
    ds_read_b64_tr_b16 a[46:47], v18 offset:8704
    buffer_load_dwordx4 v5, s[12:15], s27 offen offset:3072 lds
    v_mfma_f32_16x16x32_bf16 v[136:139], a[88:91], a[68:71], v[136:139]
    ds_read_b64_tr_b16 a[48:49], v17 offset:16384
    v_mfma_f32_16x16x32_bf16 v[140:143], a[92:95], a[68:71], v[140:143]
    v_mfma_f32_16x16x32_bf16 v[144:147], a[68:71], a[96:99], v[144:147]
    ds_read_b64_tr_b16 a[50:51], v17 offset:16896
    s_add_u32 m0, s49, 4096
    v_mfma_f32_16x16x32_bf16 v[148:151], a[68:71], a[100:103], v[148:151]
    ds_read_b64_tr_b16 a[52:53], v18 offset:16384
    v_mfma_f32_16x16x32_bf16 v[152:155], a[68:71], a[104:107], v[152:155]
    ds_read_b64_tr_b16 a[54:55], v18 offset:16896
    buffer_load_dwordx4 v4, s[12:15], s28 offen offset:0 lds
    v_mfma_f32_16x16x32_bf16 v[156:159], a[68:71], a[108:111], v[156:159]
    ds_read_b128 a[4:7], v10 offset:2048
    v_mfma_f32_16x16x32_bf16 v[160:163], a[88:91], a[72:75], v[160:163]
    ds_read_b128 a[8:11], v10 offset:4096
    buffer_load_dwordx4 v5, s[12:15], s29 offen offset:1024 lds
    v_mfma_f32_16x16x32_bf16 v[164:167], a[92:95], a[72:75], v[164:167]
    v_mfma_f32_16x16x32_bf16 v[168:171], a[72:75], a[96:99], v[168:171]
    ds_read_b128 a[12:15], v10 offset:6144
    s_add_u32 s77, s77, 393216
    v_mfma_f32_16x16x32_bf16 v[172:175], a[72:75], a[100:103], v[172:175]
    ds_read_b128 a[16:19], v10 offset:8192
    v_mfma_f32_16x16x32_bf16 v[176:179], a[72:75], a[104:107], v[176:179]
    ds_read_b128 a[20:23], v10 offset:10240
    v_mfma_f32_16x16x32_bf16 v[180:183], a[72:75], a[108:111], v[180:183]
    ds_read_b128 a[24:27], v10 offset:12288
    s_cmp_eq_u32 s77, 6291456
    v_mfma_f32_16x16x32_bf16 v[184:187], a[88:91], a[76:79], v[184:187]
    ds_read_b128 a[28:31], v10 offset:14336
    v_mfma_f32_16x16x32_bf16 v[188:191], a[92:95], a[76:79], v[188:191]
    s_cselect_b32 s77, 0, s77
    v_mfma_f32_16x16x32_bf16 v[192:195], a[76:79], a[96:99], v[192:195]
    v_mfma_f32_16x16x32_bf16 v[196:199], a[76:79], a[100:103], v[196:199]
    s_add_u32 s12, s68, s77
    v_mfma_f32_16x16x32_bf16 v[200:203], a[76:79], a[104:107], v[200:203]
    v_mfma_f32_16x16x32_bf16 v[204:207], a[76:79], a[108:111], v[204:207]
    s_addc_u32 s13, s69, 0
    v_mfma_f32_16x16x32_bf16 v[208:211], a[88:91], a[80:83], v[208:211]
    v_mfma_f32_16x16x32_bf16 v[212:215], a[92:95], a[80:83], v[212:215]
    v_mfma_f32_16x16x32_bf16 v[216:219], a[80:83], a[96:99], v[216:219]
    s_add_u32 m0, s48, 32768
    v_mfma_f32_16x16x32_bf16 v[220:223], a[80:83], a[100:103], v[220:223]
    v_mfma_f32_16x16x32_bf16 v[224:227], a[80:83], a[104:107], v[224:227]
    buffer_load_dwordx4 v2, s[8:11], s16 offen offset:0 lds
    v_mfma_f32_16x16x32_bf16 v[228:231], a[80:83], a[108:111], v[228:231]
    v_mfma_f32_16x16x32_bf16 v[232:235], a[88:91], a[84:87], v[232:235]
    buffer_load_dwordx4 v3, s[8:11], s17 offen offset:1024 lds
    v_mfma_f32_16x16x32_bf16 v[236:239], a[92:95], a[84:87], v[236:239]
    v_mfma_f32_16x16x32_bf16 v[240:243], a[84:87], a[96:99], v[240:243]
    buffer_load_dwordx4 v2, s[8:11], s18 offen offset:2048 lds
    v_mfma_f32_16x16x32_bf16 v[244:247], a[84:87], a[100:103], v[244:247]
    v_mfma_f32_16x16x32_bf16 v[248:251], a[84:87], a[104:107], v[248:251]
    v_mfma_f32_16x16x32_bf16 v[252:255], a[84:87], a[108:111], v[252:255]
    s_waitcnt lgkmcnt(15)
    v_mfma_f32_16x16x32_bf16 v[64:67], a[32:35], a[0:3], v[64:67]
    ds_read_b128 a[56:59], v11 offset:0
    v_mfma_f32_16x16x32_bf16 v[68:71], a[36:39], a[0:3], v[68:71]
    ds_read_b64_tr_b16 a[88:89], v17 offset:4096
    buffer_load_dwordx4 v3, s[8:11], s19 offen offset:3072 lds
    s_waitcnt lgkmcnt(15)
    v_mfma_f32_16x16x32_bf16 v[72:75], a[0:3], a[40:43], v[72:75]
    ds_read_b64_tr_b16 a[90:91], v17 offset:4608
    s_waitcnt lgkmcnt(14)
    v_mfma_f32_16x16x32_bf16 v[76:79], a[0:3], a[44:47], v[76:79]
    s_waitcnt lgkmcnt(12)
    v_mfma_f32_16x16x32_bf16 v[80:83], a[0:3], a[48:51], v[80:83]
    ds_read_b64_tr_b16 a[92:93], v18 offset:4096
    s_waitcnt lgkmcnt(11)
    v_mfma_f32_16x16x32_bf16 v[84:87], a[0:3], a[52:55], v[84:87]
    ds_read_b64_tr_b16 a[94:95], v18 offset:4608
    s_add_u32 m0, s48, 36864
    s_waitcnt lgkmcnt(11)
    v_mfma_f32_16x16x32_bf16 v[88:91], a[32:35], a[4:7], v[88:91]
    v_mfma_f32_16x16x32_bf16 v[92:95], a[36:39], a[4:7], v[92:95]
    ds_read_b64_tr_b16 a[96:97], v17 offset:12288
    v_mfma_f32_16x16x32_bf16 v[96:99], a[4:7], a[40:43], v[96:99]
    ds_read_b64_tr_b16 a[98:99], v17 offset:12800
    v_mfma_f32_16x16x32_bf16 v[100:103], a[4:7], a[44:47], v[100:103]
    ds_read_b64_tr_b16 a[100:101], v18 offset:12288
    v_mfma_f32_16x16x32_bf16 v[104:107], a[4:7], a[48:51], v[104:107]
    buffer_load_dwordx4 v2, s[8:11], s20 offen offset:0 lds
    v_mfma_f32_16x16x32_bf16 v[108:111], a[4:7], a[52:55], v[108:111]
    ds_read_b64_tr_b16 a[102:103], v18 offset:12800
    s_waitcnt lgkmcnt(14)
    v_mfma_f32_16x16x32_bf16 v[112:115], a[32:35], a[8:11], v[112:115]
    ds_read_b64_tr_b16 a[104:105], v17 offset:20480
    v_mfma_f32_16x16x32_bf16 v[116:119], a[36:39], a[8:11], v[116:119]
    v_mfma_f32_16x16x32_bf16 v[120:123], a[8:11], a[40:43], v[120:123]
    ds_read_b64_tr_b16 a[106:107], v17 offset:20992
    buffer_load_dwordx4 v3, s[8:11], s21 offen offset:1024 lds
    v_mfma_f32_16x16x32_bf16 v[124:127], a[8:11], a[44:47], v[124:127]
    ds_read_b64_tr_b16 a[108:109], v18 offset:20480
    v_mfma_f32_16x16x32_bf16 v[128:131], a[8:11], a[48:51], v[128:131]
    ds_read_b64_tr_b16 a[110:111], v18 offset:20992
    v_mfma_f32_16x16x32_bf16 v[132:135], a[8:11], a[52:55], v[132:135]
    s_waitcnt lgkmcnt(15)
    v_mfma_f32_16x16x32_bf16 v[136:139], a[32:35], a[12:15], v[136:139]
    ds_read_b128 a[60:63], v11 offset:2048
    v_mfma_f32_16x16x32_bf16 v[140:143], a[36:39], a[12:15], v[140:143]
    ds_read_b128 a[64:67], v11 offset:4096
    buffer_load_dwordx4 v2, s[8:11], s22 offen offset:2048 lds
    v_mfma_f32_16x16x32_bf16 v[144:147], a[12:15], a[40:43], v[144:147]
    v_mfma_f32_16x16x32_bf16 v[148:151], a[12:15], a[44:47], v[148:151]
    ds_read_b128 a[68:71], v11 offset:6144
    v_mfma_f32_16x16x32_bf16 v[152:155], a[12:15], a[48:51], v[152:155]
    ds_read_b128 a[72:75], v11 offset:8192
    v_mfma_f32_16x16x32_bf16 v[156:159], a[12:15], a[52:55], v[156:159]
    ds_read_b128 a[76:79], v11 offset:10240
    v_mfma_f32_16x16x32_bf16 v[160:163], a[32:35], a[16:19], v[160:163]
    buffer_load_dwordx4 v3, s[8:11], s23 offen offset:3072 lds
    v_mfma_f32_16x16x32_bf16 v[164:167], a[36:39], a[16:19], v[164:167]
    ds_read_b128 a[80:83], v11 offset:12288
    v_mfma_f32_16x16x32_bf16 v[168:171], a[16:19], a[40:43], v[168:171]
    ds_read_b128 a[84:87], v11 offset:14336
    v_mfma_f32_16x16x32_bf16 v[172:175], a[16:19], a[44:47], v[172:175]
    v_mfma_f32_16x16x32_bf16 v[176:179], a[16:19], a[48:51], v[176:179]
    s_add_u32 s76, s76, 128
    v_mfma_f32_16x16x32_bf16 v[180:183], a[16:19], a[52:55], v[180:183]
    v_mfma_f32_16x16x32_bf16 v[184:187], a[32:35], a[20:23], v[184:187]
    v_mfma_f32_16x16x32_bf16 v[188:191], a[36:39], a[20:23], v[188:191]
    v_mfma_f32_16x16x32_bf16 v[192:195], a[20:23], a[40:43], v[192:195]
    v_mfma_f32_16x16x32_bf16 v[196:199], a[20:23], a[44:47], v[196:199]
    s_and_b32 s76, s76, 2047
    v_mfma_f32_16x16x32_bf16 v[200:203], a[20:23], a[48:51], v[200:203]
    v_mfma_f32_16x16x32_bf16 v[204:207], a[20:23], a[52:55], v[204:207]
    s_waitcnt lgkmcnt(15)
    v_mfma_f32_16x16x32_bf16 v[208:211], a[32:35], a[24:27], v[208:211]
    v_mfma_f32_16x16x32_bf16 v[212:215], a[36:39], a[24:27], v[212:215]
    s_add_u32 s8, s80, s76
    v_mfma_f32_16x16x32_bf16 v[216:219], a[24:27], a[40:43], v[216:219]
    v_mfma_f32_16x16x32_bf16 v[220:223], a[24:27], a[44:47], v[220:223]
    v_mfma_f32_16x16x32_bf16 v[224:227], a[24:27], a[48:51], v[224:227]
    v_mfma_f32_16x16x32_bf16 v[228:231], a[24:27], a[52:55], v[228:231]
    v_mfma_f32_16x16x32_bf16 v[232:235], a[32:35], a[28:31], v[232:235]
    s_addc_u32 s9, s81, 0
    v_mfma_f32_16x16x32_bf16 v[236:239], a[36:39], a[28:31], v[236:239]
    v_mfma_f32_16x16x32_bf16 v[240:243], a[28:31], a[40:43], v[240:243]
    v_mfma_f32_16x16x32_bf16 v[244:247], a[28:31], a[44:47], v[244:247]
    v_mfma_f32_16x16x32_bf16 v[248:251], a[28:31], a[48:51], v[248:251]
    v_mfma_f32_16x16x32_bf16 v[252:255], a[28:31], a[52:55], v[252:255]
    v_mfma_f32_16x16x32_bf16 v[64:67], a[88:91], a[56:59], v[64:67]
    v_mfma_f32_16x16x32_bf16 v[68:71], a[92:95], a[56:59], v[68:71]
    s_waitcnt lgkmcnt(13)
    v_mfma_f32_16x16x32_bf16 v[72:75], a[56:59], a[96:99], v[72:75]
    s_waitcnt lgkmcnt(11)
    v_mfma_f32_16x16x32_bf16 v[76:79], a[56:59], a[100:103], v[76:79]
    s_waitcnt lgkmcnt(9)
    v_mfma_f32_16x16x32_bf16 v[80:83], a[56:59], a[104:107], v[80:83]
    s_waitcnt lgkmcnt(7)
    v_mfma_f32_16x16x32_bf16 v[84:87], a[56:59], a[108:111], v[84:87]
    s_waitcnt lgkmcnt(6)
    v_mfma_f32_16x16x32_bf16 v[88:91], a[88:91], a[60:63], v[88:91]
    v_mfma_f32_16x16x32_bf16 v[92:95], a[92:95], a[60:63], v[92:95]
    s_waitcnt lgkmcnt(0)
    s_waitcnt vmcnt(8)
    s_barrier
    v_mfma_f32_16x16x32_bf16 v[96:99], a[60:63], a[96:99], v[96:99]
    ds_read_b128 a[0:3], v8 offset:0
    v_mfma_f32_16x16x32_bf16 v[100:103], a[60:63], a[100:103], v[100:103]
    ds_read_b64_tr_b16 a[32:33], v12 offset:0
    s_add_u32 m0, s49, 24576
    v_mfma_f32_16x16x32_bf16 v[104:107], a[60:63], a[104:107], v[104:107]
    ds_read_b64_tr_b16 a[34:35], v12 offset:512
    v_mfma_f32_16x16x32_bf16 v[108:111], a[60:63], a[108:111], v[108:111]
    ds_read_b64_tr_b16 a[36:37], v13 offset:0
    buffer_load_dwordx4 v4, s[12:15], s24 offen offset:0 lds
    v_mfma_f32_16x16x32_bf16 v[112:115], a[88:91], a[64:67], v[112:115]
    ds_read_b64_tr_b16 a[38:39], v13 offset:512
    v_mfma_f32_16x16x32_bf16 v[116:119], a[92:95], a[64:67], v[116:119]
    buffer_load_dwordx4 v5, s[12:15], s25 offen offset:1024 lds
    v_mfma_f32_16x16x32_bf16 v[120:123], a[64:67], a[96:99], v[120:123]
    ds_read_b64_tr_b16 a[40:41], v12 offset:8192
    v_mfma_f32_16x16x32_bf16 v[124:127], a[64:67], a[100:103], v[124:127]
    ds_read_b64_tr_b16 a[42:43], v12 offset:8704
    buffer_load_dwordx4 v4, s[12:15], s26 offen offset:2048 lds
    v_mfma_f32_16x16x32_bf16 v[128:131], a[64:67], a[104:107], v[128:131]
    ds_read_b64_tr_b16 a[44:45], v13 offset:8192
    v_mfma_f32_16x16x32_bf16 v[132:135], a[64:67], a[108:111], v[132:135]
    ds_read_b64_tr_b16 a[46:47], v13 offset:8704
    buffer_load_dwordx4 v5, s[12:15], s27 offen offset:3072 lds
    v_mfma_f32_16x16x32_bf16 v[136:139], a[88:91], a[68:71], v[136:139]
    ds_read_b64_tr_b16 a[48:49], v12 offset:16384
    v_mfma_f32_16x16x32_bf16 v[140:143], a[92:95], a[68:71], v[140:143]
    v_mfma_f32_16x16x32_bf16 v[144:147], a[68:71], a[96:99], v[144:147]
    ds_read_b64_tr_b16 a[50:51], v12 offset:16896
    s_add_u32 m0, s49, 28672
    v_mfma_f32_16x16x32_bf16 v[148:151], a[68:71], a[100:103], v[148:151]
    ds_read_b64_tr_b16 a[52:53], v13 offset:16384
    v_mfma_f32_16x16x32_bf16 v[152:155], a[68:71], a[104:107], v[152:155]
    ds_read_b64_tr_b16 a[54:55], v13 offset:16896
    buffer_load_dwordx4 v4, s[12:15], s28 offen offset:0 lds
    v_mfma_f32_16x16x32_bf16 v[156:159], a[68:71], a[108:111], v[156:159]
    ds_read_b128 a[4:7], v8 offset:2048
    v_mfma_f32_16x16x32_bf16 v[160:163], a[88:91], a[72:75], v[160:163]
    ds_read_b128 a[8:11], v8 offset:4096
    buffer_load_dwordx4 v5, s[12:15], s29 offen offset:1024 lds
    v_mfma_f32_16x16x32_bf16 v[164:167], a[92:95], a[72:75], v[164:167]
    v_mfma_f32_16x16x32_bf16 v[168:171], a[72:75], a[96:99], v[168:171]
    ds_read_b128 a[12:15], v8 offset:6144
    s_add_u32 s77, s77, 393216
    v_mfma_f32_16x16x32_bf16 v[172:175], a[72:75], a[100:103], v[172:175]
    ds_read_b128 a[16:19], v8 offset:8192
    v_mfma_f32_16x16x32_bf16 v[176:179], a[72:75], a[104:107], v[176:179]
    ds_read_b128 a[20:23], v8 offset:10240
    v_mfma_f32_16x16x32_bf16 v[180:183], a[72:75], a[108:111], v[180:183]
    ds_read_b128 a[24:27], v8 offset:12288
    s_cmp_eq_u32 s77, 6291456
    v_mfma_f32_16x16x32_bf16 v[184:187], a[88:91], a[76:79], v[184:187]
    ds_read_b128 a[28:31], v8 offset:14336
    v_mfma_f32_16x16x32_bf16 v[188:191], a[92:95], a[76:79], v[188:191]
    s_cselect_b32 s77, 0, s77
    v_mfma_f32_16x16x32_bf16 v[192:195], a[76:79], a[96:99], v[192:195]
    v_mfma_f32_16x16x32_bf16 v[196:199], a[76:79], a[100:103], v[196:199]
    s_add_u32 s12, s68, s77
    v_mfma_f32_16x16x32_bf16 v[200:203], a[76:79], a[104:107], v[200:203]
    v_mfma_f32_16x16x32_bf16 v[204:207], a[76:79], a[108:111], v[204:207]
    s_addc_u32 s13, s69, 0
    v_mfma_f32_16x16x32_bf16 v[208:211], a[88:91], a[80:83], v[208:211]
    v_mfma_f32_16x16x32_bf16 v[212:215], a[92:95], a[80:83], v[212:215]
    v_mfma_f32_16x16x32_bf16 v[216:219], a[80:83], a[96:99], v[216:219]
    s_add_u32 m0, s48, 65536
    v_mfma_f32_16x16x32_bf16 v[220:223], a[80:83], a[100:103], v[220:223]
    v_mfma_f32_16x16x32_bf16 v[224:227], a[80:83], a[104:107], v[224:227]
    buffer_load_dwordx4 v2, s[8:11], s16 offen offset:0 lds
    v_mfma_f32_16x16x32_bf16 v[228:231], a[80:83], a[108:111], v[228:231]
    v_mfma_f32_16x16x32_bf16 v[232:235], a[88:91], a[84:87], v[232:235]
    buffer_load_dwordx4 v3, s[8:11], s17 offen offset:1024 lds
    v_mfma_f32_16x16x32_bf16 v[236:239], a[92:95], a[84:87], v[236:239]
    v_mfma_f32_16x16x32_bf16 v[240:243], a[84:87], a[96:99], v[240:243]
    buffer_load_dwordx4 v2, s[8:11], s18 offen offset:2048 lds
    v_mfma_f32_16x16x32_bf16 v[244:247], a[84:87], a[100:103], v[244:247]
    v_mfma_f32_16x16x32_bf16 v[248:251], a[84:87], a[104:107], v[248:251]
    v_mfma_f32_16x16x32_bf16 v[252:255], a[84:87], a[108:111], v[252:255]
    s_waitcnt lgkmcnt(15)
    v_mfma_f32_16x16x32_bf16 v[64:67], a[32:35], a[0:3], v[64:67]
    ds_read_b128 a[56:59], v9 offset:0
    v_mfma_f32_16x16x32_bf16 v[68:71], a[36:39], a[0:3], v[68:71]
    ds_read_b64_tr_b16 a[88:89], v12 offset:4096
    buffer_load_dwordx4 v3, s[8:11], s19 offen offset:3072 lds
    s_waitcnt lgkmcnt(15)
    v_mfma_f32_16x16x32_bf16 v[72:75], a[0:3], a[40:43], v[72:75]
    ds_read_b64_tr_b16 a[90:91], v12 offset:4608
    s_waitcnt lgkmcnt(14)
    v_mfma_f32_16x16x32_bf16 v[76:79], a[0:3], a[44:47], v[76:79]
    s_waitcnt lgkmcnt(12)
    v_mfma_f32_16x16x32_bf16 v[80:83], a[0:3], a[48:51], v[80:83]
    ds_read_b64_tr_b16 a[92:93], v13 offset:4096
    s_waitcnt lgkmcnt(11)
    v_mfma_f32_16x16x32_bf16 v[84:87], a[0:3], a[52:55], v[84:87]
    ds_read_b64_tr_b16 a[94:95], v13 offset:4608
    s_add_u32 m0, s48, 69632
    s_waitcnt lgkmcnt(11)
    v_mfma_f32_16x16x32_bf16 v[88:91], a[32:35], a[4:7], v[88:91]
    v_mfma_f32_16x16x32_bf16 v[92:95], a[36:39], a[4:7], v[92:95]
    ds_read_b64_tr_b16 a[96:97], v12 offset:12288
    v_mfma_f32_16x16x32_bf16 v[96:99], a[4:7], a[40:43], v[96:99]
    ds_read_b64_tr_b16 a[98:99], v12 offset:12800
    v_mfma_f32_16x16x32_bf16 v[100:103], a[4:7], a[44:47], v[100:103]
    ds_read_b64_tr_b16 a[100:101], v13 offset:12288
    v_mfma_f32_16x16x32_bf16 v[104:107], a[4:7], a[48:51], v[104:107]
    buffer_load_dwordx4 v2, s[8:11], s20 offen offset:0 lds
    v_mfma_f32_16x16x32_bf16 v[108:111], a[4:7], a[52:55], v[108:111]
    ds_read_b64_tr_b16 a[102:103], v13 offset:12800
    s_waitcnt lgkmcnt(14)
    v_mfma_f32_16x16x32_bf16 v[112:115], a[32:35], a[8:11], v[112:115]
    ds_read_b64_tr_b16 a[104:105], v12 offset:20480
    v_mfma_f32_16x16x32_bf16 v[116:119], a[36:39], a[8:11], v[116:119]
    v_mfma_f32_16x16x32_bf16 v[120:123], a[8:11], a[40:43], v[120:123]
    ds_read_b64_tr_b16 a[106:107], v12 offset:20992
    buffer_load_dwordx4 v3, s[8:11], s21 offen offset:1024 lds
    v_mfma_f32_16x16x32_bf16 v[124:127], a[8:11], a[44:47], v[124:127]
    ds_read_b64_tr_b16 a[108:109], v13 offset:20480
    v_mfma_f32_16x16x32_bf16 v[128:131], a[8:11], a[48:51], v[128:131]
    ds_read_b64_tr_b16 a[110:111], v13 offset:20992
    v_mfma_f32_16x16x32_bf16 v[132:135], a[8:11], a[52:55], v[132:135]
    s_waitcnt lgkmcnt(15)
    v_mfma_f32_16x16x32_bf16 v[136:139], a[32:35], a[12:15], v[136:139]
    ds_read_b128 a[60:63], v9 offset:2048
    v_mfma_f32_16x16x32_bf16 v[140:143], a[36:39], a[12:15], v[140:143]
    ds_read_b128 a[64:67], v9 offset:4096
    buffer_load_dwordx4 v2, s[8:11], s22 offen offset:2048 lds
    v_mfma_f32_16x16x32_bf16 v[144:147], a[12:15], a[40:43], v[144:147]
    v_mfma_f32_16x16x32_bf16 v[148:151], a[12:15], a[44:47], v[148:151]
    ds_read_b128 a[68:71], v9 offset:6144
    v_mfma_f32_16x16x32_bf16 v[152:155], a[12:15], a[48:51], v[152:155]
    ds_read_b128 a[72:75], v9 offset:8192
    v_mfma_f32_16x16x32_bf16 v[156:159], a[12:15], a[52:55], v[156:159]
    ds_read_b128 a[76:79], v9 offset:10240
    v_mfma_f32_16x16x32_bf16 v[160:163], a[32:35], a[16:19], v[160:163]
    buffer_load_dwordx4 v3, s[8:11], s23 offen offset:3072 lds
    v_mfma_f32_16x16x32_bf16 v[164:167], a[36:39], a[16:19], v[164:167]
    ds_read_b128 a[80:83], v9 offset:12288
    v_mfma_f32_16x16x32_bf16 v[168:171], a[16:19], a[40:43], v[168:171]
    ds_read_b128 a[84:87], v9 offset:14336
    v_mfma_f32_16x16x32_bf16 v[172:175], a[16:19], a[44:47], v[172:175]
    v_mfma_f32_16x16x32_bf16 v[176:179], a[16:19], a[48:51], v[176:179]
    s_add_u32 s76, s76, 128
    v_mfma_f32_16x16x32_bf16 v[180:183], a[16:19], a[52:55], v[180:183]
    v_mfma_f32_16x16x32_bf16 v[184:187], a[32:35], a[20:23], v[184:187]
    v_mfma_f32_16x16x32_bf16 v[188:191], a[36:39], a[20:23], v[188:191]
    v_mfma_f32_16x16x32_bf16 v[192:195], a[20:23], a[40:43], v[192:195]
    v_mfma_f32_16x16x32_bf16 v[196:199], a[20:23], a[44:47], v[196:199]
    s_and_b32 s76, s76, 2047
    v_mfma_f32_16x16x32_bf16 v[200:203], a[20:23], a[48:51], v[200:203]
    v_mfma_f32_16x16x32_bf16 v[204:207], a[20:23], a[52:55], v[204:207]
    s_waitcnt lgkmcnt(15)
    v_mfma_f32_16x16x32_bf16 v[208:211], a[32:35], a[24:27], v[208:211]
    v_mfma_f32_16x16x32_bf16 v[212:215], a[36:39], a[24:27], v[212:215]
    s_add_u32 s8, s80, s76
    v_mfma_f32_16x16x32_bf16 v[216:219], a[24:27], a[40:43], v[216:219]
    v_mfma_f32_16x16x32_bf16 v[220:223], a[24:27], a[44:47], v[220:223]
    v_mfma_f32_16x16x32_bf16 v[224:227], a[24:27], a[48:51], v[224:227]
    v_mfma_f32_16x16x32_bf16 v[228:231], a[24:27], a[52:55], v[228:231]
    v_mfma_f32_16x16x32_bf16 v[232:235], a[32:35], a[28:31], v[232:235]
    s_addc_u32 s9, s81, 0
    v_mfma_f32_16x16x32_bf16 v[236:239], a[36:39], a[28:31], v[236:239]
    v_mfma_f32_16x16x32_bf16 v[240:243], a[28:31], a[40:43], v[240:243]
    v_mfma_f32_16x16x32_bf16 v[244:247], a[28:31], a[44:47], v[244:247]
    v_mfma_f32_16x16x32_bf16 v[248:251], a[28:31], a[48:51], v[248:251]
    v_mfma_f32_16x16x32_bf16 v[252:255], a[28:31], a[52:55], v[252:255]
    v_mfma_f32_16x16x32_bf16 v[64:67], a[88:91], a[56:59], v[64:67]
    v_mfma_f32_16x16x32_bf16 v[68:71], a[92:95], a[56:59], v[68:71]
    s_waitcnt lgkmcnt(13)
    v_mfma_f32_16x16x32_bf16 v[72:75], a[56:59], a[96:99], v[72:75]
    s_waitcnt lgkmcnt(11)
    v_mfma_f32_16x16x32_bf16 v[76:79], a[56:59], a[100:103], v[76:79]
    s_waitcnt lgkmcnt(9)
    v_mfma_f32_16x16x32_bf16 v[80:83], a[56:59], a[104:107], v[80:83]
    s_waitcnt lgkmcnt(7)
    v_mfma_f32_16x16x32_bf16 v[84:87], a[56:59], a[108:111], v[84:87]
    s_waitcnt lgkmcnt(6)
    v_mfma_f32_16x16x32_bf16 v[88:91], a[88:91], a[60:63], v[88:91]
    v_mfma_f32_16x16x32_bf16 v[92:95], a[92:95], a[60:63], v[92:95]
    s_waitcnt lgkmcnt(0)
    s_waitcnt vmcnt(8)
    s_barrier
    v_mfma_f32_16x16x32_bf16 v[96:99], a[60:63], a[96:99], v[96:99]
    ds_read_b128 a[0:3], v8 offset:32768
    v_mfma_f32_16x16x32_bf16 v[100:103], a[60:63], a[100:103], v[100:103]
    ds_read_b64_tr_b16 a[32:33], v17 offset:0
    s_add_u32 m0, s49, 0
    v_mfma_f32_16x16x32_bf16 v[104:107], a[60:63], a[104:107], v[104:107]
    ds_read_b64_tr_b16 a[34:35], v17 offset:512
    v_mfma_f32_16x16x32_bf16 v[108:111], a[60:63], a[108:111], v[108:111]
    ds_read_b64_tr_b16 a[36:37], v18 offset:0
    buffer_load_dwordx4 v4, s[12:15], s24 offen offset:0 lds
    v_mfma_f32_16x16x32_bf16 v[112:115], a[88:91], a[64:67], v[112:115]
    ds_read_b64_tr_b16 a[38:39], v18 offset:512
    v_mfma_f32_16x16x32_bf16 v[116:119], a[92:95], a[64:67], v[116:119]
    buffer_load_dwordx4 v5, s[12:15], s25 offen offset:1024 lds
    v_mfma_f32_16x16x32_bf16 v[120:123], a[64:67], a[96:99], v[120:123]
    ds_read_b64_tr_b16 a[40:41], v17 offset:8192
    v_mfma_f32_16x16x32_bf16 v[124:127], a[64:67], a[100:103], v[124:127]
    ds_read_b64_tr_b16 a[42:43], v17 offset:8704
    buffer_load_dwordx4 v4, s[12:15], s26 offen offset:2048 lds
    v_mfma_f32_16x16x32_bf16 v[128:131], a[64:67], a[104:107], v[128:131]
    ds_read_b64_tr_b16 a[44:45], v18 offset:8192
    v_mfma_f32_16x16x32_bf16 v[132:135], a[64:67], a[108:111], v[132:135]
    ds_read_b64_tr_b16 a[46:47], v18 offset:8704
    buffer_load_dwordx4 v5, s[12:15], s27 offen offset:3072 lds
    v_mfma_f32_16x16x32_bf16 v[136:139], a[88:91], a[68:71], v[136:139]
    ds_read_b64_tr_b16 a[48:49], v17 offset:16384
    v_mfma_f32_16x16x32_bf16 v[140:143], a[92:95], a[68:71], v[140:143]
    v_mfma_f32_16x16x32_bf16 v[144:147], a[68:71], a[96:99], v[144:147]
    ds_read_b64_tr_b16 a[50:51], v17 offset:16896
    s_add_u32 m0, s49, 4096
    v_mfma_f32_16x16x32_bf16 v[148:151], a[68:71], a[100:103], v[148:151]
    ds_read_b64_tr_b16 a[52:53], v18 offset:16384
    v_mfma_f32_16x16x32_bf16 v[152:155], a[68:71], a[104:107], v[152:155]
    ds_read_b64_tr_b16 a[54:55], v18 offset:16896
    buffer_load_dwordx4 v4, s[12:15], s28 offen offset:0 lds
    v_mfma_f32_16x16x32_bf16 v[156:159], a[68:71], a[108:111], v[156:159]
    ds_read_b128 a[4:7], v8 offset:34816
    v_mfma_f32_16x16x32_bf16 v[160:163], a[88:91], a[72:75], v[160:163]
    ds_read_b128 a[8:11], v8 offset:36864
    buffer_load_dwordx4 v5, s[12:15], s29 offen offset:1024 lds
    v_mfma_f32_16x16x32_bf16 v[164:167], a[92:95], a[72:75], v[164:167]
    v_mfma_f32_16x16x32_bf16 v[168:171], a[72:75], a[96:99], v[168:171]
    ds_read_b128 a[12:15], v8 offset:38912
    s_add_u32 s77, s77, 393216
    v_mfma_f32_16x16x32_bf16 v[172:175], a[72:75], a[100:103], v[172:175]
    ds_read_b128 a[16:19], v8 offset:40960
    v_mfma_f32_16x16x32_bf16 v[176:179], a[72:75], a[104:107], v[176:179]
    ds_read_b128 a[20:23], v8 offset:43008
    v_mfma_f32_16x16x32_bf16 v[180:183], a[72:75], a[108:111], v[180:183]
    ds_read_b128 a[24:27], v8 offset:45056
    s_cmp_eq_u32 s77, 6291456
    v_mfma_f32_16x16x32_bf16 v[184:187], a[88:91], a[76:79], v[184:187]
    ds_read_b128 a[28:31], v8 offset:47104
    v_mfma_f32_16x16x32_bf16 v[188:191], a[92:95], a[76:79], v[188:191]
    s_cselect_b32 s77, 0, s77
    v_mfma_f32_16x16x32_bf16 v[192:195], a[76:79], a[96:99], v[192:195]
    v_mfma_f32_16x16x32_bf16 v[196:199], a[76:79], a[100:103], v[196:199]
    s_add_u32 s12, s68, s77
    v_mfma_f32_16x16x32_bf16 v[200:203], a[76:79], a[104:107], v[200:203]
    v_mfma_f32_16x16x32_bf16 v[204:207], a[76:79], a[108:111], v[204:207]
    s_addc_u32 s13, s69, 0
    v_mfma_f32_16x16x32_bf16 v[208:211], a[88:91], a[80:83], v[208:211]
    v_mfma_f32_16x16x32_bf16 v[212:215], a[92:95], a[80:83], v[212:215]
    v_mfma_f32_16x16x32_bf16 v[216:219], a[80:83], a[96:99], v[216:219]
    s_add_u32 m0, s48, 0
    v_mfma_f32_16x16x32_bf16 v[220:223], a[80:83], a[100:103], v[220:223]
    v_mfma_f32_16x16x32_bf16 v[224:227], a[80:83], a[104:107], v[224:227]
    buffer_load_dwordx4 v2, s[8:11], s16 offen offset:0 lds
    v_mfma_f32_16x16x32_bf16 v[228:231], a[80:83], a[108:111], v[228:231]
    v_mfma_f32_16x16x32_bf16 v[232:235], a[88:91], a[84:87], v[232:235]
    buffer_load_dwordx4 v3, s[8:11], s17 offen offset:1024 lds
    v_mfma_f32_16x16x32_bf16 v[236:239], a[92:95], a[84:87], v[236:239]
    v_mfma_f32_16x16x32_bf16 v[240:243], a[84:87], a[96:99], v[240:243]
    buffer_load_dwordx4 v2, s[8:11], s18 offen offset:2048 lds
    v_mfma_f32_16x16x32_bf16 v[244:247], a[84:87], a[100:103], v[244:247]
    v_mfma_f32_16x16x32_bf16 v[248:251], a[84:87], a[104:107], v[248:251]
    v_mfma_f32_16x16x32_bf16 v[252:255], a[84:87], a[108:111], v[252:255]
    s_waitcnt lgkmcnt(15)
    v_mfma_f32_16x16x32_bf16 v[64:67], a[32:35], a[0:3], v[64:67]
    ds_read_b128 a[56:59], v9 offset:32768
    v_mfma_f32_16x16x32_bf16 v[68:71], a[36:39], a[0:3], v[68:71]
    ds_read_b64_tr_b16 a[88:89], v17 offset:4096
    buffer_load_dwordx4 v3, s[8:11], s19 offen offset:3072 lds
    s_waitcnt lgkmcnt(15)
    v_mfma_f32_16x16x32_bf16 v[72:75], a[0:3], a[40:43], v[72:75]
    ds_read_b64_tr_b16 a[90:91], v17 offset:4608
    s_waitcnt lgkmcnt(14)
    v_mfma_f32_16x16x32_bf16 v[76:79], a[0:3], a[44:47], v[76:79]
    s_waitcnt lgkmcnt(12)
    v_mfma_f32_16x16x32_bf16 v[80:83], a[0:3], a[48:51], v[80:83]
    ds_read_b64_tr_b16 a[92:93], v18 offset:4096
    s_waitcnt lgkmcnt(11)
    v_mfma_f32_16x16x32_bf16 v[84:87], a[0:3], a[52:55], v[84:87]
    ds_read_b64_tr_b16 a[94:95], v18 offset:4608
    s_add_u32 m0, s48, 4096
    s_waitcnt lgkmcnt(11)
    v_mfma_f32_16x16x32_bf16 v[88:91], a[32:35], a[4:7], v[88:91]
    v_mfma_f32_16x16x32_bf16 v[92:95], a[36:39], a[4:7], v[92:95]
    ds_read_b64_tr_b16 a[96:97], v17 offset:12288
    v_mfma_f32_16x16x32_bf16 v[96:99], a[4:7], a[40:43], v[96:99]
    ds_read_b64_tr_b16 a[98:99], v17 offset:12800
    v_mfma_f32_16x16x32_bf16 v[100:103], a[4:7], a[44:47], v[100:103]
    ds_read_b64_tr_b16 a[100:101], v18 offset:12288
    v_mfma_f32_16x16x32_bf16 v[104:107], a[4:7], a[48:51], v[104:107]
    buffer_load_dwordx4 v2, s[8:11], s20 offen offset:0 lds
    v_mfma_f32_16x16x32_bf16 v[108:111], a[4:7], a[52:55], v[108:111]
    ds_read_b64_tr_b16 a[102:103], v18 offset:12800
    s_waitcnt lgkmcnt(14)
    v_mfma_f32_16x16x32_bf16 v[112:115], a[32:35], a[8:11], v[112:115]
    ds_read_b64_tr_b16 a[104:105], v17 offset:20480
    v_mfma_f32_16x16x32_bf16 v[116:119], a[36:39], a[8:11], v[116:119]
    v_mfma_f32_16x16x32_bf16 v[120:123], a[8:11], a[40:43], v[120:123]
    ds_read_b64_tr_b16 a[106:107], v17 offset:20992
    buffer_load_dwordx4 v3, s[8:11], s21 offen offset:1024 lds
    v_mfma_f32_16x16x32_bf16 v[124:127], a[8:11], a[44:47], v[124:127]
    ds_read_b64_tr_b16 a[108:109], v18 offset:20480
    v_mfma_f32_16x16x32_bf16 v[128:131], a[8:11], a[48:51], v[128:131]
    ds_read_b64_tr_b16 a[110:111], v18 offset:20992
    v_mfma_f32_16x16x32_bf16 v[132:135], a[8:11], a[52:55], v[132:135]
    s_waitcnt lgkmcnt(15)
    v_mfma_f32_16x16x32_bf16 v[136:139], a[32:35], a[12:15], v[136:139]
    ds_read_b128 a[60:63], v9 offset:34816
    v_mfma_f32_16x16x32_bf16 v[140:143], a[36:39], a[12:15], v[140:143]
    ds_read_b128 a[64:67], v9 offset:36864
    buffer_load_dwordx4 v2, s[8:11], s22 offen offset:2048 lds
    v_mfma_f32_16x16x32_bf16 v[144:147], a[12:15], a[40:43], v[144:147]
    v_mfma_f32_16x16x32_bf16 v[148:151], a[12:15], a[44:47], v[148:151]
    ds_read_b128 a[68:71], v9 offset:38912
    v_mfma_f32_16x16x32_bf16 v[152:155], a[12:15], a[48:51], v[152:155]
    ds_read_b128 a[72:75], v9 offset:40960
    v_mfma_f32_16x16x32_bf16 v[156:159], a[12:15], a[52:55], v[156:159]
    ds_read_b128 a[76:79], v9 offset:43008
    v_mfma_f32_16x16x32_bf16 v[160:163], a[32:35], a[16:19], v[160:163]
    buffer_load_dwordx4 v3, s[8:11], s23 offen offset:3072 lds
    v_mfma_f32_16x16x32_bf16 v[164:167], a[36:39], a[16:19], v[164:167]
    ds_read_b128 a[80:83], v9 offset:45056
    v_mfma_f32_16x16x32_bf16 v[168:171], a[16:19], a[40:43], v[168:171]
    ds_read_b128 a[84:87], v9 offset:47104
    v_mfma_f32_16x16x32_bf16 v[172:175], a[16:19], a[44:47], v[172:175]
    v_mfma_f32_16x16x32_bf16 v[176:179], a[16:19], a[48:51], v[176:179]
    s_add_u32 s76, s76, 128
    v_mfma_f32_16x16x32_bf16 v[180:183], a[16:19], a[52:55], v[180:183]
    v_mfma_f32_16x16x32_bf16 v[184:187], a[32:35], a[20:23], v[184:187]
    v_mfma_f32_16x16x32_bf16 v[188:191], a[36:39], a[20:23], v[188:191]
    v_mfma_f32_16x16x32_bf16 v[192:195], a[20:23], a[40:43], v[192:195]
    v_mfma_f32_16x16x32_bf16 v[196:199], a[20:23], a[44:47], v[196:199]
    s_and_b32 s76, s76, 2047
    v_mfma_f32_16x16x32_bf16 v[200:203], a[20:23], a[48:51], v[200:203]
    v_mfma_f32_16x16x32_bf16 v[204:207], a[20:23], a[52:55], v[204:207]
    s_waitcnt lgkmcnt(15)
    v_mfma_f32_16x16x32_bf16 v[208:211], a[32:35], a[24:27], v[208:211]
    v_mfma_f32_16x16x32_bf16 v[212:215], a[36:39], a[24:27], v[212:215]
    s_add_u32 s8, s80, s76
    v_mfma_f32_16x16x32_bf16 v[216:219], a[24:27], a[40:43], v[216:219]
    v_mfma_f32_16x16x32_bf16 v[220:223], a[24:27], a[44:47], v[220:223]
    v_mfma_f32_16x16x32_bf16 v[224:227], a[24:27], a[48:51], v[224:227]
    v_mfma_f32_16x16x32_bf16 v[228:231], a[24:27], a[52:55], v[228:231]
    v_mfma_f32_16x16x32_bf16 v[232:235], a[32:35], a[28:31], v[232:235]
    s_addc_u32 s9, s81, 0
    v_mfma_f32_16x16x32_bf16 v[236:239], a[36:39], a[28:31], v[236:239]
    v_mfma_f32_16x16x32_bf16 v[240:243], a[28:31], a[40:43], v[240:243]
    v_mfma_f32_16x16x32_bf16 v[244:247], a[28:31], a[44:47], v[244:247]
    v_mfma_f32_16x16x32_bf16 v[248:251], a[28:31], a[48:51], v[248:251]
    v_mfma_f32_16x16x32_bf16 v[252:255], a[28:31], a[52:55], v[252:255]
    v_mfma_f32_16x16x32_bf16 v[64:67], a[88:91], a[56:59], v[64:67]
    v_mfma_f32_16x16x32_bf16 v[68:71], a[92:95], a[56:59], v[68:71]
    s_waitcnt lgkmcnt(13)
    v_mfma_f32_16x16x32_bf16 v[72:75], a[56:59], a[96:99], v[72:75]
    s_waitcnt lgkmcnt(11)
    v_mfma_f32_16x16x32_bf16 v[76:79], a[56:59], a[100:103], v[76:79]
    s_waitcnt lgkmcnt(9)
    v_mfma_f32_16x16x32_bf16 v[80:83], a[56:59], a[104:107], v[80:83]
    s_waitcnt lgkmcnt(7)
    v_mfma_f32_16x16x32_bf16 v[84:87], a[56:59], a[108:111], v[84:87]
    s_waitcnt lgkmcnt(6)
    v_mfma_f32_16x16x32_bf16 v[88:91], a[88:91], a[60:63], v[88:91]
    v_mfma_f32_16x16x32_bf16 v[92:95], a[92:95], a[60:63], v[92:95]
    s_waitcnt lgkmcnt(0)
    s_waitcnt vmcnt(8)
    s_barrier
    v_mfma_f32_16x16x32_bf16 v[96:99], a[60:63], a[96:99], v[96:99]
    ds_read_b128 a[0:3], v10 offset:0
    v_mfma_f32_16x16x32_bf16 v[100:103], a[60:63], a[100:103], v[100:103]
    ds_read_b64_tr_b16 a[32:33], v12 offset:0
    s_add_u32 m0, s49, 24576
    v_mfma_f32_16x16x32_bf16 v[104:107], a[60:63], a[104:107], v[104:107]
    ds_read_b64_tr_b16 a[34:35], v12 offset:512
    v_mfma_f32_16x16x32_bf16 v[108:111], a[60:63], a[108:111], v[108:111]
    ds_read_b64_tr_b16 a[36:37], v13 offset:0
    v_mfma_f32_16x16x32_bf16 v[112:115], a[88:91], a[64:67], v[112:115]
    ds_read_b64_tr_b16 a[38:39], v13 offset:512
    v_mfma_f32_16x16x32_bf16 v[116:119], a[92:95], a[64:67], v[116:119]
    buffer_load_dwordx4 v4, s[12:15], s24 offen offset:0 lds
    v_mfma_f32_16x16x32_bf16 v[120:123], a[64:67], a[96:99], v[120:123]
    ds_read_b64_tr_b16 a[40:41], v12 offset:8192
    v_mfma_f32_16x16x32_bf16 v[124:127], a[64:67], a[100:103], v[124:127]
    ds_read_b64_tr_b16 a[42:43], v12 offset:8704
    v_mfma_f32_16x16x32_bf16 v[128:131], a[64:67], a[104:107], v[128:131]
    ds_read_b64_tr_b16 a[44:45], v13 offset:8192
    v_mfma_f32_16x16x32_bf16 v[132:135], a[64:67], a[108:111], v[132:135]
    ds_read_b64_tr_b16 a[46:47], v13 offset:8704
    v_mfma_f32_16x16x32_bf16 v[136:139], a[88:91], a[68:71], v[136:139]
    ds_read_b64_tr_b16 a[48:49], v12 offset:16384
    buffer_load_dwordx4 v5, s[12:15], s25 offen offset:1024 lds
    v_mfma_f32_16x16x32_bf16 v[140:143], a[92:95], a[68:71], v[140:143]
    v_mfma_f32_16x16x32_bf16 v[144:147], a[68:71], a[96:99], v[144:147]
    ds_read_b64_tr_b16 a[50:51], v12 offset:16896
    v_mfma_f32_16x16x32_bf16 v[148:151], a[68:71], a[100:103], v[148:151]
    ds_read_b64_tr_b16 a[52:53], v13 offset:16384
    v_mfma_f32_16x16x32_bf16 v[152:155], a[68:71], a[104:107], v[152:155]
    ds_read_b64_tr_b16 a[54:55], v13 offset:16896
    v_mfma_f32_16x16x32_bf16 v[156:159], a[68:71], a[108:111], v[156:159]
    ds_read_b128 a[4:7], v10 offset:2048
    buffer_load_dwordx4 v4, s[12:15], s26 offen offset:2048 lds
    v_mfma_f32_16x16x32_bf16 v[160:163], a[88:91], a[72:75], v[160:163]
    ds_read_b128 a[8:11], v10 offset:4096
    v_mfma_f32_16x16x32_bf16 v[164:167], a[92:95], a[72:75], v[164:167]
    v_mfma_f32_16x16x32_bf16 v[168:171], a[72:75], a[96:99], v[168:171]
    ds_read_b128 a[12:15], v10 offset:6144
    v_mfma_f32_16x16x32_bf16 v[172:175], a[72:75], a[100:103], v[172:175]
    ds_read_b128 a[16:19], v10 offset:8192
    v_mfma_f32_16x16x32_bf16 v[176:179], a[72:75], a[104:107], v[176:179]
    ds_read_b128 a[20:23], v10 offset:10240
    buffer_load_dwordx4 v5, s[12:15], s27 offen offset:3072 lds
    v_mfma_f32_16x16x32_bf16 v[180:183], a[72:75], a[108:111], v[180:183]
    ds_read_b128 a[24:27], v10 offset:12288
    v_mfma_f32_16x16x32_bf16 v[184:187], a[88:91], a[76:79], v[184:187]
    ds_read_b128 a[28:31], v10 offset:14336
    v_mfma_f32_16x16x32_bf16 v[188:191], a[92:95], a[76:79], v[188:191]
    v_mfma_f32_16x16x32_bf16 v[192:195], a[76:79], a[96:99], v[192:195]
    s_add_u32 m0, s49, 28672
    v_mfma_f32_16x16x32_bf16 v[196:199], a[76:79], a[100:103], v[196:199]
    v_mfma_f32_16x16x32_bf16 v[200:203], a[76:79], a[104:107], v[200:203]
    v_mfma_f32_16x16x32_bf16 v[204:207], a[76:79], a[108:111], v[204:207]
    v_mfma_f32_16x16x32_bf16 v[208:211], a[88:91], a[80:83], v[208:211]
    v_mfma_f32_16x16x32_bf16 v[212:215], a[92:95], a[80:83], v[212:215]
    buffer_load_dwordx4 v4, s[12:15], s28 offen offset:0 lds
    v_mfma_f32_16x16x32_bf16 v[216:219], a[80:83], a[96:99], v[216:219]
    v_mfma_f32_16x16x32_bf16 v[220:223], a[80:83], a[100:103], v[220:223]
    v_mfma_f32_16x16x32_bf16 v[224:227], a[80:83], a[104:107], v[224:227]
    v_mfma_f32_16x16x32_bf16 v[228:231], a[80:83], a[108:111], v[228:231]
    v_mfma_f32_16x16x32_bf16 v[232:235], a[88:91], a[84:87], v[232:235]
    buffer_load_dwordx4 v5, s[12:15], s29 offen offset:1024 lds
    v_mfma_f32_16x16x32_bf16 v[236:239], a[92:95], a[84:87], v[236:239]
    v_mfma_f32_16x16x32_bf16 v[240:243], a[84:87], a[96:99], v[240:243]
    v_mfma_f32_16x16x32_bf16 v[244:247], a[84:87], a[100:103], v[244:247]
    v_mfma_f32_16x16x32_bf16 v[248:251], a[84:87], a[104:107], v[248:251]
    v_mfma_f32_16x16x32_bf16 v[252:255], a[84:87], a[108:111], v[252:255]
    s_waitcnt lgkmcnt(15)
    v_mfma_f32_16x16x32_bf16 v[64:67], a[32:35], a[0:3], v[64:67]
    ds_read_b128 a[56:59], v11 offset:0
    v_mfma_f32_16x16x32_bf16 v[68:71], a[36:39], a[0:3], v[68:71]
    ds_read_b64_tr_b16 a[88:89], v12 offset:4096
    s_add_u32 s77, s77, 393216
    s_waitcnt lgkmcnt(15)
    v_mfma_f32_16x16x32_bf16 v[72:75], a[0:3], a[40:43], v[72:75]
    ds_read_b64_tr_b16 a[90:91], v12 offset:4608
    s_waitcnt lgkmcnt(14)
    v_mfma_f32_16x16x32_bf16 v[76:79], a[0:3], a[44:47], v[76:79]
    s_waitcnt lgkmcnt(12)
    v_mfma_f32_16x16x32_bf16 v[80:83], a[0:3], a[48:51], v[80:83]
    ds_read_b64_tr_b16 a[92:93], v13 offset:4096
    s_waitcnt lgkmcnt(11)
    v_mfma_f32_16x16x32_bf16 v[84:87], a[0:3], a[52:55], v[84:87]
    ds_read_b64_tr_b16 a[94:95], v13 offset:4608
    s_waitcnt lgkmcnt(11)
    v_mfma_f32_16x16x32_bf16 v[88:91], a[32:35], a[4:7], v[88:91]
    v_mfma_f32_16x16x32_bf16 v[92:95], a[36:39], a[4:7], v[92:95]
    ds_read_b64_tr_b16 a[96:97], v12 offset:12288
    v_mfma_f32_16x16x32_bf16 v[96:99], a[4:7], a[40:43], v[96:99]
    ds_read_b64_tr_b16 a[98:99], v12 offset:12800
    v_mfma_f32_16x16x32_bf16 v[100:103], a[4:7], a[44:47], v[100:103]
    ds_read_b64_tr_b16 a[100:101], v13 offset:12288
    v_mfma_f32_16x16x32_bf16 v[104:107], a[4:7], a[48:51], v[104:107]
    s_cmp_eq_u32 s77, 6291456
    v_mfma_f32_16x16x32_bf16 v[108:111], a[4:7], a[52:55], v[108:111]
    ds_read_b64_tr_b16 a[102:103], v13 offset:12800
    s_waitcnt lgkmcnt(14)
    v_mfma_f32_16x16x32_bf16 v[112:115], a[32:35], a[8:11], v[112:115]
    ds_read_b64_tr_b16 a[104:105], v12 offset:20480
    v_mfma_f32_16x16x32_bf16 v[116:119], a[36:39], a[8:11], v[116:119]
    v_mfma_f32_16x16x32_bf16 v[120:123], a[8:11], a[40:43], v[120:123]
    ds_read_b64_tr_b16 a[106:107], v12 offset:20992
    v_mfma_f32_16x16x32_bf16 v[124:127], a[8:11], a[44:47], v[124:127]
    ds_read_b64_tr_b16 a[108:109], v13 offset:20480
    v_mfma_f32_16x16x32_bf16 v[128:131], a[8:11], a[48:51], v[128:131]
    ds_read_b64_tr_b16 a[110:111], v13 offset:20992
    v_mfma_f32_16x16x32_bf16 v[132:135], a[8:11], a[52:55], v[132:135]
    s_waitcnt lgkmcnt(15)
    v_mfma_f32_16x16x32_bf16 v[136:139], a[32:35], a[12:15], v[136:139]
    ds_read_b128 a[60:63], v11 offset:2048
    v_mfma_f32_16x16x32_bf16 v[140:143], a[36:39], a[12:15], v[140:143]
    ds_read_b128 a[64:67], v11 offset:4096
    s_cselect_b32 s77, 0, s77
    v_mfma_f32_16x16x32_bf16 v[144:147], a[12:15], a[40:43], v[144:147]
    v_mfma_f32_16x16x32_bf16 v[148:151], a[12:15], a[44:47], v[148:151]
    ds_read_b128 a[68:71], v11 offset:6144
    v_mfma_f32_16x16x32_bf16 v[152:155], a[12:15], a[48:51], v[152:155]
    ds_read_b128 a[72:75], v11 offset:8192
    v_mfma_f32_16x16x32_bf16 v[156:159], a[12:15], a[52:55], v[156:159]
    ds_read_b128 a[76:79], v11 offset:10240
    v_mfma_f32_16x16x32_bf16 v[160:163], a[32:35], a[16:19], v[160:163]
    v_mfma_f32_16x16x32_bf16 v[164:167], a[36:39], a[16:19], v[164:167]
    ds_read_b128 a[80:83], v11 offset:12288
    v_mfma_f32_16x16x32_bf16 v[168:171], a[16:19], a[40:43], v[168:171]
    ds_read_b128 a[84:87], v11 offset:14336
    v_mfma_f32_16x16x32_bf16 v[172:175], a[16:19], a[44:47], v[172:175]
    v_mfma_f32_16x16x32_bf16 v[176:179], a[16:19], a[48:51], v[176:179]
    s_add_u32 s12, s68, s77
    v_mfma_f32_16x16x32_bf16 v[180:183], a[16:19], a[52:55], v[180:183]
    v_mfma_f32_16x16x32_bf16 v[184:187], a[32:35], a[20:23], v[184:187]
    v_mfma_f32_16x16x32_bf16 v[188:191], a[36:39], a[20:23], v[188:191]
    v_mfma_f32_16x16x32_bf16 v[192:195], a[20:23], a[40:43], v[192:195]
    v_mfma_f32_16x16x32_bf16 v[196:199], a[20:23], a[44:47], v[196:199]
    v_mfma_f32_16x16x32_bf16 v[200:203], a[20:23], a[48:51], v[200:203]
    v_mfma_f32_16x16x32_bf16 v[204:207], a[20:23], a[52:55], v[204:207]
    s_waitcnt lgkmcnt(15)
    v_mfma_f32_16x16x32_bf16 v[208:211], a[32:35], a[24:27], v[208:211]
    v_mfma_f32_16x16x32_bf16 v[212:215], a[36:39], a[24:27], v[212:215]
    s_addc_u32 s13, s69, 0
    v_mfma_f32_16x16x32_bf16 v[216:219], a[24:27], a[40:43], v[216:219]
    v_mfma_f32_16x16x32_bf16 v[220:223], a[24:27], a[44:47], v[220:223]
    v_mfma_f32_16x16x32_bf16 v[224:227], a[24:27], a[48:51], v[224:227]
    v_mfma_f32_16x16x32_bf16 v[228:231], a[24:27], a[52:55], v[228:231]
    v_mfma_f32_16x16x32_bf16 v[232:235], a[32:35], a[28:31], v[232:235]
    v_mfma_f32_16x16x32_bf16 v[236:239], a[36:39], a[28:31], v[236:239]
    v_mfma_f32_16x16x32_bf16 v[240:243], a[28:31], a[40:43], v[240:243]
    v_mfma_f32_16x16x32_bf16 v[244:247], a[28:31], a[44:47], v[244:247]
    v_mfma_f32_16x16x32_bf16 v[248:251], a[28:31], a[48:51], v[248:251]
    v_mfma_f32_16x16x32_bf16 v[252:255], a[28:31], a[52:55], v[252:255]
    v_mfma_f32_16x16x32_bf16 v[64:67], a[88:91], a[56:59], v[64:67]
    v_mfma_f32_16x16x32_bf16 v[68:71], a[92:95], a[56:59], v[68:71]
    s_waitcnt lgkmcnt(13)
    v_mfma_f32_16x16x32_bf16 v[72:75], a[56:59], a[96:99], v[72:75]
    s_waitcnt lgkmcnt(11)
    v_mfma_f32_16x16x32_bf16 v[76:79], a[56:59], a[100:103], v[76:79]
    s_waitcnt lgkmcnt(9)
    v_mfma_f32_16x16x32_bf16 v[80:83], a[56:59], a[104:107], v[80:83]
    s_waitcnt lgkmcnt(7)
    v_mfma_f32_16x16x32_bf16 v[84:87], a[56:59], a[108:111], v[84:87]
    s_waitcnt lgkmcnt(6)
    v_mfma_f32_16x16x32_bf16 v[88:91], a[88:91], a[60:63], v[88:91]
    v_mfma_f32_16x16x32_bf16 v[92:95], a[92:95], a[60:63], v[92:95]
    s_waitcnt lgkmcnt(0)
    s_waitcnt vmcnt(0)
    s_barrier
    v_mfma_f32_16x16x32_bf16 v[96:99], a[60:63], a[96:99], v[96:99]
    ds_read_b128 a[0:3], v8 offset:0
    v_mfma_f32_16x16x32_bf16 v[100:103], a[60:63], a[100:103], v[100:103]
    ds_read_b64_tr_b16 a[32:33], v17 offset:0
    v_mfma_f32_16x16x32_bf16 v[104:107], a[60:63], a[104:107], v[104:107]
    ds_read_b64_tr_b16 a[34:35], v17 offset:512
    v_mfma_f32_16x16x32_bf16 v[108:111], a[60:63], a[108:111], v[108:111]
    ds_read_b64_tr_b16 a[36:37], v18 offset:0
    v_mfma_f32_16x16x32_bf16 v[112:115], a[88:91], a[64:67], v[112:115]
    ds_read_b64_tr_b16 a[38:39], v18 offset:512
    v_mfma_f32_16x16x32_bf16 v[116:119], a[92:95], a[64:67], v[116:119]
    v_mfma_f32_16x16x32_bf16 v[120:123], a[64:67], a[96:99], v[120:123]
    ds_read_b64_tr_b16 a[40:41], v17 offset:8192
    v_mfma_f32_16x16x32_bf16 v[124:127], a[64:67], a[100:103], v[124:127]
    ds_read_b64_tr_b16 a[42:43], v17 offset:8704
    v_mfma_f32_16x16x32_bf16 v[128:131], a[64:67], a[104:107], v[128:131]
    ds_read_b64_tr_b16 a[44:45], v18 offset:8192
    v_mfma_f32_16x16x32_bf16 v[132:135], a[64:67], a[108:111], v[132:135]
    ds_read_b64_tr_b16 a[46:47], v18 offset:8704
    v_mfma_f32_16x16x32_bf16 v[136:139], a[88:91], a[68:71], v[136:139]
    ds_read_b64_tr_b16 a[48:49], v17 offset:16384
    v_mfma_f32_16x16x32_bf16 v[140:143], a[92:95], a[68:71], v[140:143]
    v_mfma_f32_16x16x32_bf16 v[144:147], a[68:71], a[96:99], v[144:147]
    ds_read_b64_tr_b16 a[50:51], v17 offset:16896
    v_mfma_f32_16x16x32_bf16 v[148:151], a[68:71], a[100:103], v[148:151]
    ds_read_b64_tr_b16 a[52:53], v18 offset:16384
    v_mfma_f32_16x16x32_bf16 v[152:155], a[68:71], a[104:107], v[152:155]
    ds_read_b64_tr_b16 a[54:55], v18 offset:16896
    v_mfma_f32_16x16x32_bf16 v[156:159], a[68:71], a[108:111], v[156:159]
    ds_read_b128 a[4:7], v8 offset:2048
    v_mfma_f32_16x16x32_bf16 v[160:163], a[88:91], a[72:75], v[160:163]
    ds_read_b128 a[8:11], v8 offset:4096
    v_mfma_f32_16x16x32_bf16 v[164:167], a[92:95], a[72:75], v[164:167]
    v_mfma_f32_16x16x32_bf16 v[168:171], a[72:75], a[96:99], v[168:171]
    ds_read_b128 a[12:15], v8 offset:6144
    v_mfma_f32_16x16x32_bf16 v[172:175], a[72:75], a[100:103], v[172:175]
    ds_read_b128 a[16:19], v8 offset:8192
    v_mfma_f32_16x16x32_bf16 v[176:179], a[72:75], a[104:107], v[176:179]
    ds_read_b128 a[20:23], v8 offset:10240
    v_mfma_f32_16x16x32_bf16 v[180:183], a[72:75], a[108:111], v[180:183]
    ds_read_b128 a[24:27], v8 offset:12288
    v_mfma_f32_16x16x32_bf16 v[184:187], a[88:91], a[76:79], v[184:187]
    ds_read_b128 a[28:31], v8 offset:14336
    v_mfma_f32_16x16x32_bf16 v[188:191], a[92:95], a[76:79], v[188:191]
    v_mfma_f32_16x16x32_bf16 v[192:195], a[76:79], a[96:99], v[192:195]
    v_mfma_f32_16x16x32_bf16 v[196:199], a[76:79], a[100:103], v[196:199]
    v_mfma_f32_16x16x32_bf16 v[200:203], a[76:79], a[104:107], v[200:203]
    v_mfma_f32_16x16x32_bf16 v[204:207], a[76:79], a[108:111], v[204:207]
    v_mfma_f32_16x16x32_bf16 v[208:211], a[88:91], a[80:83], v[208:211]
    v_mfma_f32_16x16x32_bf16 v[212:215], a[92:95], a[80:83], v[212:215]
    v_mfma_f32_16x16x32_bf16 v[216:219], a[80:83], a[96:99], v[216:219]
    v_mfma_f32_16x16x32_bf16 v[220:223], a[80:83], a[100:103], v[220:223]
    v_mfma_f32_16x16x32_bf16 v[224:227], a[80:83], a[104:107], v[224:227]
    v_mfma_f32_16x16x32_bf16 v[228:231], a[80:83], a[108:111], v[228:231]
    v_mfma_f32_16x16x32_bf16 v[232:235], a[88:91], a[84:87], v[232:235]
    v_mfma_f32_16x16x32_bf16 v[236:239], a[92:95], a[84:87], v[236:239]
    v_mfma_f32_16x16x32_bf16 v[240:243], a[84:87], a[96:99], v[240:243]
    v_mfma_f32_16x16x32_bf16 v[244:247], a[84:87], a[100:103], v[244:247]
    v_mfma_f32_16x16x32_bf16 v[248:251], a[84:87], a[104:107], v[248:251]
    v_mfma_f32_16x16x32_bf16 v[252:255], a[84:87], a[108:111], v[252:255]
    s_waitcnt lgkmcnt(15)
    v_mfma_f32_16x16x32_bf16 v[64:67], a[32:35], a[0:3], v[64:67]
    ds_read_b128 a[56:59], v9 offset:0
    v_mfma_f32_16x16x32_bf16 v[68:71], a[36:39], a[0:3], v[68:71]
    ds_read_b64_tr_b16 a[88:89], v17 offset:4096
    s_waitcnt lgkmcnt(15)
    v_mfma_f32_16x16x32_bf16 v[72:75], a[0:3], a[40:43], v[72:75]
    ds_read_b64_tr_b16 a[90:91], v17 offset:4608
    s_waitcnt lgkmcnt(14)
    v_mfma_f32_16x16x32_bf16 v[76:79], a[0:3], a[44:47], v[76:79]
    s_waitcnt lgkmcnt(12)
    v_mfma_f32_16x16x32_bf16 v[80:83], a[0:3], a[48:51], v[80:83]
    ds_read_b64_tr_b16 a[92:93], v18 offset:4096
    s_waitcnt lgkmcnt(11)
    v_mfma_f32_16x16x32_bf16 v[84:87], a[0:3], a[52:55], v[84:87]
    ds_read_b64_tr_b16 a[94:95], v18 offset:4608
    s_waitcnt lgkmcnt(11)
    v_mfma_f32_16x16x32_bf16 v[88:91], a[32:35], a[4:7], v[88:91]
    v_mfma_f32_16x16x32_bf16 v[92:95], a[36:39], a[4:7], v[92:95]
    ds_read_b64_tr_b16 a[96:97], v17 offset:12288
    v_mfma_f32_16x16x32_bf16 v[96:99], a[4:7], a[40:43], v[96:99]
    ds_read_b64_tr_b16 a[98:99], v17 offset:12800
    v_mfma_f32_16x16x32_bf16 v[100:103], a[4:7], a[44:47], v[100:103]
    ds_read_b64_tr_b16 a[100:101], v18 offset:12288
    v_mfma_f32_16x16x32_bf16 v[104:107], a[4:7], a[48:51], v[104:107]
    v_mfma_f32_16x16x32_bf16 v[108:111], a[4:7], a[52:55], v[108:111]
    ds_read_b64_tr_b16 a[102:103], v18 offset:12800
    s_waitcnt lgkmcnt(14)
    v_mfma_f32_16x16x32_bf16 v[112:115], a[32:35], a[8:11], v[112:115]
    ds_read_b64_tr_b16 a[104:105], v17 offset:20480
    v_mfma_f32_16x16x32_bf16 v[116:119], a[36:39], a[8:11], v[116:119]
    v_mfma_f32_16x16x32_bf16 v[120:123], a[8:11], a[40:43], v[120:123]
    ds_read_b64_tr_b16 a[106:107], v17 offset:20992
    v_mfma_f32_16x16x32_bf16 v[124:127], a[8:11], a[44:47], v[124:127]
    ds_read_b64_tr_b16 a[108:109], v18 offset:20480
    v_mfma_f32_16x16x32_bf16 v[128:131], a[8:11], a[48:51], v[128:131]
    ds_read_b64_tr_b16 a[110:111], v18 offset:20992
    v_mfma_f32_16x16x32_bf16 v[132:135], a[8:11], a[52:55], v[132:135]
    s_waitcnt lgkmcnt(15)
    v_mfma_f32_16x16x32_bf16 v[136:139], a[32:35], a[12:15], v[136:139]
    ds_read_b128 a[60:63], v9 offset:2048
    v_mfma_f32_16x16x32_bf16 v[140:143], a[36:39], a[12:15], v[140:143]
    ds_read_b128 a[64:67], v9 offset:4096
    v_mfma_f32_16x16x32_bf16 v[144:147], a[12:15], a[40:43], v[144:147]
    v_mfma_f32_16x16x32_bf16 v[148:151], a[12:15], a[44:47], v[148:151]
    ds_read_b128 a[68:71], v9 offset:6144
    v_mfma_f32_16x16x32_bf16 v[152:155], a[12:15], a[48:51], v[152:155]
    ds_read_b128 a[72:75], v9 offset:8192
    v_mfma_f32_16x16x32_bf16 v[156:159], a[12:15], a[52:55], v[156:159]
    ds_read_b128 a[76:79], v9 offset:10240
    v_mfma_f32_16x16x32_bf16 v[160:163], a[32:35], a[16:19], v[160:163]
    v_mfma_f32_16x16x32_bf16 v[164:167], a[36:39], a[16:19], v[164:167]
    ds_read_b128 a[80:83], v9 offset:12288
    v_mfma_f32_16x16x32_bf16 v[168:171], a[16:19], a[40:43], v[168:171]
    ds_read_b128 a[84:87], v9 offset:14336
    v_mfma_f32_16x16x32_bf16 v[172:175], a[16:19], a[44:47], v[172:175]
    v_mfma_f32_16x16x32_bf16 v[176:179], a[16:19], a[48:51], v[176:179]
    v_mfma_f32_16x16x32_bf16 v[180:183], a[16:19], a[52:55], v[180:183]
    v_mfma_f32_16x16x32_bf16 v[184:187], a[32:35], a[20:23], v[184:187]
    v_mfma_f32_16x16x32_bf16 v[188:191], a[36:39], a[20:23], v[188:191]
    v_mfma_f32_16x16x32_bf16 v[192:195], a[20:23], a[40:43], v[192:195]
    v_mfma_f32_16x16x32_bf16 v[196:199], a[20:23], a[44:47], v[196:199]
    v_mfma_f32_16x16x32_bf16 v[200:203], a[20:23], a[48:51], v[200:203]
    v_mfma_f32_16x16x32_bf16 v[204:207], a[20:23], a[52:55], v[204:207]
    s_waitcnt lgkmcnt(15)
    v_mfma_f32_16x16x32_bf16 v[208:211], a[32:35], a[24:27], v[208:211]
    v_mfma_f32_16x16x32_bf16 v[212:215], a[36:39], a[24:27], v[212:215]
    v_mfma_f32_16x16x32_bf16 v[216:219], a[24:27], a[40:43], v[216:219]
    v_mfma_f32_16x16x32_bf16 v[220:223], a[24:27], a[44:47], v[220:223]
    v_mfma_f32_16x16x32_bf16 v[224:227], a[24:27], a[48:51], v[224:227]
    v_mfma_f32_16x16x32_bf16 v[228:231], a[24:27], a[52:55], v[228:231]
    v_mfma_f32_16x16x32_bf16 v[232:235], a[32:35], a[28:31], v[232:235]
    v_mfma_f32_16x16x32_bf16 v[236:239], a[36:39], a[28:31], v[236:239]
    v_mfma_f32_16x16x32_bf16 v[240:243], a[28:31], a[40:43], v[240:243]
    v_mfma_f32_16x16x32_bf16 v[244:247], a[28:31], a[44:47], v[244:247]
    v_mfma_f32_16x16x32_bf16 v[248:251], a[28:31], a[48:51], v[248:251]
    v_mfma_f32_16x16x32_bf16 v[252:255], a[28:31], a[52:55], v[252:255]
    v_mfma_f32_16x16x32_bf16 v[64:67], a[88:91], a[56:59], v[64:67]
    v_mfma_f32_16x16x32_bf16 v[68:71], a[92:95], a[56:59], v[68:71]
    s_waitcnt lgkmcnt(13)
    v_mfma_f32_16x16x32_bf16 v[72:75], a[56:59], a[96:99], v[72:75]
    s_waitcnt lgkmcnt(11)
    v_mfma_f32_16x16x32_bf16 v[76:79], a[56:59], a[100:103], v[76:79]
    s_waitcnt lgkmcnt(9)
    v_mfma_f32_16x16x32_bf16 v[80:83], a[56:59], a[104:107], v[80:83]
    s_waitcnt lgkmcnt(7)
    v_mfma_f32_16x16x32_bf16 v[84:87], a[56:59], a[108:111], v[84:87]
    s_waitcnt lgkmcnt(6)
    v_mfma_f32_16x16x32_bf16 v[88:91], a[88:91], a[60:63], v[88:91]
    v_mfma_f32_16x16x32_bf16 v[92:95], a[92:95], a[60:63], v[92:95]
    v_mfma_f32_16x16x32_bf16 v[96:99], a[60:63], a[96:99], v[96:99]
    v_mfma_f32_16x16x32_bf16 v[100:103], a[60:63], a[100:103], v[100:103]
    v_mfma_f32_16x16x32_bf16 v[104:107], a[60:63], a[104:107], v[104:107]
    v_mfma_f32_16x16x32_bf16 v[108:111], a[60:63], a[108:111], v[108:111]
    s_waitcnt lgkmcnt(5)
    v_mfma_f32_16x16x32_bf16 v[112:115], a[88:91], a[64:67], v[112:115]
    v_mfma_f32_16x16x32_bf16 v[116:119], a[92:95], a[64:67], v[116:119]
    v_mfma_f32_16x16x32_bf16 v[120:123], a[64:67], a[96:99], v[120:123]
    v_mfma_f32_16x16x32_bf16 v[124:127], a[64:67], a[100:103], v[124:127]
    v_mfma_f32_16x16x32_bf16 v[128:131], a[64:67], a[104:107], v[128:131]
    v_mfma_f32_16x16x32_bf16 v[132:135], a[64:67], a[108:111], v[132:135]
    s_waitcnt lgkmcnt(4)
    v_mfma_f32_16x16x32_bf16 v[136:139], a[88:91], a[68:71], v[136:139]
    v_mfma_f32_16x16x32_bf16 v[140:143], a[92:95], a[68:71], v[140:143]
    v_mfma_f32_16x16x32_bf16 v[144:147], a[68:71], a[96:99], v[144:147]
    v_mfma_f32_16x16x32_bf16 v[148:151], a[68:71], a[100:103], v[148:151]
    v_mfma_f32_16x16x32_bf16 v[152:155], a[68:71], a[104:107], v[152:155]
    v_mfma_f32_16x16x32_bf16 v[156:159], a[68:71], a[108:111], v[156:159]
    s_waitcnt lgkmcnt(3)
    v_mfma_f32_16x16x32_bf16 v[160:163], a[88:91], a[72:75], v[160:163]
    v_mfma_f32_16x16x32_bf16 v[164:167], a[92:95], a[72:75], v[164:167]
    v_mfma_f32_16x16x32_bf16 v[168:171], a[72:75], a[96:99], v[168:171]
    v_mfma_f32_16x16x32_bf16 v[172:175], a[72:75], a[100:103], v[172:175]
    v_mfma_f32_16x16x32_bf16 v[176:179], a[72:75], a[104:107], v[176:179]
    v_mfma_f32_16x16x32_bf16 v[180:183], a[72:75], a[108:111], v[180:183]
    s_waitcnt lgkmcnt(2)
    v_mfma_f32_16x16x32_bf16 v[184:187], a[88:91], a[76:79], v[184:187]
    v_mfma_f32_16x16x32_bf16 v[188:191], a[92:95], a[76:79], v[188:191]
    v_mfma_f32_16x16x32_bf16 v[192:195], a[76:79], a[96:99], v[192:195]
    v_mfma_f32_16x16x32_bf16 v[196:199], a[76:79], a[100:103], v[196:199]
    v_mfma_f32_16x16x32_bf16 v[200:203], a[76:79], a[104:107], v[200:203]
    v_mfma_f32_16x16x32_bf16 v[204:207], a[76:79], a[108:111], v[204:207]
    s_waitcnt lgkmcnt(1)
    v_mfma_f32_16x16x32_bf16 v[208:211], a[88:91], a[80:83], v[208:211]
    v_mfma_f32_16x16x32_bf16 v[212:215], a[92:95], a[80:83], v[212:215]
    v_mfma_f32_16x16x32_bf16 v[216:219], a[80:83], a[96:99], v[216:219]
    v_mfma_f32_16x16x32_bf16 v[220:223], a[80:83], a[100:103], v[220:223]
    v_mfma_f32_16x16x32_bf16 v[224:227], a[80:83], a[104:107], v[224:227]
    v_mfma_f32_16x16x32_bf16 v[228:231], a[80:83], a[108:111], v[228:231]
    s_waitcnt lgkmcnt(0)
    v_mfma_f32_16x16x32_bf16 v[232:235], a[88:91], a[84:87], v[232:235]
    v_mfma_f32_16x16x32_bf16 v[236:239], a[92:95], a[84:87], v[236:239]
    v_mfma_f32_16x16x32_bf16 v[240:243], a[84:87], a[96:99], v[240:243]
    v_mfma_f32_16x16x32_bf16 v[244:247], a[84:87], a[100:103], v[244:247]
    v_mfma_f32_16x16x32_bf16 v[248:251], a[84:87], a[104:107], v[248:251]
    v_mfma_f32_16x16x32_bf16 v[252:255], a[84:87], a[108:111], v[252:255]
LepiB:
    s_load_dwordx4 s[68:71], s[0:1], 40
    s_load_dwordx2 s[72:73], s[0:1], 88
    s_load_dwordx2 s[74:75], s[0:1], 104
    s_load_dwordx2 s[80:81], s[0:1], 0
    s_load_dwordx2 s[82:83], s[0:1], 64
    s_add_u32 s91, s91, 1
    s_mov_b32 s54, 0x3fb8aa3b
    s_mov_b32 s55, s54
    s_mov_b32 s56, 0x358637bd
    s_mov_b32 s57, s56
    s_nop 7
    v_pk_mul_f32 v[56:57], v[72:73], s[54:55]
    v_pk_mul_f32 v[60:61], v[96:97], s[54:55]
    v_pk_mul_f32 v[58:59], v[74:75], s[54:55]
    v_pk_mul_f32 v[62:63], v[98:99], s[54:55]
    v_exp_f32 v56, v56
    v_exp_f32 v60, v60
    v_exp_f32 v57, v57
    v_exp_f32 v61, v61
    v_exp_f32 v58, v58
    v_exp_f32 v62, v62
    v_exp_f32 v59, v59
    v_exp_f32 v63, v63
    v_pk_add_f32 v[56:57], v[56:57], s[56:57] clamp
    v_pk_add_f32 v[60:61], v[60:61], s[56:57] clamp
    v_pk_add_f32 v[58:59], v[58:59], s[56:57] clamp
    v_pk_add_f32 v[62:63], v[62:63], s[56:57] clamp
    v_pk_add_f32 v[72:73], v[72:73], v[56:57]
    v_pk_add_f32 v[96:97], v[96:97], v[60:61]
    v_pk_add_f32 v[74:75], v[74:75], v[58:59]
    v_pk_add_f32 v[98:99], v[98:99], v[62:63]
    v_max_f32 v72, v72, v56
    v_max_f32 v96, v96, v60
    v_max_f32 v73, v73, v57
    v_max_f32 v97, v97, v61
    v_max_f32 v74, v74, v58
    v_max_f32 v98, v98, v62
    v_max_f32 v75, v75, v59
    v_max_f32 v99, v99, v63
    v_cvt_pk_bf16_f32 v72, v72, v73
    v_cvt_pk_bf16_f32 v73, v74, v75
    v_cvt_pk_bf16_f32 v74, v96, v97
    v_cvt_pk_bf16_f32 v75, v98, v99
    v_pk_mul_f32 v[56:57], v[76:77], s[54:55]
    v_pk_mul_f32 v[60:61], v[100:101], s[54:55]
    v_pk_mul_f32 v[58:59], v[78:79], s[54:55]
    v_pk_mul_f32 v[62:63], v[102:103], s[54:55]
    v_exp_f32 v56, v56
    v_exp_f32 v60, v60
    v_exp_f32 v57, v57
    v_exp_f32 v61, v61
    v_exp_f32 v58, v58
    v_exp_f32 v62, v62
    v_exp_f32 v59, v59
    v_exp_f32 v63, v63
    v_pk_add_f32 v[56:57], v[56:57], s[56:57] clamp
    v_pk_add_f32 v[60:61], v[60:61], s[56:57] clamp
    v_pk_add_f32 v[58:59], v[58:59], s[56:57] clamp
    v_pk_add_f32 v[62:63], v[62:63], s[56:57] clamp
    v_pk_add_f32 v[76:77], v[76:77], v[56:57]
    v_pk_add_f32 v[100:101], v[100:101], v[60:61]
    v_pk_add_f32 v[78:79], v[78:79], v[58:59]
    v_pk_add_f32 v[102:103], v[102:103], v[62:63]
    v_max_f32 v76, v76, v56
    v_max_f32 v100, v100, v60
    v_max_f32 v77, v77, v57
    v_max_f32 v101, v101, v61
    v_max_f32 v78, v78, v58
    v_max_f32 v102, v102, v62
    v_max_f32 v79, v79, v59
    v_max_f32 v103, v103, v63
    v_cvt_pk_bf16_f32 v76, v76, v77
    v_cvt_pk_bf16_f32 v77, v78, v79
    v_cvt_pk_bf16_f32 v78, v100, v101
    v_cvt_pk_bf16_f32 v79, v102, v103
    v_cvt_pk_bf16_f32 v80, v80, v81
    v_cvt_pk_bf16_f32 v81, v82, v83
    v_cvt_pk_bf16_f32 v82, v104, v105
    v_cvt_pk_bf16_f32 v83, v106, v107
    v_cvt_pk_bf16_f32 v84, v84, v85
    v_cvt_pk_bf16_f32 v85, v86, v87
    v_cvt_pk_bf16_f32 v86, v108, v109
    v_cvt_pk_bf16_f32 v87, v110, v111
    v_pk_mul_f32 v[56:57], v[120:121], s[54:55]
    v_pk_mul_f32 v[60:61], v[144:145], s[54:55]
    v_pk_mul_f32 v[58:59], v[122:123], s[54:55]
    v_pk_mul_f32 v[62:63], v[146:147], s[54:55]
    v_exp_f32 v56, v56
    v_exp_f32 v60, v60
    v_exp_f32 v57, v57
    v_exp_f32 v61, v61
    v_exp_f32 v58, v58
    v_exp_f32 v62, v62
    v_exp_f32 v59, v59
    v_exp_f32 v63, v63
    v_pk_add_f32 v[56:57], v[56:57], s[56:57] clamp
    v_pk_add_f32 v[60:61], v[60:61], s[56:57] clamp
    v_pk_add_f32 v[58:59], v[58:59], s[56:57] clamp
    v_pk_add_f32 v[62:63], v[62:63], s[56:57] clamp
    v_pk_add_f32 v[120:121], v[120:121], v[56:57]
    v_pk_add_f32 v[144:145], v[144:145], v[60:61]
    v_pk_add_f32 v[122:123], v[122:123], v[58:59]
    v_pk_add_f32 v[146:147], v[146:147], v[62:63]
    v_max_f32 v120, v120, v56
    v_max_f32 v144, v144, v60
    v_max_f32 v121, v121, v57
    v_max_f32 v145, v145, v61
    v_max_f32 v122, v122, v58
    v_max_f32 v146, v146, v62
    v_max_f32 v123, v123, v59
    v_max_f32 v147, v147, v63
    v_cvt_pk_bf16_f32 v120, v120, v121
    v_cvt_pk_bf16_f32 v121, v122, v123
    v_cvt_pk_bf16_f32 v122, v144, v145
    v_cvt_pk_bf16_f32 v123, v146, v147
    v_pk_mul_f32 v[56:57], v[124:125], s[54:55]
    v_pk_mul_f32 v[60:61], v[148:149], s[54:55]
    v_pk_mul_f32 v[58:59], v[126:127], s[54:55]
    v_pk_mul_f32 v[62:63], v[150:151], s[54:55]
    v_exp_f32 v56, v56
    v_exp_f32 v60, v60
    v_exp_f32 v57, v57
    v_exp_f32 v61, v61
    v_exp_f32 v58, v58
    v_exp_f32 v62, v62
    v_exp_f32 v59, v59
    v_exp_f32 v63, v63
    v_pk_add_f32 v[56:57], v[56:57], s[56:57] clamp
    v_pk_add_f32 v[60:61], v[60:61], s[56:57] clamp
    v_pk_add_f32 v[58:59], v[58:59], s[56:57] clamp
    v_pk_add_f32 v[62:63], v[62:63], s[56:57] clamp
    v_pk_add_f32 v[124:125], v[124:125], v[56:57]
    v_pk_add_f32 v[148:149], v[148:149], v[60:61]
    v_pk_add_f32 v[126:127], v[126:127], v[58:59]
    v_pk_add_f32 v[150:151], v[150:151], v[62:63]
    v_max_f32 v124, v124, v56
    v_max_f32 v148, v148, v60
    v_max_f32 v125, v125, v57
    v_max_f32 v149, v149, v61
    v_max_f32 v126, v126, v58
    v_max_f32 v150, v150, v62
    v_max_f32 v127, v127, v59
    v_max_f32 v151, v151, v63
    v_cvt_pk_bf16_f32 v124, v124, v125
    v_cvt_pk_bf16_f32 v125, v126, v127
    v_cvt_pk_bf16_f32 v126, v148, v149
    v_cvt_pk_bf16_f32 v127, v150, v151
    v_cvt_pk_bf16_f32 v128, v128, v129
    v_cvt_pk_bf16_f32 v129, v130, v131
    v_cvt_pk_bf16_f32 v130, v152, v153
    v_cvt_pk_bf16_f32 v131, v154, v155
    v_cvt_pk_bf16_f32 v132, v132, v133
    v_cvt_pk_bf16_f32 v133, v134, v135
    v_cvt_pk_bf16_f32 v134, v156, v157
    v_cvt_pk_bf16_f32 v135, v158, v159
    v_pk_mul_f32 v[56:57], v[168:169], s[54:55]
    v_pk_mul_f32 v[60:61], v[192:193], s[54:55]
    v_pk_mul_f32 v[58:59], v[170:171], s[54:55]
    v_pk_mul_f32 v[62:63], v[194:195], s[54:55]
    v_exp_f32 v56, v56
    v_exp_f32 v60, v60
    v_exp_f32 v57, v57
    v_exp_f32 v61, v61
    v_exp_f32 v58, v58
    v_exp_f32 v62, v62
    v_exp_f32 v59, v59
    v_exp_f32 v63, v63
    v_pk_add_f32 v[56:57], v[56:57], s[56:57] clamp
    v_pk_add_f32 v[60:61], v[60:61], s[56:57] clamp
    v_pk_add_f32 v[58:59], v[58:59], s[56:57] clamp
    v_pk_add_f32 v[62:63], v[62:63], s[56:57] clamp
    v_pk_add_f32 v[168:169], v[168:169], v[56:57]
    v_pk_add_f32 v[192:193], v[192:193], v[60:61]
    v_pk_add_f32 v[170:171], v[170:171], v[58:59]
    v_pk_add_f32 v[194:195], v[194:195], v[62:63]
    v_max_f32 v168, v168, v56
    v_max_f32 v192, v192, v60
    v_max_f32 v169, v169, v57
    v_max_f32 v193, v193, v61
    v_max_f32 v170, v170, v58
    v_max_f32 v194, v194, v62
    v_max_f32 v171, v171, v59
    v_max_f32 v195, v195, v63
    v_cvt_pk_bf16_f32 v168, v168, v169
    v_cvt_pk_bf16_f32 v169, v170, v171
    v_cvt_pk_bf16_f32 v170, v192, v193
    v_cvt_pk_bf16_f32 v171, v194, v195
    v_pk_mul_f32 v[56:57], v[172:173], s[54:55]
    v_pk_mul_f32 v[60:61], v[196:197], s[54:55]
    v_pk_mul_f32 v[58:59], v[174:175], s[54:55]
    v_pk_mul_f32 v[62:63], v[198:199], s[54:55]
    v_exp_f32 v56, v56
    v_exp_f32 v60, v60
    v_exp_f32 v57, v57
    v_exp_f32 v61, v61
    v_exp_f32 v58, v58
    v_exp_f32 v62, v62
    v_exp_f32 v59, v59
    v_exp_f32 v63, v63
    v_pk_add_f32 v[56:57], v[56:57], s[56:57] clamp
    v_pk_add_f32 v[60:61], v[60:61], s[56:57] clamp
    v_pk_add_f32 v[58:59], v[58:59], s[56:57] clamp
    v_pk_add_f32 v[62:63], v[62:63], s[56:57] clamp
    v_pk_add_f32 v[172:173], v[172:173], v[56:57]
    v_pk_add_f32 v[196:197], v[196:197], v[60:61]
    v_pk_add_f32 v[174:175], v[174:175], v[58:59]
    v_pk_add_f32 v[198:199], v[198:199], v[62:63]
    v_max_f32 v172, v172, v56
    v_max_f32 v196, v196, v60
    v_max_f32 v173, v173, v57
    v_max_f32 v197, v197, v61
    v_max_f32 v174, v174, v58
    v_max_f32 v198, v198, v62
    v_max_f32 v175, v175, v59
    v_max_f32 v199, v199, v63
    v_cvt_pk_bf16_f32 v172, v172, v173
    v_cvt_pk_bf16_f32 v173, v174, v175
    v_cvt_pk_bf16_f32 v174, v196, v197
    v_cvt_pk_bf16_f32 v175, v198, v199
    v_cvt_pk_bf16_f32 v176, v176, v177
    v_cvt_pk_bf16_f32 v177, v178, v179
    v_cvt_pk_bf16_f32 v178, v200, v201
    v_cvt_pk_bf16_f32 v179, v202, v203
    v_cvt_pk_bf16_f32 v180, v180, v181
    v_cvt_pk_bf16_f32 v181, v182, v183
    v_cvt_pk_bf16_f32 v182, v204, v205
    v_cvt_pk_bf16_f32 v183, v206, v207
    v_pk_mul_f32 v[56:57], v[216:217], s[54:55]
    v_pk_mul_f32 v[60:61], v[240:241], s[54:55]
    v_pk_mul_f32 v[58:59], v[218:219], s[54:55]
    v_pk_mul_f32 v[62:63], v[242:243], s[54:55]
    v_exp_f32 v56, v56
    v_exp_f32 v60, v60
    v_exp_f32 v57, v57
    v_exp_f32 v61, v61
    v_exp_f32 v58, v58
    v_exp_f32 v62, v62
    v_exp_f32 v59, v59
    v_exp_f32 v63, v63
    v_pk_add_f32 v[56:57], v[56:57], s[56:57] clamp
    v_pk_add_f32 v[60:61], v[60:61], s[56:57] clamp
    v_pk_add_f32 v[58:59], v[58:59], s[56:57] clamp
    v_pk_add_f32 v[62:63], v[62:63], s[56:57] clamp
    v_pk_add_f32 v[216:217], v[216:217], v[56:57]
    v_pk_add_f32 v[240:241], v[240:241], v[60:61]
    v_pk_add_f32 v[218:219], v[218:219], v[58:59]
    v_pk_add_f32 v[242:243], v[242:243], v[62:63]
    v_max_f32 v216, v216, v56
    v_max_f32 v240, v240, v60
    v_max_f32 v217, v217, v57
    v_max_f32 v241, v241, v61
    v_max_f32 v218, v218, v58
    v_max_f32 v242, v242, v62
    v_max_f32 v219, v219, v59
    v_max_f32 v243, v243, v63
    v_cvt_pk_bf16_f32 v216, v216, v217
    v_cvt_pk_bf16_f32 v217, v218, v219
    v_cvt_pk_bf16_f32 v218, v240, v241
    v_cvt_pk_bf16_f32 v219, v242, v243
    v_pk_mul_f32 v[56:57], v[220:221], s[54:55]
    v_pk_mul_f32 v[60:61], v[244:245], s[54:55]
    v_pk_mul_f32 v[58:59], v[222:223], s[54:55]
    v_pk_mul_f32 v[62:63], v[246:247], s[54:55]
    v_exp_f32 v56, v56
    v_exp_f32 v60, v60
    v_exp_f32 v57, v57
    v_exp_f32 v61, v61
    v_exp_f32 v58, v58
    v_exp_f32 v62, v62
    v_exp_f32 v59, v59
    v_exp_f32 v63, v63
    v_pk_add_f32 v[56:57], v[56:57], s[56:57] clamp
    v_pk_add_f32 v[60:61], v[60:61], s[56:57] clamp
    v_pk_add_f32 v[58:59], v[58:59], s[56:57] clamp
    v_pk_add_f32 v[62:63], v[62:63], s[56:57] clamp
    v_pk_add_f32 v[220:221], v[220:221], v[56:57]
    v_pk_add_f32 v[244:245], v[244:245], v[60:61]
    v_pk_add_f32 v[222:223], v[222:223], v[58:59]
    v_pk_add_f32 v[246:247], v[246:247], v[62:63]
    v_max_f32 v220, v220, v56
    v_max_f32 v244, v244, v60
    v_max_f32 v221, v221, v57
    v_max_f32 v245, v245, v61
    v_max_f32 v222, v222, v58
    v_max_f32 v246, v246, v62
    v_max_f32 v223, v223, v59
    v_max_f32 v247, v247, v63
    v_cvt_pk_bf16_f32 v220, v220, v221
    v_cvt_pk_bf16_f32 v221, v222, v223
    v_cvt_pk_bf16_f32 v222, v244, v245
    v_cvt_pk_bf16_f32 v223, v246, v247
    v_cvt_pk_bf16_f32 v224, v224, v225
    v_cvt_pk_bf16_f32 v225, v226, v227
    v_cvt_pk_bf16_f32 v226, v248, v249
    v_cvt_pk_bf16_f32 v227, v250, v251
    v_cvt_pk_bf16_f32 v228, v228, v229
    v_cvt_pk_bf16_f32 v229, v230, v231
    v_cvt_pk_bf16_f32 v230, v252, v253
    v_cvt_pk_bf16_f32 v231, v254, v255
    v_mov_b32 v48, 0x3f803f80
    v_mov_b32 v49, 0x3f803f80
    v_mov_b32 v50, 0x3f803f80
    v_mov_b32 v51, 0x3f803f80
    s_nop 1
    v_mfma_f32_16x16x32_bf16 v[24:27], v[72:75], v[80:83], 0
    v_mfma_f32_16x16x32_bf16 v[28:31], v[72:75], v[84:87], 0
    v_mfma_f32_16x16x32_bf16 v[32:35], v[72:75], v[48:51], 0
    v_mfma_f32_16x16x32_bf16 v[36:39], v[76:79], v[80:83], 0
    v_mfma_f32_16x16x32_bf16 v[40:43], v[76:79], v[84:87], 0
    v_mfma_f32_16x16x32_bf16 v[44:47], v[76:79], v[48:51], 0
    v_mfma_f32_16x16x32_bf16 v[24:27], v[120:123], v[128:131], v[24:27]
    v_mfma_f32_16x16x32_bf16 v[28:31], v[120:123], v[132:135], v[28:31]
    v_mfma_f32_16x16x32_bf16 v[32:35], v[120:123], v[48:51], v[32:35]
    v_mfma_f32_16x16x32_bf16 v[36:39], v[124:127], v[128:131], v[36:39]
    v_mfma_f32_16x16x32_bf16 v[40:43], v[124:127], v[132:135], v[40:43]
    v_mfma_f32_16x16x32_bf16 v[44:47], v[124:127], v[48:51], v[44:47]
    v_mfma_f32_16x16x32_bf16 v[24:27], v[168:171], v[176:179], v[24:27]
    v_mfma_f32_16x16x32_bf16 v[28:31], v[168:171], v[180:183], v[28:31]
    v_mfma_f32_16x16x32_bf16 v[32:35], v[168:171], v[48:51], v[32:35]
    v_mfma_f32_16x16x32_bf16 v[36:39], v[172:175], v[176:179], v[36:39]
    v_mfma_f32_16x16x32_bf16 v[40:43], v[172:175], v[180:183], v[40:43]
    v_mfma_f32_16x16x32_bf16 v[44:47], v[172:175], v[48:51], v[44:47]
    v_mfma_f32_16x16x32_bf16 v[24:27], v[216:219], v[224:227], v[24:27]
    v_mfma_f32_16x16x32_bf16 v[28:31], v[216:219], v[228:231], v[28:31]
    v_mfma_f32_16x16x32_bf16 v[32:35], v[216:219], v[48:51], v[32:35]
    v_mfma_f32_16x16x32_bf16 v[36:39], v[220:223], v[224:227], v[36:39]
    v_mfma_f32_16x16x32_bf16 v[40:43], v[220:223], v[228:231], v[40:43]
    v_mfma_f32_16x16x32_bf16 v[44:47], v[220:223], v[48:51], v[44:47]
    v_lshlrev_b32 v52, 4, v0
    s_mul_i32 s58, s51, 6144
    s_add_u32 s58, s58, 32768
    v_add_u32 v52, s58, v52
    s_nop 7
    s_cmp_eq_u32 s50, 0
    s_cbranch_scc1 Lb_th0_9
    ds_write_b128 v52, v[24:27] offset:0
    ds_write_b128 v52, v[28:31] offset:1024
    ds_write_b128 v52, v[32:35] offset:2048
    ds_write_b128 v52, v[36:39] offset:3072
    ds_write_b128 v52, v[40:43] offset:4096
    ds_write_b128 v52, v[44:47] offset:5120
    s_waitcnt lgkmcnt(0)
    s_barrier
    s_branch Lb_pub_done_10
Lb_th0_9:
    s_barrier
    ds_read_b128 v[72:75], v52 offset:0
    ds_read_b128 v[96:99], v52 offset:1024
    ds_read_b128 v[120:123], v52 offset:2048
    ds_read_b128 v[144:147], v52 offset:3072
    ds_read_b128 v[168:171], v52 offset:4096
    ds_read_b128 v[192:195], v52 offset:5120
    s_waitcnt lgkmcnt(0)
    v_add_f32 v24, v24, v72
    v_add_f32 v25, v25, v73
    v_add_f32 v26, v26, v74
    v_add_f32 v27, v27, v75
    v_add_f32 v28, v28, v96
    v_add_f32 v29, v29, v97
    v_add_f32 v30, v30, v98
    v_add_f32 v31, v31, v99
    v_add_f32 v32, v32, v120
    v_add_f32 v33, v33, v121
    v_add_f32 v34, v34, v122
    v_add_f32 v35, v35, v123
    v_add_f32 v36, v36, v144
    v_add_f32 v37, v37, v145
    v_add_f32 v38, v38, v146
    v_add_f32 v39, v39, v147
    v_add_f32 v40, v40, v168
    v_add_f32 v41, v41, v169
    v_add_f32 v42, v42, v170
    v_add_f32 v43, v43, v171
    v_add_f32 v44, v44, v192
    v_add_f32 v45, v45, v193
    v_add_f32 v46, v46, v194
    v_add_f32 v47, v47, v195
    s_lshl_b32 s58, s33, 3
    s_add_u32 s58, s58, s32
    s_lshl_b32 s58, s58, 1
    s_add_u32 s58, s58, s51
    s_lshl_b32 s62, s58, 7
    s_add_u32 s62, s62, 12816384
    s_mul_i32 s58, s58, 5120
    s_add_u32 s58, s58, 12910592
    v_lshlrev_b32 v53, 4, v0
    buffer_store_dwordx4 v[24:27], v53, s[64:67], s58 offen offset:0 sc1
    buffer_store_dwordx4 v[28:31], v53, s[64:67], s58 offen offset:1024 sc1
    buffer_store_dwordx4 v[36:39], v53, s[64:67], s58 offen offset:2048 sc1
    buffer_store_dwordx4 v[40:43], v53, s[64:67], s58 offen offset:3072 sc1
    s_add_u32 s59, s58, 4096
    v_and_b32 v54, 15, v0
    v_cmp_eq_u32 vcc, 0, v54
    s_and_saveexec_b64 s[60:61], vcc
    buffer_store_dwordx4 v[32:35], v0, s[64:67], s59 offen offset:0 sc1
    buffer_store_dwordx4 v[44:47], v0, s[64:67], s59 offen offset:64 sc1
    s_mov_b64 exec, s[60:61]
    s_waitcnt vmcnt(0)
    v_mov_b32 v54, s91
    v_mov_b32 v55, 0
    v_cmp_eq_u32 vcc, 0, v0
    s_and_saveexec_b64 s[60:61], vcc
    buffer_store_dword v54, v55, s[64:67], s62 offen sc1
    s_mov_b64 exec, s[60:61]
Lb_pub_done_10:
    s_lshl_b32 s58, s33, 3
    s_lshl_b32 s59, s50, 2
    s_add_u32 s58, s58, s59
    s_lshl_b32 s58, s58, 1
    s_add_u32 s58, s58, s51
    s_lshl_b32 s62, s58, 7
    s_add_u32 s62, s62, 12816384
    v_and_b32 v55, 3, v0
    v_lshlrev_b32 v55, 8, v55
    s_mov_b32 s63, 0
Lpoll_11:
    buffer_load_dword v54, v55, s[64:67], s62 offen sc1
    s_waitcnt vmcnt(0)
    v_cmp_ne_u32 vcc, s91, v54
    s_add_u32 s63, s63, 1
    s_cbranch_vccz Lpolldone_12
    s_sleep 2
    s_cmp_lt_u32 s63, 0x100000
    s_cbranch_scc1 Lpoll_11
Lpolldone_12:
    s_mul_i32 s58, s58, 5120
    s_add_u32 s58, s58, 12910592
    v_lshlrev_b32 v53, 4, v0
    v_lshrrev_b32 v54, 4, v0
    v_lshlrev_b32 v54, 4, v54
    buffer_load_dwordx4 v[72:75], v53, s[64:67], s58 offen offset:0 sc1
    buffer_load_dwordx4 v[76:79], v53, s[64:67], s58 offen offset:1024 sc1
    buffer_load_dwordx4 v[80:83], v53, s[64:67], s58 offen offset:2048 sc1
    buffer_load_dwordx4 v[84:87], v53, s[64:67], s58 offen offset:3072 sc1
    s_add_u32 s59, s58, 4096
    buffer_load_dwordx4 v[96:99], v54, s[64:67], s59 offen offset:0 sc1
    buffer_load_dwordx4 v[100:103], v54, s[64:67], s59 offen offset:64 sc1
    s_add_u32 s58, s58, 10240
    buffer_load_dwordx4 v[120:123], v53, s[64:67], s58 offen offset:0 sc1
    buffer_load_dwordx4 v[124:127], v53, s[64:67], s58 offen offset:1024 sc1
    buffer_load_dwordx4 v[128:131], v53, s[64:67], s58 offen offset:2048 sc1
    buffer_load_dwordx4 v[132:135], v53, s[64:67], s58 offen offset:3072 sc1
    s_add_u32 s59, s58, 4096
    buffer_load_dwordx4 v[144:147], v54, s[64:67], s59 offen offset:0 sc1
    buffer_load_dwordx4 v[148:151], v54, s[64:67], s59 offen offset:64 sc1
    s_add_u32 s58, s58, 10240
    buffer_load_dwordx4 v[168:171], v53, s[64:67], s58 offen offset:0 sc1
    buffer_load_dwordx4 v[172:175], v53, s[64:67], s58 offen offset:1024 sc1
    buffer_load_dwordx4 v[176:179], v53, s[64:67], s58 offen offset:2048 sc1
    buffer_load_dwordx4 v[180:183], v53, s[64:67], s58 offen offset:3072 sc1
    s_add_u32 s59, s58, 4096
    buffer_load_dwordx4 v[192:195], v54, s[64:67], s59 offen offset:0 sc1
    buffer_load_dwordx4 v[196:199], v54, s[64:67], s59 offen offset:64 sc1
    s_add_u32 s58, s58, 10240
    buffer_load_dwordx4 v[216:219], v53, s[64:67], s58 offen offset:0 sc1
    buffer_load_dwordx4 v[220:223], v53, s[64:67], s58 offen offset:1024 sc1
    buffer_load_dwordx4 v[224:227], v53, s[64:67], s58 offen offset:2048 sc1
    buffer_load_dwordx4 v[228:231], v53, s[64:67], s58 offen offset:3072 sc1
    s_add_u32 s59, s58, 4096
    buffer_load_dwordx4 v[240:243], v54, s[64:67], s59 offen offset:0 sc1
    buffer_load_dwordx4 v[244:247], v54, s[64:67], s59 offen offset:64 sc1
    v_pk_mul_f32 v[56:57], v[64:65], s[54:55]
    v_pk_mul_f32 v[60:61], v[68:69], s[54:55]
    v_pk_mul_f32 v[58:59], v[66:67], s[54:55]
    v_pk_mul_f32 v[62:63], v[70:71], s[54:55]
    v_exp_f32 v56, v56
    v_exp_f32 v60, v60
    v_exp_f32 v57, v57
    v_exp_f32 v61, v61
    v_exp_f32 v58, v58
    v_exp_f32 v62, v62
    v_exp_f32 v59, v59
    v_exp_f32 v63, v63
    v_pk_add_f32 v[56:57], v[56:57], s[56:57] clamp
    v_pk_add_f32 v[60:61], v[60:61], s[56:57] clamp
    v_pk_add_f32 v[58:59], v[58:59], s[56:57] clamp
    v_pk_add_f32 v[62:63], v[62:63], s[56:57] clamp
    v_pk_add_f32 v[64:65], v[64:65], v[56:57]
    v_pk_add_f32 v[68:69], v[68:69], v[60:61]
    v_pk_add_f32 v[66:67], v[66:67], v[58:59]
    v_pk_add_f32 v[70:71], v[70:71], v[62:63]
    v_max_f32 v64, v64, v56
    v_max_f32 v68, v68, v60
    v_max_f32 v65, v65, v57
    v_max_f32 v69, v69, v61
    v_max_f32 v66, v66, v58
    v_max_f32 v70, v70, v62
    v_max_f32 v67, v67, v59
    v_max_f32 v71, v71, v63
    v_cvt_pk_bf16_f32 v64, v64, v65
    v_cvt_pk_bf16_f32 v65, v66, v67
    v_cvt_pk_bf16_f32 v66, v68, v69
    v_cvt_pk_bf16_f32 v67, v70, v71
    v_pk_mul_f32 v[56:57], v[88:89], s[54:55]
    v_pk_mul_f32 v[60:61], v[92:93], s[54:55]
    v_pk_mul_f32 v[58:59], v[90:91], s[54:55]
    v_pk_mul_f32 v[62:63], v[94:95], s[54:55]
    v_exp_f32 v56, v56
    v_exp_f32 v60, v60
    v_exp_f32 v57, v57
    v_exp_f32 v61, v61
    v_exp_f32 v58, v58
    v_exp_f32 v62, v62
    v_exp_f32 v59, v59
    v_exp_f32 v63, v63
    v_pk_add_f32 v[56:57], v[56:57], s[56:57] clamp
    v_pk_add_f32 v[60:61], v[60:61], s[56:57] clamp
    v_pk_add_f32 v[58:59], v[58:59], s[56:57] clamp
    v_pk_add_f32 v[62:63], v[62:63], s[56:57] clamp
    v_pk_add_f32 v[88:89], v[88:89], v[56:57]
    v_pk_add_f32 v[92:93], v[92:93], v[60:61]
    v_pk_add_f32 v[90:91], v[90:91], v[58:59]
    v_pk_add_f32 v[94:95], v[94:95], v[62:63]
    v_max_f32 v88, v88, v56
    v_max_f32 v92, v92, v60
    v_max_f32 v89, v89, v57
    v_max_f32 v93, v93, v61
    v_max_f32 v90, v90, v58
    v_max_f32 v94, v94, v62
    v_max_f32 v91, v91, v59
    v_max_f32 v95, v95, v63
    v_cvt_pk_bf16_f32 v88, v88, v89
    v_cvt_pk_bf16_f32 v89, v90, v91
    v_cvt_pk_bf16_f32 v90, v92, v93
    v_cvt_pk_bf16_f32 v91, v94, v95
    v_pk_mul_f32 v[56:57], v[112:113], s[54:55]
    v_pk_mul_f32 v[60:61], v[116:117], s[54:55]
    v_pk_mul_f32 v[58:59], v[114:115], s[54:55]
    v_pk_mul_f32 v[62:63], v[118:119], s[54:55]
    v_exp_f32 v56, v56
    v_exp_f32 v60, v60
    v_exp_f32 v57, v57
    v_exp_f32 v61, v61
    v_exp_f32 v58, v58
    v_exp_f32 v62, v62
    v_exp_f32 v59, v59
    v_exp_f32 v63, v63
    v_pk_add_f32 v[56:57], v[56:57], s[56:57] clamp
    v_pk_add_f32 v[60:61], v[60:61], s[56:57] clamp
    v_pk_add_f32 v[58:59], v[58:59], s[56:57] clamp
    v_pk_add_f32 v[62:63], v[62:63], s[56:57] clamp
    v_pk_add_f32 v[112:113], v[112:113], v[56:57]
    v_pk_add_f32 v[116:117], v[116:117], v[60:61]
    v_pk_add_f32 v[114:115], v[114:115], v[58:59]
    v_pk_add_f32 v[118:119], v[118:119], v[62:63]
    v_max_f32 v112, v112, v56
    v_max_f32 v116, v116, v60
    v_max_f32 v113, v113, v57
    v_max_f32 v117, v117, v61
    v_max_f32 v114, v114, v58
    v_max_f32 v118, v118, v62
    v_max_f32 v115, v115, v59
    v_max_f32 v119, v119, v63
    v_cvt_pk_bf16_f32 v112, v112, v113
    v_cvt_pk_bf16_f32 v113, v114, v115
    v_cvt_pk_bf16_f32 v114, v116, v117
    v_cvt_pk_bf16_f32 v115, v118, v119
    v_pk_mul_f32 v[56:57], v[136:137], s[54:55]
    v_pk_mul_f32 v[60:61], v[140:141], s[54:55]
    v_pk_mul_f32 v[58:59], v[138:139], s[54:55]
    v_pk_mul_f32 v[62:63], v[142:143], s[54:55]
    v_exp_f32 v56, v56
    v_exp_f32 v60, v60
    v_exp_f32 v57, v57
    v_exp_f32 v61, v61
    v_exp_f32 v58, v58
    v_exp_f32 v62, v62
    v_exp_f32 v59, v59
    v_exp_f32 v63, v63
    v_pk_add_f32 v[56:57], v[56:57], s[56:57] clamp
    v_pk_add_f32 v[60:61], v[60:61], s[56:57] clamp
    v_pk_add_f32 v[58:59], v[58:59], s[56:57] clamp
    v_pk_add_f32 v[62:63], v[62:63], s[56:57] clamp
    v_pk_add_f32 v[136:137], v[136:137], v[56:57]
    v_pk_add_f32 v[140:141], v[140:141], v[60:61]
    v_pk_add_f32 v[138:139], v[138:139], v[58:59]
    v_pk_add_f32 v[142:143], v[142:143], v[62:63]
    v_max_f32 v136, v136, v56
    v_max_f32 v140, v140, v60
    v_max_f32 v137, v137, v57
    v_max_f32 v141, v141, v61
    v_max_f32 v138, v138, v58
    v_max_f32 v142, v142, v62
    v_max_f32 v139, v139, v59
    v_max_f32 v143, v143, v63
    v_cvt_pk_bf16_f32 v136, v136, v137
    v_cvt_pk_bf16_f32 v137, v138, v139
    v_cvt_pk_bf16_f32 v138, v140, v141
    v_cvt_pk_bf16_f32 v139, v142, v143
    v_pk_mul_f32 v[56:57], v[160:161], s[54:55]
    v_pk_mul_f32 v[60:61], v[164:165], s[54:55]
    v_pk_mul_f32 v[58:59], v[162:163], s[54:55]
    v_pk_mul_f32 v[62:63], v[166:167], s[54:55]
    v_exp_f32 v56, v56
    v_exp_f32 v60, v60
    v_exp_f32 v57, v57
    v_exp_f32 v61, v61
    v_exp_f32 v58, v58
    v_exp_f32 v62, v62
    v_exp_f32 v59, v59
    v_exp_f32 v63, v63
    v_pk_add_f32 v[56:57], v[56:57], s[56:57] clamp
    v_pk_add_f32 v[60:61], v[60:61], s[56:57] clamp
    v_pk_add_f32 v[58:59], v[58:59], s[56:57] clamp
    v_pk_add_f32 v[62:63], v[62:63], s[56:57] clamp
    v_pk_add_f32 v[160:161], v[160:161], v[56:57]
    v_pk_add_f32 v[164:165], v[164:165], v[60:61]
    v_pk_add_f32 v[162:163], v[162:163], v[58:59]
    v_pk_add_f32 v[166:167], v[166:167], v[62:63]
    v_max_f32 v160, v160, v56
    v_max_f32 v164, v164, v60
    v_max_f32 v161, v161, v57
    v_max_f32 v165, v165, v61
    v_max_f32 v162, v162, v58
    v_max_f32 v166, v166, v62
    v_max_f32 v163, v163, v59
    v_max_f32 v167, v167, v63
    v_cvt_pk_bf16_f32 v160, v160, v161
    v_cvt_pk_bf16_f32 v161, v162, v163
    v_cvt_pk_bf16_f32 v162, v164, v165
    v_cvt_pk_bf16_f32 v163, v166, v167
    v_pk_mul_f32 v[56:57], v[184:185], s[54:55]
    v_pk_mul_f32 v[60:61], v[188:189], s[54:55]
    v_pk_mul_f32 v[58:59], v[186:187], s[54:55]
    v_pk_mul_f32 v[62:63], v[190:191], s[54:55]
    v_exp_f32 v56, v56
    v_exp_f32 v60, v60
    v_exp_f32 v57, v57
    v_exp_f32 v61, v61
    v_exp_f32 v58, v58
    v_exp_f32 v62, v62
    v_exp_f32 v59, v59
    v_exp_f32 v63, v63
    v_pk_add_f32 v[56:57], v[56:57], s[56:57] clamp
    v_pk_add_f32 v[60:61], v[60:61], s[56:57] clamp
    v_pk_add_f32 v[58:59], v[58:59], s[56:57] clamp
    v_pk_add_f32 v[62:63], v[62:63], s[56:57] clamp
    v_pk_add_f32 v[184:185], v[184:185], v[56:57]
    v_pk_add_f32 v[188:189], v[188:189], v[60:61]
    v_pk_add_f32 v[186:187], v[186:187], v[58:59]
    v_pk_add_f32 v[190:191], v[190:191], v[62:63]
    v_max_f32 v184, v184, v56
    v_max_f32 v188, v188, v60
    v_max_f32 v185, v185, v57
    v_max_f32 v189, v189, v61
    v_max_f32 v186, v186, v58
    v_max_f32 v190, v190, v62
    v_max_f32 v187, v187, v59
    v_max_f32 v191, v191, v63
    v_cvt_pk_bf16_f32 v184, v184, v185
    v_cvt_pk_bf16_f32 v185, v186, v187
    v_cvt_pk_bf16_f32 v186, v188, v189
    v_cvt_pk_bf16_f32 v187, v190, v191
    v_pk_mul_f32 v[56:57], v[208:209], s[54:55]
    v_pk_mul_f32 v[60:61], v[212:213], s[54:55]
    v_pk_mul_f32 v[58:59], v[210:211], s[54:55]
    v_pk_mul_f32 v[62:63], v[214:215], s[54:55]
    v_exp_f32 v56, v56
    v_exp_f32 v60, v60
    v_exp_f32 v57, v57
    v_exp_f32 v61, v61
    v_exp_f32 v58, v58
    v_exp_f32 v62, v62
    v_exp_f32 v59, v59
    v_exp_f32 v63, v63
    v_pk_add_f32 v[56:57], v[56:57], s[56:57] clamp
    v_pk_add_f32 v[60:61], v[60:61], s[56:57] clamp
    v_pk_add_f32 v[58:59], v[58:59], s[56:57] clamp
    v_pk_add_f32 v[62:63], v[62:63], s[56:57] clamp
    v_pk_add_f32 v[208:209], v[208:209], v[56:57]
    v_pk_add_f32 v[212:213], v[212:213], v[60:61]
    v_pk_add_f32 v[210:211], v[210:211], v[58:59]
    v_pk_add_f32 v[214:215], v[214:215], v[62:63]
    v_max_f32 v208, v208, v56
    v_max_f32 v212, v212, v60
    v_max_f32 v209, v209, v57
    v_max_f32 v213, v213, v61
    v_max_f32 v210, v210, v58
    v_max_f32 v214, v214, v62
    v_max_f32 v211, v211, v59
    v_max_f32 v215, v215, v63
    v_cvt_pk_bf16_f32 v208, v208, v209
    v_cvt_pk_bf16_f32 v209, v210, v211
    v_cvt_pk_bf16_f32 v210, v212, v213
    v_cvt_pk_bf16_f32 v211, v214, v215
    v_pk_mul_f32 v[56:57], v[232:233], s[54:55]
    v_pk_mul_f32 v[60:61], v[236:237], s[54:55]
    v_pk_mul_f32 v[58:59], v[234:235], s[54:55]
    v_pk_mul_f32 v[62:63], v[238:239], s[54:55]
    v_exp_f32 v56, v56
    v_exp_f32 v60, v60
    v_exp_f32 v57, v57
    v_exp_f32 v61, v61
    v_exp_f32 v58, v58
    v_exp_f32 v62, v62
    v_exp_f32 v59, v59
    v_exp_f32 v63, v63
    v_pk_add_f32 v[56:57], v[56:57], s[56:57] clamp
    v_pk_add_f32 v[60:61], v[60:61], s[56:57] clamp
    v_pk_add_f32 v[58:59], v[58:59], s[56:57] clamp
    v_pk_add_f32 v[62:63], v[62:63], s[56:57] clamp
    v_pk_add_f32 v[232:233], v[232:233], v[56:57]
    v_pk_add_f32 v[236:237], v[236:237], v[60:61]
    v_pk_add_f32 v[234:235], v[234:235], v[58:59]
    v_pk_add_f32 v[238:239], v[238:239], v[62:63]
    v_max_f32 v232, v232, v56
    v_max_f32 v236, v236, v60
    v_max_f32 v233, v233, v57
    v_max_f32 v237, v237, v61
    v_max_f32 v234, v234, v58
    v_max_f32 v238, v238, v62
    v_max_f32 v235, v235, v59
    v_max_f32 v239, v239, v63
    v_cvt_pk_bf16_f32 v232, v232, v233
    v_cvt_pk_bf16_f32 v233, v234, v235
    v_cvt_pk_bf16_f32 v234, v236, v237
    v_cvt_pk_bf16_f32 v235, v238, v239
    s_waitcnt vmcnt(12)
    v_add_f32 v24, v72, v120
    v_add_f32 v25, v73, v121
    v_add_f32 v26, v74, v122
    v_add_f32 v27, v75, v123
    v_add_f32 v28, v76, v124
    v_add_f32 v29, v77, v125
    v_add_f32 v30, v78, v126
    v_add_f32 v31, v79, v127
    v_add_f32 v32, v96, v144
    v_add_f32 v33, v97, v145
    v_add_f32 v34, v98, v146
    v_add_f32 v35, v99, v147
    v_add_f32 v36, v80, v128
    v_add_f32 v37, v81, v129
    v_add_f32 v38, v82, v130
    v_add_f32 v39, v83, v131
    v_add_f32 v40, v84, v132
    v_add_f32 v41, v85, v133
    v_add_f32 v42, v86, v134
    v_add_f32 v43, v87, v135
    v_add_f32 v44, v100, v148
    v_add_f32 v45, v101, v149
    v_add_f32 v46, v102, v150
    v_add_f32 v47, v103, v151
    s_waitcnt vmcnt(6)
    v_add_f32 v24, v24, v168
    v_add_f32 v25, v25, v169
    v_add_f32 v26, v26, v170
    v_add_f32 v27, v27, v171
    v_add_f32 v28, v28, v172
    v_add_f32 v29, v29, v173
    v_add_f32 v30, v30, v174
    v_add_f32 v31, v31, v175
    v_add_f32 v32, v32, v192
    v_add_f32 v33, v33, v193
    v_add_f32 v34, v34, v194
    v_add_f32 v35, v35, v195
    v_add_f32 v36, v36, v176
    v_add_f32 v37, v37, v177
    v_add_f32 v38, v38, v178
    v_add_f32 v39, v39, v179
    v_add_f32 v40, v40, v180
    v_add_f32 v41, v41, v181
    v_add_f32 v42, v42, v182
    v_add_f32 v43, v43, v183
    v_add_f32 v44, v44, v196
    v_add_f32 v45, v45, v197
    v_add_f32 v46, v46, v198
    v_add_f32 v47, v47, v199
    s_waitcnt vmcnt(0)
    v_add_f32 v24, v24, v216
    v_add_f32 v25, v25, v217
    v_add_f32 v26, v26, v218
    v_add_f32 v27, v27, v219
    v_add_f32 v28, v28, v220
    v_add_f32 v29, v29, v221
    v_add_f32 v30, v30, v222
    v_add_f32 v31, v31, v223
    v_add_f32 v32, v32, v240
    v_add_f32 v33, v33, v241
    v_add_f32 v34, v34, v242
    v_add_f32 v35, v35, v243
    v_add_f32 v36, v36, v224
    v_add_f32 v37, v37, v225
    v_add_f32 v38, v38, v226
    v_add_f32 v39, v39, v227
    v_add_f32 v40, v40, v228
    v_add_f32 v41, v41, v229
    v_add_f32 v42, v42, v230
    v_add_f32 v43, v43, v231
    v_add_f32 v44, v44, v244
    v_add_f32 v45, v45, v245
    v_add_f32 v46, v46, v246
    v_add_f32 v47, v47, v247
    v_lshlrev_b32 v52, 4, v0
    s_mul_i32 s58, s35, 6144
    s_add_u32 s58, s58, 49152
    v_add_u32 v53, s58, v52
    s_xor_b32 s59, s35, 2
    s_mul_i32 s59, s59, 6144
    s_add_u32 s59, s59, 49152
    v_add_u32 v54, s59, v52
    ds_write_b128 v53, v[24:27] offset:0
    ds_write_b128 v53, v[28:31] offset:1024
    ds_write_b128 v53, v[32:35] offset:2048
    ds_write_b128 v53, v[36:39] offset:3072
    ds_write_b128 v53, v[40:43] offset:4096
    ds_write_b128 v53, v[44:47] offset:5120
    s_waitcnt lgkmcnt(0)
    s_barrier
    ds_read_b128 v[72:75], v54 offset:0
    ds_read_b128 v[96:99], v54 offset:1024
    ds_read_b128 v[120:123], v54 offset:2048
    ds_read_b128 v[144:147], v54 offset:3072
    ds_read_b128 v[168:171], v54 offset:4096
    ds_read_b128 v[192:195], v54 offset:5120
    s_waitcnt lgkmcnt(0)
    v_add_f32 v24, v24, v72
    v_add_f32 v25, v25, v73
    v_add_f32 v26, v26, v74
    v_add_f32 v27, v27, v75
    v_add_f32 v28, v28, v96
    v_add_f32 v29, v29, v97
    v_add_f32 v30, v30, v98
    v_add_f32 v31, v31, v99
    v_add_f32 v32, v32, v120
    v_add_f32 v33, v33, v121
    v_add_f32 v34, v34, v122
    v_add_f32 v35, v35, v123
    v_add_f32 v36, v36, v144
    v_add_f32 v37, v37, v145
    v_add_f32 v38, v38, v146
    v_add_f32 v39, v39, v147
    v_add_f32 v40, v40, v168
    v_add_f32 v41, v41, v169
    v_add_f32 v42, v42, v170
    v_add_f32 v43, v43, v171
    v_add_f32 v44, v44, v192
    v_add_f32 v45, v45, v193
    v_add_f32 v46, v46, v194
    v_add_f32 v47, v47, v195
    v_cvt_pk_bf16_f32 v48, v24, v25
    v_cvt_pk_bf16_f32 v49, v26, v27
    v_cvt_pk_bf16_f32 v50, v36, v37
    v_cvt_pk_bf16_f32 v51, v38, v39
    v_cvt_pk_bf16_f32 v52, v28, v29
    v_cvt_pk_bf16_f32 v53, v30, v31
    v_cvt_pk_bf16_f32 v54, v40, v41
    v_cvt_pk_bf16_f32 v55, v42, v43
    v_cvt_pk_bf16_f32 v56, v32, v33
    v_cvt_pk_bf16_f32 v57, v34, v35
    v_cvt_pk_bf16_f32 v58, v44, v45
    v_cvt_pk_bf16_f32 v59, v46, v47
    s_lshl_b32 s58, s32, 1
    s_add_u32 s58, s58, s50
    s_lshl_b32 s58, s58, 4
    s_add_u32 s58, s58, s33
    s_lshl_b32 s58, s58, 14
    s_lshl_b32 s59, s51, 10
    s_add_u32 s58, s58, s59
    s_add_u32 s58, s58, 8388608
    v_lshlrev_b32 v60, 4, v0
    s_nop 0
    v_mfma_f32_16x16x32_bf16 v[72:75], v[48:51], v[64:67], 0
    v_mfma_f32_16x16x32_bf16 v[76:79], v[52:55], v[64:67], 0
    v_mfma_f32_16x16x32_bf16 v[80:83], v[56:59], v[64:67], 0
    v_mfma_f32_16x16x32_bf16 v[96:99], v[48:51], v[88:91], 0
    v_mfma_f32_16x16x32_bf16 v[100:103], v[52:55], v[88:91], 0
    v_mfma_f32_16x16x32_bf16 v[104:107], v[56:59], v[88:91], 0
    v_mfma_f32_16x16x32_bf16 v[120:123], v[48:51], v[112:115], 0
    v_mfma_f32_16x16x32_bf16 v[124:127], v[52:55], v[112:115], 0
    v_mfma_f32_16x16x32_bf16 v[128:131], v[56:59], v[112:115], 0
    v_mfma_f32_16x16x32_bf16 v[144:147], v[48:51], v[136:139], 0
    v_mfma_f32_16x16x32_bf16 v[148:151], v[52:55], v[136:139], 0
    v_mfma_f32_16x16x32_bf16 v[152:155], v[56:59], v[136:139], 0
    v_mfma_f32_16x16x32_bf16 v[168:171], v[48:51], v[160:163], 0
    v_mfma_f32_16x16x32_bf16 v[172:175], v[52:55], v[160:163], 0
    v_mfma_f32_16x16x32_bf16 v[176:179], v[56:59], v[160:163], 0
    v_mfma_f32_16x16x32_bf16 v[192:195], v[48:51], v[184:187], 0
    v_mfma_f32_16x16x32_bf16 v[196:199], v[52:55], v[184:187], 0
    v_mfma_f32_16x16x32_bf16 v[200:203], v[56:59], v[184:187], 0
    v_mfma_f32_16x16x32_bf16 v[216:219], v[48:51], v[208:211], 0
    v_mfma_f32_16x16x32_bf16 v[220:223], v[52:55], v[208:211], 0
    v_mfma_f32_16x16x32_bf16 v[224:227], v[56:59], v[208:211], 0
    v_mfma_f32_16x16x32_bf16 v[240:243], v[48:51], v[232:235], 0
    v_mfma_f32_16x16x32_bf16 v[244:247], v[52:55], v[232:235], 0
    v_mfma_f32_16x16x32_bf16 v[248:251], v[56:59], v[232:235], 0
    s_nop 4
    v_add_f32 v80, s56, v80
    v_rcp_f32 v80, v80
    s_nop 0
    v_mul_f32 v72, v72, v80
    v_mul_f32 v73, v73, v80
    v_mul_f32 v74, v74, v80
    v_mul_f32 v75, v75, v80
    v_mul_f32 v76, v76, v80
    v_mul_f32 v77, v77, v80
    v_mul_f32 v78, v78, v80
    v_mul_f32 v79, v79, v80
    v_cvt_pk_bf16_f32 v84, v72, v73
    v_cvt_pk_bf16_f32 v85, v74, v75
    v_cvt_pk_bf16_f32 v86, v76, v77
    v_cvt_pk_bf16_f32 v87, v78, v79
    buffer_store_dwordx4 v[84:87], v60, s[64:67], s58 offen offset:0 sc1
    v_add_f32 v104, s56, v104
    v_rcp_f32 v104, v104
    s_nop 0
    v_mul_f32 v96, v96, v104
    v_mul_f32 v97, v97, v104
    v_mul_f32 v98, v98, v104
    v_mul_f32 v99, v99, v104
    v_mul_f32 v100, v100, v104
    v_mul_f32 v101, v101, v104
    v_mul_f32 v102, v102, v104
    v_mul_f32 v103, v103, v104
    v_cvt_pk_bf16_f32 v108, v96, v97
    v_cvt_pk_bf16_f32 v109, v98, v99
    v_cvt_pk_bf16_f32 v110, v100, v101
    v_cvt_pk_bf16_f32 v111, v102, v103
    buffer_store_dwordx4 v[108:111], v60, s[64:67], s58 offen offset:2048 sc1
    v_add_f32 v128, s56, v128
    v_rcp_f32 v128, v128
    s_nop 0
    v_mul_f32 v120, v120, v128
    v_mul_f32 v121, v121, v128
    v_mul_f32 v122, v122, v128
    v_mul_f32 v123, v123, v128
    v_mul_f32 v124, v124, v128
    v_mul_f32 v125, v125, v128
    v_mul_f32 v126, v126, v128
    v_mul_f32 v127, v127, v128
    v_cvt_pk_bf16_f32 v132, v120, v121
    v_cvt_pk_bf16_f32 v133, v122, v123
    v_cvt_pk_bf16_f32 v134, v124, v125
    v_cvt_pk_bf16_f32 v135, v126, v127
    s_add_u32 s58, s58, 4096
    buffer_store_dwordx4 v[132:135], v60, s[64:67], s58 offen offset:0 sc1
    v_add_f32 v152, s56, v152
    v_rcp_f32 v152, v152
    s_nop 0
    v_mul_f32 v144, v144, v152
    v_mul_f32 v145, v145, v152
    v_mul_f32 v146, v146, v152
    v_mul_f32 v147, v147, v152
    v_mul_f32 v148, v148, v152
    v_mul_f32 v149, v149, v152
    v_mul_f32 v150, v150, v152
    v_mul_f32 v151, v151, v152
    v_cvt_pk_bf16_f32 v156, v144, v145
    v_cvt_pk_bf16_f32 v157, v146, v147
    v_cvt_pk_bf16_f32 v158, v148, v149
    v_cvt_pk_bf16_f32 v159, v150, v151
    buffer_store_dwordx4 v[156:159], v60, s[64:67], s58 offen offset:2048 sc1
    v_add_f32 v176, s56, v176
    v_rcp_f32 v176, v176
    s_nop 0
    v_mul_f32 v168, v168, v176
    v_mul_f32 v169, v169, v176
    v_mul_f32 v170, v170, v176
    v_mul_f32 v171, v171, v176
    v_mul_f32 v172, v172, v176
    v_mul_f32 v173, v173, v176
    v_mul_f32 v174, v174, v176
    v_mul_f32 v175, v175, v176
    v_cvt_pk_bf16_f32 v180, v168, v169
    v_cvt_pk_bf16_f32 v181, v170, v171
    v_cvt_pk_bf16_f32 v182, v172, v173
    v_cvt_pk_bf16_f32 v183, v174, v175
    s_add_u32 s58, s58, 4096
    buffer_store_dwordx4 v[180:183], v60, s[64:67], s58 offen offset:0 sc1
    v_add_f32 v200, s56, v200
    v_rcp_f32 v200, v200
    s_nop 0
    v_mul_f32 v192, v192, v200
    v_mul_f32 v193, v193, v200
    v_mul_f32 v194, v194, v200
    v_mul_f32 v195, v195, v200
    v_mul_f32 v196, v196, v200
    v_mul_f32 v197, v197, v200
    v_mul_f32 v198, v198, v200
    v_mul_f32 v199, v199, v200
    v_cvt_pk_bf16_f32 v204, v192, v193
    v_cvt_pk_bf16_f32 v205, v194, v195
    v_cvt_pk_bf16_f32 v206, v196, v197
    v_cvt_pk_bf16_f32 v207, v198, v199
    buffer_store_dwordx4 v[204:207], v60, s[64:67], s58 offen offset:2048 sc1
    v_add_f32 v224, s56, v224
    v_rcp_f32 v224, v224
    s_nop 0
    v_mul_f32 v216, v216, v224
    v_mul_f32 v217, v217, v224
    v_mul_f32 v218, v218, v224
    v_mul_f32 v219, v219, v224
    v_mul_f32 v220, v220, v224
    v_mul_f32 v221, v221, v224
    v_mul_f32 v222, v222, v224
    v_mul_f32 v223, v223, v224
    v_cvt_pk_bf16_f32 v228, v216, v217
    v_cvt_pk_bf16_f32 v229, v218, v219
    v_cvt_pk_bf16_f32 v230, v220, v221
    v_cvt_pk_bf16_f32 v231, v222, v223
    s_add_u32 s58, s58, 4096
    buffer_store_dwordx4 v[228:231], v60, s[64:67], s58 offen offset:0 sc1
    v_add_f32 v248, s56, v248
    v_rcp_f32 v248, v248
    s_nop 0
    v_mul_f32 v240, v240, v248
    v_mul_f32 v241, v241, v248
    v_mul_f32 v242, v242, v248
    v_mul_f32 v243, v243, v248
    v_mul_f32 v244, v244, v248
    v_mul_f32 v245, v245, v248
    v_mul_f32 v246, v246, v248
    v_mul_f32 v247, v247, v248
    v_cvt_pk_bf16_f32 v252, v240, v241
    v_cvt_pk_bf16_f32 v253, v242, v243
    v_cvt_pk_bf16_f32 v254, v244, v245
    v_cvt_pk_bf16_f32 v255, v246, v247
    buffer_store_dwordx4 v[252:255], v60, s[64:67], s58 offen offset:2048 sc1
    s_lshl_b32 s58, s32, 4
    s_add_u32 s58, s58, s33
    s_lshl_b32 s58, s58, 7
    s_lshl_b32 s59, s35, 2
    s_add_u32 s58, s58, s59
    s_add_u32 s58, s58, 12800000
    s_waitcnt vmcnt(0)
    v_mov_b32 v54, s91
    v_mov_b32 v55, 0
    v_cmp_eq_u32 vcc, 0, v0
    s_and_saveexec_b64 s[60:61], vcc
    buffer_store_dword v54, v55, s[64:67], s58 offen sc1
    s_mov_b64 exec, s[60:61]
    s_and_b32 s32, s30, 1
    s_lshl_b32 s32, s32, 3
    s_bfe_u32 s33, s30, 0x10001
    s_lshl_b32 s33, s33, 2
    s_add_u32 s32, s32, s33
    s_and_b32 s33, s31, 3
    s_add_u32 s32, s32, s33
    s_lshr_b32 s33, s30, 2
    s_lshl_b32 s33, s33, 2
    s_bfe_u32 s34, s31, 0x20002
    s_add_u32 s33, s33, s34
    s_waitcnt lgkmcnt(0)
    s_barrier
    v_lshlrev_b32 v2, 4, v0
    s_lshl_b32 s16, s35, 12
    s_lshl_b32 s48, s35, 12
    s_add_u32 s49, s48, 16384
    s_mov_b32 s11, 0x20000
    s_mov_b32 s15, 0x20000
    s_mov_b32 s14, 2097152
    s_lshl_b32 s36, s32, 19
    s_add_u32 s36, s36, 0
    s_add_u32 s88, s78, s36
    s_addc_u32 s89, s79, 0
    s_and_b32 s89, s89, 0xffff
    s_lshl_b32 s90, s32, 1
    s_add_u32 s90, s90, 26
    s_and_b32 s90, s90, 31
    s_lshl_b32 s76, s90, 14
    s_add_u32 s8, s88, s76
    s_addc_u32 s9, s89, 0
    s_mov_b32 s10, 524288
    s_and_b32 s69, s69, 0xffff
    s_and_b32 s71, s71, 0xffff
    s_and_b32 s73, s73, 0xffff
    s_cmp_lt_u32 s90, 16
    s_cselect_b32 s12, s68, s70
    s_cselect_b32 s13, s69, s71
    s_and_b32 s77, s90, 15
    s_lshl_b32 s77, s77, 7
    s_add_u32 s12, s12, s77
    s_addc_u32 s13, s13, 0
    v_lshrrev_b32 v4, 3, v0
    v_lshlrev_b32 v4, 11, v4
    v_and_b32 v5, 7, v0
    v_lshrrev_b32 v6, 4, v0
    v_xor_b32 v5, v5, v6
    v_lshlrev_b32 v5, 4, v5
    v_add_u32 v4, v4, v5
    v_xor_b32 v5, 64, v4
    s_lshl_b32 s36, s33, 7
    s_lshl_b32 s37, s35, 5
    s_add_u32 s36, s36, s37
    s_lshl_b32 s36, s36, 11
    s_add_u32 s24, s36, 0
    s_add_u32 s25, s36, 15360
    s_add_u32 s26, s36, 30720
    s_add_u32 s27, s36, 46080
    v_lshrrev_b32 v8, 4, v0
    v_lshlrev_b32 v6, 11, v8
    v_and_b32 v7, 15, v0
    v_lshlrev_b32 v8, 1, v8
    v_xor_b32 v7, v7, v8
    v_lshlrev_b32 v7, 4, v7
    v_add_u32 v6, v6, v7
    v_xor_b32 v7, 128, v6
    s_lshl_b32 s36, s35, 15
    s_lshl_b32 s37, s33, 8
    s_add_u32 s36, s36, s37
    s_add_u32 s20, s36, 0
    s_add_u32 s21, s36, 7168
    s_add_u32 s22, s36, 14336
    s_add_u32 s23, s36, 21504
    s_lshl_b32 s36, s32, 18
    s_add_u32 s36, s36, 8388608
    s_add_u32 s92, s78, s36
    s_addc_u32 s93, s79, 0
    s_and_b32 s93, s93, 0xffff
    s_lshl_b32 s94, s32, 14
    s_lshl_b32 s95, s32, 17
    s_add_u32 m0, s49, 0
    s_nop 0
    buffer_load_dwordx4 v4, s[12:15], s24 offen offset:0 lds
    buffer_load_dwordx4 v5, s[12:15], s25 offen offset:1024 lds
    buffer_load_dwordx4 v4, s[12:15], s26 offen offset:2048 lds
    buffer_load_dwordx4 v5, s[12:15], s27 offen offset:3072 lds
    s_add_u32 s90, s90, 1
    s_and_b32 s90, s90, 31
    s_cmp_lt_u32 s90, 16
    s_cselect_b32 s12, s68, s70
    s_cselect_b32 s13, s69, s71
    s_and_b32 s77, s90, 15
    s_lshl_b32 s77, s77, 7
    s_add_u32 s12, s12, s77
    s_addc_u32 s13, s13, 0
    s_add_u32 m0, s49, 32768
    s_nop 0
    buffer_load_dwordx4 v4, s[12:15], s24 offen offset:0 lds
    buffer_load_dwordx4 v5, s[12:15], s25 offen offset:1024 lds
    buffer_load_dwordx4 v4, s[12:15], s26 offen offset:2048 lds
    buffer_load_dwordx4 v5, s[12:15], s27 offen offset:3072 lds
    s_add_u32 s90, s90, 1
    s_and_b32 s90, s90, 31
    s_cmp_lt_u32 s90, 16
    s_cselect_b32 s12, s68, s70
    s_cselect_b32 s13, s69, s71
    s_and_b32 s77, s90, 15
    s_lshl_b32 s77, s77, 7
    s_add_u32 s12, s12, s77
    s_addc_u32 s13, s13, 0
    s_add_u32 m0, s49, 65536
    s_nop 0
    buffer_load_dwordx4 v4, s[12:15], s24 offen offset:0 lds
    buffer_load_dwordx4 v5, s[12:15], s25 offen offset:1024 lds
    buffer_load_dwordx4 v4, s[12:15], s26 offen offset:2048 lds
    buffer_load_dwordx4 v5, s[12:15], s27 offen offset:3072 lds
    s_add_u32 s90, s90, 1
    s_and_b32 s90, s90, 31
    s_cmp_lt_u32 s90, 16
    s_cselect_b32 s12, s68, s70
    s_cselect_b32 s13, s69, s71
    s_and_b32 s77, s90, 15
    s_lshl_b32 s77, s77, 7
    s_add_u32 s12, s12, s77
    s_addc_u32 s13, s13, 0
    v_and_b32 v14, 15, v0
    v_lshlrev_b32 v14, 7, v14
    v_lshrrev_b32 v15, 4, v0
    v_bfe_u32 v16, v0, 1, 3
    v_xor_b32 v15, v15, v16
    v_lshlrev_b32 v15, 4, v15
    v_add_u32 v14, v14, v15
    s_lshl_b32 s52, s50, 13
    s_add_u32 s52, s52, 16384
    v_add_u32 v32, s52, v14
    v_xor_b32 v33, 64, v32
    v_add_u32 v34, 0x10000, v32
    v_add_u32 v35, 0x10000, v33
    v_lshrrev_b32 v14, 5, v0
    v_lshlrev_b32 v14, 12, v14
    v_bfe_u32 v15, v0, 1, 1
    v_lshlrev_b32 v16, 10, v15
    v_add_u32 v14, v14, v16
    v_bfe_u32 v16, v0, 4, 1
    v_lshlrev_b32 v16, 3, v16
    v_bfe_u32 v19, v0, 2, 2
    v_add_u32 v16, v16, v19
    v_lshlrev_b32 v15, 2, v15
    v_xor_b32 v16, v16, v15
    v_lshlrev_b32 v16, 4, v16
    v_add_u32 v14, v14, v16
    v_and_b32 v16, 1, v0
    v_lshlrev_b32 v16, 3, v16
    v_add_u32 v14, v14, v16
    s_lshl_b32 s53, s51, 9
    v_add_u32 v36, s53, v14
    v_xor_b32 v37, 64, v36
    v_add_u32 v38, 0x10000, v36
    v_add_u32 v39, 0x10000, v37
    v_lshrrev_b32 v14, 4, v0
    v_lshlrev_b32 v15, 2, v14
    v_bfe_u32 v16, v0, 2, 2
    v_add_u32 v15, v15, v16
    v_and_b32 v16, 7, v15
    v_lshlrev_b32 v16, 1, v16
    v_lshlrev_b32 v15, 8, v15
    v_bfe_u32 v19, v0, 1, 1
    s_lshl_b32 s52, s50, 3
    v_add_u32 v19, s52, v19
    v_xor_b32 v19, v19, v16
    v_lshlrev_b32 v19, 4, v19
    v_add_u32 v15, v15, v19
    v_and_b32 v19, 1, v0
    v_lshlrev_b32 v19, 3, v19
    v_add_u32 v15, v15, v19
    v_add_u32 v40, 16384, v15
    v_xor_b32 v41, 32, v40
    v_xor_b32 v42, 64, v40
    v_xor_b32 v43, 96, v40
    v_add_u32 v44, 0x10000, v40
    v_add_u32 v45, 0x10000, v41
    v_add_u32 v46, 0x10000, v42
    v_add_u32 v47, 0x10000, v43
    s_lshl_b32 s53, s51, 13
    v_add_u32 v48, s53, v2
    v_add_u32 v49, 0x10000, v48
    v_and_b32 v20, 15, v0
    s_lshl_b32 s36, s32, 7
    s_lshl_b32 s37, s51, 6
    s_add_u32 s36, s36, s37
    v_add_u32 v20, s36, v20
    v_lshlrev_b32 v22, 2, v20
    v_lshrrev_b32 v28, 4, v0
    v_lshlrev_b32 v28, 3, v28
    s_lshl_b32 s36, s33, 7
    s_lshl_b32 s37, s50, 6
    s_add_u32 s36, s36, s37
    s_lshl_b32 s36, s36, 1
    v_add_u32 v28, s36, v28
    s_lshr_b32 s36, s32, 1
    s_lshl_b32 s36, s36, 11
    s_add_u32 s37, s36, 12783616
    s_add_u32 s96, s36, 12800000
    v_lshrrev_b32 v23, 2, v0
    v_lshlrev_b32 v23, 7, v23
    v_and_b32 v24, 3, v0
    v_lshlrev_b32 v24, 2, v24
    v_add_u32 v23, v23, v24
    s_mov_b32 s63, 0
Lpoll_13:
    buffer_load_dword v24, v23, s[64:67], s37 offen sc1
    s_waitcnt vmcnt(0)
    v_cmp_ne_u32 vcc, s91, v24
    s_add_u32 s63, s63, 1
    s_cbranch_vccz Lpolldone_14
    s_sleep 2
    s_cmp_lt_u32 s63, 0x100000
    s_cbranch_scc1 Lpoll_13
Lpolldone_14:
    s_add_u32 m0, s48, 0
    s_nop 0
    buffer_load_dwordx4 v2, s[8:11], s16 offen offset:0 lds
    buffer_load_dwordx4 v2, s[8:11], s16 offen offset:1024 lds
    buffer_load_dwordx4 v2, s[8:11], s16 offen offset:2048 lds
    buffer_load_dwordx4 v2, s[8:11], s16 offen offset:3072 lds
    s_add_u32 s76, s76, 16384
    s_and_b32 s76, s76, 524287
    s_add_u32 s8, s88, s76
    s_addc_u32 s9, s89, 0
    s_add_u32 m0, s48, 32768
    s_nop 0
    buffer_load_dwordx4 v2, s[8:11], s16 offen offset:0 lds
    buffer_load_dwordx4 v2, s[8:11], s16 offen offset:1024 lds
    buffer_load_dwordx4 v2, s[8:11], s16 offen offset:2048 lds
    buffer_load_dwordx4 v2, s[8:11], s16 offen offset:3072 lds
    s_add_u32 s76, s76, 16384
    s_and_b32 s76, s76, 524287
    s_add_u32 s8, s88, s76
    s_addc_u32 s9, s89, 0
    s_add_u32 m0, s48, 65536
    s_nop 0
    buffer_load_dwordx4 v2, s[8:11], s16 offen offset:0 lds
    buffer_load_dwordx4 v2, s[8:11], s16 offen offset:1024 lds
    buffer_load_dwordx4 v2, s[8:11], s16 offen offset:2048 lds
    buffer_load_dwordx4 v2, s[8:11], s16 offen offset:3072 lds
    s_add_u32 s76, s76, 16384
    s_and_b32 s76, s76, 524287
    s_add_u32 s8, s88, s76
    s_addc_u32 s9, s89, 0
    s_mov_b32 s58, 12582912
    buffer_load_dword v24, v22, s[64:67], s58 offen offset:0 sc1
    buffer_load_dword v25, v22, s[64:67], s58 offen offset:64 sc1
    buffer_load_dword v26, v22, s[64:67], s58 offen offset:128 sc1
    buffer_load_dword v27, v22, s[64:67], s58 offen offset:192 sc1
    s_lshl_b32 s58, s32, 3
    s_add_u32 s58, s58, s33
    s_lshl_b32 s97, s58, 7
    s_lshl_b32 s36, s35, 2
    s_add_u32 s97, s97, s36
    s_add_u32 s97, s97, 12849152
    s_lshl_b32 s40, s58, 16
    s_lshl_b32 s36, s35, 14
    s_add_u32 s40, s40, s36
    s_add_u32 s40, s40, 14680064
    s_add_u32 s41, s40, 4096
    s_add_u32 s42, s40, 8192
    s_add_u32 s43, s40, 12288
    s_waitcnt vmcnt(12)
    s_barrier
    ds_read_b128 a[0:3], v32 offset:0
    ds_read_b64_tr_b16 a[16:17], v36 offset:0
    ds_read_b64_tr_b16 a[18:19], v37 offset:0
    ds_read_b128 a[4:7], v32 offset:2048
    ds_read_b128 a[8:11], v32 offset:4096
    ds_read_b128 a[12:15], v32 offset:6144
    ds_read_b64_tr_b16 a[20:21], v36 offset:2048
    ds_read_b64_tr_b16 a[22:23], v37 offset:2048
    ds_read_b64_tr_b16 a[24:25], v36 offset:256
    ds_read_b64_tr_b16 a[26:27], v37 offset:256
    ds_read_b64_tr_b16 a[28:29], v36 offset:2304
    ds_read_b64_tr_b16 a[30:31], v37 offset:2304
    s_waitcnt lgkmcnt(9)
    v_mfma_f32_16x16x32_bf16 v[128:131], a[0:3], a[16:19], 0
    ds_read_b128 a[32:35], v33 offset:0
    ds_read_b64_tr_b16 a[48:49], v36 offset:8192
    s_waitcnt lgkmcnt(10)
    v_mfma_f32_16x16x32_bf16 v[144:147], a[4:7], a[16:19], 0
    ds_read_b64_tr_b16 a[50:51], v37 offset:8192
    s_waitcnt lgkmcnt(10)
    v_mfma_f32_16x16x32_bf16 v[160:163], a[8:11], a[16:19], 0
    ds_read_b128 a[36:39], v33 offset:2048
    s_waitcnt lgkmcnt(10)
    v_mfma_f32_16x16x32_bf16 v[176:179], a[12:15], a[16:19], 0
    ds_read_b128 a[40:43], v33 offset:4096
    ds_read_b128 a[44:47], v33 offset:6144
    s_waitcnt lgkmcnt(10)
    v_mfma_f32_16x16x32_bf16 v[132:135], a[0:3], a[20:23], 0
    ds_read_b64_tr_b16 a[52:53], v36 offset:10240
    v_mfma_f32_16x16x32_bf16 v[148:151], a[4:7], a[20:23], 0
    ds_read_b64_tr_b16 a[54:55], v37 offset:10240
    v_mfma_f32_16x16x32_bf16 v[164:167], a[8:11], a[20:23], 0
    ds_read_b64_tr_b16 a[56:57], v36 offset:8448
    ds_read_b64_tr_b16 a[58:59], v37 offset:8448
    v_mfma_f32_16x16x32_bf16 v[180:183], a[12:15], a[20:23], 0
    ds_read_b64_tr_b16 a[60:61], v36 offset:10496
    s_waitcnt lgkmcnt(13)
    v_mfma_f32_16x16x32_bf16 v[136:139], a[0:3], a[24:27], 0
    ds_read_b64_tr_b16 a[62:63], v37 offset:10496
    v_mfma_f32_16x16x32_bf16 v[152:155], a[4:7], a[24:27], 0
    v_mfma_f32_16x16x32_bf16 v[168:171], a[8:11], a[24:27], 0
    v_mfma_f32_16x16x32_bf16 v[184:187], a[12:15], a[24:27], 0
    s_waitcnt lgkmcnt(12)
    v_mfma_f32_16x16x32_bf16 v[140:143], a[0:3], a[28:31], 0
    v_mfma_f32_16x16x32_bf16 v[156:159], a[4:7], a[28:31], 0
    v_mfma_f32_16x16x32_bf16 v[172:175], a[8:11], a[28:31], 0
    v_mfma_f32_16x16x32_bf16 v[188:191], a[12:15], a[28:31], 0
    s_waitcnt lgkmcnt(9)
    v_mfma_f32_16x16x32_bf16 v[128:131], a[32:35], a[48:51], v[128:131]
    s_waitcnt lgkmcnt(8)
    v_mfma_f32_16x16x32_bf16 v[144:147], a[36:39], a[48:51], v[144:147]
    s_waitcnt lgkmcnt(7)
    v_mfma_f32_16x16x32_bf16 v[160:163], a[40:43], a[48:51], v[160:163]
    s_waitcnt lgkmcnt(0)
    s_waitcnt vmcnt(8)
    s_barrier
    v_mfma_f32_16x16x32_bf16 v[176:179], a[44:47], a[48:51], v[176:179]
    ds_read_b128 a[0:3], v32 offset:32768
    ds_read_b64_tr_b16 a[16:17], v36 offset:32768
    v_mfma_f32_16x16x32_bf16 v[132:135], a[32:35], a[52:55], v[132:135]
    ds_read_b64_tr_b16 a[18:19], v37 offset:32768
    ds_read_b128 a[4:7], v32 offset:34816
    s_add_u32 m0, s49, 98304
    s_nop 0
    buffer_load_dwordx4 v4, s[12:15], s24 offen offset:0 lds
    v_mfma_f32_16x16x32_bf16 v[148:151], a[36:39], a[52:55], v[148:151]
    ds_read_b128 a[8:11], v32 offset:36864
    ds_read_b128 a[12:15], v32 offset:38912
    buffer_load_dwordx4 v5, s[12:15], s25 offen offset:1024 lds
    v_mfma_f32_16x16x32_bf16 v[164:167], a[40:43], a[52:55], v[164:167]
    ds_read_b64_tr_b16 a[20:21], v36 offset:34816
    buffer_load_dwordx4 v4, s[12:15], s26 offen offset:2048 lds
    v_mfma_f32_16x16x32_bf16 v[180:183], a[44:47], a[52:55], v[180:183]
    ds_read_b64_tr_b16 a[22:23], v37 offset:34816
    ds_read_b64_tr_b16 a[24:25], v36 offset:33024
    buffer_load_dwordx4 v5, s[12:15], s27 offen offset:3072 lds
    s_add_u32 s90, s90, 1
    v_mfma_f32_16x16x32_bf16 v[136:139], a[32:35], a[56:59], v[136:139]
    ds_read_b64_tr_b16 a[26:27], v37 offset:33024
    ds_read_b64_tr_b16 a[28:29], v36 offset:35072
    s_and_b32 s90, s90, 31
    v_mfma_f32_16x16x32_bf16 v[152:155], a[36:39], a[56:59], v[152:155]
    ds_read_b64_tr_b16 a[30:31], v37 offset:35072
    s_cmp_lt_u32 s90, 16
    v_mfma_f32_16x16x32_bf16 v[168:171], a[40:43], a[56:59], v[168:171]
    s_cselect_b32 s12, s68, s70
    v_mfma_f32_16x16x32_bf16 v[184:187], a[44:47], a[56:59], v[184:187]
    s_cselect_b32 s13, s69, s71
    s_and_b32 s77, s90, 15
    v_mfma_f32_16x16x32_bf16 v[140:143], a[32:35], a[60:63], v[140:143]
    s_lshl_b32 s77, s77, 7
    v_mfma_f32_16x16x32_bf16 v[156:159], a[36:39], a[60:63], v[156:159]
    s_add_u32 s12, s12, s77
    v_mfma_f32_16x16x32_bf16 v[172:175], a[40:43], a[60:63], v[172:175]
    s_addc_u32 s13, s13, 0
    v_mfma_f32_16x16x32_bf16 v[188:191], a[44:47], a[60:63], v[188:191]
    s_waitcnt lgkmcnt(9)
    v_mfma_f32_16x16x32_bf16 v[128:131], a[0:3], a[16:19], v[128:131]
    ds_read_b128 a[32:35], v33 offset:32768
    ds_read_b64_tr_b16 a[48:49], v36 offset:40960
    s_waitcnt lgkmcnt(10)
    v_mfma_f32_16x16x32_bf16 v[144:147], a[4:7], a[16:19], v[144:147]
    ds_read_b64_tr_b16 a[50:51], v37 offset:40960
    s_add_u32 m0, s48, 98304
    s_waitcnt lgkmcnt(10)
    v_mfma_f32_16x16x32_bf16 v[160:163], a[8:11], a[16:19], v[160:163]
    ds_read_b128 a[36:39], v33 offset:34816
    buffer_load_dwordx4 v2, s[8:11], s16 offen offset:0 lds
    s_waitcnt lgkmcnt(10)
    v_mfma_f32_16x16x32_bf16 v[176:179], a[12:15], a[16:19], v[176:179]
    ds_read_b128 a[40:43], v33 offset:36864
    ds_read_b128 a[44:47], v33 offset:38912
    s_waitcnt lgkmcnt(10)
    v_mfma_f32_16x16x32_bf16 v[132:135], a[0:3], a[20:23], v[132:135]
    ds_read_b64_tr_b16 a[52:53], v36 offset:43008
    buffer_load_dwordx4 v2, s[8:11], s16 offen offset:1024 lds
    v_mfma_f32_16x16x32_bf16 v[148:151], a[4:7], a[20:23], v[148:151]
    ds_read_b64_tr_b16 a[54:55], v37 offset:43008
    buffer_load_dwordx4 v2, s[8:11], s16 offen offset:2048 lds
    v_mfma_f32_16x16x32_bf16 v[164:167], a[8:11], a[20:23], v[164:167]
    ds_read_b64_tr_b16 a[56:57], v36 offset:41216
    ds_read_b64_tr_b16 a[58:59], v37 offset:41216
    v_mfma_f32_16x16x32_bf16 v[180:183], a[12:15], a[20:23], v[180:183]
    ds_read_b64_tr_b16 a[60:61], v36 offset:43264
    buffer_load_dwordx4 v2, s[8:11], s16 offen offset:3072 lds
    s_waitcnt lgkmcnt(13)
    v_mfma_f32_16x16x32_bf16 v[136:139], a[0:3], a[24:27], v[136:139]
    ds_read_b64_tr_b16 a[62:63], v37 offset:43264
    s_add_u32 s76, s76, 16384
    v_mfma_f32_16x16x32_bf16 v[152:155], a[4:7], a[24:27], v[152:155]
    v_mfma_f32_16x16x32_bf16 v[168:171], a[8:11], a[24:27], v[168:171]
    s_and_b32 s76, s76, 524287
    v_mfma_f32_16x16x32_bf16 v[184:187], a[12:15], a[24:27], v[184:187]
    s_add_u32 s8, s88, s76
    s_waitcnt lgkmcnt(12)
    v_mfma_f32_16x16x32_bf16 v[140:143], a[0:3], a[28:31], v[140:143]
    v_mfma_f32_16x16x32_bf16 v[156:159], a[4:7], a[28:31], v[156:159]
    s_addc_u32 s9, s89, 0
    v_mfma_f32_16x16x32_bf16 v[172:175], a[8:11], a[28:31], v[172:175]
    v_mfma_f32_16x16x32_bf16 v[188:191], a[12:15], a[28:31], v[188:191]
    s_waitcnt lgkmcnt(9)
    v_mfma_f32_16x16x32_bf16 v[128:131], a[32:35], a[48:51], v[128:131]
    s_waitcnt lgkmcnt(8)
    v_mfma_f32_16x16x32_bf16 v[144:147], a[36:39], a[48:51], v[144:147]
    s_waitcnt lgkmcnt(7)
    v_mfma_f32_16x16x32_bf16 v[160:163], a[40:43], a[48:51], v[160:163]
    s_waitcnt lgkmcnt(0)
    s_waitcnt vmcnt(12)
    s_barrier
    v_mfma_f32_16x16x32_bf16 v[176:179], a[44:47], a[48:51], v[176:179]
    ds_read_b128 a[0:3], v34 offset:0
    ds_read_b64_tr_b16 a[16:17], v38 offset:0
    v_mfma_f32_16x16x32_bf16 v[132:135], a[32:35], a[52:55], v[132:135]
    ds_read_b64_tr_b16 a[18:19], v39 offset:0
    ds_read_b128 a[4:7], v34 offset:2048
    s_add_u32 m0, s49, 0
    s_nop 0
    buffer_load_dwordx4 v4, s[12:15], s24 offen offset:0 lds
    v_mfma_f32_16x16x32_bf16 v[148:151], a[36:39], a[52:55], v[148:151]
    ds_read_b128 a[8:11], v34 offset:4096
    ds_read_b128 a[12:15], v34 offset:6144
    buffer_load_dwordx4 v5, s[12:15], s25 offen offset:1024 lds
    v_mfma_f32_16x16x32_bf16 v[164:167], a[40:43], a[52:55], v[164:167]
    ds_read_b64_tr_b16 a[20:21], v38 offset:2048
    buffer_load_dwordx4 v4, s[12:15], s26 offen offset:2048 lds
    v_mfma_f32_16x16x32_bf16 v[180:183], a[44:47], a[52:55], v[180:183]
    ds_read_b64_tr_b16 a[22:23], v39 offset:2048
    ds_read_b64_tr_b16 a[24:25], v38 offset:256
    buffer_load_dwordx4 v5, s[12:15], s27 offen offset:3072 lds
    s_add_u32 s90, s90, 1
    v_mfma_f32_16x16x32_bf16 v[136:139], a[32:35], a[56:59], v[136:139]
    ds_read_b64_tr_b16 a[26:27], v39 offset:256
    ds_read_b64_tr_b16 a[28:29], v38 offset:2304
    s_and_b32 s90, s90, 31
    v_mfma_f32_16x16x32_bf16 v[152:155], a[36:39], a[56:59], v[152:155]
    ds_read_b64_tr_b16 a[30:31], v39 offset:2304
    s_cmp_lt_u32 s90, 16
    v_mfma_f32_16x16x32_bf16 v[168:171], a[40:43], a[56:59], v[168:171]
    s_cselect_b32 s12, s68, s70
    v_mfma_f32_16x16x32_bf16 v[184:187], a[44:47], a[56:59], v[184:187]
    s_cselect_b32 s13, s69, s71
    s_and_b32 s77, s90, 15
    v_mfma_f32_16x16x32_bf16 v[140:143], a[32:35], a[60:63], v[140:143]
    s_lshl_b32 s77, s77, 7
    v_mfma_f32_16x16x32_bf16 v[156:159], a[36:39], a[60:63], v[156:159]
    s_add_u32 s12, s12, s77
    v_mfma_f32_16x16x32_bf16 v[172:175], a[40:43], a[60:63], v[172:175]
    s_addc_u32 s13, s13, 0
    v_mfma_f32_16x16x32_bf16 v[188:191], a[44:47], a[60:63], v[188:191]
    s_waitcnt lgkmcnt(9)
    v_mfma_f32_16x16x32_bf16 v[128:131], a[0:3], a[16:19], v[128:131]
    ds_read_b128 a[32:35], v35 offset:0
    ds_read_b64_tr_b16 a[48:49], v38 offset:8192
    s_waitcnt lgkmcnt(10)
    v_mfma_f32_16x16x32_bf16 v[144:147], a[4:7], a[16:19], v[144:147]
    ds_read_b64_tr_b16 a[50:51], v39 offset:8192
    s_add_u32 m0, s48, 0
    s_waitcnt lgkmcnt(10)
    v_mfma_f32_16x16x32_bf16 v[160:163], a[8:11], a[16:19], v[160:163]
    ds_read_b128 a[36:39], v35 offset:2048
    buffer_load_dwordx4 v2, s[8:11], s16 offen offset:0 lds
    s_waitcnt lgkmcnt(10)
    v_mfma_f32_16x16x32_bf16 v[176:179], a[12:15], a[16:19], v[176:179]
    ds_read_b128 a[40:43], v35 offset:4096
    ds_read_b128 a[44:47], v35 offset:6144
    s_waitcnt lgkmcnt(10)
    v_mfma_f32_16x16x32_bf16 v[132:135], a[0:3], a[20:23], v[132:135]
    ds_read_b64_tr_b16 a[52:53], v38 offset:10240
    buffer_load_dwordx4 v2, s[8:11], s16 offen offset:1024 lds
    v_mfma_f32_16x16x32_bf16 v[148:151], a[4:7], a[20:23], v[148:151]
    ds_read_b64_tr_b16 a[54:55], v39 offset:10240
    buffer_load_dwordx4 v2, s[8:11], s16 offen offset:2048 lds
    v_mfma_f32_16x16x32_bf16 v[164:167], a[8:11], a[20:23], v[164:167]
    ds_read_b64_tr_b16 a[56:57], v38 offset:8448
    ds_read_b64_tr_b16 a[58:59], v39 offset:8448
    v_mfma_f32_16x16x32_bf16 v[180:183], a[12:15], a[20:23], v[180:183]
    ds_read_b64_tr_b16 a[60:61], v38 offset:10496
    buffer_load_dwordx4 v2, s[8:11], s16 offen offset:3072 lds
    s_waitcnt lgkmcnt(13)
    v_mfma_f32_16x16x32_bf16 v[136:139], a[0:3], a[24:27], v[136:139]
    ds_read_b64_tr_b16 a[62:63], v39 offset:10496
    s_add_u32 s76, s76, 16384
    v_mfma_f32_16x16x32_bf16 v[152:155], a[4:7], a[24:27], v[152:155]
    v_mfma_f32_16x16x32_bf16 v[168:171], a[8:11], a[24:27], v[168:171]
    s_and_b32 s76, s76, 524287
    v_mfma_f32_16x16x32_bf16 v[184:187], a[12:15], a[24:27], v[184:187]
    s_add_u32 s8, s88, s76
    s_waitcnt lgkmcnt(12)
    v_mfma_f32_16x16x32_bf16 v[140:143], a[0:3], a[28:31], v[140:143]
    v_mfma_f32_16x16x32_bf16 v[156:159], a[4:7], a[28:31], v[156:159]
    s_addc_u32 s9, s89, 0
    v_mfma_f32_16x16x32_bf16 v[172:175], a[8:11], a[28:31], v[172:175]
    v_mfma_f32_16x16x32_bf16 v[188:191], a[12:15], a[28:31], v[188:191]
    s_waitcnt lgkmcnt(9)
    v_mfma_f32_16x16x32_bf16 v[128:131], a[32:35], a[48:51], v[128:131]
    s_waitcnt lgkmcnt(8)
    v_mfma_f32_16x16x32_bf16 v[144:147], a[36:39], a[48:51], v[144:147]
    s_waitcnt lgkmcnt(7)
    v_mfma_f32_16x16x32_bf16 v[160:163], a[40:43], a[48:51], v[160:163]
    s_waitcnt lgkmcnt(0)
    s_waitcnt vmcnt(8)
    s_barrier
    v_mfma_f32_16x16x32_bf16 v[176:179], a[44:47], a[48:51], v[176:179]
    ds_read_b128 a[0:3], v34 offset:32768
    ds_read_b64_tr_b16 a[16:17], v38 offset:32768
    v_mfma_f32_16x16x32_bf16 v[132:135], a[32:35], a[52:55], v[132:135]
    ds_read_b64_tr_b16 a[18:19], v39 offset:32768
    ds_read_b128 a[4:7], v34 offset:34816
    s_add_u32 m0, s49, 32768
    v_mfma_f32_16x16x32_bf16 v[148:151], a[36:39], a[52:55], v[148:151]
    ds_read_b128 a[8:11], v34 offset:36864
    ds_read_b128 a[12:15], v34 offset:38912
    buffer_load_dwordx4 v4, s[12:15], s24 offen offset:0 lds
    v_mfma_f32_16x16x32_bf16 v[164:167], a[40:43], a[52:55], v[164:167]
    ds_read_b64_tr_b16 a[20:21], v38 offset:34816
    buffer_load_dwordx4 v5, s[12:15], s25 offen offset:1024 lds
    v_mfma_f32_16x16x32_bf16 v[180:183], a[44:47], a[52:55], v[180:183]
    ds_read_b64_tr_b16 a[22:23], v39 offset:34816
    ds_read_b64_tr_b16 a[24:25], v38 offset:33024
    buffer_load_dwordx4 v4, s[12:15], s26 offen offset:2048 lds
    v_mfma_f32_16x16x32_bf16 v[136:139], a[32:35], a[56:59], v[136:139]
    ds_read_b64_tr_b16 a[26:27], v39 offset:33024
    ds_read_b64_tr_b16 a[28:29], v38 offset:35072
    buffer_load_dwordx4 v5, s[12:15], s27 offen offset:3072 lds
    v_mfma_f32_16x16x32_bf16 v[152:155], a[36:39], a[56:59], v[152:155]
    ds_read_b64_tr_b16 a[30:31], v39 offset:35072
    v_mfma_f32_16x16x32_bf16 v[168:171], a[40:43], a[56:59], v[168:171]
    s_add_u32 s12, s72, s95
    v_mfma_f32_16x16x32_bf16 v[184:187], a[44:47], a[56:59], v[184:187]
    s_addc_u32 s13, s73, 0
    v_mfma_f32_16x16x32_bf16 v[140:143], a[32:35], a[60:63], v[140:143]
    s_add_u32 m0, s48, 32768
    v_mfma_f32_16x16x32_bf16 v[156:159], a[36:39], a[60:63], v[156:159]
    buffer_load_dwordx4 v2, s[8:11], s16 offen offset:0 lds
    v_mfma_f32_16x16x32_bf16 v[172:175], a[40:43], a[60:63], v[172:175]
    v_mfma_f32_16x16x32_bf16 v[188:191], a[44:47], a[60:63], v[188:191]
    s_waitcnt lgkmcnt(9)
    v_mfma_f32_16x16x32_bf16 v[128:131], a[0:3], a[16:19], v[128:131]
    ds_read_b128 a[32:35], v35 offset:32768
    ds_read_b64_tr_b16 a[48:49], v38 offset:40960
    s_waitcnt lgkmcnt(10)
    v_mfma_f32_16x16x32_bf16 v[144:147], a[4:7], a[16:19], v[144:147]
    ds_read_b64_tr_b16 a[50:51], v39 offset:40960
    buffer_load_dwordx4 v2, s[8:11], s16 offen offset:1024 lds
    s_waitcnt lgkmcnt(10)
    v_mfma_f32_16x16x32_bf16 v[160:163], a[8:11], a[16:19], v[160:163]
    ds_read_b128 a[36:39], v35 offset:34816
    s_waitcnt lgkmcnt(10)
    v_mfma_f32_16x16x32_bf16 v[176:179], a[12:15], a[16:19], v[176:179]
    ds_read_b128 a[40:43], v35 offset:36864
    ds_read_b128 a[44:47], v35 offset:38912
    buffer_load_dwordx4 v2, s[8:11], s16 offen offset:2048 lds
    s_waitcnt lgkmcnt(10)
    v_mfma_f32_16x16x32_bf16 v[132:135], a[0:3], a[20:23], v[132:135]
    ds_read_b64_tr_b16 a[52:53], v38 offset:43008
    v_mfma_f32_16x16x32_bf16 v[148:151], a[4:7], a[20:23], v[148:151]
    ds_read_b64_tr_b16 a[54:55], v39 offset:43008
    v_mfma_f32_16x16x32_bf16 v[164:167], a[8:11], a[20:23], v[164:167]
    ds_read_b64_tr_b16 a[56:57], v38 offset:41216
    ds_read_b64_tr_b16 a[58:59], v39 offset:41216
    buffer_load_dwordx4 v2, s[8:11], s16 offen offset:3072 lds
    v_mfma_f32_16x16x32_bf16 v[180:183], a[12:15], a[20:23], v[180:183]
    ds_read_b64_tr_b16 a[60:61], v38 offset:43264
    s_waitcnt lgkmcnt(13)
    v_mfma_f32_16x16x32_bf16 v[136:139], a[0:3], a[24:27], v[136:139]
    ds_read_b64_tr_b16 a[62:63], v39 offset:43264
    v_mfma_f32_16x16x32_bf16 v[152:155], a[4:7], a[24:27], v[152:155]
    s_add_u32 s8, s92, s94
    v_mfma_f32_16x16x32_bf16 v[168:171], a[8:11], a[24:27], v[168:171]
    v_mfma_f32_16x16x32_bf16 v[184:187], a[12:15], a[24:27], v[184:187]
    s_waitcnt lgkmcnt(12)
    v_mfma_f32_16x16x32_bf16 v[140:143], a[0:3], a[28:31], v[140:143]
    s_addc_u32 s9, s93, 0
    v_mfma_f32_16x16x32_bf16 v[156:159], a[4:7], a[28:31], v[156:159]
    v_mfma_f32_16x16x32_bf16 v[172:175], a[8:11], a[28:31], v[172:175]
    v_mfma_f32_16x16x32_bf16 v[188:191], a[12:15], a[28:31], v[188:191]
    s_waitcnt lgkmcnt(9)
    v_mfma_f32_16x16x32_bf16 v[128:131], a[32:35], a[48:51], v[128:131]
    s_waitcnt lgkmcnt(8)
    v_mfma_f32_16x16x32_bf16 v[144:147], a[36:39], a[48:51], v[144:147]
    s_waitcnt lgkmcnt(7)
    v_mfma_f32_16x16x32_bf16 v[160:163], a[40:43], a[48:51], v[160:163]
    s_waitcnt lgkmcnt(0)
    s_waitcnt vmcnt(8)
    s_barrier
    s_mov_b32 s63, 0
Lpoll_15:
    buffer_load_dword v50, v23, s[64:67], s96 offen sc1
    s_waitcnt vmcnt(0)
    v_cmp_ne_u32 vcc, s91, v50
    s_add_u32 s63, s63, 1
    s_cbranch_vccz Lpolldone_16
    s_sleep 2
    s_cmp_lt_u32 s63, 0x100000
    s_cbranch_scc1 Lpoll_15
Lpolldone_16:
    v_mfma_f32_16x16x32_bf16 v[176:179], a[44:47], a[48:51], v[176:179]
    ds_read_b128 a[0:3], v32 offset:0
    ds_read_b64_tr_b16 a[16:17], v36 offset:0
    v_mfma_f32_16x16x32_bf16 v[132:135], a[32:35], a[52:55], v[132:135]
    ds_read_b64_tr_b16 a[18:19], v37 offset:0
    ds_read_b128 a[4:7], v32 offset:2048
    s_add_u32 m0, s49, 65536
    v_mfma_f32_16x16x32_bf16 v[148:151], a[36:39], a[52:55], v[148:151]
    ds_read_b128 a[8:11], v32 offset:4096
    ds_read_b128 a[12:15], v32 offset:6144
    buffer_load_dwordx4 v6, s[12:15], s20 offen offset:0 lds
    v_mfma_f32_16x16x32_bf16 v[164:167], a[40:43], a[52:55], v[164:167]
    ds_read_b64_tr_b16 a[20:21], v36 offset:2048
    buffer_load_dwordx4 v7, s[12:15], s21 offen offset:1024 lds
    v_mfma_f32_16x16x32_bf16 v[180:183], a[44:47], a[52:55], v[180:183]
    ds_read_b64_tr_b16 a[22:23], v37 offset:2048
    ds_read_b64_tr_b16 a[24:25], v36 offset:256
    buffer_load_dwordx4 v6, s[12:15], s22 offen offset:2048 lds
    v_mfma_f32_16x16x32_bf16 v[136:139], a[32:35], a[56:59], v[136:139]
    ds_read_b64_tr_b16 a[26:27], v37 offset:256
    ds_read_b64_tr_b16 a[28:29], v36 offset:2304
    buffer_load_dwordx4 v7, s[12:15], s23 offen offset:3072 lds
    v_mfma_f32_16x16x32_bf16 v[152:155], a[36:39], a[56:59], v[152:155]
    ds_read_b64_tr_b16 a[30:31], v37 offset:2304
    s_add_u32 s95, s95, 131072
    v_mfma_f32_16x16x32_bf16 v[168:171], a[40:43], a[56:59], v[168:171]
    s_and_b32 s95, s95, 0x1fffff
    v_mfma_f32_16x16x32_bf16 v[184:187], a[44:47], a[56:59], v[184:187]
    s_add_u32 s12, s72, s95
    v_mfma_f32_16x16x32_bf16 v[140:143], a[32:35], a[60:63], v[140:143]
    s_addc_u32 s13, s73, 0
    v_mfma_f32_16x16x32_bf16 v[156:159], a[36:39], a[60:63], v[156:159]
    s_add_u32 m0, s48, 65536
    v_mfma_f32_16x16x32_bf16 v[172:175], a[40:43], a[60:63], v[172:175]
    buffer_load_dwordx4 v2, s[8:11], s16 offen offset:0 lds
    v_mfma_f32_16x16x32_bf16 v[188:191], a[44:47], a[60:63], v[188:191]
    v_mov_b32 v51, 0
    s_waitcnt lgkmcnt(9)
    v_mfma_f32_16x16x32_bf16 v[128:131], a[0:3], a[16:19], v[128:131]
    ds_read_b128 a[32:35], v33 offset:0
    ds_read_b64_tr_b16 a[48:49], v36 offset:8192
    s_waitcnt lgkmcnt(10)
    v_mfma_f32_16x16x32_bf16 v[144:147], a[4:7], a[16:19], v[144:147]
    ds_read_b64_tr_b16 a[50:51], v37 offset:8192
    buffer_load_dwordx4 v2, s[8:11], s16 offen offset:1024 lds
    s_waitcnt lgkmcnt(10)
    v_mfma_f32_16x16x32_bf16 v[160:163], a[8:11], a[16:19], v[160:163]
    ds_read_b128 a[36:39], v33 offset:2048
    s_waitcnt lgkmcnt(10)
    v_mfma_f32_16x16x32_bf16 v[176:179], a[12:15], a[16:19], v[176:179]
    ds_read_b128 a[40:43], v33 offset:4096
    ds_read_b128 a[44:47], v33 offset:6144
    buffer_load_dwordx4 v2, s[8:11], s16 offen offset:2048 lds
    s_waitcnt lgkmcnt(10)
    v_mfma_f32_16x16x32_bf16 v[132:135], a[0:3], a[20:23], v[132:135]
    ds_read_b64_tr_b16 a[52:53], v36 offset:10240
    v_mfma_f32_16x16x32_bf16 v[148:151], a[4:7], a[20:23], v[148:151]
    ds_read_b64_tr_b16 a[54:55], v37 offset:10240
    buffer_load_dwordx4 v2, s[8:11], s16 offen offset:3072 lds
    v_mfma_f32_16x16x32_bf16 v[164:167], a[8:11], a[20:23], v[164:167]
    ds_read_b64_tr_b16 a[56:57], v36 offset:8448
    ds_read_b64_tr_b16 a[58:59], v37 offset:8448
    v_mfma_f32_16x16x32_bf16 v[180:183], a[12:15], a[20:23], v[180:183]
    ds_read_b64_tr_b16 a[60:61], v36 offset:10496
    s_add_u32 s94, s94, 16384
    s_waitcnt lgkmcnt(13)
    v_mfma_f32_16x16x32_bf16 v[136:139], a[0:3], a[24:27], v[136:139]
    ds_read_b64_tr_b16 a[62:63], v37 offset:10496
    v_mfma_f32_16x16x32_bf16 v[152:155], a[4:7], a[24:27], v[152:155]
    s_and_b32 s94, s94, 262143
    v_mfma_f32_16x16x32_bf16 v[168:171], a[8:11], a[24:27], v[168:171]
    v_mfma_f32_16x16x32_bf16 v[184:187], a[12:15], a[24:27], v[184:187]
    s_add_u32 s8, s92, s94
    s_waitcnt lgkmcnt(12)
    v_mfma_f32_16x16x32_bf16 v[140:143], a[0:3], a[28:31], v[140:143]
    v_mfma_f32_16x16x32_bf16 v[156:159], a[4:7], a[28:31], v[156:159]
    s_addc_u32 s9, s93, 0
    v_mfma_f32_16x16x32_bf16 v[172:175], a[8:11], a[28:31], v[172:175]
    v_mfma_f32_16x16x32_bf16 v[188:191], a[12:15], a[28:31], v[188:191]
    s_waitcnt lgkmcnt(9)
    v_mfma_f32_16x16x32_bf16 v[128:131], a[32:35], a[48:51], v[128:131]
    s_waitcnt lgkmcnt(8)
    v_mfma_f32_16x16x32_bf16 v[144:147], a[36:39], a[48:51], v[144:147]
    s_waitcnt lgkmcnt(7)
    v_mfma_f32_16x16x32_bf16 v[160:163], a[40:43], a[48:51], v[160:163]
    s_waitcnt lgkmcnt(0)
    s_barrier
    v_mfma_f32_16x16x32_bf16 v[176:179], a[44:47], a[48:51], v[176:179]
    ds_read_b128 a[0:3], v32 offset:32768
    ds_read_b64_tr_b16 a[16:17], v36 offset:32768
    v_mfma_f32_16x16x32_bf16 v[132:135], a[32:35], a[52:55], v[132:135]
    ds_read_b64_tr_b16 a[18:19], v37 offset:32768
    ds_read_b128 a[4:7], v32 offset:34816
    s_add_u32 m0, s49, 98304
    v_mfma_f32_16x16x32_bf16 v[148:151], a[36:39], a[52:55], v[148:151]
    ds_read_b128 a[8:11], v32 offset:36864
    ds_read_b128 a[12:15], v32 offset:38912
    buffer_load_dwordx4 v6, s[12:15], s20 offen offset:0 lds
    v_mfma_f32_16x16x32_bf16 v[164:167], a[40:43], a[52:55], v[164:167]
    ds_read_b64_tr_b16 a[20:21], v36 offset:34816
    buffer_load_dwordx4 v7, s[12:15], s21 offen offset:1024 lds
    v_mfma_f32_16x16x32_bf16 v[180:183], a[44:47], a[52:55], v[180:183]
    ds_read_b64_tr_b16 a[22:23], v37 offset:34816
    ds_read_b64_tr_b16 a[24:25], v36 offset:33024
    buffer_load_dwordx4 v6, s[12:15], s22 offen offset:2048 lds
    v_mfma_f32_16x16x32_bf16 v[136:139], a[32:35], a[56:59], v[136:139]
    ds_read_b64_tr_b16 a[26:27], v37 offset:33024
    ds_read_b64_tr_b16 a[28:29], v36 offset:35072
    buffer_load_dwordx4 v7, s[12:15], s23 offen offset:3072 lds
    v_mfma_f32_16x16x32_bf16 v[152:155], a[36:39], a[56:59], v[152:155]
    ds_read_b64_tr_b16 a[30:31], v37 offset:35072
    s_add_u32 s95, s95, 131072
    v_mfma_f32_16x16x32_bf16 v[168:171], a[40:43], a[56:59], v[168:171]
    s_and_b32 s95, s95, 0x1fffff
    v_mfma_f32_16x16x32_bf16 v[184:187], a[44:47], a[56:59], v[184:187]
    s_add_u32 s12, s72, s95
    v_mfma_f32_16x16x32_bf16 v[140:143], a[32:35], a[60:63], v[140:143]
    s_addc_u32 s13, s73, 0
    v_mfma_f32_16x16x32_bf16 v[156:159], a[36:39], a[60:63], v[156:159]
    s_add_u32 m0, s48, 98304
    v_mfma_f32_16x16x32_bf16 v[172:175], a[40:43], a[60:63], v[172:175]
    buffer_load_dwordx4 v2, s[8:11], s16 offen offset:0 lds
    v_mfma_f32_16x16x32_bf16 v[188:191], a[44:47], a[60:63], v[188:191]
    s_waitcnt lgkmcnt(9)
    v_mfma_f32_16x16x32_bf16 v[128:131], a[0:3], a[16:19], v[128:131]
    ds_read_b128 a[32:35], v33 offset:32768
    ds_read_b64_tr_b16 a[48:49], v36 offset:40960
    s_waitcnt lgkmcnt(10)
    v_mfma_f32_16x16x32_bf16 v[144:147], a[4:7], a[16:19], v[144:147]
    ds_read_b64_tr_b16 a[50:51], v37 offset:40960
    buffer_load_dwordx4 v2, s[8:11], s16 offen offset:1024 lds
    s_waitcnt lgkmcnt(10)
    v_mfma_f32_16x16x32_bf16 v[160:163], a[8:11], a[16:19], v[160:163]
    ds_read_b128 a[36:39], v33 offset:34816
    s_waitcnt lgkmcnt(10)
    v_mfma_f32_16x16x32_bf16 v[176:179], a[12:15], a[16:19], v[176:179]
    ds_read_b128 a[40:43], v33 offset:36864
    ds_read_b128 a[44:47], v33 offset:38912
    buffer_load_dwordx4 v2, s[8:11], s16 offen offset:2048 lds
    s_waitcnt lgkmcnt(10)
    v_mfma_f32_16x16x32_bf16 v[132:135], a[0:3], a[20:23], v[132:135]
    ds_read_b64_tr_b16 a[52:53], v36 offset:43008
    v_mfma_f32_16x16x32_bf16 v[148:151], a[4:7], a[20:23], v[148:151]
    ds_read_b64_tr_b16 a[54:55], v37 offset:43008
    buffer_load_dwordx4 v2, s[8:11], s16 offen offset:3072 lds
    v_mfma_f32_16x16x32_bf16 v[164:167], a[8:11], a[20:23], v[164:167]
    ds_read_b64_tr_b16 a[56:57], v36 offset:41216
    ds_read_b64_tr_b16 a[58:59], v37 offset:41216
    v_mfma_f32_16x16x32_bf16 v[180:183], a[12:15], a[20:23], v[180:183]
    ds_read_b64_tr_b16 a[60:61], v36 offset:43264
    s_add_u32 s94, s94, 16384
    s_waitcnt lgkmcnt(13)
    v_mfma_f32_16x16x32_bf16 v[136:139], a[0:3], a[24:27], v[136:139]
    ds_read_b64_tr_b16 a[62:63], v37 offset:43264
    v_mfma_f32_16x16x32_bf16 v[152:155], a[4:7], a[24:27], v[152:155]
    s_and_b32 s94, s94, 262143
    v_mfma_f32_16x16x32_bf16 v[168:171], a[8:11], a[24:27], v[168:171]
    v_mfma_f32_16x16x32_bf16 v[184:187], a[12:15], a[24:27], v[184:187]
    s_add_u32 s8, s92, s94
    s_waitcnt lgkmcnt(12)
    v_mfma_f32_16x16x32_bf16 v[140:143], a[0:3], a[28:31], v[140:143]
    v_mfma_f32_16x16x32_bf16 v[156:159], a[4:7], a[28:31], v[156:159]
    s_addc_u32 s9, s93, 0
    v_mfma_f32_16x16x32_bf16 v[172:175], a[8:11], a[28:31], v[172:175]
    v_mfma_f32_16x16x32_bf16 v[188:191], a[12:15], a[28:31], v[188:191]
    s_waitcnt lgkmcnt(9)
    v_mfma_f32_16x16x32_bf16 v[128:131], a[32:35], a[48:51], v[128:131]
    s_waitcnt lgkmcnt(8)
    v_mfma_f32_16x16x32_bf16 v[144:147], a[36:39], a[48:51], v[144:147]
    s_waitcnt lgkmcnt(7)
    v_mfma_f32_16x16x32_bf16 v[160:163], a[40:43], a[48:51], v[160:163]
    s_waitcnt lgkmcnt(0)
    s_waitcnt vmcnt(8)
    s_barrier
    v_mfma_f32_16x16x32_bf16 v[176:179], a[44:47], a[48:51], v[176:179]
    ds_read_b128 a[16:19], v49 offset:0
    ds_read_b64_tr_b16 a[0:1], v44 offset:0
    v_mfma_f32_16x16x32_bf16 v[132:135], a[32:35], a[52:55], v[132:135]
    ds_read_b64_tr_b16 a[2:3], v44 offset:4096
    ds_read_b64_tr_b16 a[4:5], v45 offset:0
    s_add_u32 m0, s49, 0
    v_mfma_f32_16x16x32_bf16 v[148:151], a[36:39], a[52:55], v[148:151]
    ds_read_b64_tr_b16 a[6:7], v45 offset:4096
    ds_read_b64_tr_b16 a[8:9], v46 offset:0
    buffer_load_dwordx4 v6, s[12:15], s20 offen offset:0 lds
    v_mfma_f32_16x16x32_bf16 v[164:167], a[40:43], a[52:55], v[164:167]
    ds_read_b64_tr_b16 a[10:11], v46 offset:4096
    buffer_load_dwordx4 v7, s[12:15], s21 offen offset:1024 lds
    v_mfma_f32_16x16x32_bf16 v[180:183], a[44:47], a[52:55], v[180:183]
    ds_read_b64_tr_b16 a[12:13], v47 offset:0
    ds_read_b64_tr_b16 a[14:15], v47 offset:4096
    buffer_load_dwordx4 v6, s[12:15], s22 offen offset:2048 lds
    v_mfma_f32_16x16x32_bf16 v[136:139], a[32:35], a[56:59], v[136:139]
    ds_read_b128 a[20:23], v49 offset:2048
    ds_read_b128 a[24:27], v49 offset:4096
    buffer_load_dwordx4 v7, s[12:15], s23 offen offset:3072 lds
    v_mfma_f32_16x16x32_bf16 v[152:155], a[36:39], a[56:59], v[152:155]
    ds_read_b128 a[28:31], v49 offset:6144
    s_add_u32 s95, s95, 131072
    v_mfma_f32_16x16x32_bf16 v[168:171], a[40:43], a[56:59], v[168:171]
    s_and_b32 s95, s95, 0x1fffff
    v_mfma_f32_16x16x32_bf16 v[184:187], a[44:47], a[56:59], v[184:187]
    s_add_u32 s12, s72, s95
    v_mfma_f32_16x16x32_bf16 v[140:143], a[32:35], a[60:63], v[140:143]
    s_addc_u32 s13, s73, 0
    v_mfma_f32_16x16x32_bf16 v[156:159], a[36:39], a[60:63], v[156:159]
    s_add_u32 m0, s48, 0
    v_mfma_f32_16x16x32_bf16 v[172:175], a[40:43], a[60:63], v[172:175]
    buffer_load_dwordx4 v2, s[8:11], s16 offen offset:0 lds
    v_mfma_f32_16x16x32_bf16 v[188:191], a[44:47], a[60:63], v[188:191]
    s_waitcnt lgkmcnt(9)
    v_mfma_f32_16x16x32_bf16 v[192:195], a[0:3], a[16:19], 0
    ds_read_b128 a[48:51], v49 offset:1024
    ds_read_b64_tr_b16 a[32:33], v44 offset:8192
    s_waitcnt lgkmcnt(9)
    v_mfma_f32_16x16x32_bf16 v[208:211], a[4:7], a[16:19], 0
    ds_read_b64_tr_b16 a[34:35], v44 offset:12288
    buffer_load_dwordx4 v2, s[8:11], s16 offen offset:1024 lds
    s_waitcnt lgkmcnt(8)
    v_mfma_f32_16x16x32_bf16 v[224:227], a[8:11], a[16:19], 0
    ds_read_b64_tr_b16 a[36:37], v45 offset:8192
    s_waitcnt lgkmcnt(7)
    v_mfma_f32_16x16x32_bf16 v[240:243], a[12:15], a[16:19], 0
    ds_read_b64_tr_b16 a[38:39], v45 offset:12288
    ds_read_b64_tr_b16 a[40:41], v46 offset:8192
    buffer_load_dwordx4 v2, s[8:11], s16 offen offset:2048 lds
    s_waitcnt lgkmcnt(8)
    v_mfma_f32_16x16x32_bf16 v[196:199], a[0:3], a[20:23], 0
    ds_read_b64_tr_b16 a[42:43], v46 offset:12288
    v_mfma_f32_16x16x32_bf16 v[212:215], a[4:7], a[20:23], 0
    ds_read_b64_tr_b16 a[44:45], v47 offset:8192
    buffer_load_dwordx4 v2, s[8:11], s16 offen offset:3072 lds
    v_mfma_f32_16x16x32_bf16 v[228:231], a[8:11], a[20:23], 0
    ds_read_b64_tr_b16 a[46:47], v47 offset:12288
    ds_read_b128 a[52:55], v49 offset:3072
    v_mfma_f32_16x16x32_bf16 v[244:247], a[12:15], a[20:23], 0
    ds_read_b128 a[56:59], v49 offset:5120
    s_add_u32 s94, s94, 16384
    s_waitcnt lgkmcnt(12)
    v_mfma_f32_16x16x32_bf16 v[200:203], a[0:3], a[24:27], 0
    ds_read_b128 a[60:63], v49 offset:7168
    v_mfma_f32_16x16x32_bf16 v[216:219], a[4:7], a[24:27], 0
    s_and_b32 s94, s94, 262143
    v_mfma_f32_16x16x32_bf16 v[232:235], a[8:11], a[24:27], 0
    v_mfma_f32_16x16x32_bf16 v[248:251], a[12:15], a[24:27], 0
    s_add_u32 s8, s92, s94
    s_waitcnt lgkmcnt(12)
    v_mfma_f32_16x16x32_bf16 v[204:207], a[0:3], a[28:31], 0
    v_mfma_f32_16x16x32_bf16 v[220:223], a[4:7], a[28:31], 0
    s_addc_u32 s9, s93, 0
    v_mfma_f32_16x16x32_bf16 v[236:239], a[8:11], a[28:31], 0
    v_mfma_f32_16x16x32_bf16 v[252:255], a[12:15], a[28:31], 0
    s_waitcnt lgkmcnt(9)
    v_mfma_f32_16x16x32_bf16 v[192:195], a[32:35], a[48:51], v[192:195]
    s_waitcnt lgkmcnt(7)
    v_mfma_f32_16x16x32_bf16 v[208:211], a[36:39], a[48:51], v[208:211]
    s_waitcnt lgkmcnt(5)
    v_mfma_f32_16x16x32_bf16 v[224:227], a[40:43], a[48:51], v[224:227]
    s_waitcnt lgkmcnt(0)
    s_waitcnt vmcnt(8)
    s_barrier
    v_mfma_f32_16x16x32_bf16 v[240:243], a[44:47], a[48:51], v[240:243]
    ds_read_b128 a[16:19], v49 offset:32768
    ds_read_b64_tr_b16 a[0:1], v44 offset:32768
    v_mfma_f32_16x16x32_bf16 v[196:199], a[32:35], a[52:55], v[196:199]
    ds_read_b64_tr_b16 a[2:3], v44 offset:36864
    ds_read_b64_tr_b16 a[4:5], v45 offset:32768
    s_add_u32 m0, s49, 32768
    v_mfma_f32_16x16x32_bf16 v[212:215], a[36:39], a[52:55], v[212:215]
    ds_read_b64_tr_b16 a[6:7], v45 offset:36864
    ds_read_b64_tr_b16 a[8:9], v46 offset:32768
    buffer_load_dwordx4 v6, s[12:15], s20 offen offset:0 lds
    v_mfma_f32_16x16x32_bf16 v[228:231], a[40:43], a[52:55], v[228:231]
    ds_read_b64_tr_b16 a[10:11], v46 offset:36864
    buffer_load_dwordx4 v7, s[12:15], s21 offen offset:1024 lds
    v_mfma_f32_16x16x32_bf16 v[244:247], a[44:47], a[52:55], v[244:247]
    ds_read_b64_tr_b16 a[12:13], v47 offset:32768
    ds_read_b64_tr_b16 a[14:15], v47 offset:36864
    buffer_load_dwordx4 v6, s[12:15], s22 offen offset:2048 lds
    v_mfma_f32_16x16x32_bf16 v[200:203], a[32:35], a[56:59], v[200:203]
    ds_read_b128 a[20:23], v49 offset:34816
    ds_read_b128 a[24:27], v49 offset:36864
    buffer_load_dwordx4 v7, s[12:15], s23 offen offset:3072 lds
    v_mfma_f32_16x16x32_bf16 v[216:219], a[36:39], a[56:59], v[216:219]
    ds_read_b128 a[28:31], v49 offset:38912
    s_add_u32 s95, s95, 131072
    v_mfma_f32_16x16x32_bf16 v[232:235], a[40:43], a[56:59], v[232:235]
    s_and_b32 s95, s95, 0x1fffff
    v_mfma_f32_16x16x32_bf16 v[248:251], a[44:47], a[56:59], v[248:251]
    s_add_u32 s12, s72, s95
    v_mfma_f32_16x16x32_bf16 v[204:207], a[32:35], a[60:63], v[204:207]
    s_addc_u32 s13, s73, 0
    v_mfma_f32_16x16x32_bf16 v[220:223], a[36:39], a[60:63], v[220:223]
    s_add_u32 m0, s48, 32768
    v_mfma_f32_16x16x32_bf16 v[236:239], a[40:43], a[60:63], v[236:239]
    buffer_load_dwordx4 v2, s[8:11], s16 offen offset:0 lds
    v_mfma_f32_16x16x32_bf16 v[252:255], a[44:47], a[60:63], v[252:255]
    s_waitcnt lgkmcnt(9)
    v_mfma_f32_16x16x32_bf16 v[192:195], a[0:3], a[16:19], v[192:195]
    ds_read_b128 a[48:51], v49 offset:33792
    ds_read_b64_tr_b16 a[32:33], v44 offset:40960
    s_waitcnt lgkmcnt(9)
    v_mfma_f32_16x16x32_bf16 v[208:211], a[4:7], a[16:19], v[208:211]
    ds_read_b64_tr_b16 a[34:35], v44 offset:45056
    buffer_load_dwordx4 v2, s[8:11], s16 offen offset:1024 lds
    s_waitcnt lgkmcnt(8)
    v_mfma_f32_16x16x32_bf16 v[224:227], a[8:11], a[16:19], v[224:227]
    ds_read_b64_tr_b16 a[36:37], v45 offset:40960
    s_waitcnt lgkmcnt(7)
    v_mfma_f32_16x16x32_bf16 v[240:243], a[12:15], a[16:19], v[240:243]
    ds_read_b64_tr_b16 a[38:39], v45 offset:45056
    ds_read_b64_tr_b16 a[40:41], v46 offset:40960
    buffer_load_dwordx4 v2, s[8:11], s16 offen offset:2048 lds
    s_waitcnt lgkmcnt(8)
    v_mfma_f32_16x16x32_bf16 v[196:199], a[0:3], a[20:23], v[196:199]
    ds_read_b64_tr_b16 a[42:43], v46 offset:45056
    v_mfma_f32_16x16x32_bf16 v[212:215], a[4:7], a[20:23], v[212:215]
    ds_read_b64_tr_b16 a[44:45], v47 offset:40960
    buffer_load_dwordx4 v2, s[8:11], s16 offen offset:3072 lds
    v_mfma_f32_16x16x32_bf16 v[228:231], a[8:11], a[20:23], v[228:231]
    ds_read_b64_tr_b16 a[46:47], v47 offset:45056
    ds_read_b128 a[52:55], v49 offset:35840
    v_mfma_f32_16x16x32_bf16 v[244:247], a[12:15], a[20:23], v[244:247]
    ds_read_b128 a[56:59], v49 offset:37888
    s_add_u32 s94, s94, 16384
    s_waitcnt lgkmcnt(12)
    v_mfma_f32_16x16x32_bf16 v[200:203], a[0:3], a[24:27], v[200:203]
    ds_read_b128 a[60:63], v49 offset:39936
    v_mfma_f32_16x16x32_bf16 v[216:219], a[4:7], a[24:27], v[216:219]
    s_and_b32 s94, s94, 262143
    v_mfma_f32_16x16x32_bf16 v[232:235], a[8:11], a[24:27], v[232:235]
    v_mfma_f32_16x16x32_bf16 v[248:251], a[12:15], a[24:27], v[248:251]
    s_add_u32 s8, s92, s94
    s_waitcnt lgkmcnt(12)
    v_mfma_f32_16x16x32_bf16 v[204:207], a[0:3], a[28:31], v[204:207]
    v_mfma_f32_16x16x32_bf16 v[220:223], a[4:7], a[28:31], v[220:223]
    s_addc_u32 s9, s93, 0
    v_mfma_f32_16x16x32_bf16 v[236:239], a[8:11], a[28:31], v[236:239]
    v_mfma_f32_16x16x32_bf16 v[252:255], a[12:15], a[28:31], v[252:255]
    s_waitcnt lgkmcnt(9)
    v_mfma_f32_16x16x32_bf16 v[192:195], a[32:35], a[48:51], v[192:195]
    s_waitcnt lgkmcnt(7)
    v_mfma_f32_16x16x32_bf16 v[208:211], a[36:39], a[48:51], v[208:211]
    s_waitcnt lgkmcnt(5)
    v_mfma_f32_16x16x32_bf16 v[224:227], a[40:43], a[48:51], v[224:227]
    s_waitcnt lgkmcnt(0)
    s_waitcnt vmcnt(8)
    s_barrier
    v_mfma_f32_16x16x32_bf16 v[240:243], a[44:47], a[48:51], v[240:243]
    ds_read_b128 a[16:19], v48 offset:0
    ds_read_b64_tr_b16 a[0:1], v40 offset:0
    v_mfma_f32_16x16x32_bf16 v[196:199], a[32:35], a[52:55], v[196:199]
    ds_read_b64_tr_b16 a[2:3], v40 offset:4096
    ds_read_b64_tr_b16 a[4:5], v41 offset:0
    s_add_u32 m0, s49, 65536
    v_mfma_f32_16x16x32_bf16 v[212:215], a[36:39], a[52:55], v[212:215]
    ds_read_b64_tr_b16 a[6:7], v41 offset:4096
    ds_read_b64_tr_b16 a[8:9], v42 offset:0
    buffer_load_dwordx4 v6, s[12:15], s20 offen offset:0 lds
    v_mfma_f32_16x16x32_bf16 v[228:231], a[40:43], a[52:55], v[228:231]
    ds_read_b64_tr_b16 a[10:11], v42 offset:4096
    buffer_load_dwordx4 v7, s[12:15], s21 offen offset:1024 lds
    v_mfma_f32_16x16x32_bf16 v[244:247], a[44:47], a[52:55], v[244:247]
    ds_read_b64_tr_b16 a[12:13], v43 offset:0
    ds_read_b64_tr_b16 a[14:15], v43 offset:4096
    buffer_load_dwordx4 v6, s[12:15], s22 offen offset:2048 lds
    v_mfma_f32_16x16x32_bf16 v[200:203], a[32:35], a[56:59], v[200:203]
    ds_read_b128 a[20:23], v48 offset:2048
    ds_read_b128 a[24:27], v48 offset:4096
    buffer_load_dwordx4 v7, s[12:15], s23 offen offset:3072 lds
    v_mfma_f32_16x16x32_bf16 v[216:219], a[36:39], a[56:59], v[216:219]
    ds_read_b128 a[28:31], v48 offset:6144
    s_add_u32 s95, s95, 131072
    v_mfma_f32_16x16x32_bf16 v[232:235], a[40:43], a[56:59], v[232:235]
    s_and_b32 s95, s95, 0x1fffff
    v_mfma_f32_16x16x32_bf16 v[248:251], a[44:47], a[56:59], v[248:251]
    s_add_u32 s12, s72, s95
    v_mfma_f32_16x16x32_bf16 v[204:207], a[32:35], a[60:63], v[204:207]
    s_addc_u32 s13, s73, 0
    v_mfma_f32_16x16x32_bf16 v[220:223], a[36:39], a[60:63], v[220:223]
    s_add_u32 m0, s48, 65536
    v_mfma_f32_16x16x32_bf16 v[236:239], a[40:43], a[60:63], v[236:239]
    buffer_load_dwordx4 v2, s[8:11], s16 offen offset:0 lds
    v_mfma_f32_16x16x32_bf16 v[252:255], a[44:47], a[60:63], v[252:255]
    s_waitcnt lgkmcnt(9)
    v_mfma_f32_16x16x32_bf16 v[192:195], a[0:3], a[16:19], v[192:195]
    ds_read_b128 a[48:51], v48 offset:1024
    ds_read_b64_tr_b16 a[32:33], v40 offset:8192
    s_waitcnt lgkmcnt(9)
    v_mfma_f32_16x16x32_bf16 v[208:211], a[4:7], a[16:19], v[208:211]
    ds_read_b64_tr_b16 a[34:35], v40 offset:12288
    buffer_load_dwordx4 v2, s[8:11], s16 offen offset:1024 lds
    s_waitcnt lgkmcnt(8)
    v_mfma_f32_16x16x32_bf16 v[224:227], a[8:11], a[16:19], v[224:227]
    ds_read_b64_tr_b16 a[36:37], v41 offset:8192
    s_waitcnt lgkmcnt(7)
    v_mfma_f32_16x16x32_bf16 v[240:243], a[12:15], a[16:19], v[240:243]
    ds_read_b64_tr_b16 a[38:39], v41 offset:12288
    ds_read_b64_tr_b16 a[40:41], v42 offset:8192
    buffer_load_dwordx4 v2, s[8:11], s16 offen offset:2048 lds
    s_waitcnt lgkmcnt(8)
    v_mfma_f32_16x16x32_bf16 v[196:199], a[0:3], a[20:23], v[196:199]
    ds_read_b64_tr_b16 a[42:43], v42 offset:12288
    v_mfma_f32_16x16x32_bf16 v[212:215], a[4:7], a[20:23], v[212:215]
    ds_read_b64_tr_b16 a[44:45], v43 offset:8192
    buffer_load_dwordx4 v2, s[8:11], s16 offen offset:3072 lds
    v_mfma_f32_16x16x32_bf16 v[228:231], a[8:11], a[20:23], v[228:231]
    ds_read_b64_tr_b16 a[46:47], v43 offset:12288
    ds_read_b128 a[52:55], v48 offset:3072
    v_mfma_f32_16x16x32_bf16 v[244:247], a[12:15], a[20:23], v[244:247]
    ds_read_b128 a[56:59], v48 offset:5120
    s_add_u32 s94, s94, 16384
    s_waitcnt lgkmcnt(12)
    v_mfma_f32_16x16x32_bf16 v[200:203], a[0:3], a[24:27], v[200:203]
    ds_read_b128 a[60:63], v48 offset:7168
    v_mfma_f32_16x16x32_bf16 v[216:219], a[4:7], a[24:27], v[216:219]
    s_and_b32 s94, s94, 262143
    v_mfma_f32_16x16x32_bf16 v[232:235], a[8:11], a[24:27], v[232:235]
    v_mfma_f32_16x16x32_bf16 v[248:251], a[12:15], a[24:27], v[248:251]
    s_add_u32 s8, s92, s94
    s_waitcnt lgkmcnt(12)
    v_mfma_f32_16x16x32_bf16 v[204:207], a[0:3], a[28:31], v[204:207]
    v_mfma_f32_16x16x32_bf16 v[220:223], a[4:7], a[28:31], v[220:223]
    s_addc_u32 s9, s93, 0
    v_mfma_f32_16x16x32_bf16 v[236:239], a[8:11], a[28:31], v[236:239]
    v_mfma_f32_16x16x32_bf16 v[252:255], a[12:15], a[28:31], v[252:255]
    s_waitcnt lgkmcnt(9)
    v_mfma_f32_16x16x32_bf16 v[192:195], a[32:35], a[48:51], v[192:195]
    s_waitcnt lgkmcnt(7)
    v_mfma_f32_16x16x32_bf16 v[208:211], a[36:39], a[48:51], v[208:211]
    s_waitcnt lgkmcnt(5)
    v_mfma_f32_16x16x32_bf16 v[224:227], a[40:43], a[48:51], v[224:227]
    s_waitcnt lgkmcnt(0)
    s_waitcnt vmcnt(8)
    s_barrier
    v_mfma_f32_16x16x32_bf16 v[240:243], a[44:47], a[48:51], v[240:243]
    ds_read_b128 a[16:19], v48 offset:32768
    ds_read_b64_tr_b16 a[0:1], v40 offset:32768
    v_mfma_f32_16x16x32_bf16 v[196:199], a[32:35], a[52:55], v[196:199]
    ds_read_b64_tr_b16 a[2:3], v40 offset:36864
    ds_read_b64_tr_b16 a[4:5], v41 offset:32768
    s_add_u32 m0, s49, 98304
    v_mfma_f32_16x16x32_bf16 v[212:215], a[36:39], a[52:55], v[212:215]
    ds_read_b64_tr_b16 a[6:7], v41 offset:36864
    ds_read_b64_tr_b16 a[8:9], v42 offset:32768
    buffer_load_dwordx4 v6, s[12:15], s20 offen offset:0 lds
    v_mfma_f32_16x16x32_bf16 v[228:231], a[40:43], a[52:55], v[228:231]
    ds_read_b64_tr_b16 a[10:11], v42 offset:36864
    buffer_load_dwordx4 v7, s[12:15], s21 offen offset:1024 lds
    v_mfma_f32_16x16x32_bf16 v[244:247], a[44:47], a[52:55], v[244:247]
    ds_read_b64_tr_b16 a[12:13], v43 offset:32768
    ds_read_b64_tr_b16 a[14:15], v43 offset:36864
    buffer_load_dwordx4 v6, s[12:15], s22 offen offset:2048 lds
    v_mfma_f32_16x16x32_bf16 v[200:203], a[32:35], a[56:59], v[200:203]
    ds_read_b128 a[20:23], v48 offset:34816
    ds_read_b128 a[24:27], v48 offset:36864
    buffer_load_dwordx4 v7, s[12:15], s23 offen offset:3072 lds
    v_mfma_f32_16x16x32_bf16 v[216:219], a[36:39], a[56:59], v[216:219]
    ds_read_b128 a[28:31], v48 offset:38912
    s_add_u32 s95, s95, 131072
    v_mfma_f32_16x16x32_bf16 v[232:235], a[40:43], a[56:59], v[232:235]
    s_and_b32 s95, s95, 0x1fffff
    v_mfma_f32_16x16x32_bf16 v[248:251], a[44:47], a[56:59], v[248:251]
    s_add_u32 s12, s72, s95
    v_mfma_f32_16x16x32_bf16 v[204:207], a[32:35], a[60:63], v[204:207]
    s_addc_u32 s13, s73, 0
    v_mfma_f32_16x16x32_bf16 v[220:223], a[36:39], a[60:63], v[220:223]
    s_add_u32 m0, s48, 98304
    v_mfma_f32_16x16x32_bf16 v[236:239], a[40:43], a[60:63], v[236:239]
    buffer_load_dwordx4 v2, s[8:11], s16 offen offset:0 lds
    v_mfma_f32_16x16x32_bf16 v[252:255], a[44:47], a[60:63], v[252:255]
    s_waitcnt lgkmcnt(9)
    v_mfma_f32_16x16x32_bf16 v[192:195], a[0:3], a[16:19], v[192:195]
    ds_read_b128 a[48:51], v48 offset:33792
    ds_read_b64_tr_b16 a[32:33], v40 offset:40960
    s_waitcnt lgkmcnt(9)
    v_mfma_f32_16x16x32_bf16 v[208:211], a[4:7], a[16:19], v[208:211]
    ds_read_b64_tr_b16 a[34:35], v40 offset:45056
    buffer_load_dwordx4 v2, s[8:11], s16 offen offset:1024 lds
    s_waitcnt lgkmcnt(8)
    v_mfma_f32_16x16x32_bf16 v[224:227], a[8:11], a[16:19], v[224:227]
    ds_read_b64_tr_b16 a[36:37], v41 offset:40960
    s_waitcnt lgkmcnt(7)
    v_mfma_f32_16x16x32_bf16 v[240:243], a[12:15], a[16:19], v[240:243]
    ds_read_b64_tr_b16 a[38:39], v41 offset:45056
    ds_read_b64_tr_b16 a[40:41], v42 offset:40960
    buffer_load_dwordx4 v2, s[8:11], s16 offen offset:2048 lds
    s_waitcnt lgkmcnt(8)
    v_mfma_f32_16x16x32_bf16 v[196:199], a[0:3], a[20:23], v[196:199]
    ds_read_b64_tr_b16 a[42:43], v42 offset:45056
    v_mfma_f32_16x16x32_bf16 v[212:215], a[4:7], a[20:23], v[212:215]
    ds_read_b64_tr_b16 a[44:45], v43 offset:40960
    buffer_load_dwordx4 v2, s[8:11], s16 offen offset:3072 lds
    v_mfma_f32_16x16x32_bf16 v[228:231], a[8:11], a[20:23], v[228:231]
    ds_read_b64_tr_b16 a[46:47], v43 offset:45056
    ds_read_b128 a[52:55], v48 offset:35840
    v_mfma_f32_16x16x32_bf16 v[244:247], a[12:15], a[20:23], v[244:247]
    ds_read_b128 a[56:59], v48 offset:37888
    s_add_u32 s94, s94, 16384
    s_waitcnt lgkmcnt(12)
    v_mfma_f32_16x16x32_bf16 v[200:203], a[0:3], a[24:27], v[200:203]
    ds_read_b128 a[60:63], v48 offset:39936
    v_mfma_f32_16x16x32_bf16 v[216:219], a[4:7], a[24:27], v[216:219]
    s_and_b32 s94, s94, 262143
    v_mfma_f32_16x16x32_bf16 v[232:235], a[8:11], a[24:27], v[232:235]
    v_mfma_f32_16x16x32_bf16 v[248:251], a[12:15], a[24:27], v[248:251]
    s_add_u32 s8, s92, s94
    s_waitcnt lgkmcnt(12)
    v_mfma_f32_16x16x32_bf16 v[204:207], a[0:3], a[28:31], v[204:207]
    v_mfma_f32_16x16x32_bf16 v[220:223], a[4:7], a[28:31], v[220:223]
    s_addc_u32 s9, s93, 0
    v_mfma_f32_16x16x32_bf16 v[236:239], a[8:11], a[28:31], v[236:239]
    v_mfma_f32_16x16x32_bf16 v[252:255], a[12:15], a[28:31], v[252:255]
    s_waitcnt lgkmcnt(9)
    v_mfma_f32_16x16x32_bf16 v[192:195], a[32:35], a[48:51], v[192:195]
    s_waitcnt lgkmcnt(7)
    v_mfma_f32_16x16x32_bf16 v[208:211], a[36:39], a[48:51], v[208:211]
    s_waitcnt lgkmcnt(5)
    v_mfma_f32_16x16x32_bf16 v[224:227], a[40:43], a[48:51], v[224:227]
    s_waitcnt lgkmcnt(0)
    s_waitcnt vmcnt(8)
    s_barrier
    v_mfma_f32_16x16x32_bf16 v[240:243], a[44:47], a[48:51], v[240:243]
    ds_read_b128 a[16:19], v49 offset:0
    ds_read_b64_tr_b16 a[0:1], v44 offset:0
    v_mfma_f32_16x16x32_bf16 v[196:199], a[32:35], a[52:55], v[196:199]
    ds_read_b64_tr_b16 a[2:3], v44 offset:4096
    ds_read_b64_tr_b16 a[4:5], v45 offset:0
    s_add_u32 m0, s49, 0
    v_mfma_f32_16x16x32_bf16 v[212:215], a[36:39], a[52:55], v[212:215]
    ds_read_b64_tr_b16 a[6:7], v45 offset:4096
    ds_read_b64_tr_b16 a[8:9], v46 offset:0
    buffer_load_dwordx4 v6, s[12:15], s20 offen offset:0 lds
    v_mfma_f32_16x16x32_bf16 v[228:231], a[40:43], a[52:55], v[228:231]
    ds_read_b64_tr_b16 a[10:11], v46 offset:4096
    buffer_load_dwordx4 v7, s[12:15], s21 offen offset:1024 lds
    v_mfma_f32_16x16x32_bf16 v[244:247], a[44:47], a[52:55], v[244:247]
    ds_read_b64_tr_b16 a[12:13], v47 offset:0
    ds_read_b64_tr_b16 a[14:15], v47 offset:4096
    buffer_load_dwordx4 v6, s[12:15], s22 offen offset:2048 lds
    v_mfma_f32_16x16x32_bf16 v[200:203], a[32:35], a[56:59], v[200:203]
    ds_read_b128 a[20:23], v49 offset:2048
    ds_read_b128 a[24:27], v49 offset:4096
    buffer_load_dwordx4 v7, s[12:15], s23 offen offset:3072 lds
    v_mfma_f32_16x16x32_bf16 v[216:219], a[36:39], a[56:59], v[216:219]
    ds_read_b128 a[28:31], v49 offset:6144
    s_add_u32 s95, s95, 131072
    v_mfma_f32_16x16x32_bf16 v[232:235], a[40:43], a[56:59], v[232:235]
    s_and_b32 s95, s95, 0x1fffff
    v_mfma_f32_16x16x32_bf16 v[248:251], a[44:47], a[56:59], v[248:251]
    s_add_u32 s12, s72, s95
    v_mfma_f32_16x16x32_bf16 v[204:207], a[32:35], a[60:63], v[204:207]
    s_addc_u32 s13, s73, 0
    v_mfma_f32_16x16x32_bf16 v[220:223], a[36:39], a[60:63], v[220:223]
    s_add_u32 m0, s48, 0
    v_mfma_f32_16x16x32_bf16 v[236:239], a[40:43], a[60:63], v[236:239]
    buffer_load_dwordx4 v2, s[8:11], s16 offen offset:0 lds
    v_mfma_f32_16x16x32_bf16 v[252:255], a[44:47], a[60:63], v[252:255]
    s_waitcnt lgkmcnt(9)
    v_mfma_f32_16x16x32_bf16 v[192:195], a[0:3], a[16:19], v[192:195]
    ds_read_b128 a[48:51], v49 offset:1024
    ds_read_b64_tr_b16 a[32:33], v44 offset:8192
    s_waitcnt lgkmcnt(9)
    v_mfma_f32_16x16x32_bf16 v[208:211], a[4:7], a[16:19], v[208:211]
    ds_read_b64_tr_b16 a[34:35], v44 offset:12288
    buffer_load_dwordx4 v2, s[8:11], s16 offen offset:1024 lds
    s_waitcnt lgkmcnt(8)
    v_mfma_f32_16x16x32_bf16 v[224:227], a[8:11], a[16:19], v[224:227]
    ds_read_b64_tr_b16 a[36:37], v45 offset:8192
    s_waitcnt lgkmcnt(7)
    v_mfma_f32_16x16x32_bf16 v[240:243], a[12:15], a[16:19], v[240:243]
    ds_read_b64_tr_b16 a[38:39], v45 offset:12288
    ds_read_b64_tr_b16 a[40:41], v46 offset:8192
    buffer_load_dwordx4 v2, s[8:11], s16 offen offset:2048 lds
    s_waitcnt lgkmcnt(8)
    v_mfma_f32_16x16x32_bf16 v[196:199], a[0:3], a[20:23], v[196:199]
    ds_read_b64_tr_b16 a[42:43], v46 offset:12288
    v_mfma_f32_16x16x32_bf16 v[212:215], a[4:7], a[20:23], v[212:215]
    ds_read_b64_tr_b16 a[44:45], v47 offset:8192
    buffer_load_dwordx4 v2, s[8:11], s16 offen offset:3072 lds
    v_mfma_f32_16x16x32_bf16 v[228:231], a[8:11], a[20:23], v[228:231]
    ds_read_b64_tr_b16 a[46:47], v47 offset:12288
    ds_read_b128 a[52:55], v49 offset:3072
    v_mfma_f32_16x16x32_bf16 v[244:247], a[12:15], a[20:23], v[244:247]
    ds_read_b128 a[56:59], v49 offset:5120
    s_add_u32 s94, s94, 16384
    s_waitcnt lgkmcnt(12)
    v_mfma_f32_16x16x32_bf16 v[200:203], a[0:3], a[24:27], v[200:203]
    ds_read_b128 a[60:63], v49 offset:7168
    v_mfma_f32_16x16x32_bf16 v[216:219], a[4:7], a[24:27], v[216:219]
    s_and_b32 s94, s94, 262143
    v_mfma_f32_16x16x32_bf16 v[232:235], a[8:11], a[24:27], v[232:235]
    v_mfma_f32_16x16x32_bf16 v[248:251], a[12:15], a[24:27], v[248:251]
    s_add_u32 s8, s92, s94
    s_waitcnt lgkmcnt(12)
    v_mfma_f32_16x16x32_bf16 v[204:207], a[0:3], a[28:31], v[204:207]
    v_mfma_f32_16x16x32_bf16 v[220:223], a[4:7], a[28:31], v[220:223]
    s_addc_u32 s9, s93, 0
    v_mfma_f32_16x16x32_bf16 v[236:239], a[8:11], a[28:31], v[236:239]
    v_mfma_f32_16x16x32_bf16 v[252:255], a[12:15], a[28:31], v[252:255]
    s_waitcnt lgkmcnt(9)
    v_mfma_f32_16x16x32_bf16 v[192:195], a[32:35], a[48:51], v[192:195]
    s_waitcnt lgkmcnt(7)
    v_mfma_f32_16x16x32_bf16 v[208:211], a[36:39], a[48:51], v[208:211]
    s_waitcnt lgkmcnt(5)
    v_mfma_f32_16x16x32_bf16 v[224:227], a[40:43], a[48:51], v[224:227]
    s_waitcnt lgkmcnt(0)
    s_waitcnt vmcnt(8)
    s_barrier
    v_mfma_f32_16x16x32_bf16 v[240:243], a[44:47], a[48:51], v[240:243]
    ds_read_b128 a[16:19], v49 offset:32768
    ds_read_b64_tr_b16 a[0:1], v44 offset:32768
    v_mfma_f32_16x16x32_bf16 v[196:199], a[32:35], a[52:55], v[196:199]
    ds_read_b64_tr_b16 a[2:3], v44 offset:36864
    ds_read_b64_tr_b16 a[4:5], v45 offset:32768
    s_add_u32 m0, s49, 32768
    v_mfma_f32_16x16x32_bf16 v[212:215], a[36:39], a[52:55], v[212:215]
    ds_read_b64_tr_b16 a[6:7], v45 offset:36864
    ds_read_b64_tr_b16 a[8:9], v46 offset:32768
    buffer_load_dwordx4 v6, s[12:15], s20 offen offset:0 lds
    v_mfma_f32_16x16x32_bf16 v[228:231], a[40:43], a[52:55], v[228:231]
    ds_read_b64_tr_b16 a[10:11], v46 offset:36864
    buffer_load_dwordx4 v7, s[12:15], s21 offen offset:1024 lds
    v_mfma_f32_16x16x32_bf16 v[244:247], a[44:47], a[52:55], v[244:247]
    ds_read_b64_tr_b16 a[12:13], v47 offset:32768
    ds_read_b64_tr_b16 a[14:15], v47 offset:36864
    buffer_load_dwordx4 v6, s[12:15], s22 offen offset:2048 lds
    v_mfma_f32_16x16x32_bf16 v[200:203], a[32:35], a[56:59], v[200:203]
    ds_read_b128 a[20:23], v49 offset:34816
    ds_read_b128 a[24:27], v49 offset:36864
    buffer_load_dwordx4 v7, s[12:15], s23 offen offset:3072 lds
    v_mfma_f32_16x16x32_bf16 v[216:219], a[36:39], a[56:59], v[216:219]
    ds_read_b128 a[28:31], v49 offset:38912
    s_add_u32 s95, s95, 131072
    v_mfma_f32_16x16x32_bf16 v[232:235], a[40:43], a[56:59], v[232:235]
    s_and_b32 s95, s95, 0x1fffff
    v_mfma_f32_16x16x32_bf16 v[248:251], a[44:47], a[56:59], v[248:251]
    s_add_u32 s12, s72, s95
    v_mfma_f32_16x16x32_bf16 v[204:207], a[32:35], a[60:63], v[204:207]
    s_addc_u32 s13, s73, 0
    v_mfma_f32_16x16x32_bf16 v[220:223], a[36:39], a[60:63], v[220:223]
    s_add_u32 m0, s48, 32768
    v_mfma_f32_16x16x32_bf16 v[236:239], a[40:43], a[60:63], v[236:239]
    buffer_load_dwordx4 v2, s[8:11], s16 offen offset:0 lds
    v_mfma_f32_16x16x32_bf16 v[252:255], a[44:47], a[60:63], v[252:255]
    s_waitcnt lgkmcnt(9)
    v_mfma_f32_16x16x32_bf16 v[192:195], a[0:3], a[16:19], v[192:195]
    ds_read_b128 a[48:51], v49 offset:33792
    ds_read_b64_tr_b16 a[32:33], v44 offset:40960
    s_waitcnt lgkmcnt(9)
    v_mfma_f32_16x16x32_bf16 v[208:211], a[4:7], a[16:19], v[208:211]
    ds_read_b64_tr_b16 a[34:35], v44 offset:45056
    buffer_load_dwordx4 v2, s[8:11], s16 offen offset:1024 lds
    s_waitcnt lgkmcnt(8)
    v_mfma_f32_16x16x32_bf16 v[224:227], a[8:11], a[16:19], v[224:227]
    ds_read_b64_tr_b16 a[36:37], v45 offset:40960
    s_waitcnt lgkmcnt(7)
    v_mfma_f32_16x16x32_bf16 v[240:243], a[12:15], a[16:19], v[240:243]
    ds_read_b64_tr_b16 a[38:39], v45 offset:45056
    ds_read_b64_tr_b16 a[40:41], v46 offset:40960
    buffer_load_dwordx4 v2, s[8:11], s16 offen offset:2048 lds
    s_waitcnt lgkmcnt(8)
    v_mfma_f32_16x16x32_bf16 v[196:199], a[0:3], a[20:23], v[196:199]
    ds_read_b64_tr_b16 a[42:43], v46 offset:45056
    v_mfma_f32_16x16x32_bf16 v[212:215], a[4:7], a[20:23], v[212:215]
    ds_read_b64_tr_b16 a[44:45], v47 offset:40960
    buffer_load_dwordx4 v2, s[8:11], s16 offen offset:3072 lds
    v_mfma_f32_16x16x32_bf16 v[228:231], a[8:11], a[20:23], v[228:231]
    ds_read_b64_tr_b16 a[46:47], v47 offset:45056
    ds_read_b128 a[52:55], v49 offset:35840
    v_mfma_f32_16x16x32_bf16 v[244:247], a[12:15], a[20:23], v[244:247]
    ds_read_b128 a[56:59], v49 offset:37888
    s_add_u32 s94, s94, 16384
    s_waitcnt lgkmcnt(12)
    v_mfma_f32_16x16x32_bf16 v[200:203], a[0:3], a[24:27], v[200:203]
    ds_read_b128 a[60:63], v49 offset:39936
    v_mfma_f32_16x16x32_bf16 v[216:219], a[4:7], a[24:27], v[216:219]
    s_and_b32 s94, s94, 262143
    v_mfma_f32_16x16x32_bf16 v[232:235], a[8:11], a[24:27], v[232:235]
    v_mfma_f32_16x16x32_bf16 v[248:251], a[12:15], a[24:27], v[248:251]
    s_add_u32 s8, s92, s94
    s_waitcnt lgkmcnt(12)
    v_mfma_f32_16x16x32_bf16 v[204:207], a[0:3], a[28:31], v[204:207]
    v_mfma_f32_16x16x32_bf16 v[220:223], a[4:7], a[28:31], v[220:223]
    s_addc_u32 s9, s93, 0
    v_mfma_f32_16x16x32_bf16 v[236:239], a[8:11], a[28:31], v[236:239]
    v_mfma_f32_16x16x32_bf16 v[252:255], a[12:15], a[28:31], v[252:255]
    s_waitcnt lgkmcnt(9)
    v_mfma_f32_16x16x32_bf16 v[192:195], a[32:35], a[48:51], v[192:195]
    s_waitcnt lgkmcnt(7)
    v_mfma_f32_16x16x32_bf16 v[208:211], a[36:39], a[48:51], v[208:211]
    s_waitcnt lgkmcnt(5)
    v_mfma_f32_16x16x32_bf16 v[224:227], a[40:43], a[48:51], v[224:227]
    s_waitcnt lgkmcnt(0)
    s_waitcnt vmcnt(8)
    s_barrier
    v_mfma_f32_16x16x32_bf16 v[240:243], a[44:47], a[48:51], v[240:243]
    ds_read_b128 a[16:19], v48 offset:0
    ds_read_b64_tr_b16 a[0:1], v40 offset:0
    v_mfma_f32_16x16x32_bf16 v[196:199], a[32:35], a[52:55], v[196:199]
    ds_read_b64_tr_b16 a[2:3], v40 offset:4096
    ds_read_b64_tr_b16 a[4:5], v41 offset:0
    s_add_u32 m0, s49, 65536
    v_mfma_f32_16x16x32_bf16 v[212:215], a[36:39], a[52:55], v[212:215]
    ds_read_b64_tr_b16 a[6:7], v41 offset:4096
    ds_read_b64_tr_b16 a[8:9], v42 offset:0
    buffer_load_dwordx4 v6, s[12:15], s20 offen offset:0 lds
    v_mfma_f32_16x16x32_bf16 v[228:231], a[40:43], a[52:55], v[228:231]
    ds_read_b64_tr_b16 a[10:11], v42 offset:4096
    buffer_load_dwordx4 v7, s[12:15], s21 offen offset:1024 lds
    v_mfma_f32_16x16x32_bf16 v[244:247], a[44:47], a[52:55], v[244:247]
    ds_read_b64_tr_b16 a[12:13], v43 offset:0
    ds_read_b64_tr_b16 a[14:15], v43 offset:4096
    buffer_load_dwordx4 v6, s[12:15], s22 offen offset:2048 lds
    v_mfma_f32_16x16x32_bf16 v[200:203], a[32:35], a[56:59], v[200:203]
    ds_read_b128 a[20:23], v48 offset:2048
    ds_read_b128 a[24:27], v48 offset:4096
    buffer_load_dwordx4 v7, s[12:15], s23 offen offset:3072 lds
    v_mfma_f32_16x16x32_bf16 v[216:219], a[36:39], a[56:59], v[216:219]
    ds_read_b128 a[28:31], v48 offset:6144
    s_add_u32 s95, s95, 131072
    v_mfma_f32_16x16x32_bf16 v[232:235], a[40:43], a[56:59], v[232:235]
    s_and_b32 s95, s95, 0x1fffff
    v_mfma_f32_16x16x32_bf16 v[248:251], a[44:47], a[56:59], v[248:251]
    s_add_u32 s12, s72, s95
    v_mfma_f32_16x16x32_bf16 v[204:207], a[32:35], a[60:63], v[204:207]
    s_addc_u32 s13, s73, 0
    v_mfma_f32_16x16x32_bf16 v[220:223], a[36:39], a[60:63], v[220:223]
    s_add_u32 m0, s48, 65536
    v_mfma_f32_16x16x32_bf16 v[236:239], a[40:43], a[60:63], v[236:239]
    buffer_load_dwordx4 v2, s[8:11], s16 offen offset:0 lds
    v_mfma_f32_16x16x32_bf16 v[252:255], a[44:47], a[60:63], v[252:255]
    s_waitcnt lgkmcnt(9)
    v_mfma_f32_16x16x32_bf16 v[192:195], a[0:3], a[16:19], v[192:195]
    ds_read_b128 a[48:51], v48 offset:1024
    ds_read_b64_tr_b16 a[32:33], v40 offset:8192
    s_waitcnt lgkmcnt(9)
    v_mfma_f32_16x16x32_bf16 v[208:211], a[4:7], a[16:19], v[208:211]
    ds_read_b64_tr_b16 a[34:35], v40 offset:12288
    buffer_load_dwordx4 v2, s[8:11], s16 offen offset:1024 lds
    s_waitcnt lgkmcnt(8)
    v_mfma_f32_16x16x32_bf16 v[224:227], a[8:11], a[16:19], v[224:227]
    ds_read_b64_tr_b16 a[36:37], v41 offset:8192
    s_waitcnt lgkmcnt(7)
    v_mfma_f32_16x16x32_bf16 v[240:243], a[12:15], a[16:19], v[240:243]
    ds_read_b64_tr_b16 a[38:39], v41 offset:12288
    ds_read_b64_tr_b16 a[40:41], v42 offset:8192
    buffer_load_dwordx4 v2, s[8:11], s16 offen offset:2048 lds
    s_waitcnt lgkmcnt(8)
    v_mfma_f32_16x16x32_bf16 v[196:199], a[0:3], a[20:23], v[196:199]
    ds_read_b64_tr_b16 a[42:43], v42 offset:12288
    v_mfma_f32_16x16x32_bf16 v[212:215], a[4:7], a[20:23], v[212:215]
    ds_read_b64_tr_b16 a[44:45], v43 offset:8192
    buffer_load_dwordx4 v2, s[8:11], s16 offen offset:3072 lds
    v_mfma_f32_16x16x32_bf16 v[228:231], a[8:11], a[20:23], v[228:231]
    ds_read_b64_tr_b16 a[46:47], v43 offset:12288
    ds_read_b128 a[52:55], v48 offset:3072
    v_mfma_f32_16x16x32_bf16 v[244:247], a[12:15], a[20:23], v[244:247]
    ds_read_b128 a[56:59], v48 offset:5120
    s_add_u32 s94, s94, 16384
    s_waitcnt lgkmcnt(12)
    v_mfma_f32_16x16x32_bf16 v[200:203], a[0:3], a[24:27], v[200:203]
    ds_read_b128 a[60:63], v48 offset:7168
    v_mfma_f32_16x16x32_bf16 v[216:219], a[4:7], a[24:27], v[216:219]
    s_and_b32 s94, s94, 262143
    v_mfma_f32_16x16x32_bf16 v[232:235], a[8:11], a[24:27], v[232:235]
    v_mfma_f32_16x16x32_bf16 v[248:251], a[12:15], a[24:27], v[248:251]
    s_add_u32 s8, s92, s94
    s_waitcnt lgkmcnt(12)
    v_mfma_f32_16x16x32_bf16 v[204:207], a[0:3], a[28:31], v[204:207]
    v_mfma_f32_16x16x32_bf16 v[220:223], a[4:7], a[28:31], v[220:223]
    s_addc_u32 s9, s93, 0
    v_mfma_f32_16x16x32_bf16 v[236:239], a[8:11], a[28:31], v[236:239]
    v_mfma_f32_16x16x32_bf16 v[252:255], a[12:15], a[28:31], v[252:255]
    s_waitcnt lgkmcnt(9)
    v_mfma_f32_16x16x32_bf16 v[192:195], a[32:35], a[48:51], v[192:195]
    s_waitcnt lgkmcnt(7)
    v_mfma_f32_16x16x32_bf16 v[208:211], a[36:39], a[48:51], v[208:211]
    s_waitcnt lgkmcnt(5)
    v_mfma_f32_16x16x32_bf16 v[224:227], a[40:43], a[48:51], v[224:227]
    s_waitcnt lgkmcnt(0)
    s_waitcnt vmcnt(8)
    s_barrier
    v_mfma_f32_16x16x32_bf16 v[240:243], a[44:47], a[48:51], v[240:243]
    ds_read_b128 a[16:19], v48 offset:32768
    ds_read_b64_tr_b16 a[0:1], v40 offset:32768
    v_mfma_f32_16x16x32_bf16 v[196:199], a[32:35], a[52:55], v[196:199]
    ds_read_b64_tr_b16 a[2:3], v40 offset:36864
    ds_read_b64_tr_b16 a[4:5], v41 offset:32768
    s_add_u32 m0, s49, 98304
    v_mfma_f32_16x16x32_bf16 v[212:215], a[36:39], a[52:55], v[212:215]
    ds_read_b64_tr_b16 a[6:7], v41 offset:36864
    ds_read_b64_tr_b16 a[8:9], v42 offset:32768
    buffer_load_dwordx4 v6, s[12:15], s20 offen offset:0 lds
    v_mfma_f32_16x16x32_bf16 v[228:231], a[40:43], a[52:55], v[228:231]
    ds_read_b64_tr_b16 a[10:11], v42 offset:36864
    buffer_load_dwordx4 v7, s[12:15], s21 offen offset:1024 lds
    v_mfma_f32_16x16x32_bf16 v[244:247], a[44:47], a[52:55], v[244:247]
    ds_read_b64_tr_b16 a[12:13], v43 offset:32768
    ds_read_b64_tr_b16 a[14:15], v43 offset:36864
    buffer_load_dwordx4 v6, s[12:15], s22 offen offset:2048 lds
    v_mfma_f32_16x16x32_bf16 v[200:203], a[32:35], a[56:59], v[200:203]
    ds_read_b128 a[20:23], v48 offset:34816
    ds_read_b128 a[24:27], v48 offset:36864
    buffer_load_dwordx4 v7, s[12:15], s23 offen offset:3072 lds
    v_mfma_f32_16x16x32_bf16 v[216:219], a[36:39], a[56:59], v[216:219]
    ds_read_b128 a[28:31], v48 offset:38912
    s_add_u32 s95, s95, 131072
    v_mfma_f32_16x16x32_bf16 v[232:235], a[40:43], a[56:59], v[232:235]
    s_and_b32 s95, s95, 0x1fffff
    v_mfma_f32_16x16x32_bf16 v[248:251], a[44:47], a[56:59], v[248:251]
    s_add_u32 s12, s72, s95
    v_mfma_f32_16x16x32_bf16 v[204:207], a[32:35], a[60:63], v[204:207]
    s_addc_u32 s13, s73, 0
    v_mfma_f32_16x16x32_bf16 v[220:223], a[36:39], a[60:63], v[220:223]
    s_add_u32 m0, s48, 98304
    v_mfma_f32_16x16x32_bf16 v[236:239], a[40:43], a[60:63], v[236:239]
    buffer_load_dwordx4 v2, s[8:11], s16 offen offset:0 lds
    v_mfma_f32_16x16x32_bf16 v[252:255], a[44:47], a[60:63], v[252:255]
    s_waitcnt lgkmcnt(9)
    v_mfma_f32_16x16x32_bf16 v[192:195], a[0:3], a[16:19], v[192:195]
    ds_read_b128 a[48:51], v48 offset:33792
    ds_read_b64_tr_b16 a[32:33], v40 offset:40960
    s_waitcnt lgkmcnt(9)
    v_mfma_f32_16x16x32_bf16 v[208:211], a[4:7], a[16:19], v[208:211]
    ds_read_b64_tr_b16 a[34:35], v40 offset:45056
    buffer_load_dwordx4 v2, s[8:11], s16 offen offset:1024 lds
    s_waitcnt lgkmcnt(8)
    v_mfma_f32_16x16x32_bf16 v[224:227], a[8:11], a[16:19], v[224:227]
    ds_read_b64_tr_b16 a[36:37], v41 offset:40960
    s_waitcnt lgkmcnt(7)
    v_mfma_f32_16x16x32_bf16 v[240:243], a[12:15], a[16:19], v[240:243]
    ds_read_b64_tr_b16 a[38:39], v41 offset:45056
    ds_read_b64_tr_b16 a[40:41], v42 offset:40960
    buffer_load_dwordx4 v2, s[8:11], s16 offen offset:2048 lds
    s_waitcnt lgkmcnt(8)
    v_mfma_f32_16x16x32_bf16 v[196:199], a[0:3], a[20:23], v[196:199]
    ds_read_b64_tr_b16 a[42:43], v42 offset:45056
    v_mfma_f32_16x16x32_bf16 v[212:215], a[4:7], a[20:23], v[212:215]
    ds_read_b64_tr_b16 a[44:45], v43 offset:40960
    buffer_load_dwordx4 v2, s[8:11], s16 offen offset:3072 lds
    v_mfma_f32_16x16x32_bf16 v[228:231], a[8:11], a[20:23], v[228:231]
    ds_read_b64_tr_b16 a[46:47], v43 offset:45056
    ds_read_b128 a[52:55], v48 offset:35840
    v_mfma_f32_16x16x32_bf16 v[244:247], a[12:15], a[20:23], v[244:247]
    ds_read_b128 a[56:59], v48 offset:37888
    s_add_u32 s94, s94, 16384
    s_waitcnt lgkmcnt(12)
    v_mfma_f32_16x16x32_bf16 v[200:203], a[0:3], a[24:27], v[200:203]
    ds_read_b128 a[60:63], v48 offset:39936
    v_mfma_f32_16x16x32_bf16 v[216:219], a[4:7], a[24:27], v[216:219]
    s_and_b32 s94, s94, 262143
    v_mfma_f32_16x16x32_bf16 v[232:235], a[8:11], a[24:27], v[232:235]
    v_mfma_f32_16x16x32_bf16 v[248:251], a[12:15], a[24:27], v[248:251]
    s_add_u32 s8, s92, s94
    s_waitcnt lgkmcnt(12)
    v_mfma_f32_16x16x32_bf16 v[204:207], a[0:3], a[28:31], v[204:207]
    v_mfma_f32_16x16x32_bf16 v[220:223], a[4:7], a[28:31], v[220:223]
    s_addc_u32 s9, s93, 0
    v_mfma_f32_16x16x32_bf16 v[236:239], a[8:11], a[28:31], v[236:239]
    v_mfma_f32_16x16x32_bf16 v[252:255], a[12:15], a[28:31], v[252:255]
    s_waitcnt lgkmcnt(9)
    v_mfma_f32_16x16x32_bf16 v[192:195], a[32:35], a[48:51], v[192:195]
    s_waitcnt lgkmcnt(7)
    v_mfma_f32_16x16x32_bf16 v[208:211], a[36:39], a[48:51], v[208:211]
    s_waitcnt lgkmcnt(5)
    v_mfma_f32_16x16x32_bf16 v[224:227], a[40:43], a[48:51], v[224:227]
    s_waitcnt lgkmcnt(0)
    s_waitcnt vmcnt(8)
    s_barrier
    v_mfma_f32_16x16x32_bf16 v[240:243], a[44:47], a[48:51], v[240:243]
    ds_read_b128 a[16:19], v49 offset:0
    ds_read_b64_tr_b16 a[0:1], v44 offset:0
    v_mfma_f32_16x16x32_bf16 v[196:199], a[32:35], a[52:55], v[196:199]
    ds_read_b64_tr_b16 a[2:3], v44 offset:4096
    ds_read_b64_tr_b16 a[4:5], v45 offset:0
    s_add_u32 m0, s49, 0
    v_mfma_f32_16x16x32_bf16 v[212:215], a[36:39], a[52:55], v[212:215]
    ds_read_b64_tr_b16 a[6:7], v45 offset:4096
    ds_read_b64_tr_b16 a[8:9], v46 offset:0
    buffer_load_dwordx4 v6, s[12:15], s20 offen offset:0 lds
    v_mfma_f32_16x16x32_bf16 v[228:231], a[40:43], a[52:55], v[228:231]
    ds_read_b64_tr_b16 a[10:11], v46 offset:4096
    buffer_load_dwordx4 v7, s[12:15], s21 offen offset:1024 lds
    v_mfma_f32_16x16x32_bf16 v[244:247], a[44:47], a[52:55], v[244:247]
    ds_read_b64_tr_b16 a[12:13], v47 offset:0
    ds_read_b64_tr_b16 a[14:15], v47 offset:4096
    buffer_load_dwordx4 v6, s[12:15], s22 offen offset:2048 lds
    v_mfma_f32_16x16x32_bf16 v[200:203], a[32:35], a[56:59], v[200:203]
    ds_read_b128 a[20:23], v49 offset:2048
    ds_read_b128 a[24:27], v49 offset:4096
    buffer_load_dwordx4 v7, s[12:15], s23 offen offset:3072 lds
    v_mfma_f32_16x16x32_bf16 v[216:219], a[36:39], a[56:59], v[216:219]
    ds_read_b128 a[28:31], v49 offset:6144
    s_add_u32 s95, s95, 131072
    v_mfma_f32_16x16x32_bf16 v[232:235], a[40:43], a[56:59], v[232:235]
    s_and_b32 s95, s95, 0x1fffff
    v_mfma_f32_16x16x32_bf16 v[248:251], a[44:47], a[56:59], v[248:251]
    s_add_u32 s12, s72, s95
    v_mfma_f32_16x16x32_bf16 v[204:207], a[32:35], a[60:63], v[204:207]
    s_addc_u32 s13, s73, 0
    v_mfma_f32_16x16x32_bf16 v[220:223], a[36:39], a[60:63], v[220:223]
    s_add_u32 m0, s48, 0
    v_mfma_f32_16x16x32_bf16 v[236:239], a[40:43], a[60:63], v[236:239]
    buffer_load_dwordx4 v2, s[8:11], s16 offen offset:0 lds
    v_mfma_f32_16x16x32_bf16 v[252:255], a[44:47], a[60:63], v[252:255]
    s_waitcnt lgkmcnt(9)
    v_mfma_f32_16x16x32_bf16 v[192:195], a[0:3], a[16:19], v[192:195]
    ds_read_b128 a[48:51], v49 offset:1024
    ds_read_b64_tr_b16 a[32:33], v44 offset:8192
    s_waitcnt lgkmcnt(9)
    v_mfma_f32_16x16x32_bf16 v[208:211], a[4:7], a[16:19], v[208:211]
    ds_read_b64_tr_b16 a[34:35], v44 offset:12288
    buffer_load_dwordx4 v2, s[8:11], s16 offen offset:1024 lds
    s_waitcnt lgkmcnt(8)
    v_mfma_f32_16x16x32_bf16 v[224:227], a[8:11], a[16:19], v[224:227]
    ds_read_b64_tr_b16 a[36:37], v45 offset:8192
    s_waitcnt lgkmcnt(7)
    v_mfma_f32_16x16x32_bf16 v[240:243], a[12:15], a[16:19], v[240:243]
    ds_read_b64_tr_b16 a[38:39], v45 offset:12288
    ds_read_b64_tr_b16 a[40:41], v46 offset:8192
    buffer_load_dwordx4 v2, s[8:11], s16 offen offset:2048 lds
    s_waitcnt lgkmcnt(8)
    v_mfma_f32_16x16x32_bf16 v[196:199], a[0:3], a[20:23], v[196:199]
    ds_read_b64_tr_b16 a[42:43], v46 offset:12288
    v_mfma_f32_16x16x32_bf16 v[212:215], a[4:7], a[20:23], v[212:215]
    ds_read_b64_tr_b16 a[44:45], v47 offset:8192
    buffer_load_dwordx4 v2, s[8:11], s16 offen offset:3072 lds
    v_mfma_f32_16x16x32_bf16 v[228:231], a[8:11], a[20:23], v[228:231]
    ds_read_b64_tr_b16 a[46:47], v47 offset:12288
    ds_read_b128 a[52:55], v49 offset:3072
    v_mfma_f32_16x16x32_bf16 v[244:247], a[12:15], a[20:23], v[244:247]
    ds_read_b128 a[56:59], v49 offset:5120
    s_add_u32 s94, s94, 16384
    s_waitcnt lgkmcnt(12)
    v_mfma_f32_16x16x32_bf16 v[200:203], a[0:3], a[24:27], v[200:203]
    ds_read_b128 a[60:63], v49 offset:7168
    v_mfma_f32_16x16x32_bf16 v[216:219], a[4:7], a[24:27], v[216:219]
    s_and_b32 s94, s94, 262143
    v_mfma_f32_16x16x32_bf16 v[232:235], a[8:11], a[24:27], v[232:235]
    v_mfma_f32_16x16x32_bf16 v[248:251], a[12:15], a[24:27], v[248:251]
    s_add_u32 s8, s92, s94
    s_waitcnt lgkmcnt(12)
    v_mfma_f32_16x16x32_bf16 v[204:207], a[0:3], a[28:31], v[204:207]
    v_mfma_f32_16x16x32_bf16 v[220:223], a[4:7], a[28:31], v[220:223]
    s_addc_u32 s9, s93, 0
    v_mfma_f32_16x16x32_bf16 v[236:239], a[8:11], a[28:31], v[236:239]
    v_mfma_f32_16x16x32_bf16 v[252:255], a[12:15], a[28:31], v[252:255]
    s_waitcnt lgkmcnt(9)
    v_mfma_f32_16x16x32_bf16 v[192:195], a[32:35], a[48:51], v[192:195]
    s_waitcnt lgkmcnt(7)
    v_mfma_f32_16x16x32_bf16 v[208:211], a[36:39], a[48:51], v[208:211]
    s_waitcnt lgkmcnt(5)
    v_mfma_f32_16x16x32_bf16 v[224:227], a[40:43], a[48:51], v[224:227]
    s_waitcnt lgkmcnt(0)
    s_waitcnt vmcnt(8)
    s_barrier
    v_mfma_f32_16x16x32_bf16 v[240:243], a[44:47], a[48:51], v[240:243]
    ds_read_b128 a[16:19], v49 offset:32768
    ds_read_b64_tr_b16 a[0:1], v44 offset:32768
    v_mfma_f32_16x16x32_bf16 v[196:199], a[32:35], a[52:55], v[196:199]
    ds_read_b64_tr_b16 a[2:3], v44 offset:36864
    ds_read_b64_tr_b16 a[4:5], v45 offset:32768
    s_add_u32 m0, s49, 32768
    v_mfma_f32_16x16x32_bf16 v[212:215], a[36:39], a[52:55], v[212:215]
    ds_read_b64_tr_b16 a[6:7], v45 offset:36864
    ds_read_b64_tr_b16 a[8:9], v46 offset:32768
    buffer_load_dwordx4 v6, s[12:15], s20 offen offset:0 lds
    v_mfma_f32_16x16x32_bf16 v[228:231], a[40:43], a[52:55], v[228:231]
    ds_read_b64_tr_b16 a[10:11], v46 offset:36864
    buffer_load_dwordx4 v7, s[12:15], s21 offen offset:1024 lds
    v_mfma_f32_16x16x32_bf16 v[244:247], a[44:47], a[52:55], v[244:247]
    ds_read_b64_tr_b16 a[12:13], v47 offset:32768
    ds_read_b64_tr_b16 a[14:15], v47 offset:36864
    buffer_load_dwordx4 v6, s[12:15], s22 offen offset:2048 lds
    v_mfma_f32_16x16x32_bf16 v[200:203], a[32:35], a[56:59], v[200:203]
    ds_read_b128 a[20:23], v49 offset:34816
    ds_read_b128 a[24:27], v49 offset:36864
    buffer_load_dwordx4 v7, s[12:15], s23 offen offset:3072 lds
    v_mfma_f32_16x16x32_bf16 v[216:219], a[36:39], a[56:59], v[216:219]
    ds_read_b128 a[28:31], v49 offset:38912
    s_add_u32 s95, s95, 131072
    v_mfma_f32_16x16x32_bf16 v[232:235], a[40:43], a[56:59], v[232:235]
    s_and_b32 s95, s95, 0x1fffff
    v_mfma_f32_16x16x32_bf16 v[248:251], a[44:47], a[56:59], v[248:251]
    s_add_u32 s12, s72, s95
    v_mfma_f32_16x16x32_bf16 v[204:207], a[32:35], a[60:63], v[204:207]
    s_addc_u32 s13, s73, 0
    v_mfma_f32_16x16x32_bf16 v[220:223], a[36:39], a[60:63], v[220:223]
    s_add_u32 m0, s48, 32768
    v_mfma_f32_16x16x32_bf16 v[236:239], a[40:43], a[60:63], v[236:239]
    buffer_load_dwordx4 v2, s[8:11], s16 offen offset:0 lds
    v_mfma_f32_16x16x32_bf16 v[252:255], a[44:47], a[60:63], v[252:255]
    s_waitcnt lgkmcnt(9)
    v_mfma_f32_16x16x32_bf16 v[192:195], a[0:3], a[16:19], v[192:195]
    ds_read_b128 a[48:51], v49 offset:33792
    ds_read_b64_tr_b16 a[32:33], v44 offset:40960
    s_waitcnt lgkmcnt(9)
    v_mfma_f32_16x16x32_bf16 v[208:211], a[4:7], a[16:19], v[208:211]
    ds_read_b64_tr_b16 a[34:35], v44 offset:45056
    buffer_load_dwordx4 v2, s[8:11], s16 offen offset:1024 lds
    s_waitcnt lgkmcnt(8)
    v_mfma_f32_16x16x32_bf16 v[224:227], a[8:11], a[16:19], v[224:227]
    ds_read_b64_tr_b16 a[36:37], v45 offset:40960
    s_waitcnt lgkmcnt(7)
    v_mfma_f32_16x16x32_bf16 v[240:243], a[12:15], a[16:19], v[240:243]
    ds_read_b64_tr_b16 a[38:39], v45 offset:45056
    ds_read_b64_tr_b16 a[40:41], v46 offset:40960
    buffer_load_dwordx4 v2, s[8:11], s16 offen offset:2048 lds
    s_waitcnt lgkmcnt(8)
    v_mfma_f32_16x16x32_bf16 v[196:199], a[0:3], a[20:23], v[196:199]
    ds_read_b64_tr_b16 a[42:43], v46 offset:45056
    v_mfma_f32_16x16x32_bf16 v[212:215], a[4:7], a[20:23], v[212:215]
    ds_read_b64_tr_b16 a[44:45], v47 offset:40960
    buffer_load_dwordx4 v2, s[8:11], s16 offen offset:3072 lds
    v_mfma_f32_16x16x32_bf16 v[228:231], a[8:11], a[20:23], v[228:231]
    ds_read_b64_tr_b16 a[46:47], v47 offset:45056
    ds_read_b128 a[52:55], v49 offset:35840
    v_mfma_f32_16x16x32_bf16 v[244:247], a[12:15], a[20:23], v[244:247]
    ds_read_b128 a[56:59], v49 offset:37888
    s_add_u32 s94, s94, 16384
    s_waitcnt lgkmcnt(12)
    v_mfma_f32_16x16x32_bf16 v[200:203], a[0:3], a[24:27], v[200:203]
    ds_read_b128 a[60:63], v49 offset:39936
    v_mfma_f32_16x16x32_bf16 v[216:219], a[4:7], a[24:27], v[216:219]
    s_and_b32 s94, s94, 262143
    v_mfma_f32_16x16x32_bf16 v[232:235], a[8:11], a[24:27], v[232:235]
    v_mfma_f32_16x16x32_bf16 v[248:251], a[12:15], a[24:27], v[248:251]
    s_add_u32 s8, s92, s94
    s_waitcnt lgkmcnt(12)
    v_mfma_f32_16x16x32_bf16 v[204:207], a[0:3], a[28:31], v[204:207]
    v_mfma_f32_16x16x32_bf16 v[220:223], a[4:7], a[28:31], v[220:223]
    s_addc_u32 s9, s93, 0
    v_mfma_f32_16x16x32_bf16 v[236:239], a[8:11], a[28:31], v[236:239]
    v_mfma_f32_16x16x32_bf16 v[252:255], a[12:15], a[28:31], v[252:255]
    s_waitcnt lgkmcnt(9)
    v_mfma_f32_16x16x32_bf16 v[192:195], a[32:35], a[48:51], v[192:195]
    s_waitcnt lgkmcnt(7)
    v_mfma_f32_16x16x32_bf16 v[208:211], a[36:39], a[48:51], v[208:211]
    s_waitcnt lgkmcnt(5)
    v_mfma_f32_16x16x32_bf16 v[224:227], a[40:43], a[48:51], v[224:227]
    s_waitcnt lgkmcnt(0)
    s_waitcnt vmcnt(8)
    s_barrier
    v_mfma_f32_16x16x32_bf16 v[240:243], a[44:47], a[48:51], v[240:243]
    ds_read_b128 a[16:19], v48 offset:0
    ds_read_b64_tr_b16 a[0:1], v40 offset:0
    v_mfma_f32_16x16x32_bf16 v[196:199], a[32:35], a[52:55], v[196:199]
    ds_read_b64_tr_b16 a[2:3], v40 offset:4096
    ds_read_b64_tr_b16 a[4:5], v41 offset:0
    s_add_u32 m0, s49, 65536
    v_mfma_f32_16x16x32_bf16 v[212:215], a[36:39], a[52:55], v[212:215]
    ds_read_b64_tr_b16 a[6:7], v41 offset:4096
    ds_read_b64_tr_b16 a[8:9], v42 offset:0
    buffer_load_dwordx4 v6, s[12:15], s20 offen offset:0 lds
    v_mfma_f32_16x16x32_bf16 v[228:231], a[40:43], a[52:55], v[228:231]
    ds_read_b64_tr_b16 a[10:11], v42 offset:4096
    buffer_load_dwordx4 v7, s[12:15], s21 offen offset:1024 lds
    v_mfma_f32_16x16x32_bf16 v[244:247], a[44:47], a[52:55], v[244:247]
    ds_read_b64_tr_b16 a[12:13], v43 offset:0
    ds_read_b64_tr_b16 a[14:15], v43 offset:4096
    buffer_load_dwordx4 v6, s[12:15], s22 offen offset:2048 lds
    v_mfma_f32_16x16x32_bf16 v[200:203], a[32:35], a[56:59], v[200:203]
    ds_read_b128 a[20:23], v48 offset:2048
    ds_read_b128 a[24:27], v48 offset:4096
    buffer_load_dwordx4 v7, s[12:15], s23 offen offset:3072 lds
    v_mfma_f32_16x16x32_bf16 v[216:219], a[36:39], a[56:59], v[216:219]
    ds_read_b128 a[28:31], v48 offset:6144
    s_add_u32 s95, s95, 131072
    v_mfma_f32_16x16x32_bf16 v[232:235], a[40:43], a[56:59], v[232:235]
    s_and_b32 s95, s95, 0x1fffff
    v_mfma_f32_16x16x32_bf16 v[248:251], a[44:47], a[56:59], v[248:251]
    s_add_u32 s12, s72, s95
    v_mfma_f32_16x16x32_bf16 v[204:207], a[32:35], a[60:63], v[204:207]
    s_addc_u32 s13, s73, 0
    v_mfma_f32_16x16x32_bf16 v[220:223], a[36:39], a[60:63], v[220:223]
    s_add_u32 m0, s48, 65536
    v_mfma_f32_16x16x32_bf16 v[236:239], a[40:43], a[60:63], v[236:239]
    buffer_load_dwordx4 v2, s[8:11], s16 offen offset:0 lds
    v_mfma_f32_16x16x32_bf16 v[252:255], a[44:47], a[60:63], v[252:255]
    s_waitcnt lgkmcnt(9)
    v_mfma_f32_16x16x32_bf16 v[192:195], a[0:3], a[16:19], v[192:195]
    ds_read_b128 a[48:51], v48 offset:1024
    ds_read_b64_tr_b16 a[32:33], v40 offset:8192
    s_waitcnt lgkmcnt(9)
    v_mfma_f32_16x16x32_bf16 v[208:211], a[4:7], a[16:19], v[208:211]
    ds_read_b64_tr_b16 a[34:35], v40 offset:12288
    buffer_load_dwordx4 v2, s[8:11], s16 offen offset:1024 lds
    s_waitcnt lgkmcnt(8)
    v_mfma_f32_16x16x32_bf16 v[224:227], a[8:11], a[16:19], v[224:227]
    ds_read_b64_tr_b16 a[36:37], v41 offset:8192
    s_waitcnt lgkmcnt(7)
    v_mfma_f32_16x16x32_bf16 v[240:243], a[12:15], a[16:19], v[240:243]
    ds_read_b64_tr_b16 a[38:39], v41 offset:12288
    ds_read_b64_tr_b16 a[40:41], v42 offset:8192
    buffer_load_dwordx4 v2, s[8:11], s16 offen offset:2048 lds
    s_waitcnt lgkmcnt(8)
    v_mfma_f32_16x16x32_bf16 v[196:199], a[0:3], a[20:23], v[196:199]
    ds_read_b64_tr_b16 a[42:43], v42 offset:12288
    v_mfma_f32_16x16x32_bf16 v[212:215], a[4:7], a[20:23], v[212:215]
    ds_read_b64_tr_b16 a[44:45], v43 offset:8192
    buffer_load_dwordx4 v2, s[8:11], s16 offen offset:3072 lds
    v_mfma_f32_16x16x32_bf16 v[228:231], a[8:11], a[20:23], v[228:231]
    ds_read_b64_tr_b16 a[46:47], v43 offset:12288
    ds_read_b128 a[52:55], v48 offset:3072
    v_mfma_f32_16x16x32_bf16 v[244:247], a[12:15], a[20:23], v[244:247]
    ds_read_b128 a[56:59], v48 offset:5120
    s_add_u32 s94, s94, 16384
    s_waitcnt lgkmcnt(12)
    v_mfma_f32_16x16x32_bf16 v[200:203], a[0:3], a[24:27], v[200:203]
    ds_read_b128 a[60:63], v48 offset:7168
    v_mfma_f32_16x16x32_bf16 v[216:219], a[4:7], a[24:27], v[216:219]
    s_and_b32 s94, s94, 262143
    v_mfma_f32_16x16x32_bf16 v[232:235], a[8:11], a[24:27], v[232:235]
    v_mfma_f32_16x16x32_bf16 v[248:251], a[12:15], a[24:27], v[248:251]
    s_add_u32 s8, s92, s94
    s_waitcnt lgkmcnt(12)
    v_mfma_f32_16x16x32_bf16 v[204:207], a[0:3], a[28:31], v[204:207]
    v_mfma_f32_16x16x32_bf16 v[220:223], a[4:7], a[28:31], v[220:223]
    s_addc_u32 s9, s93, 0
    v_mfma_f32_16x16x32_bf16 v[236:239], a[8:11], a[28:31], v[236:239]
    v_mfma_f32_16x16x32_bf16 v[252:255], a[12:15], a[28:31], v[252:255]
    s_waitcnt lgkmcnt(9)
    v_mfma_f32_16x16x32_bf16 v[192:195], a[32:35], a[48:51], v[192:195]
    s_waitcnt lgkmcnt(7)
    v_mfma_f32_16x16x32_bf16 v[208:211], a[36:39], a[48:51], v[208:211]
    s_waitcnt lgkmcnt(5)
    v_mfma_f32_16x16x32_bf16 v[224:227], a[40:43], a[48:51], v[224:227]
    s_waitcnt lgkmcnt(0)
    s_waitcnt vmcnt(8)
    s_barrier
    v_mfma_f32_16x16x32_bf16 v[240:243], a[44:47], a[48:51], v[240:243]
    ds_read_b128 a[16:19], v48 offset:32768
    ds_read_b64_tr_b16 a[0:1], v40 offset:32768
    v_mfma_f32_16x16x32_bf16 v[196:199], a[32:35], a[52:55], v[196:199]
    ds_read_b64_tr_b16 a[2:3], v40 offset:36864
    ds_read_b64_tr_b16 a[4:5], v41 offset:32768
    s_add_u32 m0, s49, 98304
    v_mfma_f32_16x16x32_bf16 v[212:215], a[36:39], a[52:55], v[212:215]
    ds_read_b64_tr_b16 a[6:7], v41 offset:36864
    ds_read_b64_tr_b16 a[8:9], v42 offset:32768
    buffer_load_dwordx4 v6, s[12:15], s20 offen offset:0 lds
    v_mfma_f32_16x16x32_bf16 v[228:231], a[40:43], a[52:55], v[228:231]
    ds_read_b64_tr_b16 a[10:11], v42 offset:36864
    buffer_load_dwordx4 v7, s[12:15], s21 offen offset:1024 lds
    v_mfma_f32_16x16x32_bf16 v[244:247], a[44:47], a[52:55], v[244:247]
    ds_read_b64_tr_b16 a[12:13], v43 offset:32768
    ds_read_b64_tr_b16 a[14:15], v43 offset:36864
    buffer_load_dwordx4 v6, s[12:15], s22 offen offset:2048 lds
    v_mfma_f32_16x16x32_bf16 v[200:203], a[32:35], a[56:59], v[200:203]
    ds_read_b128 a[20:23], v48 offset:34816
    ds_read_b128 a[24:27], v48 offset:36864
    buffer_load_dwordx4 v7, s[12:15], s23 offen offset:3072 lds
    v_mfma_f32_16x16x32_bf16 v[216:219], a[36:39], a[56:59], v[216:219]
    ds_read_b128 a[28:31], v48 offset:38912
    s_add_u32 s95, s95, 131072
    v_mfma_f32_16x16x32_bf16 v[232:235], a[40:43], a[56:59], v[232:235]
    s_and_b32 s95, s95, 0x1fffff
    v_mfma_f32_16x16x32_bf16 v[248:251], a[44:47], a[56:59], v[248:251]
    s_add_u32 s12, s72, s95
    v_mfma_f32_16x16x32_bf16 v[204:207], a[32:35], a[60:63], v[204:207]
    s_addc_u32 s13, s73, 0
    v_mfma_f32_16x16x32_bf16 v[220:223], a[36:39], a[60:63], v[220:223]
    s_add_u32 m0, s48, 98304
    v_mfma_f32_16x16x32_bf16 v[236:239], a[40:43], a[60:63], v[236:239]
    buffer_load_dwordx4 v2, s[8:11], s16 offen offset:0 lds
    v_mfma_f32_16x16x32_bf16 v[252:255], a[44:47], a[60:63], v[252:255]
    s_waitcnt lgkmcnt(9)
    v_mfma_f32_16x16x32_bf16 v[192:195], a[0:3], a[16:19], v[192:195]
    ds_read_b128 a[48:51], v48 offset:33792
    ds_read_b64_tr_b16 a[32:33], v40 offset:40960
    s_waitcnt lgkmcnt(9)
    v_mfma_f32_16x16x32_bf16 v[208:211], a[4:7], a[16:19], v[208:211]
    ds_read_b64_tr_b16 a[34:35], v40 offset:45056
    buffer_load_dwordx4 v2, s[8:11], s16 offen offset:1024 lds
    s_waitcnt lgkmcnt(8)
    v_mfma_f32_16x16x32_bf16 v[224:227], a[8:11], a[16:19], v[224:227]
    ds_read_b64_tr_b16 a[36:37], v41 offset:40960
    s_waitcnt lgkmcnt(7)
    v_mfma_f32_16x16x32_bf16 v[240:243], a[12:15], a[16:19], v[240:243]
    ds_read_b64_tr_b16 a[38:39], v41 offset:45056
    ds_read_b64_tr_b16 a[40:41], v42 offset:40960
    buffer_load_dwordx4 v2, s[8:11], s16 offen offset:2048 lds
    s_waitcnt lgkmcnt(8)
    v_mfma_f32_16x16x32_bf16 v[196:199], a[0:3], a[20:23], v[196:199]
    ds_read_b64_tr_b16 a[42:43], v42 offset:45056
    v_mfma_f32_16x16x32_bf16 v[212:215], a[4:7], a[20:23], v[212:215]
    ds_read_b64_tr_b16 a[44:45], v43 offset:40960
    buffer_load_dwordx4 v2, s[8:11], s16 offen offset:3072 lds
    v_mfma_f32_16x16x32_bf16 v[228:231], a[8:11], a[20:23], v[228:231]
    ds_read_b64_tr_b16 a[46:47], v43 offset:45056
    ds_read_b128 a[52:55], v48 offset:35840
    v_mfma_f32_16x16x32_bf16 v[244:247], a[12:15], a[20:23], v[244:247]
    ds_read_b128 a[56:59], v48 offset:37888
    s_add_u32 s94, s94, 16384
    s_waitcnt lgkmcnt(12)
    v_mfma_f32_16x16x32_bf16 v[200:203], a[0:3], a[24:27], v[200:203]
    ds_read_b128 a[60:63], v48 offset:39936
    v_mfma_f32_16x16x32_bf16 v[216:219], a[4:7], a[24:27], v[216:219]
    s_and_b32 s94, s94, 262143
    v_mfma_f32_16x16x32_bf16 v[232:235], a[8:11], a[24:27], v[232:235]
    v_mfma_f32_16x16x32_bf16 v[248:251], a[12:15], a[24:27], v[248:251]
    s_add_u32 s8, s92, s94
    s_waitcnt lgkmcnt(12)
    v_mfma_f32_16x16x32_bf16 v[204:207], a[0:3], a[28:31], v[204:207]
    v_mfma_f32_16x16x32_bf16 v[220:223], a[4:7], a[28:31], v[220:223]
    s_addc_u32 s9, s93, 0
    v_mfma_f32_16x16x32_bf16 v[236:239], a[8:11], a[28:31], v[236:239]
    v_mfma_f32_16x16x32_bf16 v[252:255], a[12:15], a[28:31], v[252:255]
    s_waitcnt lgkmcnt(9)
    v_mfma_f32_16x16x32_bf16 v[192:195], a[32:35], a[48:51], v[192:195]
    s_waitcnt lgkmcnt(7)
    v_mfma_f32_16x16x32_bf16 v[208:211], a[36:39], a[48:51], v[208:211]
    s_waitcnt lgkmcnt(5)
    v_mfma_f32_16x16x32_bf16 v[224:227], a[40:43], a[48:51], v[224:227]
    s_waitcnt lgkmcnt(0)
    s_waitcnt vmcnt(8)
    s_barrier
    v_mfma_f32_16x16x32_bf16 v[240:243], a[44:47], a[48:51], v[240:243]
    ds_read_b128 a[16:19], v49 offset:0
    ds_read_b64_tr_b16 a[0:1], v44 offset:0
    v_mfma_f32_16x16x32_bf16 v[196:199], a[32:35], a[52:55], v[196:199]
    ds_read_b64_tr_b16 a[2:3], v44 offset:4096
    ds_read_b64_tr_b16 a[4:5], v45 offset:0
    s_add_u32 m0, s49, 0
    v_mfma_f32_16x16x32_bf16 v[212:215], a[36:39], a[52:55], v[212:215]
    ds_read_b64_tr_b16 a[6:7], v45 offset:4096
    ds_read_b64_tr_b16 a[8:9], v46 offset:0
    buffer_load_dwordx4 v6, s[12:15], s20 offen offset:0 lds
    v_mfma_f32_16x16x32_bf16 v[228:231], a[40:43], a[52:55], v[228:231]
    ds_read_b64_tr_b16 a[10:11], v46 offset:4096
    buffer_load_dwordx4 v7, s[12:15], s21 offen offset:1024 lds
    v_mfma_f32_16x16x32_bf16 v[244:247], a[44:47], a[52:55], v[244:247]
    ds_read_b64_tr_b16 a[12:13], v47 offset:0
    ds_read_b64_tr_b16 a[14:15], v47 offset:4096
    buffer_load_dwordx4 v6, s[12:15], s22 offen offset:2048 lds
    v_mfma_f32_16x16x32_bf16 v[200:203], a[32:35], a[56:59], v[200:203]
    ds_read_b128 a[20:23], v49 offset:2048
    ds_read_b128 a[24:27], v49 offset:4096
    buffer_load_dwordx4 v7, s[12:15], s23 offen offset:3072 lds
    v_mfma_f32_16x16x32_bf16 v[216:219], a[36:39], a[56:59], v[216:219]
    ds_read_b128 a[28:31], v49 offset:6144
    s_add_u32 s95, s95, 131072
    v_mfma_f32_16x16x32_bf16 v[232:235], a[40:43], a[56:59], v[232:235]
    s_and_b32 s95, s95, 0x1fffff
    v_mfma_f32_16x16x32_bf16 v[248:251], a[44:47], a[56:59], v[248:251]
    s_add_u32 s12, s72, s95
    v_mfma_f32_16x16x32_bf16 v[204:207], a[32:35], a[60:63], v[204:207]
    s_addc_u32 s13, s73, 0
    v_mfma_f32_16x16x32_bf16 v[220:223], a[36:39], a[60:63], v[220:223]
    s_add_u32 m0, s48, 0
    v_mfma_f32_16x16x32_bf16 v[236:239], a[40:43], a[60:63], v[236:239]
    buffer_load_dwordx4 v2, s[8:11], s16 offen offset:0 lds
    v_mfma_f32_16x16x32_bf16 v[252:255], a[44:47], a[60:63], v[252:255]
    s_waitcnt lgkmcnt(9)
    v_mfma_f32_16x16x32_bf16 v[192:195], a[0:3], a[16:19], v[192:195]
    ds_read_b128 a[48:51], v49 offset:1024
    ds_read_b64_tr_b16 a[32:33], v44 offset:8192
    s_waitcnt lgkmcnt(9)
    v_mfma_f32_16x16x32_bf16 v[208:211], a[4:7], a[16:19], v[208:211]
    ds_read_b64_tr_b16 a[34:35], v44 offset:12288
    buffer_load_dwordx4 v2, s[8:11], s16 offen offset:1024 lds
    s_waitcnt lgkmcnt(8)
    v_mfma_f32_16x16x32_bf16 v[224:227], a[8:11], a[16:19], v[224:227]
    ds_read_b64_tr_b16 a[36:37], v45 offset:8192
    s_waitcnt lgkmcnt(7)
    v_mfma_f32_16x16x32_bf16 v[240:243], a[12:15], a[16:19], v[240:243]
    ds_read_b64_tr_b16 a[38:39], v45 offset:12288
    ds_read_b64_tr_b16 a[40:41], v46 offset:8192
    buffer_load_dwordx4 v2, s[8:11], s16 offen offset:2048 lds
    s_waitcnt lgkmcnt(8)
    v_mfma_f32_16x16x32_bf16 v[196:199], a[0:3], a[20:23], v[196:199]
    ds_read_b64_tr_b16 a[42:43], v46 offset:12288
    v_mfma_f32_16x16x32_bf16 v[212:215], a[4:7], a[20:23], v[212:215]
    ds_read_b64_tr_b16 a[44:45], v47 offset:8192
    buffer_load_dwordx4 v2, s[8:11], s16 offen offset:3072 lds
    v_mfma_f32_16x16x32_bf16 v[228:231], a[8:11], a[20:23], v[228:231]
    ds_read_b64_tr_b16 a[46:47], v47 offset:12288
    ds_read_b128 a[52:55], v49 offset:3072
    v_mfma_f32_16x16x32_bf16 v[244:247], a[12:15], a[20:23], v[244:247]
    ds_read_b128 a[56:59], v49 offset:5120
    s_add_u32 s94, s94, 16384
    s_waitcnt lgkmcnt(12)
    v_mfma_f32_16x16x32_bf16 v[200:203], a[0:3], a[24:27], v[200:203]
    ds_read_b128 a[60:63], v49 offset:7168
    v_mfma_f32_16x16x32_bf16 v[216:219], a[4:7], a[24:27], v[216:219]
    s_and_b32 s94, s94, 262143
    v_mfma_f32_16x16x32_bf16 v[232:235], a[8:11], a[24:27], v[232:235]
    v_mfma_f32_16x16x32_bf16 v[248:251], a[12:15], a[24:27], v[248:251]
    s_add_u32 s8, s92, s94
    s_waitcnt lgkmcnt(12)
    v_mfma_f32_16x16x32_bf16 v[204:207], a[0:3], a[28:31], v[204:207]
    v_mfma_f32_16x16x32_bf16 v[220:223], a[4:7], a[28:31], v[220:223]
    s_addc_u32 s9, s93, 0
    v_mfma_f32_16x16x32_bf16 v[236:239], a[8:11], a[28:31], v[236:239]
    v_mfma_f32_16x16x32_bf16 v[252:255], a[12:15], a[28:31], v[252:255]
    s_waitcnt lgkmcnt(9)
    v_mfma_f32_16x16x32_bf16 v[192:195], a[32:35], a[48:51], v[192:195]
    s_waitcnt lgkmcnt(7)
    v_mfma_f32_16x16x32_bf16 v[208:211], a[36:39], a[48:51], v[208:211]
    s_waitcnt lgkmcnt(5)
    v_mfma_f32_16x16x32_bf16 v[224:227], a[40:43], a[48:51], v[224:227]
    s_waitcnt lgkmcnt(0)
    s_waitcnt vmcnt(8)
    s_barrier
    v_mfma_f32_16x16x32_bf16 v[240:243], a[44:47], a[48:51], v[240:243]
    ds_read_b128 a[16:19], v49 offset:32768
    ds_read_b64_tr_b16 a[0:1], v44 offset:32768
    v_mfma_f32_16x16x32_bf16 v[196:199], a[32:35], a[52:55], v[196:199]
    ds_read_b64_tr_b16 a[2:3], v44 offset:36864
    ds_read_b64_tr_b16 a[4:5], v45 offset:32768
    s_add_u32 m0, s49, 32768
    v_mfma_f32_16x16x32_bf16 v[212:215], a[36:39], a[52:55], v[212:215]
    ds_read_b64_tr_b16 a[6:7], v45 offset:36864
    ds_read_b64_tr_b16 a[8:9], v46 offset:32768
    buffer_load_dwordx4 v6, s[12:15], s20 offen offset:0 lds
    v_mfma_f32_16x16x32_bf16 v[228:231], a[40:43], a[52:55], v[228:231]
    ds_read_b64_tr_b16 a[10:11], v46 offset:36864
    v_mfma_f32_16x16x32_bf16 v[244:247], a[44:47], a[52:55], v[244:247]
    ds_read_b64_tr_b16 a[12:13], v47 offset:32768
    ds_read_b64_tr_b16 a[14:15], v47 offset:36864
    buffer_load_dwordx4 v7, s[12:15], s21 offen offset:1024 lds
    v_mfma_f32_16x16x32_bf16 v[200:203], a[32:35], a[56:59], v[200:203]
    ds_read_b128 a[20:23], v49 offset:34816
    ds_read_b128 a[24:27], v49 offset:36864
    v_mfma_f32_16x16x32_bf16 v[216:219], a[36:39], a[56:59], v[216:219]
    ds_read_b128 a[28:31], v49 offset:38912
    buffer_load_dwordx4 v6, s[12:15], s22 offen offset:2048 lds
    v_mfma_f32_16x16x32_bf16 v[232:235], a[40:43], a[56:59], v[232:235]
    v_mfma_f32_16x16x32_bf16 v[248:251], a[44:47], a[56:59], v[248:251]
    buffer_load_dwordx4 v7, s[12:15], s23 offen offset:3072 lds
    v_mfma_f32_16x16x32_bf16 v[204:207], a[32:35], a[60:63], v[204:207]
    v_mfma_f32_16x16x32_bf16 v[220:223], a[36:39], a[60:63], v[220:223]
    s_add_u32 m0, s48, 32768
    v_mfma_f32_16x16x32_bf16 v[236:239], a[40:43], a[60:63], v[236:239]
    v_mfma_f32_16x16x32_bf16 v[252:255], a[44:47], a[60:63], v[252:255]
    s_waitcnt lgkmcnt(9)
    v_mfma_f32_16x16x32_bf16 v[192:195], a[0:3], a[16:19], v[192:195]
    ds_read_b128 a[48:51], v49 offset:33792
    ds_read_b64_tr_b16 a[32:33], v44 offset:40960
    s_waitcnt lgkmcnt(9)
    v_mfma_f32_16x16x32_bf16 v[208:211], a[4:7], a[16:19], v[208:211]
    ds_read_b64_tr_b16 a[34:35], v44 offset:45056
    buffer_load_dwordx4 v2, s[8:11], s16 offen offset:0 lds
    s_waitcnt lgkmcnt(8)
    v_mfma_f32_16x16x32_bf16 v[224:227], a[8:11], a[16:19], v[224:227]
    ds_read_b64_tr_b16 a[36:37], v45 offset:40960
    s_waitcnt lgkmcnt(7)
    v_mfma_f32_16x16x32_bf16 v[240:243], a[12:15], a[16:19], v[240:243]
    ds_read_b64_tr_b16 a[38:39], v45 offset:45056
    ds_read_b64_tr_b16 a[40:41], v46 offset:40960
    s_waitcnt lgkmcnt(8)
    v_mfma_f32_16x16x32_bf16 v[196:199], a[0:3], a[20:23], v[196:199]
    ds_read_b64_tr_b16 a[42:43], v46 offset:45056
    buffer_load_dwordx4 v2, s[8:11], s16 offen offset:1024 lds
    v_mfma_f32_16x16x32_bf16 v[212:215], a[4:7], a[20:23], v[212:215]
    ds_read_b64_tr_b16 a[44:45], v47 offset:40960
    v_mfma_f32_16x16x32_bf16 v[228:231], a[8:11], a[20:23], v[228:231]
    ds_read_b64_tr_b16 a[46:47], v47 offset:45056
    ds_read_b128 a[52:55], v49 offset:35840
    v_mfma_f32_16x16x32_bf16 v[244:247], a[12:15], a[20:23], v[244:247]
    ds_read_b128 a[56:59], v49 offset:37888
    s_waitcnt lgkmcnt(12)
    v_mfma_f32_16x16x32_bf16 v[200:203], a[0:3], a[24:27], v[200:203]
    ds_read_b128 a[60:63], v49 offset:39936
    buffer_load_dwordx4 v2, s[8:11], s16 offen offset:2048 lds
    v_mfma_f32_16x16x32_bf16 v[216:219], a[4:7], a[24:27], v[216:219]
    v_mfma_f32_16x16x32_bf16 v[232:235], a[8:11], a[24:27], v[232:235]
    v_mfma_f32_16x16x32_bf16 v[248:251], a[12:15], a[24:27], v[248:251]
    buffer_load_dwordx4 v2, s[8:11], s16 offen offset:3072 lds
    s_waitcnt lgkmcnt(12)
    v_mfma_f32_16x16x32_bf16 v[204:207], a[0:3], a[28:31], v[204:207]
    v_mfma_f32_16x16x32_bf16 v[220:223], a[4:7], a[28:31], v[220:223]
    v_mfma_f32_16x16x32_bf16 v[236:239], a[8:11], a[28:31], v[236:239]
    v_mfma_f32_16x16x32_bf16 v[252:255], a[12:15], a[28:31], v[252:255]
    s_waitcnt lgkmcnt(9)
    v_mfma_f32_16x16x32_bf16 v[192:195], a[32:35], a[48:51], v[192:195]
    s_waitcnt lgkmcnt(7)
    v_mfma_f32_16x16x32_bf16 v[208:211], a[36:39], a[48:51], v[208:211]
    s_waitcnt lgkmcnt(5)
    v_mfma_f32_16x16x32_bf16 v[224:227], a[40:43], a[48:51], v[224:227]
    s_waitcnt lgkmcnt(0)
    s_waitcnt vmcnt(8)
    s_barrier
    v_mfma_f32_16x16x32_bf16 v[240:243], a[44:47], a[48:51], v[240:243]
    ds_read_b128 a[16:19], v48 offset:0
    ds_read_b64_tr_b16 a[0:1], v40 offset:0
    v_mfma_f32_16x16x32_bf16 v[196:199], a[32:35], a[52:55], v[196:199]
    ds_read_b64_tr_b16 a[2:3], v40 offset:4096
    ds_read_b64_tr_b16 a[4:5], v41 offset:0
    v_mfma_f32_16x16x32_bf16 v[212:215], a[36:39], a[52:55], v[212:215]
    ds_read_b64_tr_b16 a[6:7], v41 offset:4096
    ds_read_b64_tr_b16 a[8:9], v42 offset:0
    v_mfma_f32_16x16x32_bf16 v[228:231], a[40:43], a[52:55], v[228:231]
    ds_read_b64_tr_b16 a[10:11], v42 offset:4096
    v_mfma_f32_16x16x32_bf16 v[244:247], a[44:47], a[52:55], v[244:247]
    ds_read_b64_tr_b16 a[12:13], v43 offset:0
    ds_read_b64_tr_b16 a[14:15], v43 offset:4096
    v_mfma_f32_16x16x32_bf16 v[200:203], a[32:35], a[56:59], v[200:203]
    ds_read_b128 a[20:23], v48 offset:2048
    ds_read_b128 a[24:27], v48 offset:4096
    v_mfma_f32_16x16x32_bf16 v[216:219], a[36:39], a[56:59], v[216:219]
    ds_read_b128 a[28:31], v48 offset:6144
    v_mfma_f32_16x16x32_bf16 v[232:235], a[40:43], a[56:59], v[232:235]
    v_mfma_f32_16x16x32_bf16 v[248:251], a[44:47], a[56:59], v[248:251]
    v_mfma_f32_16x16x32_bf16 v[204:207], a[32:35], a[60:63], v[204:207]
    v_mfma_f32_16x16x32_bf16 v[220:223], a[36:39], a[60:63], v[220:223]
    v_mfma_f32_16x16x32_bf16 v[236:239], a[40:43], a[60:63], v[236:239]
    v_mfma_f32_16x16x32_bf16 v[252:255], a[44:47], a[60:63], v[252:255]
    s_waitcnt lgkmcnt(9)
    v_mfma_f32_16x16x32_bf16 v[192:195], a[0:3], a[16:19], v[192:195]
    ds_read_b128 a[48:51], v48 offset:1024
    ds_read_b64_tr_b16 a[32:33], v40 offset:8192
    s_waitcnt lgkmcnt(9)
    v_mfma_f32_16x16x32_bf16 v[208:211], a[4:7], a[16:19], v[208:211]
    ds_read_b64_tr_b16 a[34:35], v40 offset:12288
    s_waitcnt lgkmcnt(8)
    v_mfma_f32_16x16x32_bf16 v[224:227], a[8:11], a[16:19], v[224:227]
    ds_read_b64_tr_b16 a[36:37], v41 offset:8192
    s_waitcnt lgkmcnt(7)
    v_mfma_f32_16x16x32_bf16 v[240:243], a[12:15], a[16:19], v[240:243]
    ds_read_b64_tr_b16 a[38:39], v41 offset:12288
    ds_read_b64_tr_b16 a[40:41], v42 offset:8192
    s_waitcnt lgkmcnt(8)
    v_mfma_f32_16x16x32_bf16 v[196:199], a[0:3], a[20:23], v[196:199]
    ds_read_b64_tr_b16 a[42:43], v42 offset:12288
    v_mfma_f32_16x16x32_bf16 v[212:215], a[4:7], a[20:23], v[212:215]
    ds_read_b64_tr_b16 a[44:45], v43 offset:8192
    v_mfma_f32_16x16x32_bf16 v[228:231], a[8:11], a[20:23], v[228:231]
    ds_read_b64_tr_b16 a[46:47], v43 offset:12288
    ds_read_b128 a[52:55], v48 offset:3072
    v_mfma_f32_16x16x32_bf16 v[244:247], a[12:15], a[20:23], v[244:247]
    ds_read_b128 a[56:59], v48 offset:5120
    s_waitcnt lgkmcnt(12)
    v_mfma_f32_16x16x32_bf16 v[200:203], a[0:3], a[24:27], v[200:203]
    ds_read_b128 a[60:63], v48 offset:7168
    v_mfma_f32_16x16x32_bf16 v[216:219], a[4:7], a[24:27], v[216:219]
    v_mfma_f32_16x16x32_bf16 v[232:235], a[8:11], a[24:27], v[232:235]
    v_mfma_f32_16x16x32_bf16 v[248:251], a[12:15], a[24:27], v[248:251]
    s_waitcnt lgkmcnt(12)
    v_mfma_f32_16x16x32_bf16 v[204:207], a[0:3], a[28:31], v[204:207]
    v_mfma_f32_16x16x32_bf16 v[220:223], a[4:7], a[28:31], v[220:223]
    v_mfma_f32_16x16x32_bf16 v[236:239], a[8:11], a[28:31], v[236:239]
    v_mfma_f32_16x16x32_bf16 v[252:255], a[12:15], a[28:31], v[252:255]
    s_waitcnt lgkmcnt(9)
    v_mfma_f32_16x16x32_bf16 v[192:195], a[32:35], a[48:51], v[192:195]
    s_waitcnt lgkmcnt(7)
    v_mfma_f32_16x16x32_bf16 v[208:211], a[36:39], a[48:51], v[208:211]
    s_waitcnt lgkmcnt(5)
    v_mfma_f32_16x16x32_bf16 v[224:227], a[40:43], a[48:51], v[224:227]
    s_waitcnt lgkmcnt(0)
    s_waitcnt vmcnt(0)
    s_barrier
    v_mfma_f32_16x16x32_bf16 v[240:243], a[44:47], a[48:51], v[240:243]
    ds_read_b128 a[16:19], v48 offset:32768
    ds_read_b64_tr_b16 a[0:1], v40 offset:32768
    v_mfma_f32_16x16x32_bf16 v[196:199], a[32:35], a[52:55], v[196:199]
    ds_read_b64_tr_b16 a[2:3], v40 offset:36864
    ds_read_b64_tr_b16 a[4:5], v41 offset:32768
    v_mfma_f32_16x16x32_bf16 v[212:215], a[36:39], a[52:55], v[212:215]
    ds_read_b64_tr_b16 a[6:7], v41 offset:36864
    ds_read_b64_tr_b16 a[8:9], v42 offset:32768
    v_mfma_f32_16x16x32_bf16 v[228:231], a[40:43], a[52:55], v[228:231]
    ds_read_b64_tr_b16 a[10:11], v42 offset:36864
    v_mfma_f32_16x16x32_bf16 v[244:247], a[44:47], a[52:55], v[244:247]
    ds_read_b64_tr_b16 a[12:13], v43 offset:32768
    ds_read_b64_tr_b16 a[14:15], v43 offset:36864
    v_mfma_f32_16x16x32_bf16 v[200:203], a[32:35], a[56:59], v[200:203]
    ds_read_b128 a[20:23], v48 offset:34816
    ds_read_b128 a[24:27], v48 offset:36864
    v_mfma_f32_16x16x32_bf16 v[216:219], a[36:39], a[56:59], v[216:219]
    ds_read_b128 a[28:31], v48 offset:38912
    v_mfma_f32_16x16x32_bf16 v[232:235], a[40:43], a[56:59], v[232:235]
    v_mfma_f32_16x16x32_bf16 v[248:251], a[44:47], a[56:59], v[248:251]
    v_mfma_f32_16x16x32_bf16 v[204:207], a[32:35], a[60:63], v[204:207]
    v_mfma_f32_16x16x32_bf16 v[220:223], a[36:39], a[60:63], v[220:223]
    v_mfma_f32_16x16x32_bf16 v[236:239], a[40:43], a[60:63], v[236:239]
    v_mfma_f32_16x16x32_bf16 v[252:255], a[44:47], a[60:63], v[252:255]
    s_waitcnt lgkmcnt(9)
    v_mfma_f32_16x16x32_bf16 v[192:195], a[0:3], a[16:19], v[192:195]
    ds_read_b128 a[48:51], v48 offset:33792
    ds_read_b64_tr_b16 a[32:33], v40 offset:40960
    s_waitcnt lgkmcnt(9)
    v_mfma_f32_16x16x32_bf16 v[208:211], a[4:7], a[16:19], v[208:211]
    ds_read_b64_tr_b16 a[34:35], v40 offset:45056
    buffer_load_dword v50, v51, s[64:67], s97 offen sc1
    s_waitcnt lgkmcnt(8)
    v_mfma_f32_16x16x32_bf16 v[224:227], a[8:11], a[16:19], v[224:227]
    ds_read_b64_tr_b16 a[36:37], v41 offset:40960
    s_waitcnt lgkmcnt(7)
    v_mfma_f32_16x16x32_bf16 v[240:243], a[12:15], a[16:19], v[240:243]
    ds_read_b64_tr_b16 a[38:39], v41 offset:45056
    ds_read_b64_tr_b16 a[40:41], v42 offset:40960
    s_waitcnt lgkmcnt(8)
    v_mfma_f32_16x16x32_bf16 v[196:199], a[0:3], a[20:23], v[196:199]
    ds_read_b64_tr_b16 a[42:43], v42 offset:45056
    v_mfma_f32_16x16x32_bf16 v[212:215], a[4:7], a[20:23], v[212:215]
    ds_read_b64_tr_b16 a[44:45], v43 offset:40960
    v_mfma_f32_16x16x32_bf16 v[228:231], a[8:11], a[20:23], v[228:231]
    ds_read_b64_tr_b16 a[46:47], v43 offset:45056
    ds_read_b128 a[52:55], v48 offset:35840
    v_mfma_f32_16x16x32_bf16 v[244:247], a[12:15], a[20:23], v[244:247]
    ds_read_b128 a[56:59], v48 offset:37888
    s_waitcnt lgkmcnt(12)
    v_mfma_f32_16x16x32_bf16 v[200:203], a[0:3], a[24:27], v[200:203]
    ds_read_b128 a[60:63], v48 offset:39936
    v_mfma_f32_16x16x32_bf16 v[216:219], a[4:7], a[24:27], v[216:219]
    v_mfma_f32_16x16x32_bf16 v[232:235], a[8:11], a[24:27], v[232:235]
    v_mfma_f32_16x16x32_bf16 v[248:251], a[12:15], a[24:27], v[248:251]
    s_waitcnt lgkmcnt(12)
    v_mfma_f32_16x16x32_bf16 v[204:207], a[0:3], a[28:31], v[204:207]
    v_mfma_f32_16x16x32_bf16 v[220:223], a[4:7], a[28:31], v[220:223]
    v_mfma_f32_16x16x32_bf16 v[236:239], a[8:11], a[28:31], v[236:239]
    v_mfma_f32_16x16x32_bf16 v[252:255], a[12:15], a[28:31], v[252:255]
    s_waitcnt lgkmcnt(9)
    v_mfma_f32_16x16x32_bf16 v[192:195], a[32:35], a[48:51], v[192:195]
    s_waitcnt lgkmcnt(7)
    v_mfma_f32_16x16x32_bf16 v[208:211], a[36:39], a[48:51], v[208:211]
    s_waitcnt lgkmcnt(5)
    v_mfma_f32_16x16x32_bf16 v[224:227], a[40:43], a[48:51], v[224:227]
    s_waitcnt lgkmcnt(3)
    v_mfma_f32_16x16x32_bf16 v[240:243], a[44:47], a[48:51], v[240:243]
    s_waitcnt lgkmcnt(2)
    v_mfma_f32_16x16x32_bf16 v[196:199], a[32:35], a[52:55], v[196:199]
    v_mfma_f32_16x16x32_bf16 v[212:215], a[36:39], a[52:55], v[212:215]
    v_mfma_f32_16x16x32_bf16 v[228:231], a[40:43], a[52:55], v[228:231]
    v_mfma_f32_16x16x32_bf16 v[244:247], a[44:47], a[52:55], v[244:247]
    s_waitcnt lgkmcnt(1)
    v_mfma_f32_16x16x32_bf16 v[200:203], a[32:35], a[56:59], v[200:203]
    v_mfma_f32_16x16x32_bf16 v[216:219], a[36:39], a[56:59], v[216:219]
    v_mfma_f32_16x16x32_bf16 v[232:235], a[40:43], a[56:59], v[232:235]
    v_mfma_f32_16x16x32_bf16 v[248:251], a[44:47], a[56:59], v[248:251]
    s_waitcnt lgkmcnt(0)
    v_mfma_f32_16x16x32_bf16 v[204:207], a[32:35], a[60:63], v[204:207]
    v_mfma_f32_16x16x32_bf16 v[220:223], a[36:39], a[60:63], v[220:223]
    v_mfma_f32_16x16x32_bf16 v[236:239], a[40:43], a[60:63], v[236:239]
    v_mfma_f32_16x16x32_bf16 v[252:255], a[44:47], a[60:63], v[252:255]
LtailQ:
    s_waitcnt vmcnt(0)
    v_cmp_ne_u32 vcc, s91, v50
    s_cbranch_vccz Lq_ok_17
    s_mov_b32 s63, 0
Lpoll_18:
    buffer_load_dword v50, v51, s[64:67], s97 offen sc1
    s_waitcnt vmcnt(0)
    v_cmp_ne_u32 vcc, s91, v50
    s_add_u32 s63, s63, 1
    s_cbranch_vccz Lpolldone_19
    s_sleep 2
    s_cmp_lt_u32 s63, 0x100000
    s_cbranch_scc1 Lpoll_18
Lpolldone_19:
Lq_ok_17:
    buffer_load_dwordx4 v[64:67], v2, s[64:67], s40 offen offset:0 sc1
    buffer_load_dwordx4 v[68:71], v2, s[64:67], s40 offen offset:1024 sc1
    buffer_load_dwordx4 v[72:75], v2, s[64:67], s40 offen offset:2048 sc1
    buffer_load_dwordx4 v[76:79], v2, s[64:67], s40 offen offset:3072 sc1
    buffer_load_dwordx4 v[80:83], v2, s[64:67], s41 offen offset:0 sc1
    buffer_load_dwordx4 v[84:87], v2, s[64:67], s41 offen offset:1024 sc1
    buffer_load_dwordx4 v[88:91], v2, s[64:67], s41 offen offset:2048 sc1
    buffer_load_dwordx4 v[92:95], v2, s[64:67], s41 offen offset:3072 sc1
    buffer_load_dwordx4 v[96:99], v2, s[64:67], s42 offen offset:0 sc1
    buffer_load_dwordx4 v[100:103], v2, s[64:67], s42 offen offset:1024 sc1
    buffer_load_dwordx4 v[104:107], v2, s[64:67], s42 offen offset:2048 sc1
    buffer_load_dwordx4 v[108:111], v2, s[64:67], s42 offen offset:3072 sc1
    buffer_load_dwordx4 v[112:115], v2, s[64:67], s43 offen offset:0 sc1
    buffer_load_dwordx4 v[116:119], v2, s[64:67], s43 offen offset:1024 sc1
    buffer_load_dwordx4 v[120:123], v2, s[64:67], s43 offen offset:2048 sc1
    buffer_load_dwordx4 v[124:127], v2, s[64:67], s43 offen offset:3072 sc1
    s_cmp_lg_u32 s32, 15
    s_cbranch_scc1 Lq_noep_20
    s_or_b32 s36, s33, s35
    s_cmp_lg_u32 s36, 0
    s_cbranch_scc1 Lq_noep_20
    s_mov_b32 s36, 12779520
    v_mov_b32 v52, s91
    v_mov_b32 v53, 0
    v_cmp_eq_u32 vcc, 0, v0
    s_and_saveexec_b64 s[60:61], vcc
    buffer_store_dword v52, v53, s[64:67], s36 offen sc1
    s_mov_b64 exec, s[60:61]
Lq_noep_20:
    s_mov_b32 s84, s74
    s_and_b32 s85, s75, 0xffff
    s_mov_b32 s86, 8388608
    s_mov_b32 s87, 0x20000
    v_lshlrev_b32 v23, 12, v20
    v_lshlrev_b32 v28, 1, v28
    v_add_u32 v23, v23, v28
    v_sub_f32 v52, 1.0, v24
    v_sub_f32 v53, 1.0, v25
    v_sub_f32 v54, 1.0, v26
    v_sub_f32 v55, 1.0, v27
    v_cvt_pk_bf16_f32 v56, v52, v53
    v_cvt_pk_bf16_f32 v57, v54, v55
    v_lshlrev_b32 v52, 16, v56
    v_and_b32 v53, 0xffff0000, v56
    v_lshlrev_b32 v54, 16, v57
    v_and_b32 v55, 0xffff0000, v57
    v_add_f32 v24, v24, v24
    v_add_f32 v25, v25, v25
    v_add_f32 v26, v26, v26
    v_add_f32 v27, v27, v27
    s_mov_b32 s92, 0
    s_mov_b32 s93, 65536
    s_mov_b32 s94, 131072
    s_mov_b32 s95, 196608
    v_cvt_pk_bf16_f32 v56, v192, v193
    v_cvt_pk_bf16_f32 v57, v194, v195
    v_lshlrev_b32 v192, 16, v56
    v_and_b32 v193, 0xffff0000, v56
    v_lshlrev_b32 v194, 16, v57
    v_and_b32 v195, 0xffff0000, v57
    v_mul_f32 v192, v192, v52
    v_mul_f32 v194, v194, v52
    v_mul_f32 v193, v193, v52
    v_mul_f32 v195, v195, v52
    v_cvt_pk_bf16_f32 v56, v192, v193
    v_cvt_pk_bf16_f32 v57, v194, v195
    v_lshlrev_b32 v192, 16, v56
    v_and_b32 v193, 0xffff0000, v56
    v_lshlrev_b32 v194, 16, v57
    v_and_b32 v195, 0xffff0000, v57
    v_fmac_f32 v192, v128, v24
    v_fmac_f32 v193, v129, v24
    v_fmac_f32 v194, v130, v24
    v_fmac_f32 v195, v131, v24
    v_cvt_pk_bf16_f32 v58, v196, v197
    v_cvt_pk_bf16_f32 v59, v198, v199
    v_lshlrev_b32 v196, 16, v58
    v_and_b32 v197, 0xffff0000, v58
    v_lshlrev_b32 v198, 16, v59
    v_and_b32 v199, 0xffff0000, v59
    v_mul_f32 v196, v196, v53
    v_mul_f32 v198, v198, v53
    v_mul_f32 v197, v197, v53
    v_mul_f32 v199, v199, v53
    v_cvt_pk_bf16_f32 v58, v196, v197
    v_cvt_pk_bf16_f32 v59, v198, v199
    v_lshlrev_b32 v196, 16, v58
    v_and_b32 v197, 0xffff0000, v58
    v_lshlrev_b32 v198, 16, v59
    v_and_b32 v199, 0xffff0000, v59
    v_fmac_f32 v196, v132, v25
    v_fmac_f32 v197, v133, v25
    v_fmac_f32 v198, v134, v25
    v_fmac_f32 v199, v135, v25
    v_cvt_pk_bf16_f32 v56, v200, v201
    v_cvt_pk_bf16_f32 v57, v202, v203
    v_lshlrev_b32 v200, 16, v56
    v_and_b32 v201, 0xffff0000, v56
    v_lshlrev_b32 v202, 16, v57
    v_and_b32 v203, 0xffff0000, v57
    v_mul_f32 v200, v200, v54
    v_mul_f32 v202, v202, v54
    v_mul_f32 v201, v201, v54
    v_mul_f32 v203, v203, v54
    v_cvt_pk_bf16_f32 v56, v200, v201
    v_cvt_pk_bf16_f32 v57, v202, v203
    v_lshlrev_b32 v200, 16, v56
    v_and_b32 v201, 0xffff0000, v56
    v_lshlrev_b32 v202, 16, v57
    v_and_b32 v203, 0xffff0000, v57
    v_fmac_f32 v200, v136, v26
    v_fmac_f32 v201, v137, v26
    v_fmac_f32 v202, v138, v26
    v_fmac_f32 v203, v139, v26
    v_cvt_pk_bf16_f32 v58, v204, v205
    v_cvt_pk_bf16_f32 v59, v206, v207
    v_lshlrev_b32 v204, 16, v58
    v_and_b32 v205, 0xffff0000, v58
    v_lshlrev_b32 v206, 16, v59
    v_and_b32 v207, 0xffff0000, v59
    v_mul_f32 v204, v204, v55
    v_mul_f32 v206, v206, v55
    v_mul_f32 v205, v205, v55
    v_mul_f32 v207, v207, v55
    v_cvt_pk_bf16_f32 v58, v204, v205
    v_cvt_pk_bf16_f32 v59, v206, v207
    v_lshlrev_b32 v204, 16, v58
    v_and_b32 v205, 0xffff0000, v58
    v_lshlrev_b32 v206, 16, v59
    v_and_b32 v207, 0xffff0000, v59
    v_fmac_f32 v204, v140, v27
    v_fmac_f32 v205, v141, v27
    v_fmac_f32 v206, v142, v27
    v_fmac_f32 v207, v143, v27
    v_cvt_pk_bf16_f32 v56, v208, v209
    v_cvt_pk_bf16_f32 v57, v210, v211
    v_lshlrev_b32 v208, 16, v56
    v_and_b32 v209, 0xffff0000, v56
    v_lshlrev_b32 v210, 16, v57
    v_and_b32 v211, 0xffff0000, v57
    v_mul_f32 v208, v208, v52
    v_mul_f32 v210, v210, v52
    v_mul_f32 v209, v209, v52
    v_mul_f32 v211, v211, v52
    v_cvt_pk_bf16_f32 v56, v208, v209
    v_cvt_pk_bf16_f32 v57, v210, v211
    v_lshlrev_b32 v208, 16, v56
    v_and_b32 v209, 0xffff0000, v56
    v_lshlrev_b32 v210, 16, v57
    v_and_b32 v211, 0xffff0000, v57
    v_fmac_f32 v208, v144, v24
    v_fmac_f32 v209, v145, v24
    v_fmac_f32 v210, v146, v24
    v_fmac_f32 v211, v147, v24
    v_cvt_pk_bf16_f32 v58, v212, v213
    v_cvt_pk_bf16_f32 v59, v214, v215
    v_lshlrev_b32 v212, 16, v58
    v_and_b32 v213, 0xffff0000, v58
    v_lshlrev_b32 v214, 16, v59
    v_and_b32 v215, 0xffff0000, v59
    v_mul_f32 v212, v212, v53
    v_mul_f32 v214, v214, v53
    v_mul_f32 v213, v213, v53
    v_mul_f32 v215, v215, v53
    v_cvt_pk_bf16_f32 v58, v212, v213
    v_cvt_pk_bf16_f32 v59, v214, v215
    v_lshlrev_b32 v212, 16, v58
    v_and_b32 v213, 0xffff0000, v58
    v_lshlrev_b32 v214, 16, v59
    v_and_b32 v215, 0xffff0000, v59
    v_fmac_f32 v212, v148, v25
    v_fmac_f32 v213, v149, v25
    v_fmac_f32 v214, v150, v25
    v_fmac_f32 v215, v151, v25
    v_cvt_pk_bf16_f32 v56, v216, v217
    v_cvt_pk_bf16_f32 v57, v218, v219
    v_lshlrev_b32 v216, 16, v56
    v_and_b32 v217, 0xffff0000, v56
    v_lshlrev_b32 v218, 16, v57
    v_and_b32 v219, 0xffff0000, v57
    v_mul_f32 v216, v216, v54
    v_mul_f32 v218, v218, v54
    v_mul_f32 v217, v217, v54
    v_mul_f32 v219, v219, v54
    v_cvt_pk_bf16_f32 v56, v216, v217
    v_cvt_pk_bf16_f32 v57, v218, v219
    v_lshlrev_b32 v216, 16, v56
    v_and_b32 v217, 0xffff0000, v56
    v_lshlrev_b32 v218, 16, v57
    v_and_b32 v219, 0xffff0000, v57
    v_fmac_f32 v216, v152, v26
    v_fmac_f32 v217, v153, v26
    v_fmac_f32 v218, v154, v26
    v_fmac_f32 v219, v155, v26
    v_cvt_pk_bf16_f32 v58, v220, v221
    v_cvt_pk_bf16_f32 v59, v222, v223
    v_lshlrev_b32 v220, 16, v58
    v_and_b32 v221, 0xffff0000, v58
    v_lshlrev_b32 v222, 16, v59
    v_and_b32 v223, 0xffff0000, v59
    v_mul_f32 v220, v220, v55
    v_mul_f32 v222, v222, v55
    v_mul_f32 v221, v221, v55
    v_mul_f32 v223, v223, v55
    v_cvt_pk_bf16_f32 v58, v220, v221
    v_cvt_pk_bf16_f32 v59, v222, v223
    v_lshlrev_b32 v220, 16, v58
    v_and_b32 v221, 0xffff0000, v58
    v_lshlrev_b32 v222, 16, v59
    v_and_b32 v223, 0xffff0000, v59
    v_fmac_f32 v220, v156, v27
    v_fmac_f32 v221, v157, v27
    v_fmac_f32 v222, v158, v27
    v_fmac_f32 v223, v159, v27
    v_cvt_pk_bf16_f32 v56, v224, v225
    v_cvt_pk_bf16_f32 v57, v226, v227
    v_lshlrev_b32 v224, 16, v56
    v_and_b32 v225, 0xffff0000, v56
    v_lshlrev_b32 v226, 16, v57
    v_and_b32 v227, 0xffff0000, v57
    v_mul_f32 v224, v224, v52
    v_mul_f32 v226, v226, v52
    v_mul_f32 v225, v225, v52
    v_mul_f32 v227, v227, v52
    v_cvt_pk_bf16_f32 v56, v224, v225
    v_cvt_pk_bf16_f32 v57, v226, v227
    v_lshlrev_b32 v224, 16, v56
    v_and_b32 v225, 0xffff0000, v56
    v_lshlrev_b32 v226, 16, v57
    v_and_b32 v227, 0xffff0000, v57
    v_fmac_f32 v224, v160, v24
    v_fmac_f32 v225, v161, v24
    v_fmac_f32 v226, v162, v24
    v_fmac_f32 v227, v163, v24
    v_cvt_pk_bf16_f32 v58, v228, v229
    v_cvt_pk_bf16_f32 v59, v230, v231
    v_lshlrev_b32 v228, 16, v58
    v_and_b32 v229, 0xffff0000, v58
    v_lshlrev_b32 v230, 16, v59
    v_and_b32 v231, 0xffff0000, v59
    v_mul_f32 v228, v228, v53
    v_mul_f32 v230, v230, v53
    v_mul_f32 v229, v229, v53
    v_mul_f32 v231, v231, v53
    v_cvt_pk_bf16_f32 v58, v228, v229
    v_cvt_pk_bf16_f32 v59, v230, v231
    v_lshlrev_b32 v228, 16, v58
    v_and_b32 v229, 0xffff0000, v58
    v_lshlrev_b32 v230, 16, v59
    v_and_b32 v231, 0xffff0000, v59
    v_fmac_f32 v228, v164, v25
    v_fmac_f32 v229, v165, v25
    v_fmac_f32 v230, v166, v25
    v_fmac_f32 v231, v167, v25
    v_cvt_pk_bf16_f32 v56, v232, v233
    v_cvt_pk_bf16_f32 v57, v234, v235
    v_lshlrev_b32 v232, 16, v56
    v_and_b32 v233, 0xffff0000, v56
    v_lshlrev_b32 v234, 16, v57
    v_and_b32 v235, 0xffff0000, v57
    v_mul_f32 v232, v232, v54
    v_mul_f32 v234, v234, v54
    v_mul_f32 v233, v233, v54
    v_mul_f32 v235, v235, v54
    v_cvt_pk_bf16_f32 v56, v232, v233
    v_cvt_pk_bf16_f32 v57, v234, v235
    v_lshlrev_b32 v232, 16, v56
    v_and_b32 v233, 0xffff0000, v56
    v_lshlrev_b32 v234, 16, v57
    v_and_b32 v235, 0xffff0000, v57
    v_fmac_f32 v232, v168, v26
    v_fmac_f32 v233, v169, v26
    v_fmac_f32 v234, v170, v26
    v_fmac_f32 v235, v171, v26
    v_cvt_pk_bf16_f32 v58, v236, v237
    v_cvt_pk_bf16_f32 v59, v238, v239
    v_lshlrev_b32 v236, 16, v58
    v_and_b32 v237, 0xffff0000, v58
    v_lshlrev_b32 v238, 16, v59
    v_and_b32 v239, 0xffff0000, v59
    v_mul_f32 v236, v236, v55
    v_mul_f32 v238, v238, v55
    v_mul_f32 v237, v237, v55
    v_mul_f32 v239, v239, v55
    v_cvt_pk_bf16_f32 v58, v236, v237
    v_cvt_pk_bf16_f32 v59, v238, v239
    v_lshlrev_b32 v236, 16, v58
    v_and_b32 v237, 0xffff0000, v58
    v_lshlrev_b32 v238, 16, v59
    v_and_b32 v239, 0xffff0000, v59
    v_fmac_f32 v236, v172, v27
    v_fmac_f32 v237, v173, v27
    v_fmac_f32 v238, v174, v27
    v_fmac_f32 v239, v175, v27
    v_cvt_pk_bf16_f32 v56, v240, v241
    v_cvt_pk_bf16_f32 v57, v242, v243
    v_lshlrev_b32 v240, 16, v56
    v_and_b32 v241, 0xffff0000, v56
    v_lshlrev_b32 v242, 16, v57
    v_and_b32 v243, 0xffff0000, v57
    v_mul_f32 v240, v240, v52
    v_mul_f32 v242, v242, v52
    v_mul_f32 v241, v241, v52
    v_mul_f32 v243, v243, v52
    v_cvt_pk_bf16_f32 v56, v240, v241
    v_cvt_pk_bf16_f32 v57, v242, v243
    v_lshlrev_b32 v240, 16, v56
    v_and_b32 v241, 0xffff0000, v56
    v_lshlrev_b32 v242, 16, v57
    v_and_b32 v243, 0xffff0000, v57
    v_fmac_f32 v240, v176, v24
    v_fmac_f32 v241, v177, v24
    v_fmac_f32 v242, v178, v24
    v_fmac_f32 v243, v179, v24
    v_cvt_pk_bf16_f32 v58, v244, v245
    v_cvt_pk_bf16_f32 v59, v246, v247
    v_lshlrev_b32 v244, 16, v58
    v_and_b32 v245, 0xffff0000, v58
    v_lshlrev_b32 v246, 16, v59
    v_and_b32 v247, 0xffff0000, v59
    v_mul_f32 v244, v244, v53
    v_mul_f32 v246, v246, v53
    v_mul_f32 v245, v245, v53
    v_mul_f32 v247, v247, v53
    v_cvt_pk_bf16_f32 v58, v244, v245
    v_cvt_pk_bf16_f32 v59, v246, v247
    v_lshlrev_b32 v244, 16, v58
    v_and_b32 v245, 0xffff0000, v58
    v_lshlrev_b32 v246, 16, v59
    v_and_b32 v247, 0xffff0000, v59
    v_fmac_f32 v244, v180, v25
    v_fmac_f32 v245, v181, v25
    v_fmac_f32 v246, v182, v25
    v_fmac_f32 v247, v183, v25
    v_cvt_pk_bf16_f32 v56, v248, v249
    v_cvt_pk_bf16_f32 v57, v250, v251
    v_lshlrev_b32 v248, 16, v56
    v_and_b32 v249, 0xffff0000, v56
    v_lshlrev_b32 v250, 16, v57
    v_and_b32 v251, 0xffff0000, v57
    v_mul_f32 v248, v248, v54
    v_mul_f32 v250, v250, v54
    v_mul_f32 v249, v249, v54
    v_mul_f32 v251, v251, v54
    v_cvt_pk_bf16_f32 v56, v248, v249
    v_cvt_pk_bf16_f32 v57, v250, v251
    v_lshlrev_b32 v248, 16, v56
    v_and_b32 v249, 0xffff0000, v56
    v_lshlrev_b32 v250, 16, v57
    v_and_b32 v251, 0xffff0000, v57
    v_fmac_f32 v248, v184, v26
    v_fmac_f32 v249, v185, v26
    v_fmac_f32 v250, v186, v26
    v_fmac_f32 v251, v187, v26
    v_cvt_pk_bf16_f32 v58, v252, v253
    v_cvt_pk_bf16_f32 v59, v254, v255
    v_lshlrev_b32 v252, 16, v58
    v_and_b32 v253, 0xffff0000, v58
    v_lshlrev_b32 v254, 16, v59
    v_and_b32 v255, 0xffff0000, v59
    v_mul_f32 v252, v252, v55
    v_mul_f32 v254, v254, v55
    v_mul_f32 v253, v253, v55
    v_mul_f32 v255, v255, v55
    v_cvt_pk_bf16_f32 v58, v252, v253
    v_cvt_pk_bf16_f32 v59, v254, v255
    v_lshlrev_b32 v252, 16, v58
    v_and_b32 v253, 0xffff0000, v58
    v_lshlrev_b32 v254, 16, v59
    v_and_b32 v255, 0xffff0000, v59
    v_fmac_f32 v252, v188, v27
    v_fmac_f32 v253, v189, v27
    v_fmac_f32 v254, v190, v27
    v_fmac_f32 v255, v191, v27
    s_waitcnt vmcnt(0)
    v_add_f32 v192, v192, v64
    v_add_f32 v193, v193, v65
    v_add_f32 v194, v194, v66
    v_add_f32 v195, v195, v67
    buffer_store_dwordx4 v[192:195], v23, s[84:87], s92 offen offset:0 sc1
    v_add_f32 v196, v196, v68
    v_add_f32 v197, v197, v69
    v_add_f32 v198, v198, v70
    v_add_f32 v199, v199, v71
    buffer_store_dwordx4 v[196:199], v23, s[84:87], s93 offen offset:0 sc1
    v_add_f32 v200, v200, v72
    v_add_f32 v201, v201, v73
    v_add_f32 v202, v202, v74
    v_add_f32 v203, v203, v75
    buffer_store_dwordx4 v[200:203], v23, s[84:87], s94 offen offset:0 sc1
    v_add_f32 v204, v204, v76
    v_add_f32 v205, v205, v77
    v_add_f32 v206, v206, v78
    v_add_f32 v207, v207, v79
    buffer_store_dwordx4 v[204:207], v23, s[84:87], s95 offen offset:0 sc1
    v_add_f32 v208, v208, v80
    v_add_f32 v209, v209, v81
    v_add_f32 v210, v210, v82
    v_add_f32 v211, v211, v83
    buffer_store_dwordx4 v[208:211], v23, s[84:87], s92 offen offset:64 sc1
    v_add_f32 v212, v212, v84
    v_add_f32 v213, v213, v85
    v_add_f32 v214, v214, v86
    v_add_f32 v215, v215, v87
    buffer_store_dwordx4 v[212:215], v23, s[84:87], s93 offen offset:64 sc1
    v_add_f32 v216, v216, v88
    v_add_f32 v217, v217, v89
    v_add_f32 v218, v218, v90
    v_add_f32 v219, v219, v91
    buffer_store_dwordx4 v[216:219], v23, s[84:87], s94 offen offset:64 sc1
    v_add_f32 v220, v220, v92
    v_add_f32 v221, v221, v93
    v_add_f32 v222, v222, v94
    v_add_f32 v223, v223, v95
    buffer_store_dwordx4 v[220:223], v23, s[84:87], s95 offen offset:64 sc1
    v_add_f32 v224, v224, v96
    v_add_f32 v225, v225, v97
    v_add_f32 v226, v226, v98
    v_add_f32 v227, v227, v99
    buffer_store_dwordx4 v[224:227], v23, s[84:87], s92 offen offset:128 sc1
    v_add_f32 v228, v228, v100
    v_add_f32 v229, v229, v101
    v_add_f32 v230, v230, v102
    v_add_f32 v231, v231, v103
    buffer_store_dwordx4 v[228:231], v23, s[84:87], s93 offen offset:128 sc1
    v_add_f32 v232, v232, v104
    v_add_f32 v233, v233, v105
    v_add_f32 v234, v234, v106
    v_add_f32 v235, v235, v107
    buffer_store_dwordx4 v[232:235], v23, s[84:87], s94 offen offset:128 sc1
    v_add_f32 v236, v236, v108
    v_add_f32 v237, v237, v109
    v_add_f32 v238, v238, v110
    v_add_f32 v239, v239, v111
    buffer_store_dwordx4 v[236:239], v23, s[84:87], s95 offen offset:128 sc1
    v_add_f32 v240, v240, v112
    v_add_f32 v241, v241, v113
    v_add_f32 v242, v242, v114
    v_add_f32 v243, v243, v115
    buffer_store_dwordx4 v[240:243], v23, s[84:87], s92 offen offset:192 sc1
    v_add_f32 v244, v244, v116
    v_add_f32 v245, v245, v117
    v_add_f32 v246, v246, v118
    v_add_f32 v247, v247, v119
    buffer_store_dwordx4 v[244:247], v23, s[84:87], s93 offen offset:192 sc1
    v_add_f32 v248, v248, v120
    v_add_f32 v249, v249, v121
    v_add_f32 v250, v250, v122
    v_add_f32 v251, v251, v123
    buffer_store_dwordx4 v[248:251], v23, s[84:87], s94 offen offset:192 sc1
    v_add_f32 v252, v252, v124
    v_add_f32 v253, v253, v125
    v_add_f32 v254, v254, v126
    v_add_f32 v255, v255, v127
    buffer_store_dwordx4 v[252:255], v23, s[84:87], s95 offen offset:192 sc1
Lend:
    s_endpgm
Lcode_end:
.section .rodata,"a"
.p2align 6
.amdhsa_kernel gated_mix__ssm_conv_s5__linear_attn_block__prompt_kernel
  .amdhsa_next_free_vgpr 368
  .amdhsa_next_free_sgpr 102
  .amdhsa_accum_offset 256
  .amdhsa_group_segment_fixed_size 0
  .amdhsa_kernarg_size 128
  .amdhsa_user_sgpr_count 2
  .amdhsa_user_sgpr_kernarg_segment_ptr 1
  .amdhsa_system_sgpr_workgroup_id_x 1
  .amdhsa_float_denorm_mode_32 3
.end_amdhsa_kernel
```
